```python
import torch

def _softmax(x, axis=-1):
    return torch.softmax(x, dim=axis)
def _gelu(x):
    return torch.nn.functional.gelu(x, approximate="tanh")
def _silu(x):
    return torch.nn.functional.silu(x)
def _sigmoid(x):
    return torch.sigmoid(x)
def _layernorm(x, axis=-1, eps=1e-5):
    m = x.mean(dim=axis, keepdim=True)
    v = x.var(dim=axis, keepdim=True, unbiased=False)
    return (x - m) / torch.sqrt(v + eps)
def _scatter_add(tgt, idx, src, axis=0):
    return tgt.clone().index_add_(axis, idx, src)
def _segment_sum(src, seg, n):
    out = torch.zeros((n,) + src.shape[1:], dtype=src.dtype)
    return out.index_add_(0, seg, src)
def _pad(x, pw):
    flat = tuple(v for pair in reversed(pw) for v in pair)
    return torch.nn.functional.pad(x, flat)

kernel_name = 'gated_mix__linear_kernel_hedgehog__mixer_channel_mlp__prompt'

def setup_inputs():

    _w = (lambda a: (lambda t: t.to(torch.bfloat16) if t.is_floating_point() else t)(torch.as_tensor(a)))
    def _A_setup():
        B, S, D, H = 1, 2048, 1024, 32
        Dh = D // H
        return {
            "x": _w((lambda *s: torch.randn(*s, dtype=torch.bfloat16) * 0.05)(B, S, D)),
            "wqkv": _w((lambda *s: torch.randn(*s, dtype=torch.bfloat16) * 0.8)(D, 3 * D)),
            "w_phi": _w((lambda *s: torch.randn(*s, dtype=torch.bfloat16) * 0.8)(H, Dh, Dh) * (Dh ** -0.5)),
            "wo": _w((lambda *s: torch.randn(*s, dtype=torch.bfloat16) * 0.1)(D, D)),
        }
    _A_in = _A_setup()

    def _B_setup():
        B, S, D, F = 1, 2048, 1024, 3584
        return {
            "x": _w((lambda *s: torch.randn(*s, dtype=torch.bfloat16) * 0.05)(B, S, D)),
            "w1": _w((lambda *s: torch.randn(*s, dtype=torch.bfloat16) * 1.6)(D, F) * (D ** -0.5)),
            "b1": _w((lambda *s: torch.randn(*s, dtype=torch.bfloat16) * 0.4)(F)),
            "w2": _w((lambda *s: torch.randn(*s, dtype=torch.bfloat16) * 0.05)(F, D) * (F ** -0.5)),
            "b2": _w((lambda *s: torch.randn(*s, dtype=torch.bfloat16) * 0.05)(D)),
        }
    _B_in = _B_setup()

    return {
        "A_x": _A_in["x"],
        "A_wqkv": _A_in["wqkv"],
        "A_w_phi": _A_in["w_phi"],
        "A_wo": _A_in["wo"],
        "B_x": _B_in["x"],
        "B_w1": _B_in["w1"],
        "B_b1": _B_in["b1"],
        "B_w2": _B_in["w2"],
        "B_b2": _B_in["b2"],
        "gate_w": _w((lambda *s: torch.randn(*s, dtype=torch.bfloat16) * 0.05)(1024) * 16.0),
    }

def reference(A_x, A_wqkv, A_w_phi, A_wo, B_x, B_w1, B_b1, B_w2, B_b2, gate_w):
    def _A_ref(x, wqkv, w_phi, wo):
        B, S, D = x.shape
        H = 32; Dh = D // H
        qkv = (lambda x, *d: x.permute(*d))((x @ wqkv).reshape(B, S, 3, H, Dh), 2, 0, 3, 1, 4)
        q, k, v = qkv[0], qkv[1], qkv[2]
        pq = torch.einsum("bhsd,hdf->bhsf", q, w_phi)
        pk = torch.einsum("bhsd,hdf->bhsf", k, w_phi)
        phi_q = torch.concatenate([_softmax(pq, axis=-1), _softmax(-pq, axis=-1)], axis=-1)
        phi_k = torch.concatenate([_softmax(pk, axis=-1), _softmax(-pk, axis=-1)], axis=-1)
        kv = torch.einsum("bhsf,bhsd->bhfd", phi_k, v)
        z  = torch.einsum("bhsf->bhf", phi_k)
        num = torch.einsum("bhqf,bhfd->bhqd", phi_q, kv)
        den = torch.einsum("bhqf,bhf->bhq", phi_q, z)[..., None] + 1e-6
        o = num / den
        return (lambda x, *d: x.permute(*d))(o, 0, 2, 1, 3).reshape(B, S, D) @ wo

    def _B_ref(x, w1, b1, w2, b2):
        y = _layernorm(x, axis=-1)
        h = _gelu(torch.einsum("bsd,df->bsf", y, w1) + b1)
        return torch.einsum("bsf,fd->bsd", h, w2) + b2

    x = A_x
    g = _sigmoid((x * gate_w).sum(-1, keepdims=True))
    a = _A_ref(x, A_wqkv, A_w_phi, A_wo)
    b = _B_ref(x, B_w1, B_b1, B_w2, B_b2)
    return g * a + (1 - g) * b
```

```asm
; @launch grid=(256,1,1) block=(256,1,1) lds=156672
.amdgcn_target "amdgcn-amd-amdhsa--gfx950"
.text
.macro MV c,w,x
v_mfma_f32_16x16x32_bf16 v[\c:\c+3], a[\w:\w+3], a[\x:\x+3], v[\c:\c+3]
.endm
.macro MVZ c,w,x
v_mfma_f32_16x16x32_bf16 v[\c:\c+3], a[\w:\w+3], a[\x:\x+3], 0
.endm
.macro MA c,w,x
v_mfma_f32_16x16x32_bf16 a[\c:\c+3], a[\w:\w+3], a[\x:\x+3], a[\c:\c+3]
.endm
.macro TR r,v,o
ds_read_b64_tr_b16 a[\r:\r+1], v\v offset:\o
.endm
.macro RB r,v,o
ds_read_b128 a[\r:\r+3], v\v offset:\o
.endm
.macro DL v,s
buffer_load_dwordx4 v\v, s[4:7], s\s offen lds
.endm
.macro AR v,a
v_accvgpr_read_b32 v\v, a\a
.endm
.macro D2 d,a,b,c
v_dot2_f32_bf16 \d, \a, \b, \c
.endm
.macro CP d,a,b
v_cvt_pk_bf16_f32 v\d, v\a, v\b
.endm
.globl gated_mix__linear_kernel_hedgehog__mixer_channel_mlp__prompt_kernel
.p2align 8
.type gated_mix__linear_kernel_hedgehog__mixer_channel_mlp__prompt_kernel,@function
gated_mix__linear_kernel_hedgehog__mixer_channel_mlp__prompt_kernel:
k1_code_start:
s_cmp_ge_u32 s2, 256
s_cbranch_scc1 k1_exit_near
s_load_dwordx16 s[16:31], s[0:1], 0
s_load_dwordx8 s[32:39], s[0:1], 64
s_load_dwordx2 s[40:41], s[0:1], 96
s_getpc_b64 s[72:73]
k1_pc_entry:
s_sub_u32 s72, s72, k1_pc_entry-k1_code_start
s_subb_u32 s73, s73, 0
s_and_b32 s73, s73, 0xffff
s_mov_b32 s74, k1_code_end-k1_code_start
s_mov_b32 s75, 0x20000
s_lshr_b32 s76, s2, 3
s_lshl_b32 s76, s76, 8
v_add_u32 v255, s76, v0
v_lshlrev_b32 v255, 7, v255
buffer_load_dword v254, v255, s[72:75], 0 offen
v_lshrrev_b32 v1, 6, v0
v_and_b32 v206, 63, v0
v_readfirstlane_b32 s42, v1
s_bfe_u32 s44, s2, 0x20004
s_and_b32 s3, s2, 1
s_lshl_b32 s3, s3, 2
s_add_u32 s44, s44, s3
s_lshr_b32 s45, s2, 6
s_bfe_u32 s3, s2, 0x20001
s_lshl_b32 s3, s3, 2
s_add_u32 s45, s45, s3
s_bfe_u32 s43, s2, 0x10003
s_lshl_b32 s43, s43, 2
s_add_u32 s43, s43, s42
s_cmp_eq_u32 s43, 0
s_cbranch_scc1 k1_mlp_w0
s_cmp_eq_u32 s43, 1
s_cbranch_scc1 k1_mlp_w1
s_cmp_eq_u32 s43, 2
s_cbranch_scc1 k1_mlp_w2
s_cmp_eq_u32 s43, 3
s_cbranch_scc1 k1_mlp_w3
s_cmp_eq_u32 s43, 4
s_cbranch_scc1 k1_qkv_w0
s_cmp_eq_u32 s43, 5
s_cbranch_scc1 k1_qkv_w1
s_cmp_eq_u32 s43, 6
s_cbranch_scc1 k1_qkv_w2
s_cmp_eq_u32 s43, 7
s_cbranch_scc1 k1_qkv_w3
k1_exit_near:
s_endpgm
k1_mlp_w0:
s_mov_b32 s52, 0
s_mov_b32 s53, 0
s_and_b32 s65, s45, 1
s_lshl_b32 s66, s65, 6
s_cmp_eq_u32 s65, 0
s_cselect_b32 s67, 384, 0
v_lshrrev_b32 v210, 3, v206
v_lshrrev_b32 v211, 4, v206
v_and_b32 v212, 7, v206
v_add_u32 v213, 0, v211
v_xor_b32 v213, v213, v212
v_lshlrev_b32 v213, 4, v213
v_lshl_add_u32 v213, v210, 11, v213
v_add_u32 v197, 0, v213
v_add_u32 v199, 32768, v213
v_add_u32 v201, 65536, v213
v_add_u32 v213, 4, v211
v_xor_b32 v213, v213, v212
v_lshlrev_b32 v213, 4, v213
v_lshl_add_u32 v213, v210, 11, v213
v_add_u32 v198, 16384, v213
v_add_u32 v200, 49152, v213
s_mov_b32 s3, 7168
v_mul_lo_u32 v214, v210, s3
v_and_b32 v215, 1, v211
v_or_b32 v213, 0, v215
v_lshlrev_b32 v213, 1, v213
v_xor_b32 v213, v213, v212
v_lshl_add_u32 v213, v213, 4, v214
v_add_u32 v213, s66, v213
v_add_u32 v192, 0, v213
v_add_u32 v194, 114688, v213
v_or_b32 v213, 2, v215
v_lshlrev_b32 v213, 1, v213
v_xor_b32 v213, v213, v212
v_lshl_add_u32 v213, v213, 4, v214
v_add_u32 v213, s66, v213
v_add_u32 v193, 57344, v213
v_add_u32 v195, 172032, v213
v_lshrrev_b32 v210, 2, v206
v_mul_lo_u32 v210, v210, s3
v_lshrrev_b32 v211, 5, v206
v_lshlrev_b32 v211, 1, v211
v_and_b32 v212, 3, v206
v_xor_b32 v211, v211, v212
v_lshl_add_u32 v210, v211, 4, v210
v_add_u32 v210, s67, v210
v_add_u32 v196, 0, v210
s_waitcnt lgkmcnt(0)
s_lshr_b32 s74, s2, 3
s_lshl_b32 s74, s74, 2
s_add_u32 s74, s74, s42
s_and_b32 s75, s2, 1
s_lshl_b32 s75, s75, 2
s_bfe_u32 s76, s2, 0x20001
s_lshl_b32 s76, s76, 2
s_cmp_lt_u32 s74, 48
s_cbranch_scc0 k1_mlp_w0_k1_st_w
s_mul_i32 s3, s74, 43691
s_lshr_b32 s3, s3, 19
s_mul_i32 s77, s3, 12
s_sub_u32 s77, s74, s77
s_add_u32 s3, s3, s75
s_lshl_b32 s3, s3, 19
s_and_b32 s75, s77, 3
s_lshl_b32 s75, s75, 17
s_add_u32 s3, s3, s75
s_lshr_b32 s77, s77, 2
s_cmp_ge_u32 s77, 1
s_cbranch_scc1 k1_mlp_w0_k1_st_done
s_lshl_b32 s77, s77, 7
s_add_u32 s3, s3, s77
v_lshlrev_b32 v255, 11, v206
v_add_u32 v255, s3, v255
s_mov_b32 s72, s16
s_and_b32 s73, s17, 0xffff
s_mov_b32 s74, 4194304
s_mov_b32 s75, 0x20000
s_branch k1_mlp_w0_k1_st_go
k1_mlp_w0_k1_st_w:
s_cmp_lt_u32 s74, 88
s_cselect_b32 s77, 48, 88
s_cselect_b32 s75, 1, 0
s_sub_u32 s74, s74, s77
s_mul_i32 s3, s74, 52429
s_lshr_b32 s3, s3, 19
s_mul_i32 s77, s3, 10
s_sub_u32 s77, s74, s77
s_cmp_ge_u32 s77, 4
s_cbranch_scc1 k1_mlp_w0_k1_st_done
s_add_u32 s76, s76, s3
s_lshl_b32 s77, s77, 4
v_lshrrev_b32 v255, 2, v206
v_add_u32 v255, s77, v255
v_and_b32 v254, 3, v206
s_cmp_eq_u32 s75, 1
s_cbranch_scc0 k1_mlp_w0_k1_st_q
s_mul_i32 s3, s76, 448
s_and_b32 s3, s3, 0xffffff80
s_mov_b32 s77, 7168
v_mul_lo_u32 v255, v255, s77
v_lshl_add_u32 v255, v254, 7, v255
v_add_u32 v255, s3, v255
s_mov_b32 s72, s26
s_and_b32 s73, s27, 0xffff
s_mov_b32 s74, 7340032
s_mov_b32 s75, 0x20000
s_branch k1_mlp_w0_k1_st_go
k1_mlp_w0_k1_st_q:
s_lshl_b32 s3, s76, 7
s_mov_b32 s77, 6144
v_mul_lo_u32 v255, v255, s77
v_min_u32 v254, 2, v254
v_lshl_add_u32 v255, v254, 11, v255
v_add_u32 v255, s3, v255
s_mov_b32 s72, s18
s_and_b32 s73, s19, 0xffff
s_mov_b32 s74, 6291456
s_mov_b32 s75, 0x20000
k1_mlp_w0_k1_st_go:
buffer_load_dword v254, v255, s[72:75], 0 offen
k1_mlp_w0_k1_st_done:
s_lshl_b32 s3, s44, 19
s_add_u32 s4, s16, s3
s_addc_u32 s5, s17, 0
s_and_b32 s5, s5, 0xffff
s_mov_b32 s50, 524288
s_mov_b32 s6, s50
s_mov_b32 s7, 0x20000
s_mul_i32 s3, s45, 448
s_add_u32 s8, s26, s3
s_addc_u32 s9, s27, 0
s_and_b32 s9, s9, 0xffff
s_sub_u32 s70, 7340032, s3
s_mov_b32 s10, s70
s_mov_b32 s11, 0x20000
s_mov_b32 s51, 229376
s_mov_b32 s48, 0
s_mov_b32 s64, 262144
s_mov_b32 s69, 0
s_mov_b32 m0, 98304
s_nop 0
buffer_load_dwordx4 v192, s[8:11], s69 offen lds
s_mov_b32 m0, 99328
s_nop 0
buffer_load_dwordx4 v193, s[8:11], s69 offen lds
s_mov_b32 m0, 100352
s_nop 0
buffer_load_dwordx4 v194, s[8:11], s69 offen lds
s_mov_b32 m0, 101376
s_nop 0
buffer_load_dwordx4 v195, s[8:11], s69 offen lds
s_mov_b32 m0, 110592
s_nop 0
buffer_load_dwordx4 v196, s[8:11], s69 offen lds
s_add_u32 s69, s69, s51
s_mov_b32 m0, 0
s_nop 0
DL 197,48
s_mov_b32 m0, 1024
s_nop 0
DL 198,48
s_mov_b32 m0, 2048
s_nop 0
DL 199,48
s_mov_b32 m0, 3072
s_nop 0
DL 200,48
s_mov_b32 m0, 4096
s_nop 0
DL 201,48
s_mov_b32 m0, 16384
s_nop 0
DL 197,64
s_mov_b32 m0, 17408
s_nop 0
DL 198,64
s_mov_b32 m0, 18432
s_nop 0
DL 199,64
s_mov_b32 m0, 19456
s_nop 0
DL 200,64
s_mov_b32 m0, 20480
s_nop 0
DL 201,64
s_add_u32 s48, s48, 128
s_add_u32 s64, s64, 128
s_mov_b32 m0, 112640
s_nop 0
buffer_load_dwordx4 v192, s[8:11], s69 offen lds
s_mov_b32 m0, 113664
s_nop 0
buffer_load_dwordx4 v193, s[8:11], s69 offen lds
s_mov_b32 m0, 114688
s_nop 0
buffer_load_dwordx4 v194, s[8:11], s69 offen lds
s_mov_b32 m0, 115712
s_nop 0
buffer_load_dwordx4 v195, s[8:11], s69 offen lds
s_mov_b32 m0, 124928
s_nop 0
buffer_load_dwordx4 v196, s[8:11], s69 offen lds
s_add_u32 s69, s69, s51
v_mov_b32 v210, 0x3f803f80
v_accvgpr_write_b32 a120, v210
v_mov_b32 v210, 0x3f803f80
v_accvgpr_write_b32 a121, v210
v_mov_b32 v210, 0x3f803f80
v_accvgpr_write_b32 a122, v210
v_mov_b32 v210, 0x3f803f80
v_accvgpr_write_b32 a123, v210
v_and_b32 v210, 15, v206
v_lshrrev_b32 v213, 4, v206
v_lshrrev_b32 v211, 1, v210
v_add_u32 v212, 0, v213
v_xor_b32 v212, v212, v211
v_lshlrev_b32 v212, 4, v212
v_lshl_add_u32 v212, v210, 7, v212
v_add_u32 v202, 0, v212
v_add_u32 v212, 4, v213
v_xor_b32 v212, v212, v211
v_lshlrev_b32 v212, 4, v212
v_lshl_add_u32 v212, v210, 7, v212
v_add_u32 v203, 0, v212
v_bfe_u32 v211, v206, 2, 2
v_lshl_add_u32 v214, v213, 3, v211
v_and_b32 v215, 3, v206
v_lshlrev_b32 v215, 3, v215
v_lshrrev_b32 v216, 1, v211
v_and_b32 v217, 1, v213
v_lshl_or_b32 v216, v217, 1, v216
v_lshl_add_u32 v218, v214, 7, v215
v_add_u32 v218, 98304, v218
v_xor_b32 v219, 0, v216
v_lshl_add_u32 v204, v219, 5, v218
v_xor_b32 v219, 1, v216
v_lshl_add_u32 v207, v219, 5, v218
v_xor_b32 v219, 2, v216
v_lshl_add_u32 v208, v219, 5, v218
v_xor_b32 v219, 3, v216
v_lshl_add_u32 v209, v219, 5, v218
v_mov_b32 v205, v202
s_waitcnt vmcnt(0) lgkmcnt(0)
s_barrier
TR 32,204,0
TR 34,204,512
RB 0,205,0
RB 4,205,2048
RB 8,205,4096
RB 12,205,6144
RB 16,205,8192
RB 20,205,10240
RB 24,205,12288
RB 28,205,14336
TR 36,207,0
TR 38,207,512
TR 40,208,0
TR 42,208,512
TR 44,209,0
TR 46,209,512
TR 48,204,4096
TR 50,204,4608
TR 52,207,4096
TR 54,207,4608
TR 56,208,4096
TR 58,208,4608
s_mov_b32 s46, 0
s_mov_b32 s47, 65536
s_mov_b32 s49, 0
v_mov_b32 v205, v203
s_waitcnt lgkmcnt(0)
s_barrier
MVZ 0,32,0
TR 92,204,14336
s_mov_b32 m0, 32768
MVZ 4,32,4
DL 197,48
MVZ 8,32,8
TR 94,204,14848
s_mov_b32 m0, 33792
MVZ 12,32,12
DL 198,48
MVZ 16,32,16
RB 60,205,0
s_mov_b32 m0, 34816
MVZ 20,32,20
DL 199,48
MVZ 24,32,24
RB 64,205,2048
MVZ 28,32,28
s_mov_b32 m0, 35840
MVZ 32,36,0
RB 68,205,4096
DL 200,48
MVZ 36,36,4
s_mov_b32 m0, 36864
v_mfma_f32_16x16x32_bf16 a[160:163], a[32:35], a[120:123], 0
RB 72,205,6144
DL 201,48
MVZ 40,36,8
s_mov_b32 m0, 49152
MVZ 44,36,12
RB 76,205,8192
DL 197,64
MVZ 48,36,16
MVZ 52,36,20
RB 80,205,10240
s_mov_b32 m0, 50176
MVZ 56,36,24
DL 198,64
MVZ 60,36,28
RB 84,205,12288
s_mov_b32 m0, 51200
MVZ 64,40,0
DL 199,64
MVZ 68,40,4
RB 88,205,14336
s_mov_b32 m0, 52224
MVZ 72,40,8
DL 200,64
MVZ 76,40,12
TR 96,207,14336
MVZ 80,40,16
s_mov_b32 m0, 53248
v_mfma_f32_16x16x32_bf16 a[164:167], a[36:39], a[120:123], 0
DL 201,64
MVZ 84,40,20
TR 98,207,14848
s_mov_b32 m0, 126976
MVZ 88,40,24
buffer_load_dwordx4 v192, s[8:11], s69 offen lds
MVZ 92,40,28
TR 100,208,14336
s_mov_b32 m0, 128000
MVZ 96,44,0
buffer_load_dwordx4 v193, s[8:11], s69 offen lds
MVZ 100,44,4
TR 102,208,14848
MVZ 104,44,8
s_mov_b32 m0, 129024
MVZ 108,44,12
TR 104,209,14336
buffer_load_dwordx4 v194, s[8:11], s69 offen lds
MVZ 112,44,16
s_mov_b32 m0, 130048
MVZ 116,44,20
TR 106,209,14848
buffer_load_dwordx4 v195, s[8:11], s69 offen lds
MVZ 120,44,24
s_mov_b32 m0, 139264
MVZ 124,44,28
TR 108,204,18432
buffer_load_dwordx4 v196, s[8:11], s69 offen lds
s_add_u32 s69, s69, s51
v_mfma_f32_16x16x32_bf16 a[168:171], a[40:43], a[120:123], 0
MVZ 128,48,0
TR 110,204,18944
s_mov_b32 m0, 141312
MVZ 132,48,4
buffer_load_dwordx4 v192, s[8:11], s69 offen lds
MVZ 136,48,8
TR 112,207,18432
s_mov_b32 m0, 142336
MVZ 140,48,12
buffer_load_dwordx4 v193, s[8:11], s69 offen lds
MVZ 144,48,16
TR 114,207,18944
s_mov_b32 m0, 143360
MVZ 148,48,20
buffer_load_dwordx4 v194, s[8:11], s69 offen lds
MVZ 152,48,24
TR 116,208,18432
MVZ 156,48,28
s_mov_b32 m0, 144384
MVZ 160,52,0
TR 118,208,18944
buffer_load_dwordx4 v195, s[8:11], s69 offen lds
MVZ 164,52,4
s_mov_b32 m0, 153600
MVZ 168,52,8
buffer_load_dwordx4 v196, s[8:11], s69 offen lds
v_mfma_f32_16x16x32_bf16 a[172:175], a[44:47], a[120:123], 0
MVZ 172,52,12
MVZ 176,52,16
MVZ 180,52,20
s_mov_b32 s47, s46
MVZ 184,52,24
s_add_u32 s46, s46, 32768
MVZ 188,52,28
s_cmp_eq_u32 s46, 98304
s_cselect_b32 s46, 0, s46
v_mfma_f32_16x16x32_bf16 a[128:131], a[56:59], a[0:3], 0
v_add_u32 v205, s46, v202
v_mfma_f32_16x16x32_bf16 a[132:135], a[56:59], a[4:7], 0
s_add_u32 s49, s49, 1
v_mfma_f32_16x16x32_bf16 a[136:139], a[56:59], a[8:11], 0
s_add_u32 s69, s69, s51
v_mfma_f32_16x16x32_bf16 a[140:143], a[56:59], a[12:15], 0
s_add_u32 s48, s48, 128
v_mfma_f32_16x16x32_bf16 a[144:147], a[56:59], a[16:19], 0
s_add_u32 s64, s64, 128
v_mfma_f32_16x16x32_bf16 a[148:151], a[56:59], a[20:23], 0
s_cmp_lt_u32 s49, 27
s_cselect_b32 s6, s50, 0
v_mfma_f32_16x16x32_bf16 a[152:155], a[56:59], a[24:27], 0
s_cmp_lt_u32 s49, 28
s_cselect_b32 s10, s70, 0
v_mfma_f32_16x16x32_bf16 a[156:159], a[56:59], a[28:31], 0
s_waitcnt vmcnt(5) lgkmcnt(0)
s_barrier
MV 0,92,60
TR 32,204,28672
s_mov_b32 m0, 98304
MV 4,92,64
buffer_load_dwordx4 v192, s[8:11], s69 offen lds
s_mov_b32 m0, 99328
MV 8,92,68
TR 34,204,29184
buffer_load_dwordx4 v193, s[8:11], s69 offen lds
MV 12,92,72
s_mov_b32 m0, 100352
MV 16,92,76
RB 0,205,0
buffer_load_dwordx4 v194, s[8:11], s69 offen lds
MV 20,92,80
s_mov_b32 m0, 101376
MV 24,92,84
RB 4,205,2048
buffer_load_dwordx4 v195, s[8:11], s69 offen lds
MV 28,92,88
s_mov_b32 m0, 110592
MV 32,96,60
RB 8,205,4096
buffer_load_dwordx4 v196, s[8:11], s69 offen lds
s_add_u32 s69, s69, s51
MV 36,96,64
s_mov_b32 m0, 65536
MA 160,92,120
RB 12,205,6144
DL 197,48
MV 40,96,68
s_mov_b32 m0, 66560
MV 44,96,72
RB 16,205,8192
DL 198,48
MV 48,96,76
s_mov_b32 m0, 67584
MV 52,96,80
RB 20,205,10240
DL 199,48
MV 56,96,84
s_mov_b32 m0, 68608
MV 60,96,88
RB 24,205,12288
DL 200,48
s_mov_b32 m0, 69632
MV 64,100,60
DL 201,48
MV 68,100,64
RB 28,205,14336
s_mov_b32 m0, 81920
MV 72,100,68
DL 197,64
MV 76,100,72
TR 36,207,28672
s_mov_b32 m0, 82944
MV 80,100,76
DL 198,64
MA 164,96,120
s_mov_b32 m0, 83968
MV 84,100,80
TR 38,207,29184
DL 199,64
MV 88,100,84
s_mov_b32 m0, 84992
MV 92,100,88
TR 40,208,28672
DL 200,64
MV 96,104,60
s_mov_b32 m0, 86016
MV 100,104,64
TR 42,208,29184
DL 201,64
s_add_u32 s48, s48, 128
s_add_u32 s64, s64, 128
MV 104,104,68
s_mov_b32 m0, 112640
MV 108,104,72
TR 44,209,28672
buffer_load_dwordx4 v192, s[8:11], s69 offen lds
MV 112,104,76
s_mov_b32 m0, 113664
MV 116,104,80
TR 46,209,29184
buffer_load_dwordx4 v193, s[8:11], s69 offen lds
s_mov_b32 m0, 114688
MV 120,104,84
buffer_load_dwordx4 v194, s[8:11], s69 offen lds
MV 124,104,88
TR 48,204,32768
s_mov_b32 m0, 115712
MA 168,100,120
buffer_load_dwordx4 v195, s[8:11], s69 offen lds
MV 128,108,60
TR 50,204,33280
s_mov_b32 m0, 124928
MV 132,108,64
buffer_load_dwordx4 v196, s[8:11], s69 offen lds
MV 136,108,68
TR 52,207,32768
s_mov_b32 m0, 0
MV 140,108,72
DL 197,48
MV 144,108,76
TR 54,207,33280
s_mov_b32 m0, 1024
MV 148,108,80
DL 198,48
MV 152,108,84
TR 56,208,32768
s_mov_b32 m0, 2048
MV 156,108,88
DL 199,48
MV 160,112,60
TR 58,208,33280
s_mov_b32 m0, 3072
MV 164,112,64
DL 200,48
MV 168,112,68
s_mov_b32 m0, 4096
MA 172,104,120
DL 201,48
MV 172,112,72
MV 176,112,76
MV 180,112,80
MV 184,112,84
MV 188,112,88
MA 128,116,60
MA 132,116,64
MA 136,116,68
v_add_u32 v205, s46, v203
MA 140,116,72
s_add_u32 s49, s49, 1
MA 144,116,76
s_add_u32 s69, s69, s51
MA 148,116,80
s_cmp_lt_u32 s49, 27
s_cselect_b32 s6, s50, 0
MA 152,116,84
s_cmp_lt_u32 s49, 28
s_cselect_b32 s10, s70, 0
MA 156,116,88
s_waitcnt vmcnt(25) lgkmcnt(0)
s_barrier
k1_mlp_w0_loop:
MV 0,32,0
TR 92,204,43008
s_mov_b32 m0, 126976
MV 4,32,4
buffer_load_dwordx4 v192, s[8:11], s69 offen lds
MV 8,32,8
TR 94,204,43520
MV 12,32,12
MV 16,32,16
RB 60,205,0
s_mov_b32 m0, 128000
MV 20,32,20
buffer_load_dwordx4 v193, s[8:11], s69 offen lds
MV 24,32,24
RB 64,205,2048
MV 28,32,28
MV 32,36,0
RB 68,205,4096
MV 36,36,4
s_mov_b32 m0, 129024
MA 160,32,120
RB 72,205,6144
buffer_load_dwordx4 v194, s[8:11], s69 offen lds
MV 40,36,8
MV 44,36,12
RB 76,205,8192
MV 48,36,16
MV 52,36,20
RB 80,205,10240
s_mov_b32 m0, 130048
MV 56,36,24
buffer_load_dwordx4 v195, s[8:11], s69 offen lds
MV 60,36,28
RB 84,205,12288
MV 64,40,0
MV 68,40,4
RB 88,205,14336
s_mov_b32 m0, 139264
MV 72,40,8
buffer_load_dwordx4 v196, s[8:11], s69 offen lds
MV 76,40,12
TR 96,207,43008
MV 80,40,16
MA 164,36,120
MV 84,40,20
TR 98,207,43520
s_add_u32 m0, s47, 16384
MV 88,40,24
DL 197,64
MV 92,40,28
TR 100,208,43008
MV 96,44,0
MV 100,44,4
TR 102,208,43520
MV 104,44,8
s_add_u32 m0, s47, 17408
MV 108,44,12
TR 104,209,43008
DL 198,64
MV 112,44,16
MV 116,44,20
TR 106,209,43520
MV 120,44,24
s_add_u32 m0, s47, 18432
MV 124,44,28
TR 108,204,47104
DL 199,64
MA 168,40,120
MV 128,48,0
TR 110,204,47616
MV 132,48,4
MV 136,48,8
TR 112,207,47104
s_add_u32 m0, s47, 19456
MV 140,48,12
DL 200,64
MV 144,48,16
TR 114,207,47616
MV 148,48,20
MV 152,48,24
TR 116,208,47104
MV 156,48,28
s_add_u32 m0, s47, 20480
MV 160,52,0
TR 118,208,47616
DL 201,64
MV 164,52,4
MV 168,52,8
MA 172,44,120
MV 172,52,12
MV 176,52,16
MV 180,52,20
s_mov_b32 s47, s46
MV 184,52,24
s_add_u32 s46, s46, 32768
MV 188,52,28
s_cmp_eq_u32 s46, 98304
s_cselect_b32 s46, 0, s46
MA 128,56,0
v_add_u32 v205, s46, v202
MA 132,56,4
s_add_u32 s49, s49, 1
MA 136,56,8
s_add_u32 s69, s69, s51
MA 140,56,12
s_add_u32 s48, s48, 128
MA 144,56,16
s_add_u32 s64, s64, 128
MA 148,56,20
s_cmp_lt_u32 s49, 27
s_cselect_b32 s6, s50, 0
MA 152,56,24
s_cmp_lt_u32 s49, 28
s_cselect_b32 s10, s70, 0
MA 156,56,28
s_waitcnt vmcnt(20) lgkmcnt(0)
s_barrier
MV 0,92,60
TR 32,204,0
s_mov_b32 m0, 141312
MV 4,92,64
buffer_load_dwordx4 v192, s[8:11], s69 offen lds
MV 8,92,68
TR 34,204,512
MV 12,92,72
MV 16,92,76
RB 0,205,0
s_mov_b32 m0, 142336
MV 20,92,80
buffer_load_dwordx4 v193, s[8:11], s69 offen lds
MV 24,92,84
RB 4,205,2048
MV 28,92,88
MV 32,96,60
RB 8,205,4096
MV 36,96,64
s_mov_b32 m0, 143360
MA 160,92,120
RB 12,205,6144
buffer_load_dwordx4 v194, s[8:11], s69 offen lds
MV 40,96,68
MV 44,96,72
RB 16,205,8192
MV 48,96,76
MV 52,96,80
RB 20,205,10240
s_mov_b32 m0, 144384
MV 56,96,84
buffer_load_dwordx4 v195, s[8:11], s69 offen lds
MV 60,96,88
RB 24,205,12288
MV 64,100,60
MV 68,100,64
RB 28,205,14336
s_mov_b32 m0, 153600
MV 72,100,68
buffer_load_dwordx4 v196, s[8:11], s69 offen lds
MV 76,100,72
TR 36,207,0
MV 80,100,76
MA 164,96,120
MV 84,100,80
TR 38,207,512
s_add_u32 m0, s47, 0
MV 88,100,84
DL 197,48
MV 92,100,88
TR 40,208,0
MV 96,104,60
MV 100,104,64
TR 42,208,512
MV 104,104,68
s_add_u32 m0, s47, 1024
MV 108,104,72
TR 44,209,0
DL 198,48
MV 112,104,76
MV 116,104,80
TR 46,209,512
MV 120,104,84
s_add_u32 m0, s47, 2048
MV 124,104,88
TR 48,204,4096
DL 199,48
MA 168,100,120
MV 128,108,60
TR 50,204,4608
MV 132,108,64
MV 136,108,68
TR 52,207,4096
s_add_u32 m0, s47, 3072
MV 140,108,72
DL 200,48
MV 144,108,76
TR 54,207,4608
MV 148,108,80
MV 152,108,84
TR 56,208,4096
MV 156,108,88
s_add_u32 m0, s47, 4096
MV 160,112,60
TR 58,208,4608
DL 201,48
MV 164,112,64
MV 168,112,68
MA 172,104,120
MV 172,112,72
MV 176,112,76
MV 180,112,80
MV 184,112,84
MV 188,112,88
MA 128,116,60
MA 132,116,64
MA 136,116,68
v_add_u32 v205, s46, v203
MA 140,116,72
s_add_u32 s49, s49, 1
MA 144,116,76
s_add_u32 s69, s69, s51
MA 148,116,80
s_cmp_lt_u32 s49, 27
s_cselect_b32 s6, s50, 0
MA 152,116,84
s_cmp_lt_u32 s49, 28
s_cselect_b32 s10, s70, 0
MA 156,116,88
s_waitcnt vmcnt(20) lgkmcnt(0)
s_barrier
MV 0,32,0
TR 92,204,14336
s_mov_b32 m0, 98304
MV 4,32,4
buffer_load_dwordx4 v192, s[8:11], s69 offen lds
MV 8,32,8
TR 94,204,14848
MV 12,32,12
MV 16,32,16
RB 60,205,0
s_mov_b32 m0, 99328
MV 20,32,20
buffer_load_dwordx4 v193, s[8:11], s69 offen lds
MV 24,32,24
RB 64,205,2048
MV 28,32,28
MV 32,36,0
RB 68,205,4096
MV 36,36,4
s_mov_b32 m0, 100352
MA 160,32,120
RB 72,205,6144
buffer_load_dwordx4 v194, s[8:11], s69 offen lds
MV 40,36,8
MV 44,36,12
RB 76,205,8192
MV 48,36,16
MV 52,36,20
RB 80,205,10240
s_mov_b32 m0, 101376
MV 56,36,24
buffer_load_dwordx4 v195, s[8:11], s69 offen lds
MV 60,36,28
RB 84,205,12288
MV 64,40,0
MV 68,40,4
RB 88,205,14336
s_mov_b32 m0, 110592
MV 72,40,8
buffer_load_dwordx4 v196, s[8:11], s69 offen lds
MV 76,40,12
TR 96,207,14336
MV 80,40,16
MA 164,36,120
MV 84,40,20
TR 98,207,14848
s_add_u32 m0, s47, 16384
MV 88,40,24
DL 197,64
MV 92,40,28
TR 100,208,14336
MV 96,44,0
MV 100,44,4
TR 102,208,14848
MV 104,44,8
s_add_u32 m0, s47, 17408
MV 108,44,12
TR 104,209,14336
DL 198,64
MV 112,44,16
MV 116,44,20
TR 106,209,14848
MV 120,44,24
s_add_u32 m0, s47, 18432
MV 124,44,28
TR 108,204,18432
DL 199,64
MA 168,40,120
MV 128,48,0
TR 110,204,18944
MV 132,48,4
MV 136,48,8
TR 112,207,18432
s_add_u32 m0, s47, 19456
MV 140,48,12
DL 200,64
MV 144,48,16
TR 114,207,18944
MV 148,48,20
MV 152,48,24
TR 116,208,18432
MV 156,48,28
s_add_u32 m0, s47, 20480
MV 160,52,0
TR 118,208,18944
DL 201,64
MV 164,52,4
MV 168,52,8
MA 172,44,120
MV 172,52,12
MV 176,52,16
MV 180,52,20
s_mov_b32 s47, s46
MV 184,52,24
s_add_u32 s46, s46, 32768
MV 188,52,28
s_cmp_eq_u32 s46, 98304
s_cselect_b32 s46, 0, s46
MA 128,56,0
v_add_u32 v205, s46, v202
MA 132,56,4
s_add_u32 s49, s49, 1
MA 136,56,8
s_add_u32 s69, s69, s51
MA 140,56,12
s_add_u32 s48, s48, 128
MA 144,56,16
s_add_u32 s64, s64, 128
MA 148,56,20
s_cmp_lt_u32 s49, 27
s_cselect_b32 s6, s50, 0
MA 152,56,24
s_cmp_lt_u32 s49, 28
s_cselect_b32 s10, s70, 0
MA 156,56,28
s_waitcnt vmcnt(20) lgkmcnt(0)
s_barrier
MV 0,92,60
TR 32,204,28672
s_mov_b32 m0, 112640
MV 4,92,64
buffer_load_dwordx4 v192, s[8:11], s69 offen lds
MV 8,92,68
TR 34,204,29184
MV 12,92,72
MV 16,92,76
RB 0,205,0
s_mov_b32 m0, 113664
MV 20,92,80
buffer_load_dwordx4 v193, s[8:11], s69 offen lds
MV 24,92,84
RB 4,205,2048
MV 28,92,88
MV 32,96,60
RB 8,205,4096
MV 36,96,64
s_mov_b32 m0, 114688
MA 160,92,120
RB 12,205,6144
buffer_load_dwordx4 v194, s[8:11], s69 offen lds
MV 40,96,68
MV 44,96,72
RB 16,205,8192
MV 48,96,76
MV 52,96,80
RB 20,205,10240
s_mov_b32 m0, 115712
MV 56,96,84
buffer_load_dwordx4 v195, s[8:11], s69 offen lds
MV 60,96,88
RB 24,205,12288
MV 64,100,60
MV 68,100,64
RB 28,205,14336
s_mov_b32 m0, 124928
MV 72,100,68
buffer_load_dwordx4 v196, s[8:11], s69 offen lds
MV 76,100,72
TR 36,207,28672
MV 80,100,76
MA 164,96,120
MV 84,100,80
TR 38,207,29184
s_add_u32 m0, s47, 0
MV 88,100,84
DL 197,48
MV 92,100,88
TR 40,208,28672
MV 96,104,60
MV 100,104,64
TR 42,208,29184
MV 104,104,68
s_add_u32 m0, s47, 1024
MV 108,104,72
TR 44,209,28672
DL 198,48
MV 112,104,76
MV 116,104,80
TR 46,209,29184
MV 120,104,84
s_add_u32 m0, s47, 2048
MV 124,104,88
TR 48,204,32768
DL 199,48
MA 168,100,120
MV 128,108,60
TR 50,204,33280
MV 132,108,64
MV 136,108,68
TR 52,207,32768
s_add_u32 m0, s47, 3072
MV 140,108,72
DL 200,48
MV 144,108,76
TR 54,207,33280
MV 148,108,80
MV 152,108,84
TR 56,208,32768
MV 156,108,88
s_add_u32 m0, s47, 4096
MV 160,112,60
TR 58,208,33280
DL 201,48
MV 164,112,64
MV 168,112,68
MA 172,104,120
MV 172,112,72
MV 176,112,76
MV 180,112,80
MV 184,112,84
MV 188,112,88
MA 128,116,60
MA 132,116,64
MA 136,116,68
v_add_u32 v205, s46, v203
MA 140,116,72
s_add_u32 s49, s49, 1
MA 144,116,76
s_add_u32 s69, s69, s51
MA 148,116,80
s_cmp_lt_u32 s49, 27
s_cselect_b32 s6, s50, 0
MA 152,116,84
s_cmp_lt_u32 s49, 28
s_cselect_b32 s10, s70, 0
MA 156,116,88
s_waitcnt vmcnt(20) lgkmcnt(0)
s_barrier
s_cmp_lt_u32 s49, 30
s_cbranch_scc1 k1_mlp_w0_loop
MV 0,32,0
TR 92,204,43008
v_mov_b32 v210, 0
s_mov_b32 m0, 126976
MV 4,32,4
global_load_dword v242, v210, s[38:39] sc1
buffer_load_dwordx4 v192, s[8:11], s69 offen lds
MV 8,32,8
TR 94,204,43520
MV 12,32,12
MV 16,32,16
RB 60,205,0
s_mov_b32 m0, 128000
MV 20,32,20
buffer_load_dwordx4 v193, s[8:11], s69 offen lds
MV 24,32,24
RB 64,205,2048
MV 28,32,28
MV 32,36,0
RB 68,205,4096
MV 36,36,4
s_mov_b32 m0, 129024
MA 160,32,120
RB 72,205,6144
buffer_load_dwordx4 v194, s[8:11], s69 offen lds
MV 40,36,8
MV 44,36,12
RB 76,205,8192
MV 48,36,16
MV 52,36,20
RB 80,205,10240
s_mov_b32 m0, 130048
MV 56,36,24
buffer_load_dwordx4 v195, s[8:11], s69 offen lds
MV 60,36,28
RB 84,205,12288
MV 64,40,0
MV 68,40,4
RB 88,205,14336
s_mov_b32 m0, 139264
MV 72,40,8
buffer_load_dwordx4 v196, s[8:11], s69 offen lds
MV 76,40,12
TR 96,207,43008
MV 80,40,16
MA 164,36,120
MV 84,40,20
TR 98,207,43520
s_add_u32 m0, s47, 16384
MV 88,40,24
DL 197,64
MV 92,40,28
TR 100,208,43008
MV 96,44,0
MV 100,44,4
TR 102,208,43520
MV 104,44,8
s_add_u32 m0, s47, 17408
MV 108,44,12
TR 104,209,43008
DL 198,64
MV 112,44,16
MV 116,44,20
TR 106,209,43520
MV 120,44,24
s_add_u32 m0, s47, 18432
MV 124,44,28
TR 108,204,47104
DL 199,64
MA 168,40,120
MV 128,48,0
TR 110,204,47616
MV 132,48,4
MV 136,48,8
TR 112,207,47104
s_add_u32 m0, s47, 19456
MV 140,48,12
DL 200,64
MV 144,48,16
TR 114,207,47616
MV 148,48,20
MV 152,48,24
TR 116,208,47104
MV 156,48,28
s_add_u32 m0, s47, 20480
MV 160,52,0
TR 118,208,47616
DL 201,64
MV 164,52,4
MV 168,52,8
MA 172,44,120
MV 172,52,12
MV 176,52,16
MV 180,52,20
s_mov_b32 s47, s46
MV 184,52,24
s_add_u32 s46, s46, 32768
MV 188,52,28
s_cmp_eq_u32 s46, 98304
s_cselect_b32 s46, 0, s46
MA 128,56,0
v_add_u32 v205, s46, v202
MA 132,56,4
s_add_u32 s49, s49, 1
MA 136,56,8
s_add_u32 s69, s69, s51
MA 140,56,12
s_add_u32 s48, s48, 128
MA 144,56,16
s_add_u32 s64, s64, 128
MA 148,56,20
s_cmp_lt_u32 s49, 27
s_cselect_b32 s6, s50, 0
MA 152,56,24
s_cmp_lt_u32 s49, 28
s_cselect_b32 s10, s70, 0
MA 156,56,28
s_waitcnt vmcnt(0) lgkmcnt(0)
v_readfirstlane_b32 s55, v242
s_nop 3
s_cmp_ge_u32 s55, 128
s_cbranch_scc1 k1_mlp_stats_ready
v_mov_b32 v210, 0
k1_mlp_stats_spin:
global_load_dword v242, v210, s[38:39] sc1
s_waitcnt vmcnt(0)
v_readfirstlane_b32 s55, v242
s_nop 3
s_cmp_ge_u32 s55, 128
s_cbranch_scc1 k1_mlp_stats_ok
s_sleep 2
s_branch k1_mlp_stats_spin
k1_mlp_stats_ok:
k1_mlp_stats_ready:
s_barrier
s_add_u32 s12, s40, 20971520
s_addc_u32 s13, s41, 0
s_and_b32 s13, s13, 0xffff
s_mov_b32 s14, 16384
s_mov_b32 s15, 0x20000
v_and_b32 v210, 15, v206
s_lshl_b32 s55, s44, 8
s_add_u32 s55, s55, 0
v_add_u32 v210, s55, v210
v_lshlrev_b32 v210, 3, v210
buffer_load_dwordx2 a[176:177], v210, s[12:15], 0 offen offset:0 sc1
buffer_load_dwordx2 a[178:179], v210, s[12:15], 0 offen offset:128 sc1
buffer_load_dwordx2 a[180:181], v210, s[12:15], 0 offen offset:256 sc1
buffer_load_dwordx2 a[182:183], v210, s[12:15], 0 offen offset:384 sc1
buffer_load_dwordx2 a[184:185], v210, s[12:15], 0 offen offset:512 sc1
buffer_load_dwordx2 a[186:187], v210, s[12:15], 0 offen offset:640 sc1
buffer_load_dwordx2 a[188:189], v210, s[12:15], 0 offen offset:768 sc1
buffer_load_dwordx2 a[190:191], v210, s[12:15], 0 offen offset:896 sc1
s_mov_b32 s12, s28
s_and_b32 s13, s29, 0xffff
s_mov_b32 s14, 7168
s_mov_b32 s15, 0x20000
v_lshrrev_b32 v211, 4, v206
v_lshlrev_b32 v212, 3, v211
s_mul_i32 s55, s45, 448
s_add_u32 s56, s55, s67
s_add_u32 s55, s55, s66
buffer_load_dwordx2 a[192:193], v212, s[12:15], s55 offen offset:0
buffer_load_dwordx2 a[194:195], v212, s[12:15], s55 offen offset:32
buffer_load_dwordx2 a[196:197], v212, s[12:15], s55 offen offset:64
buffer_load_dwordx2 a[198:199], v212, s[12:15], s55 offen offset:96
buffer_load_dwordx2 a[200:201], v212, s[12:15], s55 offen offset:128
buffer_load_dwordx2 a[202:203], v212, s[12:15], s55 offen offset:160
buffer_load_dwordx2 a[204:205], v212, s[12:15], s55 offen offset:192
MV 0,92,60
MV 4,92,64
MV 8,92,68
MV 12,92,72
MV 16,92,76
MV 20,92,80
MV 24,92,84
MV 28,92,88
MV 32,96,60
MV 36,96,64
MA 160,92,120
MV 40,96,68
MV 44,96,72
MV 48,96,76
MV 52,96,80
MV 56,96,84
MV 60,96,88
MV 64,100,60
MV 68,100,64
MV 72,100,68
MV 76,100,72
MV 80,100,76
MA 164,96,120
MV 84,100,80
MV 88,100,84
MV 92,100,88
MV 96,104,60
MV 100,104,64
MV 104,104,68
MV 108,104,72
MV 112,104,76
MV 116,104,80
MV 120,104,84
MV 124,104,88
MA 168,100,120
MV 128,108,60
MV 132,108,64
MV 136,108,68
MV 140,108,72
MV 144,108,76
MV 148,108,80
MV 152,108,84
MV 156,108,88
MV 160,112,60
MV 164,112,64
MV 168,112,68
MA 172,104,120
MV 172,112,72
MV 176,112,76
MV 180,112,80
MV 184,112,84
MV 188,112,88
MA 128,116,60
MA 132,116,64
MA 136,116,68
MA 140,116,72
MA 144,116,76
MA 148,116,80
MA 152,116,84
MA 156,116,88
v_lshrrev_b32 v210, 4, v206
v_lshlrev_b32 v210, 4, v210
v_add_u32 v210, 155648, v210
s_mov_b32 exec_lo, 0x00010001
s_mov_b32 exec_hi, 0x00010001
ds_write_b128 v210, a[160:163] offset:0
ds_write_b128 v210, a[164:167] offset:64
ds_write_b128 v210, a[168:171] offset:128
ds_write_b128 v210, a[172:175] offset:192
s_mov_b64 exec, -1
s_waitcnt lgkmcnt(0)
s_barrier
RB 208,210,0
RB 212,210,64
RB 216,210,128
RB 220,210,192
RB 224,210,256
RB 228,210,320
RB 232,210,384
s_waitcnt vmcnt(0) lgkmcnt(0)
s_branch k1_mlp_epi0
k1_mlp_w1:
s_mov_b32 s52, 0
s_mov_b32 s53, 1
s_and_b32 s65, s45, 1
s_lshl_b32 s66, s65, 6
s_cmp_eq_u32 s65, 0
s_cselect_b32 s67, 384, 0
v_lshrrev_b32 v210, 3, v206
v_lshrrev_b32 v211, 4, v206
v_and_b32 v212, 7, v206
v_add_u32 v213, 0, v211
v_xor_b32 v213, v213, v212
v_lshlrev_b32 v213, 4, v213
v_lshl_add_u32 v213, v210, 11, v213
v_add_u32 v198, 98304, v213
v_add_u32 v200, 131072, v213
v_add_u32 v213, 4, v211
v_xor_b32 v213, v213, v212
v_lshlrev_b32 v213, 4, v213
v_lshl_add_u32 v213, v210, 11, v213
v_add_u32 v197, 81920, v213
v_add_u32 v199, 114688, v213
v_add_u32 v201, 147456, v213
s_mov_b32 s3, 7168
v_mul_lo_u32 v214, v210, s3
v_and_b32 v215, 1, v211
v_or_b32 v213, 0, v215
v_lshlrev_b32 v213, 1, v213
v_xor_b32 v213, v213, v212
v_lshl_add_u32 v213, v213, 4, v214
v_add_u32 v213, s66, v213
v_add_u32 v192, 128, v213
v_add_u32 v194, 114816, v213
v_or_b32 v213, 2, v215
v_lshlrev_b32 v213, 1, v213
v_xor_b32 v213, v213, v212
v_lshl_add_u32 v213, v213, 4, v214
v_add_u32 v213, s66, v213
v_add_u32 v193, 57472, v213
v_add_u32 v195, 172160, v213
v_lshrrev_b32 v210, 2, v206
v_mul_lo_u32 v210, v210, s3
v_lshrrev_b32 v211, 5, v206
v_lshlrev_b32 v211, 1, v211
v_and_b32 v212, 3, v206
v_xor_b32 v211, v211, v212
v_lshl_add_u32 v210, v211, 4, v210
v_add_u32 v210, s67, v210
v_add_u32 v196, 114688, v210
s_waitcnt lgkmcnt(0)
s_lshr_b32 s74, s2, 3
s_lshl_b32 s74, s74, 2
s_add_u32 s74, s74, s42
s_and_b32 s75, s2, 1
s_lshl_b32 s75, s75, 2
s_bfe_u32 s76, s2, 0x20001
s_lshl_b32 s76, s76, 2
s_cmp_lt_u32 s74, 48
s_cbranch_scc0 k1_mlp_w1_k1_st_w
s_mul_i32 s3, s74, 43691
s_lshr_b32 s3, s3, 19
s_mul_i32 s77, s3, 12
s_sub_u32 s77, s74, s77
s_add_u32 s3, s3, s75
s_lshl_b32 s3, s3, 19
s_and_b32 s75, s77, 3
s_lshl_b32 s75, s75, 17
s_add_u32 s3, s3, s75
s_lshr_b32 s77, s77, 2
s_cmp_ge_u32 s77, 1
s_cbranch_scc1 k1_mlp_w1_k1_st_done
s_lshl_b32 s77, s77, 7
s_add_u32 s3, s3, s77
v_lshlrev_b32 v255, 11, v206
v_add_u32 v255, s3, v255
s_mov_b32 s72, s16
s_and_b32 s73, s17, 0xffff
s_mov_b32 s74, 4194304
s_mov_b32 s75, 0x20000
s_branch k1_mlp_w1_k1_st_go
k1_mlp_w1_k1_st_w:
s_cmp_lt_u32 s74, 88
s_cselect_b32 s77, 48, 88
s_cselect_b32 s75, 1, 0
s_sub_u32 s74, s74, s77
s_mul_i32 s3, s74, 52429
s_lshr_b32 s3, s3, 19
s_mul_i32 s77, s3, 10
s_sub_u32 s77, s74, s77
s_cmp_ge_u32 s77, 4
s_cbranch_scc1 k1_mlp_w1_k1_st_done
s_add_u32 s76, s76, s3
s_lshl_b32 s77, s77, 4
v_lshrrev_b32 v255, 2, v206
v_add_u32 v255, s77, v255
v_and_b32 v254, 3, v206
s_cmp_eq_u32 s75, 1
s_cbranch_scc0 k1_mlp_w1_k1_st_q
s_mul_i32 s3, s76, 448
s_and_b32 s3, s3, 0xffffff80
s_mov_b32 s77, 7168
v_mul_lo_u32 v255, v255, s77
v_lshl_add_u32 v255, v254, 7, v255
v_add_u32 v255, s3, v255
s_mov_b32 s72, s26
s_and_b32 s73, s27, 0xffff
s_mov_b32 s74, 7340032
s_mov_b32 s75, 0x20000
s_branch k1_mlp_w1_k1_st_go
k1_mlp_w1_k1_st_q:
s_lshl_b32 s3, s76, 7
s_mov_b32 s77, 6144
v_mul_lo_u32 v255, v255, s77
v_min_u32 v254, 2, v254
v_lshl_add_u32 v255, v254, 11, v255
v_add_u32 v255, s3, v255
s_mov_b32 s72, s18
s_and_b32 s73, s19, 0xffff
s_mov_b32 s74, 6291456
s_mov_b32 s75, 0x20000
k1_mlp_w1_k1_st_go:
buffer_load_dword v254, v255, s[72:75], 0 offen
k1_mlp_w1_k1_st_done:
s_lshl_b32 s3, s44, 19
s_add_u32 s4, s16, s3
s_addc_u32 s5, s17, 0
s_and_b32 s5, s5, 0xffff
s_mov_b32 s50, 524288
s_mov_b32 s6, s50
s_mov_b32 s7, 0x20000
s_mul_i32 s3, s45, 448
s_add_u32 s8, s26, s3
s_addc_u32 s9, s27, 0
s_and_b32 s9, s9, 0xffff
s_sub_u32 s70, 7340032, s3
s_mov_b32 s10, s70
s_mov_b32 s11, 0x20000
s_mov_b32 s51, 229376
s_mov_b32 s48, 0
s_mov_b32 s64, 262144
s_mov_b32 s69, 0
s_mov_b32 m0, 102400
s_nop 0
buffer_load_dwordx4 v192, s[8:11], s69 offen lds
s_mov_b32 m0, 103424
s_nop 0
buffer_load_dwordx4 v193, s[8:11], s69 offen lds
s_mov_b32 m0, 104448
s_nop 0
buffer_load_dwordx4 v194, s[8:11], s69 offen lds
s_mov_b32 m0, 105472
s_nop 0
buffer_load_dwordx4 v195, s[8:11], s69 offen lds
s_mov_b32 m0, 111616
s_nop 0
buffer_load_dwordx4 v196, s[8:11], s69 offen lds
s_add_u32 s69, s69, s51
s_mov_b32 m0, 5120
s_nop 0
DL 197,48
s_mov_b32 m0, 6144
s_nop 0
DL 198,48
s_mov_b32 m0, 7168
s_nop 0
DL 199,48
s_mov_b32 m0, 8192
s_nop 0
DL 200,48
s_mov_b32 m0, 9216
s_nop 0
DL 201,48
s_mov_b32 m0, 21504
s_nop 0
DL 197,64
s_mov_b32 m0, 22528
s_nop 0
DL 198,64
s_mov_b32 m0, 23552
s_nop 0
DL 199,64
s_mov_b32 m0, 24576
s_nop 0
DL 200,64
s_mov_b32 m0, 25600
s_nop 0
DL 201,64
s_add_u32 s48, s48, 128
s_add_u32 s64, s64, 128
s_mov_b32 m0, 116736
s_nop 0
buffer_load_dwordx4 v192, s[8:11], s69 offen lds
s_mov_b32 m0, 117760
s_nop 0
buffer_load_dwordx4 v193, s[8:11], s69 offen lds
s_mov_b32 m0, 118784
s_nop 0
buffer_load_dwordx4 v194, s[8:11], s69 offen lds
s_mov_b32 m0, 119808
s_nop 0
buffer_load_dwordx4 v195, s[8:11], s69 offen lds
s_mov_b32 m0, 125952
s_nop 0
buffer_load_dwordx4 v196, s[8:11], s69 offen lds
s_add_u32 s69, s69, s51
v_mov_b32 v210, 0x3f803f80
v_accvgpr_write_b32 a120, v210
v_mov_b32 v210, 0x3f803f80
v_accvgpr_write_b32 a121, v210
v_mov_b32 v210, 0x3f803f80
v_accvgpr_write_b32 a122, v210
v_mov_b32 v210, 0x3f803f80
v_accvgpr_write_b32 a123, v210
v_and_b32 v210, 15, v206
v_lshrrev_b32 v213, 4, v206
v_lshrrev_b32 v211, 1, v210
v_add_u32 v212, 0, v213
v_xor_b32 v212, v212, v211
v_lshlrev_b32 v212, 4, v212
v_lshl_add_u32 v212, v210, 7, v212
v_add_u32 v202, 0, v212
v_add_u32 v212, 4, v213
v_xor_b32 v212, v212, v211
v_lshlrev_b32 v212, 4, v212
v_lshl_add_u32 v212, v210, 7, v212
v_add_u32 v203, 0, v212
v_bfe_u32 v211, v206, 2, 2
v_lshl_add_u32 v214, v213, 3, v211
v_and_b32 v215, 3, v206
v_lshlrev_b32 v215, 3, v215
v_lshrrev_b32 v216, 1, v211
v_and_b32 v217, 1, v213
v_lshl_or_b32 v216, v217, 1, v216
v_lshl_add_u32 v218, v214, 7, v215
v_add_u32 v218, 98304, v218
v_xor_b32 v219, 0, v216
v_lshl_add_u32 v204, v219, 5, v218
v_xor_b32 v219, 1, v216
v_lshl_add_u32 v207, v219, 5, v218
v_xor_b32 v219, 2, v216
v_lshl_add_u32 v208, v219, 5, v218
v_xor_b32 v219, 3, v216
v_lshl_add_u32 v209, v219, 5, v218
v_lshl_add_u32 v218, v214, 6, v215
v_add_u32 v218, 110592, v218
v_xor_b32 v219, 0, v217
v_lshl_add_u32 v240, v219, 5, v218
v_xor_b32 v219, 1, v217
v_lshl_add_u32 v241, v219, 5, v218
v_mov_b32 v205, v202
s_waitcnt vmcnt(0) lgkmcnt(0)
s_barrier
TR 32,209,4096
TR 34,209,4608
RB 0,205,0
RB 4,205,2048
RB 8,205,4096
RB 12,205,6144
RB 16,205,8192
RB 20,205,10240
RB 24,205,12288
RB 28,205,14336
TR 36,204,8192
TR 38,204,8704
TR 40,207,8192
TR 42,207,8704
TR 44,208,8192
TR 46,208,8704
TR 48,209,8192
TR 50,209,8704
TR 52,240,0
TR 54,240,256
TR 56,241,0
TR 58,241,256
s_mov_b32 s46, 0
s_mov_b32 s47, 65536
s_mov_b32 s49, 0
v_mov_b32 v205, v203
s_waitcnt lgkmcnt(0)
s_barrier
MVZ 0,32,0
TR 92,209,18432
MVZ 4,32,4
s_mov_b32 m0, 37888
MVZ 8,32,8
TR 94,209,18944
DL 197,48
MVZ 12,32,12
s_mov_b32 m0, 38912
MVZ 16,32,16
RB 60,205,0
DL 198,48
MVZ 20,32,20
s_mov_b32 m0, 39936
MVZ 24,32,24
RB 64,205,2048
DL 199,48
MVZ 28,32,28
s_mov_b32 m0, 40960
MVZ 32,36,0
RB 68,205,4096
DL 200,48
MVZ 36,36,4
v_mfma_f32_16x16x32_bf16 a[160:163], a[32:35], a[120:123], 0
RB 72,205,6144
s_mov_b32 m0, 41984
MVZ 40,36,8
DL 201,48
MVZ 44,36,12
RB 76,205,8192
s_mov_b32 m0, 54272
MVZ 48,36,16
DL 197,64
MVZ 52,36,20
RB 80,205,10240
s_mov_b32 m0, 55296
MVZ 56,36,24
DL 198,64
MVZ 60,36,28
RB 84,205,12288
MVZ 64,40,0
s_mov_b32 m0, 56320
MVZ 68,40,4
RB 88,205,14336
DL 199,64
MVZ 72,40,8
s_mov_b32 m0, 57344
MVZ 76,40,12
TR 96,204,22528
DL 200,64
MVZ 80,40,16
s_mov_b32 m0, 58368
v_mfma_f32_16x16x32_bf16 a[164:167], a[36:39], a[120:123], 0
DL 201,64
MVZ 84,40,20
TR 98,204,23040
MVZ 88,40,24
s_mov_b32 m0, 131072
MVZ 92,40,28
TR 100,207,22528
buffer_load_dwordx4 v192, s[8:11], s69 offen lds
MVZ 96,44,0
s_mov_b32 m0, 132096
MVZ 100,44,4
TR 102,207,23040
buffer_load_dwordx4 v193, s[8:11], s69 offen lds
MVZ 104,44,8
s_mov_b32 m0, 133120
MVZ 108,44,12
TR 104,208,22528
buffer_load_dwordx4 v194, s[8:11], s69 offen lds
MVZ 112,44,16
s_mov_b32 m0, 134144
MVZ 116,44,20
TR 106,208,23040
buffer_load_dwordx4 v195, s[8:11], s69 offen lds
MVZ 120,44,24
MVZ 124,44,28
TR 108,209,22528
s_mov_b32 m0, 140288
v_mfma_f32_16x16x32_bf16 a[168:171], a[40:43], a[120:123], 0
buffer_load_dwordx4 v196, s[8:11], s69 offen lds
s_add_u32 s69, s69, s51
MVZ 128,48,0
TR 110,209,23040
s_mov_b32 m0, 145408
MVZ 132,48,4
buffer_load_dwordx4 v192, s[8:11], s69 offen lds
MVZ 136,48,8
TR 112,240,14336
s_mov_b32 m0, 146432
MVZ 140,48,12
buffer_load_dwordx4 v193, s[8:11], s69 offen lds
MVZ 144,48,16
TR 114,240,14592
MVZ 148,48,20
s_mov_b32 m0, 147456
MVZ 152,48,24
TR 116,241,14336
buffer_load_dwordx4 v194, s[8:11], s69 offen lds
MVZ 156,48,28
s_mov_b32 m0, 148480
MVZ 160,52,0
TR 118,241,14592
buffer_load_dwordx4 v195, s[8:11], s69 offen lds
MVZ 164,52,4
s_mov_b32 m0, 154624
MVZ 168,52,8
buffer_load_dwordx4 v196, s[8:11], s69 offen lds
v_mfma_f32_16x16x32_bf16 a[172:175], a[44:47], a[120:123], 0
MVZ 172,52,12
MVZ 176,52,16
MVZ 180,52,20
s_mov_b32 s47, s46
MVZ 184,52,24
s_add_u32 s46, s46, 32768
MVZ 188,52,28
s_cmp_eq_u32 s46, 98304
s_cselect_b32 s46, 0, s46
v_mfma_f32_16x16x32_bf16 a[128:131], a[56:59], a[0:3], 0
v_add_u32 v205, s46, v202
v_mfma_f32_16x16x32_bf16 a[132:135], a[56:59], a[4:7], 0
s_add_u32 s49, s49, 1
v_mfma_f32_16x16x32_bf16 a[136:139], a[56:59], a[8:11], 0
s_add_u32 s69, s69, s51
v_mfma_f32_16x16x32_bf16 a[140:143], a[56:59], a[12:15], 0
s_add_u32 s48, s48, 128
v_mfma_f32_16x16x32_bf16 a[144:147], a[56:59], a[16:19], 0
s_add_u32 s64, s64, 128
v_mfma_f32_16x16x32_bf16 a[148:151], a[56:59], a[20:23], 0
s_cmp_lt_u32 s49, 27
s_cselect_b32 s6, s50, 0
v_mfma_f32_16x16x32_bf16 a[152:155], a[56:59], a[24:27], 0
s_cmp_lt_u32 s49, 28
s_cselect_b32 s10, s70, 0
v_mfma_f32_16x16x32_bf16 a[156:159], a[56:59], a[28:31], 0
s_waitcnt vmcnt(5) lgkmcnt(0)
s_barrier
MV 0,92,60
TR 32,209,32768
MV 4,92,64
s_mov_b32 m0, 102400
MV 8,92,68
TR 34,209,33280
buffer_load_dwordx4 v192, s[8:11], s69 offen lds
s_mov_b32 m0, 103424
MV 12,92,72
buffer_load_dwordx4 v193, s[8:11], s69 offen lds
MV 16,92,76
RB 0,205,0
s_mov_b32 m0, 104448
MV 20,92,80
buffer_load_dwordx4 v194, s[8:11], s69 offen lds
MV 24,92,84
RB 4,205,2048
s_mov_b32 m0, 105472
MV 28,92,88
buffer_load_dwordx4 v195, s[8:11], s69 offen lds
MV 32,96,60
RB 8,205,4096
s_mov_b32 m0, 111616
MV 36,96,64
buffer_load_dwordx4 v196, s[8:11], s69 offen lds
s_add_u32 s69, s69, s51
MA 160,92,120
RB 12,205,6144
s_mov_b32 m0, 70656
MV 40,96,68
DL 197,48
MV 44,96,72
RB 16,205,8192
s_mov_b32 m0, 71680
MV 48,96,76
DL 198,48
s_mov_b32 m0, 72704
MV 52,96,80
RB 20,205,10240
DL 199,48
MV 56,96,84
s_mov_b32 m0, 73728
MV 60,96,88
RB 24,205,12288
DL 200,48
MV 64,100,60
s_mov_b32 m0, 74752
MV 68,100,64
RB 28,205,14336
DL 201,48
MV 72,100,68
s_mov_b32 m0, 87040
MV 76,100,72
TR 36,204,36864
DL 197,64
MV 80,100,76
s_mov_b32 m0, 88064
MA 164,96,120
DL 198,64
MV 84,100,80
TR 38,204,37376
s_mov_b32 m0, 89088
MV 88,100,84
DL 199,64
s_mov_b32 m0, 90112
MV 92,100,88
TR 40,207,36864
DL 200,64
MV 96,104,60
s_mov_b32 m0, 91136
MV 100,104,64
TR 42,207,37376
DL 201,64
s_add_u32 s48, s48, 128
s_add_u32 s64, s64, 128
MV 104,104,68
s_mov_b32 m0, 116736
MV 108,104,72
TR 44,208,36864
buffer_load_dwordx4 v192, s[8:11], s69 offen lds
MV 112,104,76
s_mov_b32 m0, 117760
MV 116,104,80
TR 46,208,37376
buffer_load_dwordx4 v193, s[8:11], s69 offen lds
MV 120,104,84
s_mov_b32 m0, 118784
MV 124,104,88
TR 48,209,36864
buffer_load_dwordx4 v194, s[8:11], s69 offen lds
MA 168,100,120
s_mov_b32 m0, 119808
MV 128,108,60
TR 50,209,37376
buffer_load_dwordx4 v195, s[8:11], s69 offen lds
s_mov_b32 m0, 125952
MV 132,108,64
buffer_load_dwordx4 v196, s[8:11], s69 offen lds
MV 136,108,68
TR 52,240,28672
s_mov_b32 m0, 5120
MV 140,108,72
DL 197,48
MV 144,108,76
TR 54,240,28928
s_mov_b32 m0, 6144
MV 148,108,80
DL 198,48
MV 152,108,84
TR 56,241,28672
s_mov_b32 m0, 7168
MV 156,108,88
DL 199,48
MV 160,112,60
TR 58,241,28928
s_mov_b32 m0, 8192
MV 164,112,64
DL 200,48
MV 168,112,68
s_mov_b32 m0, 9216
MA 172,104,120
DL 201,48
MV 172,112,72
MV 176,112,76
MV 180,112,80
MV 184,112,84
MV 188,112,88
MA 128,116,60
MA 132,116,64
MA 136,116,68
v_add_u32 v205, s46, v203
MA 140,116,72
s_add_u32 s49, s49, 1
MA 144,116,76
s_add_u32 s69, s69, s51
MA 148,116,80
s_cmp_lt_u32 s49, 27
s_cselect_b32 s6, s50, 0
MA 152,116,84
s_cmp_lt_u32 s49, 28
s_cselect_b32 s10, s70, 0
MA 156,116,88
s_waitcnt vmcnt(25) lgkmcnt(0)
s_barrier
k1_mlp_w1_loop:
MV 0,32,0
TR 92,209,47104
MV 4,32,4
MV 8,32,8
TR 94,209,47616
s_mov_b32 m0, 131072
MV 12,32,12
buffer_load_dwordx4 v192, s[8:11], s69 offen lds
MV 16,32,16
RB 60,205,0
MV 20,32,20
MV 24,32,24
RB 64,205,2048
s_mov_b32 m0, 132096
MV 28,32,28
buffer_load_dwordx4 v193, s[8:11], s69 offen lds
MV 32,36,0
RB 68,205,4096
MV 36,36,4
MA 160,32,120
RB 72,205,6144
MV 40,36,8
s_mov_b32 m0, 133120
MV 44,36,12
RB 76,205,8192
buffer_load_dwordx4 v194, s[8:11], s69 offen lds
MV 48,36,16
MV 52,36,20
RB 80,205,10240
MV 56,36,24
s_mov_b32 m0, 134144
MV 60,36,28
RB 84,205,12288
buffer_load_dwordx4 v195, s[8:11], s69 offen lds
MV 64,40,0
MV 68,40,4
RB 88,205,14336
MV 72,40,8
MV 76,40,12
TR 96,204,51200
s_mov_b32 m0, 140288
MV 80,40,16
buffer_load_dwordx4 v196, s[8:11], s69 offen lds
MA 164,36,120
MV 84,40,20
TR 98,204,51712
MV 88,40,24
s_add_u32 m0, s47, 21504
MV 92,40,28
TR 100,207,51200
DL 197,64
MV 96,44,0
MV 100,44,4
TR 102,207,51712
MV 104,44,8
MV 108,44,12
TR 104,208,51200
s_add_u32 m0, s47, 22528
MV 112,44,16
DL 198,64
MV 116,44,20
TR 106,208,51712
MV 120,44,24
MV 124,44,28
TR 108,209,51200
s_add_u32 m0, s47, 23552
MA 168,40,120
DL 199,64
MV 128,48,0
TR 110,209,51712
MV 132,48,4
MV 136,48,8
TR 112,240,43008
MV 140,48,12
s_add_u32 m0, s47, 24576
MV 144,48,16
TR 114,240,43264
DL 200,64
MV 148,48,20
MV 152,48,24
TR 116,241,43008
MV 156,48,28
s_add_u32 m0, s47, 25600
MV 160,52,0
TR 118,241,43264
DL 201,64
MV 164,52,4
MV 168,52,8
MA 172,44,120
MV 172,52,12
MV 176,52,16
MV 180,52,20
s_mov_b32 s47, s46
MV 184,52,24
s_add_u32 s46, s46, 32768
MV 188,52,28
s_cmp_eq_u32 s46, 98304
s_cselect_b32 s46, 0, s46
MA 128,56,0
v_add_u32 v205, s46, v202
MA 132,56,4
s_add_u32 s49, s49, 1
MA 136,56,8
s_add_u32 s69, s69, s51
MA 140,56,12
s_add_u32 s48, s48, 128
MA 144,56,16
s_add_u32 s64, s64, 128
MA 148,56,20
s_cmp_lt_u32 s49, 27
s_cselect_b32 s6, s50, 0
MA 152,56,24
s_cmp_lt_u32 s49, 28
s_cselect_b32 s10, s70, 0
MA 156,56,28
s_waitcnt vmcnt(20) lgkmcnt(0)
s_barrier
MV 0,92,60
TR 32,209,4096
MV 4,92,64
MV 8,92,68
TR 34,209,4608
s_mov_b32 m0, 145408
MV 12,92,72
buffer_load_dwordx4 v192, s[8:11], s69 offen lds
MV 16,92,76
RB 0,205,0
MV 20,92,80
MV 24,92,84
RB 4,205,2048
s_mov_b32 m0, 146432
MV 28,92,88
buffer_load_dwordx4 v193, s[8:11], s69 offen lds
MV 32,96,60
RB 8,205,4096
MV 36,96,64
MA 160,92,120
RB 12,205,6144
MV 40,96,68
s_mov_b32 m0, 147456
MV 44,96,72
RB 16,205,8192
buffer_load_dwordx4 v194, s[8:11], s69 offen lds
MV 48,96,76
MV 52,96,80
RB 20,205,10240
MV 56,96,84
s_mov_b32 m0, 148480
MV 60,96,88
RB 24,205,12288
buffer_load_dwordx4 v195, s[8:11], s69 offen lds
MV 64,100,60
MV 68,100,64
RB 28,205,14336
MV 72,100,68
MV 76,100,72
TR 36,204,8192
s_mov_b32 m0, 154624
MV 80,100,76
buffer_load_dwordx4 v196, s[8:11], s69 offen lds
MA 164,96,120
MV 84,100,80
TR 38,204,8704
MV 88,100,84
s_add_u32 m0, s47, 5120
MV 92,100,88
TR 40,207,8192
DL 197,48
MV 96,104,60
MV 100,104,64
TR 42,207,8704
MV 104,104,68
MV 108,104,72
TR 44,208,8192
s_add_u32 m0, s47, 6144
MV 112,104,76
DL 198,48
MV 116,104,80
TR 46,208,8704
MV 120,104,84
MV 124,104,88
TR 48,209,8192
s_add_u32 m0, s47, 7168
MA 168,100,120
DL 199,48
MV 128,108,60
TR 50,209,8704
MV 132,108,64
MV 136,108,68
TR 52,240,0
MV 140,108,72
s_add_u32 m0, s47, 8192
MV 144,108,76
TR 54,240,256
DL 200,48
MV 148,108,80
MV 152,108,84
TR 56,241,0
MV 156,108,88
s_add_u32 m0, s47, 9216
MV 160,112,60
TR 58,241,256
DL 201,48
MV 164,112,64
MV 168,112,68
MA 172,104,120
MV 172,112,72
MV 176,112,76
MV 180,112,80
MV 184,112,84
MV 188,112,88
MA 128,116,60
MA 132,116,64
MA 136,116,68
v_add_u32 v205, s46, v203
MA 140,116,72
s_add_u32 s49, s49, 1
MA 144,116,76
s_add_u32 s69, s69, s51
MA 148,116,80
s_cmp_lt_u32 s49, 27
s_cselect_b32 s6, s50, 0
MA 152,116,84
s_cmp_lt_u32 s49, 28
s_cselect_b32 s10, s70, 0
MA 156,116,88
s_waitcnt vmcnt(20) lgkmcnt(0)
s_barrier
MV 0,32,0
TR 92,209,18432
MV 4,32,4
MV 8,32,8
TR 94,209,18944
s_mov_b32 m0, 102400
MV 12,32,12
buffer_load_dwordx4 v192, s[8:11], s69 offen lds
MV 16,32,16
RB 60,205,0
MV 20,32,20
MV 24,32,24
RB 64,205,2048
s_mov_b32 m0, 103424
MV 28,32,28
buffer_load_dwordx4 v193, s[8:11], s69 offen lds
MV 32,36,0
RB 68,205,4096
MV 36,36,4
MA 160,32,120
RB 72,205,6144
MV 40,36,8
s_mov_b32 m0, 104448
MV 44,36,12
RB 76,205,8192
buffer_load_dwordx4 v194, s[8:11], s69 offen lds
MV 48,36,16
MV 52,36,20
RB 80,205,10240
MV 56,36,24
s_mov_b32 m0, 105472
MV 60,36,28
RB 84,205,12288
buffer_load_dwordx4 v195, s[8:11], s69 offen lds
MV 64,40,0
MV 68,40,4
RB 88,205,14336
MV 72,40,8
MV 76,40,12
TR 96,204,22528
s_mov_b32 m0, 111616
MV 80,40,16
buffer_load_dwordx4 v196, s[8:11], s69 offen lds
MA 164,36,120
MV 84,40,20
TR 98,204,23040
MV 88,40,24
s_add_u32 m0, s47, 21504
MV 92,40,28
TR 100,207,22528
DL 197,64
MV 96,44,0
MV 100,44,4
TR 102,207,23040
MV 104,44,8
MV 108,44,12
TR 104,208,22528
s_add_u32 m0, s47, 22528
MV 112,44,16
DL 198,64
MV 116,44,20
TR 106,208,23040
MV 120,44,24
MV 124,44,28
TR 108,209,22528
s_add_u32 m0, s47, 23552
MA 168,40,120
DL 199,64
MV 128,48,0
TR 110,209,23040
MV 132,48,4
MV 136,48,8
TR 112,240,14336
MV 140,48,12
s_add_u32 m0, s47, 24576
MV 144,48,16
TR 114,240,14592
DL 200,64
MV 148,48,20
MV 152,48,24
TR 116,241,14336
MV 156,48,28
s_add_u32 m0, s47, 25600
MV 160,52,0
TR 118,241,14592
DL 201,64
MV 164,52,4
MV 168,52,8
MA 172,44,120
MV 172,52,12
MV 176,52,16
MV 180,52,20
s_mov_b32 s47, s46
MV 184,52,24
s_add_u32 s46, s46, 32768
MV 188,52,28
s_cmp_eq_u32 s46, 98304
s_cselect_b32 s46, 0, s46
MA 128,56,0
v_add_u32 v205, s46, v202
MA 132,56,4
s_add_u32 s49, s49, 1
MA 136,56,8
s_add_u32 s69, s69, s51
MA 140,56,12
s_add_u32 s48, s48, 128
MA 144,56,16
s_add_u32 s64, s64, 128
MA 148,56,20
s_cmp_lt_u32 s49, 27
s_cselect_b32 s6, s50, 0
MA 152,56,24
s_cmp_lt_u32 s49, 28
s_cselect_b32 s10, s70, 0
MA 156,56,28
s_waitcnt vmcnt(20) lgkmcnt(0)
s_barrier
MV 0,92,60
TR 32,209,32768
MV 4,92,64
MV 8,92,68
TR 34,209,33280
s_mov_b32 m0, 116736
MV 12,92,72
buffer_load_dwordx4 v192, s[8:11], s69 offen lds
MV 16,92,76
RB 0,205,0
MV 20,92,80
MV 24,92,84
RB 4,205,2048
s_mov_b32 m0, 117760
MV 28,92,88
buffer_load_dwordx4 v193, s[8:11], s69 offen lds
MV 32,96,60
RB 8,205,4096
MV 36,96,64
MA 160,92,120
RB 12,205,6144
MV 40,96,68
s_mov_b32 m0, 118784
MV 44,96,72
RB 16,205,8192
buffer_load_dwordx4 v194, s[8:11], s69 offen lds
MV 48,96,76
MV 52,96,80
RB 20,205,10240
MV 56,96,84
s_mov_b32 m0, 119808
MV 60,96,88
RB 24,205,12288
buffer_load_dwordx4 v195, s[8:11], s69 offen lds
MV 64,100,60
MV 68,100,64
RB 28,205,14336
MV 72,100,68
MV 76,100,72
TR 36,204,36864
s_mov_b32 m0, 125952
MV 80,100,76
buffer_load_dwordx4 v196, s[8:11], s69 offen lds
MA 164,96,120
MV 84,100,80
TR 38,204,37376
MV 88,100,84
s_add_u32 m0, s47, 5120
MV 92,100,88
TR 40,207,36864
DL 197,48
MV 96,104,60
MV 100,104,64
TR 42,207,37376
MV 104,104,68
MV 108,104,72
TR 44,208,36864
s_add_u32 m0, s47, 6144
MV 112,104,76
DL 198,48
MV 116,104,80
TR 46,208,37376
MV 120,104,84
MV 124,104,88
TR 48,209,36864
s_add_u32 m0, s47, 7168
MA 168,100,120
DL 199,48
MV 128,108,60
TR 50,209,37376
MV 132,108,64
MV 136,108,68
TR 52,240,28672
MV 140,108,72
s_add_u32 m0, s47, 8192
MV 144,108,76
TR 54,240,28928
DL 200,48
MV 148,108,80
MV 152,108,84
TR 56,241,28672
MV 156,108,88
s_add_u32 m0, s47, 9216
MV 160,112,60
TR 58,241,28928
DL 201,48
MV 164,112,64
MV 168,112,68
MA 172,104,120
MV 172,112,72
MV 176,112,76
MV 180,112,80
MV 184,112,84
MV 188,112,88
MA 128,116,60
MA 132,116,64
MA 136,116,68
v_add_u32 v205, s46, v203
MA 140,116,72
s_add_u32 s49, s49, 1
MA 144,116,76
s_add_u32 s69, s69, s51
MA 148,116,80
s_cmp_lt_u32 s49, 27
s_cselect_b32 s6, s50, 0
MA 152,116,84
s_cmp_lt_u32 s49, 28
s_cselect_b32 s10, s70, 0
MA 156,116,88
s_waitcnt vmcnt(20) lgkmcnt(0)
s_barrier
s_cmp_lt_u32 s49, 30
s_cbranch_scc1 k1_mlp_w1_loop
MV 0,32,0
TR 92,209,47104
MV 4,32,4
MV 8,32,8
TR 94,209,47616
s_mov_b32 m0, 131072
MV 12,32,12
buffer_load_dwordx4 v192, s[8:11], s69 offen lds
MV 16,32,16
RB 60,205,0
MV 20,32,20
MV 24,32,24
RB 64,205,2048
s_mov_b32 m0, 132096
MV 28,32,28
buffer_load_dwordx4 v193, s[8:11], s69 offen lds
MV 32,36,0
RB 68,205,4096
MV 36,36,4
MA 160,32,120
RB 72,205,6144
MV 40,36,8
s_mov_b32 m0, 133120
MV 44,36,12
RB 76,205,8192
buffer_load_dwordx4 v194, s[8:11], s69 offen lds
MV 48,36,16
MV 52,36,20
RB 80,205,10240
MV 56,36,24
s_mov_b32 m0, 134144
MV 60,36,28
RB 84,205,12288
buffer_load_dwordx4 v195, s[8:11], s69 offen lds
MV 64,40,0
MV 68,40,4
RB 88,205,14336
MV 72,40,8
MV 76,40,12
TR 96,204,51200
s_mov_b32 m0, 140288
MV 80,40,16
buffer_load_dwordx4 v196, s[8:11], s69 offen lds
MA 164,36,120
MV 84,40,20
TR 98,204,51712
MV 88,40,24
s_add_u32 m0, s47, 21504
MV 92,40,28
TR 100,207,51200
DL 197,64
MV 96,44,0
MV 100,44,4
TR 102,207,51712
MV 104,44,8
MV 108,44,12
TR 104,208,51200
s_add_u32 m0, s47, 22528
MV 112,44,16
DL 198,64
MV 116,44,20
TR 106,208,51712
MV 120,44,24
MV 124,44,28
TR 108,209,51200
s_add_u32 m0, s47, 23552
MA 168,40,120
DL 199,64
MV 128,48,0
TR 110,209,51712
MV 132,48,4
MV 136,48,8
TR 112,240,43008
MV 140,48,12
s_add_u32 m0, s47, 24576
MV 144,48,16
TR 114,240,43264
DL 200,64
MV 148,48,20
MV 152,48,24
TR 116,241,43008
MV 156,48,28
s_add_u32 m0, s47, 25600
MV 160,52,0
TR 118,241,43264
DL 201,64
MV 164,52,4
MV 168,52,8
MA 172,44,120
MV 172,52,12
MV 176,52,16
MV 180,52,20
s_mov_b32 s47, s46
MV 184,52,24
s_add_u32 s46, s46, 32768
MV 188,52,28
s_cmp_eq_u32 s46, 98304
s_cselect_b32 s46, 0, s46
MA 128,56,0
v_add_u32 v205, s46, v202
MA 132,56,4
s_add_u32 s49, s49, 1
MA 136,56,8
s_add_u32 s69, s69, s51
MA 140,56,12
s_add_u32 s48, s48, 128
MA 144,56,16
s_add_u32 s64, s64, 128
MA 148,56,20
s_cmp_lt_u32 s49, 27
s_cselect_b32 s6, s50, 0
MA 152,56,24
s_cmp_lt_u32 s49, 28
s_cselect_b32 s10, s70, 0
MA 156,56,28
s_waitcnt vmcnt(20) lgkmcnt(0)
s_barrier
s_add_u32 s12, s40, 20971520
s_addc_u32 s13, s41, 0
s_and_b32 s13, s13, 0xffff
s_mov_b32 s14, 16384
s_mov_b32 s15, 0x20000
v_and_b32 v210, 15, v206
s_lshl_b32 s55, s44, 8
s_add_u32 s55, s55, 0
v_add_u32 v210, s55, v210
v_lshlrev_b32 v210, 3, v210
buffer_load_dwordx2 a[176:177], v210, s[12:15], 0 offen offset:0 sc1
buffer_load_dwordx2 a[178:179], v210, s[12:15], 0 offen offset:128 sc1
buffer_load_dwordx2 a[180:181], v210, s[12:15], 0 offen offset:256 sc1
buffer_load_dwordx2 a[182:183], v210, s[12:15], 0 offen offset:384 sc1
buffer_load_dwordx2 a[184:185], v210, s[12:15], 0 offen offset:512 sc1
buffer_load_dwordx2 a[186:187], v210, s[12:15], 0 offen offset:640 sc1
buffer_load_dwordx2 a[188:189], v210, s[12:15], 0 offen offset:768 sc1
buffer_load_dwordx2 a[190:191], v210, s[12:15], 0 offen offset:896 sc1
s_mov_b32 s12, s28
s_and_b32 s13, s29, 0xffff
s_mov_b32 s14, 7168
s_mov_b32 s15, 0x20000
v_lshrrev_b32 v211, 4, v206
v_lshlrev_b32 v212, 3, v211
s_mul_i32 s55, s45, 448
s_add_u32 s56, s55, s67
s_add_u32 s55, s55, s66
buffer_load_dwordx2 a[192:193], v212, s[12:15], s55 offen offset:224
buffer_load_dwordx2 a[194:195], v212, s[12:15], s55 offen offset:256
buffer_load_dwordx2 a[196:197], v212, s[12:15], s55 offen offset:288
buffer_load_dwordx2 a[198:199], v212, s[12:15], s55 offen offset:320
buffer_load_dwordx2 a[200:201], v212, s[12:15], s55 offen offset:352
buffer_load_dwordx2 a[202:203], v212, s[12:15], s56 offen offset:0
buffer_load_dwordx2 a[204:205], v212, s[12:15], s56 offen offset:32
MV 0,92,60
MV 4,92,64
MV 8,92,68
MV 12,92,72
MV 16,92,76
MV 20,92,80
MV 24,92,84
MV 28,92,88
MV 32,96,60
MV 36,96,64
MA 160,92,120
MV 40,96,68
MV 44,96,72
MV 48,96,76
MV 52,96,80
MV 56,96,84
MV 60,96,88
MV 64,100,60
MV 68,100,64
MV 72,100,68
MV 76,100,72
MV 80,100,76
MA 164,96,120
MV 84,100,80
MV 88,100,84
MV 92,100,88
MV 96,104,60
MV 100,104,64
MV 104,104,68
MV 108,104,72
MV 112,104,76
MV 116,104,80
MV 120,104,84
MV 124,104,88
MA 168,100,120
MV 128,108,60
MV 132,108,64
MV 136,108,68
MV 140,108,72
MV 144,108,76
MV 148,108,80
MV 152,108,84
MV 156,108,88
MV 160,112,60
MV 164,112,64
MV 168,112,68
MA 172,104,120
MV 172,112,72
MV 176,112,76
MV 180,112,80
MV 184,112,84
MV 188,112,88
MA 128,116,60
MA 132,116,64
MA 136,116,68
MA 140,116,72
MA 144,116,76
MA 148,116,80
MA 152,116,84
MA 156,116,88
v_lshrrev_b32 v210, 4, v206
v_lshlrev_b32 v210, 4, v210
v_add_u32 v210, 156096, v210
s_mov_b32 exec_lo, 0x00010001
s_mov_b32 exec_hi, 0x00010001
ds_write_b128 v210, a[160:163] offset:0
ds_write_b128 v210, a[164:167] offset:64
ds_write_b128 v210, a[168:171] offset:128
ds_write_b128 v210, a[172:175] offset:192
s_mov_b64 exec, -1
s_waitcnt lgkmcnt(0)
s_barrier
RB 208,210,0
RB 212,210,64
RB 216,210,128
RB 220,210,192
RB 224,210,256
RB 228,210,320
RB 232,210,384
s_waitcnt vmcnt(0) lgkmcnt(0)
s_branch k1_mlp_epi1
k1_mlp_w2:
s_mov_b32 s52, 1
s_mov_b32 s53, 0
s_and_b32 s65, s45, 1
s_lshl_b32 s66, s65, 6
s_cmp_eq_u32 s65, 0
s_cselect_b32 s67, 384, 0
v_lshrrev_b32 v210, 3, v206
v_lshrrev_b32 v211, 4, v206
v_and_b32 v212, 7, v206
v_add_u32 v213, 0, v211
v_xor_b32 v213, v213, v212
v_lshlrev_b32 v213, 4, v213
v_lshl_add_u32 v213, v210, 11, v213
v_add_u32 v196, 163840, v213
v_add_u32 v198, 196608, v213
v_add_u32 v200, 229376, v213
v_add_u32 v213, 4, v211
v_xor_b32 v213, v213, v212
v_lshlrev_b32 v213, 4, v213
v_lshl_add_u32 v213, v210, 11, v213
v_add_u32 v197, 180224, v213
v_add_u32 v199, 212992, v213
v_add_u32 v201, 245760, v213
s_mov_b32 s3, 7168
v_mul_lo_u32 v214, v210, s3
v_and_b32 v215, 1, v211
v_or_b32 v213, 0, v215
v_lshlrev_b32 v213, 1, v213
v_xor_b32 v213, v213, v212
v_lshl_add_u32 v213, v213, 4, v214
v_add_u32 v213, s66, v213
v_add_u32 v192, 256, v213
v_add_u32 v194, 114944, v213
v_or_b32 v213, 2, v215
v_lshlrev_b32 v213, 1, v213
v_xor_b32 v213, v213, v212
v_lshl_add_u32 v213, v213, 4, v214
v_add_u32 v213, s66, v213
v_add_u32 v193, 57600, v213
v_add_u32 v195, 172288, v213
s_waitcnt lgkmcnt(0)
s_lshr_b32 s74, s2, 3
s_lshl_b32 s74, s74, 2
s_add_u32 s74, s74, s42
s_and_b32 s75, s2, 1
s_lshl_b32 s75, s75, 2
s_bfe_u32 s76, s2, 0x20001
s_lshl_b32 s76, s76, 2
s_cmp_lt_u32 s74, 48
s_cbranch_scc0 k1_mlp_w2_k1_st_w
s_mul_i32 s3, s74, 43691
s_lshr_b32 s3, s3, 19
s_mul_i32 s77, s3, 12
s_sub_u32 s77, s74, s77
s_add_u32 s3, s3, s75
s_lshl_b32 s3, s3, 19
s_and_b32 s75, s77, 3
s_lshl_b32 s75, s75, 17
s_add_u32 s3, s3, s75
s_lshr_b32 s77, s77, 2
s_cmp_ge_u32 s77, 1
s_cbranch_scc1 k1_mlp_w2_k1_st_done
s_lshl_b32 s77, s77, 7
s_add_u32 s3, s3, s77
v_lshlrev_b32 v255, 11, v206
v_add_u32 v255, s3, v255
s_mov_b32 s72, s16
s_and_b32 s73, s17, 0xffff
s_mov_b32 s74, 4194304
s_mov_b32 s75, 0x20000
s_branch k1_mlp_w2_k1_st_go
k1_mlp_w2_k1_st_w:
s_cmp_lt_u32 s74, 88
s_cselect_b32 s77, 48, 88
s_cselect_b32 s75, 1, 0
s_sub_u32 s74, s74, s77
s_mul_i32 s3, s74, 52429
s_lshr_b32 s3, s3, 19
s_mul_i32 s77, s3, 10
s_sub_u32 s77, s74, s77
s_cmp_ge_u32 s77, 4
s_cbranch_scc1 k1_mlp_w2_k1_st_done
s_add_u32 s76, s76, s3
s_lshl_b32 s77, s77, 4
v_lshrrev_b32 v255, 2, v206
v_add_u32 v255, s77, v255
v_and_b32 v254, 3, v206
s_cmp_eq_u32 s75, 1
s_cbranch_scc0 k1_mlp_w2_k1_st_q
s_mul_i32 s3, s76, 448
s_and_b32 s3, s3, 0xffffff80
s_mov_b32 s77, 7168
v_mul_lo_u32 v255, v255, s77
v_lshl_add_u32 v255, v254, 7, v255
v_add_u32 v255, s3, v255
s_mov_b32 s72, s26
s_and_b32 s73, s27, 0xffff
s_mov_b32 s74, 7340032
s_mov_b32 s75, 0x20000
s_branch k1_mlp_w2_k1_st_go
k1_mlp_w2_k1_st_q:
s_lshl_b32 s3, s76, 7
s_mov_b32 s77, 6144
v_mul_lo_u32 v255, v255, s77
v_min_u32 v254, 2, v254
v_lshl_add_u32 v255, v254, 11, v255
v_add_u32 v255, s3, v255
s_mov_b32 s72, s18
s_and_b32 s73, s19, 0xffff
s_mov_b32 s74, 6291456
s_mov_b32 s75, 0x20000
k1_mlp_w2_k1_st_go:
buffer_load_dword v254, v255, s[72:75], 0 offen
k1_mlp_w2_k1_st_done:
s_lshl_b32 s3, s44, 19
s_add_u32 s4, s16, s3
s_addc_u32 s5, s17, 0
s_and_b32 s5, s5, 0xffff
s_mov_b32 s50, 524288
s_mov_b32 s6, s50
s_mov_b32 s7, 0x20000
s_mul_i32 s3, s45, 448
s_add_u32 s8, s26, s3
s_addc_u32 s9, s27, 0
s_and_b32 s9, s9, 0xffff
s_sub_u32 s70, 7340032, s3
s_mov_b32 s10, s70
s_mov_b32 s11, 0x20000
s_mov_b32 s51, 229376
s_mov_b32 s48, 0
s_mov_b32 s64, 262144
s_mov_b32 s69, 0
s_mov_b32 m0, 106496
s_nop 0
buffer_load_dwordx4 v192, s[8:11], s69 offen lds
s_mov_b32 m0, 107520
s_nop 0
buffer_load_dwordx4 v193, s[8:11], s69 offen lds
s_mov_b32 m0, 108544
s_nop 0
buffer_load_dwordx4 v194, s[8:11], s69 offen lds
s_mov_b32 m0, 109568
s_nop 0
buffer_load_dwordx4 v195, s[8:11], s69 offen lds
s_add_u32 s69, s69, s51
s_mov_b32 m0, 10240
s_nop 0
DL 196,48
s_mov_b32 m0, 11264
s_nop 0
DL 197,48
s_mov_b32 m0, 12288
s_nop 0
DL 198,48
s_mov_b32 m0, 13312
s_nop 0
DL 199,48
s_mov_b32 m0, 14336
s_nop 0
DL 200,48
s_mov_b32 m0, 15360
s_nop 0
DL 201,48
s_mov_b32 m0, 26624
s_nop 0
DL 196,64
s_mov_b32 m0, 27648
s_nop 0
DL 197,64
s_mov_b32 m0, 28672
s_nop 0
DL 198,64
s_mov_b32 m0, 29696
s_nop 0
DL 199,64
s_mov_b32 m0, 30720
s_nop 0
DL 200,64
s_mov_b32 m0, 31744
s_nop 0
DL 201,64
s_add_u32 s48, s48, 128
s_add_u32 s64, s64, 128
s_mov_b32 m0, 120832
s_nop 0
buffer_load_dwordx4 v192, s[8:11], s69 offen lds
s_mov_b32 m0, 121856
s_nop 0
buffer_load_dwordx4 v193, s[8:11], s69 offen lds
s_mov_b32 m0, 122880
s_nop 0
buffer_load_dwordx4 v194, s[8:11], s69 offen lds
s_mov_b32 m0, 123904
s_nop 0
buffer_load_dwordx4 v195, s[8:11], s69 offen lds
s_add_u32 s69, s69, s51
v_mov_b32 v210, 0x3f803f80
v_accvgpr_write_b32 a120, v210
v_mov_b32 v210, 0x3f803f80
v_accvgpr_write_b32 a121, v210
v_mov_b32 v210, 0x3f803f80
v_accvgpr_write_b32 a122, v210
v_mov_b32 v210, 0x3f803f80
v_accvgpr_write_b32 a123, v210
v_and_b32 v210, 15, v206
v_lshrrev_b32 v213, 4, v206
v_lshrrev_b32 v211, 1, v210
v_add_u32 v212, 0, v213
v_xor_b32 v212, v212, v211
v_lshlrev_b32 v212, 4, v212
v_lshl_add_u32 v212, v210, 7, v212
v_add_u32 v202, 16384, v212
v_add_u32 v212, 4, v213
v_xor_b32 v212, v212, v211
v_lshlrev_b32 v212, 4, v212
v_lshl_add_u32 v212, v210, 7, v212
v_add_u32 v203, 16384, v212
v_bfe_u32 v211, v206, 2, 2
v_lshl_add_u32 v214, v213, 3, v211
v_and_b32 v215, 3, v206
v_lshlrev_b32 v215, 3, v215
v_lshrrev_b32 v216, 1, v211
v_and_b32 v217, 1, v213
v_lshl_or_b32 v216, v217, 1, v216
v_lshl_add_u32 v218, v214, 7, v215
v_add_u32 v218, 98304, v218
v_xor_b32 v219, 0, v216
v_lshl_add_u32 v204, v219, 5, v218
v_xor_b32 v219, 1, v216
v_lshl_add_u32 v207, v219, 5, v218
v_xor_b32 v219, 2, v216
v_lshl_add_u32 v208, v219, 5, v218
v_xor_b32 v219, 3, v216
v_lshl_add_u32 v209, v219, 5, v218
v_mov_b32 v205, v202
s_waitcnt vmcnt(0) lgkmcnt(0)
s_barrier
TR 32,204,0
TR 34,204,512
RB 0,205,0
RB 4,205,2048
RB 8,205,4096
RB 12,205,6144
RB 16,205,8192
RB 20,205,10240
RB 24,205,12288
RB 28,205,14336
TR 36,207,0
TR 38,207,512
TR 40,208,0
TR 42,208,512
TR 44,209,0
TR 46,209,512
TR 48,204,4096
TR 50,204,4608
TR 52,207,4096
TR 54,207,4608
TR 56,208,4096
TR 58,208,4608
s_mov_b32 s46, 0
s_mov_b32 s47, 65536
s_mov_b32 s49, 0
v_mov_b32 v205, v203
s_waitcnt lgkmcnt(0)
s_barrier
MVZ 0,32,0
TR 92,204,14336
s_mov_b32 m0, 43008
MVZ 4,32,4
DL 196,48
MVZ 8,32,8
TR 94,204,14848
s_mov_b32 m0, 44032
MVZ 12,32,12
DL 197,48
MVZ 16,32,16
RB 60,205,0
s_mov_b32 m0, 45056
MVZ 20,32,20
DL 198,48
MVZ 24,32,24
RB 64,205,2048
s_mov_b32 m0, 46080
MVZ 28,32,28
DL 199,48
MVZ 32,36,0
RB 68,205,4096
MVZ 36,36,4
s_mov_b32 m0, 47104
v_mfma_f32_16x16x32_bf16 a[160:163], a[48:51], a[120:123], 0
RB 72,205,6144
DL 200,48
MVZ 40,36,8
s_mov_b32 m0, 48128
MVZ 44,36,12
RB 76,205,8192
DL 201,48
MVZ 48,36,16
s_mov_b32 m0, 59392
MVZ 52,36,20
RB 80,205,10240
DL 196,64
MVZ 56,36,24
MVZ 60,36,28
RB 84,205,12288
s_mov_b32 m0, 60416
MVZ 64,40,0
DL 197,64
MVZ 68,40,4
RB 88,205,14336
s_mov_b32 m0, 61440
MVZ 72,40,8
DL 198,64
MVZ 76,40,12
TR 96,207,14336
s_mov_b32 m0, 62464
MVZ 80,40,16
DL 199,64
v_mfma_f32_16x16x32_bf16 a[164:167], a[52:55], a[120:123], 0
TR 98,207,14848
MVZ 84,40,20
s_mov_b32 m0, 63488
MVZ 88,40,24
TR 100,208,14336
DL 200,64
MVZ 92,40,28
s_mov_b32 m0, 64512
MVZ 96,44,0
TR 102,208,14848
DL 201,64
MVZ 100,44,4
s_mov_b32 m0, 135168
MVZ 104,44,8
TR 104,209,14336
buffer_load_dwordx4 v192, s[8:11], s69 offen lds
MVZ 108,44,12
s_mov_b32 m0, 136192
MVZ 112,44,16
TR 106,209,14848
buffer_load_dwordx4 v193, s[8:11], s69 offen lds
MVZ 116,44,20
MVZ 120,44,24
TR 108,204,18432
s_mov_b32 m0, 137216
MVZ 124,44,28
buffer_load_dwordx4 v194, s[8:11], s69 offen lds
v_mfma_f32_16x16x32_bf16 a[168:171], a[56:59], a[120:123], 0
TR 110,204,18944
s_mov_b32 m0, 138240
MVZ 128,48,0
buffer_load_dwordx4 v195, s[8:11], s69 offen lds
s_add_u32 s69, s69, s51
MVZ 132,48,4
TR 112,207,18432
s_mov_b32 m0, 149504
MVZ 136,48,8
buffer_load_dwordx4 v192, s[8:11], s69 offen lds
MVZ 140,48,12
TR 114,207,18944
MVZ 144,48,16
s_mov_b32 m0, 150528
MVZ 148,48,20
TR 116,208,18432
buffer_load_dwordx4 v193, s[8:11], s69 offen lds
MVZ 152,48,24
s_mov_b32 m0, 151552
MVZ 156,48,28
TR 118,208,18944
buffer_load_dwordx4 v194, s[8:11], s69 offen lds
MVZ 160,52,0
s_mov_b32 m0, 152576
MVZ 164,52,4
buffer_load_dwordx4 v195, s[8:11], s69 offen lds
MVZ 168,52,8
MVZ 172,52,12
MVZ 176,52,16
MVZ 180,52,20
s_mov_b32 s47, s46
MVZ 184,52,24
s_add_u32 s46, s46, 32768
MVZ 188,52,28
s_cmp_eq_u32 s46, 98304
s_cselect_b32 s46, 0, s46
v_mfma_f32_16x16x32_bf16 a[128:131], a[56:59], a[0:3], 0
v_add_u32 v205, s46, v202
v_mfma_f32_16x16x32_bf16 a[132:135], a[56:59], a[4:7], 0
s_add_u32 s49, s49, 1
v_mfma_f32_16x16x32_bf16 a[136:139], a[56:59], a[8:11], 0
s_add_u32 s69, s69, s51
v_mfma_f32_16x16x32_bf16 a[140:143], a[56:59], a[12:15], 0
s_add_u32 s48, s48, 128
v_mfma_f32_16x16x32_bf16 a[144:147], a[56:59], a[16:19], 0
s_add_u32 s64, s64, 128
v_mfma_f32_16x16x32_bf16 a[148:151], a[56:59], a[20:23], 0
s_cmp_lt_u32 s49, 27
s_cselect_b32 s6, s50, 0
v_mfma_f32_16x16x32_bf16 a[152:155], a[56:59], a[24:27], 0
s_cmp_lt_u32 s49, 28
s_cselect_b32 s10, s70, 0
v_mfma_f32_16x16x32_bf16 a[156:159], a[56:59], a[28:31], 0
s_waitcnt vmcnt(4) lgkmcnt(0)
s_barrier
MV 0,92,60
TR 32,204,28672
s_mov_b32 m0, 106496
MV 4,92,64
buffer_load_dwordx4 v192, s[8:11], s69 offen lds
s_mov_b32 m0, 107520
MV 8,92,68
TR 34,204,29184
buffer_load_dwordx4 v193, s[8:11], s69 offen lds
MV 12,92,72
s_mov_b32 m0, 108544
MV 16,92,76
RB 0,205,0
buffer_load_dwordx4 v194, s[8:11], s69 offen lds
MV 20,92,80
s_mov_b32 m0, 109568
MV 24,92,84
RB 4,205,2048
buffer_load_dwordx4 v195, s[8:11], s69 offen lds
s_add_u32 s69, s69, s51
MV 28,92,88
s_mov_b32 m0, 75776
MV 32,96,60
RB 8,205,4096
DL 196,48
s_mov_b32 m0, 76800
MV 36,96,64
DL 197,48
MA 160,108,120
RB 12,205,6144
s_mov_b32 m0, 77824
MV 40,96,68
DL 198,48
MV 44,96,72
RB 16,205,8192
s_mov_b32 m0, 78848
MV 48,96,76
DL 199,48
MV 52,96,80
RB 20,205,10240
s_mov_b32 m0, 79872
MV 56,96,84
DL 200,48
s_mov_b32 m0, 80896
MV 60,96,88
RB 24,205,12288
DL 201,48
MV 64,100,60
s_mov_b32 m0, 92160
MV 68,100,64
RB 28,205,14336
DL 196,64
MV 72,100,68
s_mov_b32 m0, 93184
MV 76,100,72
TR 36,207,28672
DL 197,64
MV 80,100,76
s_mov_b32 m0, 94208
MA 164,112,120
TR 38,207,29184
DL 198,64
MV 84,100,80
s_mov_b32 m0, 95232
MV 88,100,84
TR 40,208,28672
DL 199,64
s_mov_b32 m0, 96256
MV 92,100,88
DL 200,64
MV 96,104,60
TR 42,208,29184
s_mov_b32 m0, 97280
MV 100,104,64
DL 201,64
s_add_u32 s48, s48, 128
s_add_u32 s64, s64, 128
MV 104,104,68
TR 44,209,28672
s_mov_b32 m0, 120832
MV 108,104,72
buffer_load_dwordx4 v192, s[8:11], s69 offen lds
MV 112,104,76
TR 46,209,29184
s_mov_b32 m0, 121856
MV 116,104,80
buffer_load_dwordx4 v193, s[8:11], s69 offen lds
s_mov_b32 m0, 122880
MV 120,104,84
TR 48,204,32768
buffer_load_dwordx4 v194, s[8:11], s69 offen lds
MV 124,104,88
s_mov_b32 m0, 123904
MA 168,116,120
TR 50,204,33280
buffer_load_dwordx4 v195, s[8:11], s69 offen lds
MV 128,108,60
s_mov_b32 m0, 10240
MV 132,108,64
TR 52,207,32768
DL 196,48
MV 136,108,68
s_mov_b32 m0, 11264
MV 140,108,72
TR 54,207,33280
DL 197,48
s_mov_b32 m0, 12288
MV 144,108,76
DL 198,48
MV 148,108,80
TR 56,208,32768
s_mov_b32 m0, 13312
MV 152,108,84
DL 199,48
MV 156,108,88
TR 58,208,33280
s_mov_b32 m0, 14336
MV 160,112,60
DL 200,48
MV 164,112,64
s_mov_b32 m0, 15360
MV 168,112,68
DL 201,48
MV 172,112,72
MV 176,112,76
MV 180,112,80
MV 184,112,84
MV 188,112,88
MA 128,116,60
MA 132,116,64
MA 136,116,68
v_add_u32 v205, s46, v203
MA 140,116,72
s_add_u32 s49, s49, 1
MA 144,116,76
s_add_u32 s69, s69, s51
MA 148,116,80
s_cmp_lt_u32 s49, 27
s_cselect_b32 s6, s50, 0
MA 152,116,84
s_cmp_lt_u32 s49, 28
s_cselect_b32 s10, s70, 0
MA 156,116,88
s_waitcnt vmcnt(26) lgkmcnt(0)
s_barrier
k1_mlp_w2_loop:
MV 0,32,0
TR 92,204,43008
MV 4,32,4
MV 8,32,8
TR 94,204,43520
MV 12,32,12
MV 16,32,16
RB 60,205,0
s_mov_b32 m0, 135168
MV 20,32,20
buffer_load_dwordx4 v192, s[8:11], s69 offen lds
MV 24,32,24
RB 64,205,2048
MV 28,32,28
MV 32,36,0
RB 68,205,4096
s_mov_b32 m0, 136192
MV 36,36,4
buffer_load_dwordx4 v193, s[8:11], s69 offen lds
MA 160,48,120
RB 72,205,6144
MV 40,36,8
MV 44,36,12
RB 76,205,8192
s_mov_b32 m0, 137216
MV 48,36,16
buffer_load_dwordx4 v194, s[8:11], s69 offen lds
MV 52,36,20
RB 80,205,10240
MV 56,36,24
MV 60,36,28
RB 84,205,12288
s_mov_b32 m0, 138240
MV 64,40,0
buffer_load_dwordx4 v195, s[8:11], s69 offen lds
MV 68,40,4
RB 88,205,14336
MV 72,40,8
MV 76,40,12
TR 96,207,43008
s_add_u32 m0, s47, 26624
MV 80,40,16
DL 196,64
MA 164,52,120
TR 98,207,43520
MV 84,40,20
MV 88,40,24
TR 100,208,43008
MV 92,40,28
s_add_u32 m0, s47, 27648
MV 96,44,0
TR 102,208,43520
DL 197,64
MV 100,44,4
MV 104,44,8
TR 104,209,43008
MV 108,44,12
s_add_u32 m0, s47, 28672
MV 112,44,16
TR 106,209,43520
DL 198,64
MV 116,44,20
MV 120,44,24
TR 108,204,47104
MV 124,44,28
s_add_u32 m0, s47, 29696
MA 168,56,120
TR 110,204,47616
DL 199,64
MV 128,48,0
MV 132,48,4
TR 112,207,47104
MV 136,48,8
s_add_u32 m0, s47, 30720
MV 140,48,12
TR 114,207,47616
DL 200,64
MV 144,48,16
MV 148,48,20
TR 116,208,47104
MV 152,48,24
s_add_u32 m0, s47, 31744
MV 156,48,28
TR 118,208,47616
DL 201,64
MV 160,52,0
MV 164,52,4
MV 168,52,8
MV 172,52,12
MV 176,52,16
MV 180,52,20
s_mov_b32 s47, s46
MV 184,52,24
s_add_u32 s46, s46, 32768
MV 188,52,28
s_cmp_eq_u32 s46, 98304
s_cselect_b32 s46, 0, s46
MA 128,56,0
v_add_u32 v205, s46, v202
MA 132,56,4
s_add_u32 s49, s49, 1
MA 136,56,8
s_add_u32 s69, s69, s51
MA 140,56,12
s_add_u32 s48, s48, 128
MA 144,56,16
s_add_u32 s64, s64, 128
MA 148,56,20
s_cmp_lt_u32 s49, 27
s_cselect_b32 s6, s50, 0
MA 152,56,24
s_cmp_lt_u32 s49, 28
s_cselect_b32 s10, s70, 0
MA 156,56,28
s_waitcnt vmcnt(20) lgkmcnt(0)
s_barrier
MV 0,92,60
TR 32,204,0
MV 4,92,64
MV 8,92,68
TR 34,204,512
MV 12,92,72
MV 16,92,76
RB 0,205,0
s_mov_b32 m0, 149504
MV 20,92,80
buffer_load_dwordx4 v192, s[8:11], s69 offen lds
MV 24,92,84
RB 4,205,2048
MV 28,92,88
MV 32,96,60
RB 8,205,4096
s_mov_b32 m0, 150528
MV 36,96,64
buffer_load_dwordx4 v193, s[8:11], s69 offen lds
MA 160,108,120
RB 12,205,6144
MV 40,96,68
MV 44,96,72
RB 16,205,8192
s_mov_b32 m0, 151552
MV 48,96,76
buffer_load_dwordx4 v194, s[8:11], s69 offen lds
MV 52,96,80
RB 20,205,10240
MV 56,96,84
MV 60,96,88
RB 24,205,12288
s_mov_b32 m0, 152576
MV 64,100,60
buffer_load_dwordx4 v195, s[8:11], s69 offen lds
MV 68,100,64
RB 28,205,14336
MV 72,100,68
MV 76,100,72
TR 36,207,0
s_add_u32 m0, s47, 10240
MV 80,100,76
DL 196,48
MA 164,112,120
TR 38,207,512
MV 84,100,80
MV 88,100,84
TR 40,208,0
MV 92,100,88
s_add_u32 m0, s47, 11264
MV 96,104,60
TR 42,208,512
DL 197,48
MV 100,104,64
MV 104,104,68
TR 44,209,0
MV 108,104,72
s_add_u32 m0, s47, 12288
MV 112,104,76
TR 46,209,512
DL 198,48
MV 116,104,80
MV 120,104,84
TR 48,204,4096
MV 124,104,88
s_add_u32 m0, s47, 13312
MA 168,116,120
TR 50,204,4608
DL 199,48
MV 128,108,60
MV 132,108,64
TR 52,207,4096
MV 136,108,68
s_add_u32 m0, s47, 14336
MV 140,108,72
TR 54,207,4608
DL 200,48
MV 144,108,76
MV 148,108,80
TR 56,208,4096
MV 152,108,84
s_add_u32 m0, s47, 15360
MV 156,108,88
TR 58,208,4608
DL 201,48
MV 160,112,60
MV 164,112,64
MV 168,112,68
MV 172,112,72
MV 176,112,76
MV 180,112,80
MV 184,112,84
MV 188,112,88
MA 128,116,60
MA 132,116,64
MA 136,116,68
v_add_u32 v205, s46, v203
MA 140,116,72
s_add_u32 s49, s49, 1
MA 144,116,76
s_add_u32 s69, s69, s51
MA 148,116,80
s_cmp_lt_u32 s49, 27
s_cselect_b32 s6, s50, 0
MA 152,116,84
s_cmp_lt_u32 s49, 28
s_cselect_b32 s10, s70, 0
MA 156,116,88
s_waitcnt vmcnt(20) lgkmcnt(0)
s_barrier
MV 0,32,0
TR 92,204,14336
MV 4,32,4
MV 8,32,8
TR 94,204,14848
MV 12,32,12
MV 16,32,16
RB 60,205,0
s_mov_b32 m0, 106496
MV 20,32,20
buffer_load_dwordx4 v192, s[8:11], s69 offen lds
MV 24,32,24
RB 64,205,2048
MV 28,32,28
MV 32,36,0
RB 68,205,4096
s_mov_b32 m0, 107520
MV 36,36,4
buffer_load_dwordx4 v193, s[8:11], s69 offen lds
MA 160,48,120
RB 72,205,6144
MV 40,36,8
MV 44,36,12
RB 76,205,8192
s_mov_b32 m0, 108544
MV 48,36,16
buffer_load_dwordx4 v194, s[8:11], s69 offen lds
MV 52,36,20
RB 80,205,10240
MV 56,36,24
MV 60,36,28
RB 84,205,12288
s_mov_b32 m0, 109568
MV 64,40,0
buffer_load_dwordx4 v195, s[8:11], s69 offen lds
MV 68,40,4
RB 88,205,14336
MV 72,40,8
MV 76,40,12
TR 96,207,14336
s_add_u32 m0, s47, 26624
MV 80,40,16
DL 196,64
MA 164,52,120
TR 98,207,14848
MV 84,40,20
MV 88,40,24
TR 100,208,14336
MV 92,40,28
s_add_u32 m0, s47, 27648
MV 96,44,0
TR 102,208,14848
DL 197,64
MV 100,44,4
MV 104,44,8
TR 104,209,14336
MV 108,44,12
s_add_u32 m0, s47, 28672
MV 112,44,16
TR 106,209,14848
DL 198,64
MV 116,44,20
MV 120,44,24
TR 108,204,18432
MV 124,44,28
s_add_u32 m0, s47, 29696
MA 168,56,120
TR 110,204,18944
DL 199,64
MV 128,48,0
MV 132,48,4
TR 112,207,18432
MV 136,48,8
s_add_u32 m0, s47, 30720
MV 140,48,12
TR 114,207,18944
DL 200,64
MV 144,48,16
MV 148,48,20
TR 116,208,18432
MV 152,48,24
s_add_u32 m0, s47, 31744
MV 156,48,28
TR 118,208,18944
DL 201,64
MV 160,52,0
MV 164,52,4
MV 168,52,8
MV 172,52,12
MV 176,52,16
MV 180,52,20
s_mov_b32 s47, s46
MV 184,52,24
s_add_u32 s46, s46, 32768
MV 188,52,28
s_cmp_eq_u32 s46, 98304
s_cselect_b32 s46, 0, s46
MA 128,56,0
v_add_u32 v205, s46, v202
MA 132,56,4
s_add_u32 s49, s49, 1
MA 136,56,8
s_add_u32 s69, s69, s51
MA 140,56,12
s_add_u32 s48, s48, 128
MA 144,56,16
s_add_u32 s64, s64, 128
MA 148,56,20
s_cmp_lt_u32 s49, 27
s_cselect_b32 s6, s50, 0
MA 152,56,24
s_cmp_lt_u32 s49, 28
s_cselect_b32 s10, s70, 0
MA 156,56,28
s_waitcnt vmcnt(20) lgkmcnt(0)
s_barrier
MV 0,92,60
TR 32,204,28672
MV 4,92,64
MV 8,92,68
TR 34,204,29184
MV 12,92,72
MV 16,92,76
RB 0,205,0
s_mov_b32 m0, 120832
MV 20,92,80
buffer_load_dwordx4 v192, s[8:11], s69 offen lds
MV 24,92,84
RB 4,205,2048
MV 28,92,88
MV 32,96,60
RB 8,205,4096
s_mov_b32 m0, 121856
MV 36,96,64
buffer_load_dwordx4 v193, s[8:11], s69 offen lds
MA 160,108,120
RB 12,205,6144
MV 40,96,68
MV 44,96,72
RB 16,205,8192
s_mov_b32 m0, 122880
MV 48,96,76
buffer_load_dwordx4 v194, s[8:11], s69 offen lds
MV 52,96,80
RB 20,205,10240
MV 56,96,84
MV 60,96,88
RB 24,205,12288
s_mov_b32 m0, 123904
MV 64,100,60
buffer_load_dwordx4 v195, s[8:11], s69 offen lds
MV 68,100,64
RB 28,205,14336
MV 72,100,68
MV 76,100,72
TR 36,207,28672
s_add_u32 m0, s47, 10240
MV 80,100,76
DL 196,48
MA 164,112,120
TR 38,207,29184
MV 84,100,80
MV 88,100,84
TR 40,208,28672
MV 92,100,88
s_add_u32 m0, s47, 11264
MV 96,104,60
TR 42,208,29184
DL 197,48
MV 100,104,64
MV 104,104,68
TR 44,209,28672
MV 108,104,72
s_add_u32 m0, s47, 12288
MV 112,104,76
TR 46,209,29184
DL 198,48
MV 116,104,80
MV 120,104,84
TR 48,204,32768
MV 124,104,88
s_add_u32 m0, s47, 13312
MA 168,116,120
TR 50,204,33280
DL 199,48
MV 128,108,60
MV 132,108,64
TR 52,207,32768
MV 136,108,68
s_add_u32 m0, s47, 14336
MV 140,108,72
TR 54,207,33280
DL 200,48
MV 144,108,76
MV 148,108,80
TR 56,208,32768
MV 152,108,84
s_add_u32 m0, s47, 15360
MV 156,108,88
TR 58,208,33280
DL 201,48
MV 160,112,60
MV 164,112,64
MV 168,112,68
MV 172,112,72
MV 176,112,76
MV 180,112,80
MV 184,112,84
MV 188,112,88
MA 128,116,60
MA 132,116,64
MA 136,116,68
v_add_u32 v205, s46, v203
MA 140,116,72
s_add_u32 s49, s49, 1
MA 144,116,76
s_add_u32 s69, s69, s51
MA 148,116,80
s_cmp_lt_u32 s49, 27
s_cselect_b32 s6, s50, 0
MA 152,116,84
s_cmp_lt_u32 s49, 28
s_cselect_b32 s10, s70, 0
MA 156,116,88
s_waitcnt vmcnt(20) lgkmcnt(0)
s_barrier
s_cmp_lt_u32 s49, 30
s_cbranch_scc1 k1_mlp_w2_loop
MV 0,32,0
TR 92,204,43008
MV 4,32,4
MV 8,32,8
TR 94,204,43520
MV 12,32,12
MV 16,32,16
RB 60,205,0
s_mov_b32 m0, 135168
MV 20,32,20
buffer_load_dwordx4 v192, s[8:11], s69 offen lds
MV 24,32,24
RB 64,205,2048
MV 28,32,28
MV 32,36,0
RB 68,205,4096
s_mov_b32 m0, 136192
MV 36,36,4
buffer_load_dwordx4 v193, s[8:11], s69 offen lds
MA 160,48,120
RB 72,205,6144
MV 40,36,8
MV 44,36,12
RB 76,205,8192
s_mov_b32 m0, 137216
MV 48,36,16
buffer_load_dwordx4 v194, s[8:11], s69 offen lds
MV 52,36,20
RB 80,205,10240
MV 56,36,24
MV 60,36,28
RB 84,205,12288
s_mov_b32 m0, 138240
MV 64,40,0
buffer_load_dwordx4 v195, s[8:11], s69 offen lds
MV 68,40,4
RB 88,205,14336
MV 72,40,8
MV 76,40,12
TR 96,207,43008
s_add_u32 m0, s47, 26624
MV 80,40,16
DL 196,64
MA 164,52,120
TR 98,207,43520
MV 84,40,20
MV 88,40,24
TR 100,208,43008
MV 92,40,28
s_add_u32 m0, s47, 27648
MV 96,44,0
TR 102,208,43520
DL 197,64
MV 100,44,4
MV 104,44,8
TR 104,209,43008
MV 108,44,12
s_add_u32 m0, s47, 28672
MV 112,44,16
TR 106,209,43520
DL 198,64
MV 116,44,20
MV 120,44,24
TR 108,204,47104
MV 124,44,28
s_add_u32 m0, s47, 29696
MA 168,56,120
TR 110,204,47616
DL 199,64
MV 128,48,0
MV 132,48,4
TR 112,207,47104
MV 136,48,8
s_add_u32 m0, s47, 30720
MV 140,48,12
TR 114,207,47616
DL 200,64
MV 144,48,16
MV 148,48,20
TR 116,208,47104
MV 152,48,24
s_add_u32 m0, s47, 31744
MV 156,48,28
TR 118,208,47616
DL 201,64
MV 160,52,0
MV 164,52,4
MV 168,52,8
MV 172,52,12
MV 176,52,16
MV 180,52,20
s_mov_b32 s47, s46
MV 184,52,24
s_add_u32 s46, s46, 32768
MV 188,52,28
s_cmp_eq_u32 s46, 98304
s_cselect_b32 s46, 0, s46
MA 128,56,0
v_add_u32 v205, s46, v202
MA 132,56,4
s_add_u32 s49, s49, 1
MA 136,56,8
s_add_u32 s69, s69, s51
MA 140,56,12
s_add_u32 s48, s48, 128
MA 144,56,16
s_add_u32 s64, s64, 128
MA 148,56,20
s_cmp_lt_u32 s49, 27
s_cselect_b32 s6, s50, 0
MA 152,56,24
s_cmp_lt_u32 s49, 28
s_cselect_b32 s10, s70, 0
MA 156,56,28
s_waitcnt vmcnt(20) lgkmcnt(0)
s_barrier
s_add_u32 s12, s40, 20971520
s_addc_u32 s13, s41, 0
s_and_b32 s13, s13, 0xffff
s_mov_b32 s14, 16384
s_mov_b32 s15, 0x20000
v_and_b32 v210, 15, v206
s_lshl_b32 s55, s44, 8
s_add_u32 s55, s55, 128
v_add_u32 v210, s55, v210
v_lshlrev_b32 v210, 3, v210
buffer_load_dwordx2 a[176:177], v210, s[12:15], 0 offen offset:0 sc1
buffer_load_dwordx2 a[178:179], v210, s[12:15], 0 offen offset:128 sc1
buffer_load_dwordx2 a[180:181], v210, s[12:15], 0 offen offset:256 sc1
buffer_load_dwordx2 a[182:183], v210, s[12:15], 0 offen offset:384 sc1
buffer_load_dwordx2 a[184:185], v210, s[12:15], 0 offen offset:512 sc1
buffer_load_dwordx2 a[186:187], v210, s[12:15], 0 offen offset:640 sc1
buffer_load_dwordx2 a[188:189], v210, s[12:15], 0 offen offset:768 sc1
buffer_load_dwordx2 a[190:191], v210, s[12:15], 0 offen offset:896 sc1
s_mov_b32 s12, s28
s_and_b32 s13, s29, 0xffff
s_mov_b32 s14, 7168
s_mov_b32 s15, 0x20000
v_lshrrev_b32 v211, 4, v206
v_lshlrev_b32 v212, 3, v211
s_mul_i32 s55, s45, 448
s_add_u32 s56, s55, s67
s_add_u32 s55, s55, s66
buffer_load_dwordx2 a[192:193], v212, s[12:15], s55 offen offset:0
buffer_load_dwordx2 a[194:195], v212, s[12:15], s55 offen offset:32
buffer_load_dwordx2 a[196:197], v212, s[12:15], s55 offen offset:64
buffer_load_dwordx2 a[198:199], v212, s[12:15], s55 offen offset:96
buffer_load_dwordx2 a[200:201], v212, s[12:15], s55 offen offset:128
buffer_load_dwordx2 a[202:203], v212, s[12:15], s55 offen offset:160
buffer_load_dwordx2 a[204:205], v212, s[12:15], s55 offen offset:192
MV 0,92,60
MV 4,92,64
MV 8,92,68
MV 12,92,72
MV 16,92,76
MV 20,92,80
MV 24,92,84
MV 28,92,88
MV 32,96,60
MV 36,96,64
MA 160,108,120
MV 40,96,68
MV 44,96,72
MV 48,96,76
MV 52,96,80
MV 56,96,84
MV 60,96,88
MV 64,100,60
MV 68,100,64
MV 72,100,68
MV 76,100,72
MV 80,100,76
MA 164,112,120
MV 84,100,80
MV 88,100,84
MV 92,100,88
MV 96,104,60
MV 100,104,64
MV 104,104,68
MV 108,104,72
MV 112,104,76
MV 116,104,80
MV 120,104,84
MV 124,104,88
MA 168,116,120
MV 128,108,60
MV 132,108,64
MV 136,108,68
MV 140,108,72
MV 144,108,76
MV 148,108,80
MV 152,108,84
MV 156,108,88
MV 160,112,60
MV 164,112,64
MV 168,112,68
MV 172,112,72
MV 176,112,76
MV 180,112,80
MV 184,112,84
MV 188,112,88
MA 128,116,60
MA 132,116,64
MA 136,116,68
MA 140,116,72
MA 144,116,76
MA 148,116,80
MA 152,116,84
MA 156,116,88
v_lshrrev_b32 v210, 4, v206
v_lshlrev_b32 v210, 4, v210
v_add_u32 v210, 155648, v210
s_mov_b32 exec_lo, 0x00010001
s_mov_b32 exec_hi, 0x00010001
ds_write_b128 v210, a[160:163] offset:256
ds_write_b128 v210, a[164:167] offset:320
ds_write_b128 v210, a[168:171] offset:384
s_mov_b64 exec, -1
s_waitcnt lgkmcnt(0)
s_barrier
RB 208,210,0
RB 212,210,64
RB 216,210,128
RB 220,210,192
RB 224,210,256
RB 228,210,320
RB 232,210,384
s_waitcnt vmcnt(0) lgkmcnt(0)
s_branch k1_mlp_epi0
k1_mlp_w3:
s_mov_b32 s52, 1
s_mov_b32 s53, 1
s_and_b32 s65, s45, 1
s_lshl_b32 s66, s65, 6
s_cmp_eq_u32 s65, 0
s_cselect_b32 s67, 384, 0
s_waitcnt lgkmcnt(0)
s_lshr_b32 s74, s2, 3
s_lshl_b32 s74, s74, 2
s_add_u32 s74, s74, s42
s_and_b32 s75, s2, 1
s_lshl_b32 s75, s75, 2
s_bfe_u32 s76, s2, 0x20001
s_lshl_b32 s76, s76, 2
s_cmp_lt_u32 s74, 48
s_cbranch_scc0 k1_mlp_w3_k1_st_w
s_mul_i32 s3, s74, 43691
s_lshr_b32 s3, s3, 19
s_mul_i32 s77, s3, 12
s_sub_u32 s77, s74, s77
s_add_u32 s3, s3, s75
s_lshl_b32 s3, s3, 19
s_and_b32 s75, s77, 3
s_lshl_b32 s75, s75, 17
s_add_u32 s3, s3, s75
s_lshr_b32 s77, s77, 2
s_cmp_ge_u32 s77, 1
s_cbranch_scc1 k1_mlp_w3_k1_st_done
s_lshl_b32 s77, s77, 7
s_add_u32 s3, s3, s77
v_lshlrev_b32 v255, 11, v206
v_add_u32 v255, s3, v255
s_mov_b32 s72, s16
s_and_b32 s73, s17, 0xffff
s_mov_b32 s74, 4194304
s_mov_b32 s75, 0x20000
s_branch k1_mlp_w3_k1_st_go
k1_mlp_w3_k1_st_w:
s_cmp_lt_u32 s74, 88
s_cselect_b32 s77, 48, 88
s_cselect_b32 s75, 1, 0
s_sub_u32 s74, s74, s77
s_mul_i32 s3, s74, 52429
s_lshr_b32 s3, s3, 19
s_mul_i32 s77, s3, 10
s_sub_u32 s77, s74, s77
s_cmp_ge_u32 s77, 4
s_cbranch_scc1 k1_mlp_w3_k1_st_done
s_add_u32 s76, s76, s3
s_lshl_b32 s77, s77, 4
v_lshrrev_b32 v255, 2, v206
v_add_u32 v255, s77, v255
v_and_b32 v254, 3, v206
s_cmp_eq_u32 s75, 1
s_cbranch_scc0 k1_mlp_w3_k1_st_q
s_mul_i32 s3, s76, 448
s_and_b32 s3, s3, 0xffffff80
s_mov_b32 s77, 7168
v_mul_lo_u32 v255, v255, s77
v_lshl_add_u32 v255, v254, 7, v255
v_add_u32 v255, s3, v255
s_mov_b32 s72, s26
s_and_b32 s73, s27, 0xffff
s_mov_b32 s74, 7340032
s_mov_b32 s75, 0x20000
s_branch k1_mlp_w3_k1_st_go
k1_mlp_w3_k1_st_q:
s_lshl_b32 s3, s76, 7
s_mov_b32 s77, 6144
v_mul_lo_u32 v255, v255, s77
v_min_u32 v254, 2, v254
v_lshl_add_u32 v255, v254, 11, v255
v_add_u32 v255, s3, v255
s_mov_b32 s72, s18
s_and_b32 s73, s19, 0xffff
s_mov_b32 s74, 6291456
s_mov_b32 s75, 0x20000
k1_mlp_w3_k1_st_go:
buffer_load_dword v254, v255, s[72:75], 0 offen
k1_mlp_w3_k1_st_done:
v_mov_b32 v210, 0x3f803f80
v_accvgpr_write_b32 a120, v210
v_mov_b32 v210, 0x3f803f80
v_accvgpr_write_b32 a121, v210
v_mov_b32 v210, 0x3f803f80
v_accvgpr_write_b32 a122, v210
v_mov_b32 v210, 0x3f803f80
v_accvgpr_write_b32 a123, v210
v_and_b32 v210, 15, v206
v_lshrrev_b32 v213, 4, v206
v_lshrrev_b32 v211, 1, v210
v_add_u32 v212, 0, v213
v_xor_b32 v212, v212, v211
v_lshlrev_b32 v212, 4, v212
v_lshl_add_u32 v212, v210, 7, v212
v_add_u32 v202, 16384, v212
v_add_u32 v212, 4, v213
v_xor_b32 v212, v212, v211
v_lshlrev_b32 v212, 4, v212
v_lshl_add_u32 v212, v210, 7, v212
v_add_u32 v203, 16384, v212
v_bfe_u32 v211, v206, 2, 2
v_lshl_add_u32 v214, v213, 3, v211
v_and_b32 v215, 3, v206
v_lshlrev_b32 v215, 3, v215
v_lshrrev_b32 v216, 1, v211
v_and_b32 v217, 1, v213
v_lshl_or_b32 v216, v217, 1, v216
v_lshl_add_u32 v218, v214, 7, v215
v_add_u32 v218, 98304, v218
v_xor_b32 v219, 0, v216
v_lshl_add_u32 v204, v219, 5, v218
v_xor_b32 v219, 1, v216
v_lshl_add_u32 v207, v219, 5, v218
v_xor_b32 v219, 2, v216
v_lshl_add_u32 v208, v219, 5, v218
v_xor_b32 v219, 3, v216
v_lshl_add_u32 v209, v219, 5, v218
v_lshl_add_u32 v218, v214, 6, v215
v_add_u32 v218, 110592, v218
v_xor_b32 v219, 0, v217
v_lshl_add_u32 v240, v219, 5, v218
v_xor_b32 v219, 1, v217
v_lshl_add_u32 v241, v219, 5, v218
v_mov_b32 v205, v202
s_cmp_lt_u32 s2, 96
s_cbranch_scc1 k1_mlp_w3_tsq
s_mov_b32 s4, s26
s_and_b32 s5, s27, 0xffff
s_mov_b32 s6, 7340032
s_mov_b32 s7, 0x20000
s_sub_u32 s55, s2, 96
s_lshl_b32 s55, s55, 13
s_mov_b32 s77, 917504
s_cmp_lt_u32 s2, 208
s_cselect_b32 s6, s6, 0
s_branch k1_mlp_w3_tsd
k1_mlp_w3_tsq:
s_mov_b32 s4, s18
s_and_b32 s5, s19, 0xffff
s_mov_b32 s6, 6291456
s_mov_b32 s7, 0x20000
s_lshl_b32 s55, s2, 13
s_mov_b32 s77, 786432
k1_mlp_w3_tsd:
v_lshlrev_b32 v252, 7, v206
v_add_u32 v252, s55, v252
v_add_u32 v252, s77, v252
buffer_load_dword v253, v252, s[4:7], 0 offen
v_add_u32 v252, s77, v252
buffer_load_dword v253, v252, s[4:7], 0 offen
s_waitcnt lgkmcnt(0)
s_barrier
TR 32,209,4096
TR 34,209,4608
RB 0,205,0
RB 4,205,2048
RB 8,205,4096
RB 12,205,6144
RB 16,205,8192
RB 20,205,10240
RB 24,205,12288
RB 28,205,14336
TR 36,204,8192
TR 38,204,8704
TR 40,207,8192
TR 42,207,8704
TR 44,208,8192
TR 46,208,8704
TR 48,209,8192
TR 50,209,8704
TR 52,240,0
TR 54,240,256
TR 56,241,0
TR 58,241,256
s_mov_b32 s46, 0
s_mov_b32 s47, 65536
s_mov_b32 s49, 0
v_mov_b32 v205, v203
s_waitcnt lgkmcnt(0)
s_barrier
MVZ 0,32,0
TR 92,209,18432
MVZ 4,32,4
MVZ 8,32,8
TR 94,209,18944
MVZ 12,32,12
MVZ 16,32,16
RB 60,205,0
MVZ 20,32,20
MVZ 24,32,24
RB 64,205,2048
MVZ 28,32,28
MVZ 32,36,0
RB 68,205,4096
MVZ 36,36,4
v_mfma_f32_16x16x32_bf16 a[160:163], a[48:51], a[120:123], 0
RB 72,205,6144
MVZ 40,36,8
MVZ 44,36,12
RB 76,205,8192
MVZ 48,36,16
MVZ 52,36,20
RB 80,205,10240
MVZ 56,36,24
MVZ 60,36,28
RB 84,205,12288
MVZ 64,40,0
MVZ 68,40,4
RB 88,205,14336
MVZ 72,40,8
MVZ 76,40,12
TR 96,204,22528
MVZ 80,40,16
v_mfma_f32_16x16x32_bf16 a[164:167], a[52:55], a[120:123], 0
TR 98,204,23040
MVZ 84,40,20
MVZ 88,40,24
TR 100,207,22528
MVZ 92,40,28
MVZ 96,44,0
TR 102,207,23040
MVZ 100,44,4
MVZ 104,44,8
TR 104,208,22528
MVZ 108,44,12
MVZ 112,44,16
TR 106,208,23040
MVZ 116,44,20
MVZ 120,44,24
TR 108,209,22528
MVZ 124,44,28
v_mfma_f32_16x16x32_bf16 a[168:171], a[56:59], a[120:123], 0
TR 110,209,23040
MVZ 128,48,0
MVZ 132,48,4
TR 112,240,14336
MVZ 136,48,8
MVZ 140,48,12
TR 114,240,14592
MVZ 144,48,16
MVZ 148,48,20
TR 116,241,14336
MVZ 152,48,24
MVZ 156,48,28
TR 118,241,14592
MVZ 160,52,0
MVZ 164,52,4
MVZ 168,52,8
MVZ 172,52,12
MVZ 176,52,16
MVZ 180,52,20
MVZ 184,52,24
MVZ 188,52,28
v_mfma_f32_16x16x32_bf16 a[128:131], a[56:59], a[0:3], 0
v_mfma_f32_16x16x32_bf16 a[132:135], a[56:59], a[4:7], 0
v_mfma_f32_16x16x32_bf16 a[136:139], a[56:59], a[8:11], 0
s_mov_b32 s47, s46
v_mfma_f32_16x16x32_bf16 a[140:143], a[56:59], a[12:15], 0
s_add_u32 s46, s46, 32768
v_mfma_f32_16x16x32_bf16 a[144:147], a[56:59], a[16:19], 0
s_cmp_eq_u32 s46, 98304
s_cselect_b32 s46, 0, s46
v_mfma_f32_16x16x32_bf16 a[148:151], a[56:59], a[20:23], 0
v_add_u32 v205, s46, v202
v_mfma_f32_16x16x32_bf16 a[152:155], a[56:59], a[24:27], 0
s_add_u32 s49, s49, 1
v_mfma_f32_16x16x32_bf16 a[156:159], a[56:59], a[28:31], 0
s_waitcnt lgkmcnt(0)
s_barrier
MV 0,92,60
TR 32,209,32768
MV 4,92,64
MV 8,92,68
TR 34,209,33280
MV 12,92,72
MV 16,92,76
RB 0,205,0
MV 20,92,80
MV 24,92,84
RB 4,205,2048
MV 28,92,88
MV 32,96,60
RB 8,205,4096
MV 36,96,64
MA 160,108,120
RB 12,205,6144
MV 40,96,68
MV 44,96,72
RB 16,205,8192
MV 48,96,76
MV 52,96,80
RB 20,205,10240
MV 56,96,84
MV 60,96,88
RB 24,205,12288
MV 64,100,60
MV 68,100,64
RB 28,205,14336
MV 72,100,68
MV 76,100,72
TR 36,204,36864
MV 80,100,76
MA 164,112,120
TR 38,204,37376
MV 84,100,80
MV 88,100,84
TR 40,207,36864
MV 92,100,88
MV 96,104,60
TR 42,207,37376
MV 100,104,64
MV 104,104,68
TR 44,208,36864
MV 108,104,72
MV 112,104,76
TR 46,208,37376
MV 116,104,80
MV 120,104,84
TR 48,209,36864
MV 124,104,88
MA 168,116,120
TR 50,209,37376
MV 128,108,60
MV 132,108,64
TR 52,240,28672
MV 136,108,68
MV 140,108,72
TR 54,240,28928
MV 144,108,76
MV 148,108,80
TR 56,241,28672
MV 152,108,84
MV 156,108,88
TR 58,241,28928
MV 160,112,60
MV 164,112,64
MV 168,112,68
MV 172,112,72
MV 176,112,76
MV 180,112,80
MV 184,112,84
MV 188,112,88
MA 128,116,60
MA 132,116,64
MA 136,116,68
MA 140,116,72
MA 144,116,76
MA 148,116,80
v_add_u32 v205, s46, v203
MA 152,116,84
s_add_u32 s49, s49, 1
MA 156,116,88
s_waitcnt lgkmcnt(0)
s_barrier
v_add_u32 v252, s77, v252
buffer_load_dword v253, v252, s[4:7], 0 offen
k1_mlp_w3_loop:
MV 0,32,0
TR 92,209,47104
MV 4,32,4
MV 8,32,8
TR 94,209,47616
MV 12,32,12
MV 16,32,16
RB 60,205,0
MV 20,32,20
MV 24,32,24
RB 64,205,2048
MV 28,32,28
MV 32,36,0
RB 68,205,4096
MV 36,36,4
MA 160,48,120
RB 72,205,6144
MV 40,36,8
MV 44,36,12
RB 76,205,8192
MV 48,36,16
MV 52,36,20
RB 80,205,10240
MV 56,36,24
MV 60,36,28
RB 84,205,12288
MV 64,40,0
MV 68,40,4
RB 88,205,14336
MV 72,40,8
MV 76,40,12
TR 96,204,51200
MV 80,40,16
MA 164,52,120
TR 98,204,51712
MV 84,40,20
MV 88,40,24
TR 100,207,51200
MV 92,40,28
MV 96,44,0
TR 102,207,51712
MV 100,44,4
MV 104,44,8
TR 104,208,51200
MV 108,44,12
MV 112,44,16
TR 106,208,51712
MV 116,44,20
MV 120,44,24
TR 108,209,51200
MV 124,44,28
MA 168,56,120
TR 110,209,51712
MV 128,48,0
MV 132,48,4
TR 112,240,43008
MV 136,48,8
MV 140,48,12
TR 114,240,43264
MV 144,48,16
MV 148,48,20
TR 116,241,43008
MV 152,48,24
MV 156,48,28
TR 118,241,43264
MV 160,52,0
MV 164,52,4
MV 168,52,8
MV 172,52,12
MV 176,52,16
MV 180,52,20
MV 184,52,24
MV 188,52,28
MA 128,56,0
MA 132,56,4
MA 136,56,8
s_mov_b32 s47, s46
MA 140,56,12
s_add_u32 s46, s46, 32768
MA 144,56,16
s_cmp_eq_u32 s46, 98304
s_cselect_b32 s46, 0, s46
MA 148,56,20
v_add_u32 v205, s46, v202
MA 152,56,24
s_add_u32 s49, s49, 1
MA 156,56,28
s_waitcnt lgkmcnt(0)
s_barrier
MV 0,92,60
TR 32,209,4096
MV 4,92,64
MV 8,92,68
TR 34,209,4608
MV 12,92,72
MV 16,92,76
RB 0,205,0
MV 20,92,80
MV 24,92,84
RB 4,205,2048
MV 28,92,88
MV 32,96,60
RB 8,205,4096
MV 36,96,64
MA 160,108,120
RB 12,205,6144
MV 40,96,68
MV 44,96,72
RB 16,205,8192
MV 48,96,76
MV 52,96,80
RB 20,205,10240
MV 56,96,84
MV 60,96,88
RB 24,205,12288
MV 64,100,60
MV 68,100,64
RB 28,205,14336
MV 72,100,68
MV 76,100,72
TR 36,204,8192
MV 80,100,76
MA 164,112,120
TR 38,204,8704
MV 84,100,80
MV 88,100,84
TR 40,207,8192
MV 92,100,88
MV 96,104,60
TR 42,207,8704
MV 100,104,64
MV 104,104,68
TR 44,208,8192
MV 108,104,72
MV 112,104,76
TR 46,208,8704
MV 116,104,80
MV 120,104,84
TR 48,209,8192
MV 124,104,88
MA 168,116,120
TR 50,209,8704
MV 128,108,60
MV 132,108,64
TR 52,240,0
MV 136,108,68
MV 140,108,72
TR 54,240,256
MV 144,108,76
MV 148,108,80
TR 56,241,0
MV 152,108,84
MV 156,108,88
TR 58,241,256
MV 160,112,60
MV 164,112,64
MV 168,112,68
MV 172,112,72
MV 176,112,76
MV 180,112,80
MV 184,112,84
MV 188,112,88
MA 128,116,60
MA 132,116,64
MA 136,116,68
MA 140,116,72
MA 144,116,76
MA 148,116,80
v_add_u32 v205, s46, v203
MA 152,116,84
s_add_u32 s49, s49, 1
MA 156,116,88
s_waitcnt lgkmcnt(0)
s_barrier
s_and_b32 s55, s49, 3
s_cmp_eq_u32 s55, 2
s_cbranch_scc0 k1_mlp_w3_a_nogrp
s_cmp_le_u32 s49, 18
s_cbranch_scc0 k1_mlp_w3_a_nogrp
v_add_u32 v252, s77, v252
buffer_load_dword v253, v252, s[4:7], 0 offen
k1_mlp_w3_a_nogrp:
s_cmp_lt_u32 s49, 20
s_cbranch_scc1 k1_mlp_w3_a_nopf
s_cmp_ge_u32 s49, 30
s_cbranch_scc1 k1_mlp_w3_a_nopf
s_sub_u32 s56, s49, 20
s_lshl_b32 s56, s56, 7
s_add_u32 s56, s56, s2
s_cmp_ge_u32 s49, 28
s_cbranch_scc1 k1_mlp_w3_a_pfo
s_mov_b32 s72, s30
s_and_b32 s73, s31, 0xffff
s_mov_b32 s74, 7340032
s_mov_b32 s75, 0x20000
s_lshl_b32 s76, s56, 13
v_lshlrev_b32 v255, 7, v206
v_add_u32 v255, s76, v255
buffer_load_dword v253, v255, s[72:75], 0 offen
s_branch k1_mlp_w3_a_nopf
k1_mlp_w3_a_pfo:
s_sub_u32 s56, s56, 1024
s_mov_b32 s72, s22
s_and_b32 s73, s23, 0xffff
s_mov_b32 s74, 2097152
s_mov_b32 s75, 0x20000
s_lshl_b32 s76, s56, 13
v_lshlrev_b32 v255, 7, v206
v_add_u32 v255, s76, v255
buffer_load_dword v253, v255, s[72:75], 0 offen
k1_mlp_w3_a_nopf:
MV 0,32,0
TR 92,209,18432
MV 4,32,4
MV 8,32,8
TR 94,209,18944
MV 12,32,12
MV 16,32,16
RB 60,205,0
MV 20,32,20
MV 24,32,24
RB 64,205,2048
MV 28,32,28
MV 32,36,0
RB 68,205,4096
MV 36,36,4
MA 160,48,120
RB 72,205,6144
MV 40,36,8
MV 44,36,12
RB 76,205,8192
MV 48,36,16
MV 52,36,20
RB 80,205,10240
MV 56,36,24
MV 60,36,28
RB 84,205,12288
MV 64,40,0
MV 68,40,4
RB 88,205,14336
MV 72,40,8
MV 76,40,12
TR 96,204,22528
MV 80,40,16
MA 164,52,120
TR 98,204,23040
MV 84,40,20
MV 88,40,24
TR 100,207,22528
MV 92,40,28
MV 96,44,0
TR 102,207,23040
MV 100,44,4
MV 104,44,8
TR 104,208,22528
MV 108,44,12
MV 112,44,16
TR 106,208,23040
MV 116,44,20
MV 120,44,24
TR 108,209,22528
MV 124,44,28
MA 168,56,120
TR 110,209,23040
MV 128,48,0
MV 132,48,4
TR 112,240,14336
MV 136,48,8
MV 140,48,12
TR 114,240,14592
MV 144,48,16
MV 148,48,20
TR 116,241,14336
MV 152,48,24
MV 156,48,28
TR 118,241,14592
MV 160,52,0
MV 164,52,4
MV 168,52,8
MV 172,52,12
MV 176,52,16
MV 180,52,20
MV 184,52,24
MV 188,52,28
MA 128,56,0
MA 132,56,4
MA 136,56,8
s_mov_b32 s47, s46
MA 140,56,12
s_add_u32 s46, s46, 32768
MA 144,56,16
s_cmp_eq_u32 s46, 98304
s_cselect_b32 s46, 0, s46
MA 148,56,20
v_add_u32 v205, s46, v202
MA 152,56,24
s_add_u32 s49, s49, 1
MA 156,56,28
s_waitcnt lgkmcnt(0)
s_barrier
MV 0,92,60
TR 32,209,32768
MV 4,92,64
MV 8,92,68
TR 34,209,33280
MV 12,92,72
MV 16,92,76
RB 0,205,0
MV 20,92,80
MV 24,92,84
RB 4,205,2048
MV 28,92,88
MV 32,96,60
RB 8,205,4096
MV 36,96,64
MA 160,108,120
RB 12,205,6144
MV 40,96,68
MV 44,96,72
RB 16,205,8192
MV 48,96,76
MV 52,96,80
RB 20,205,10240
MV 56,96,84
MV 60,96,88
RB 24,205,12288
MV 64,100,60
MV 68,100,64
RB 28,205,14336
MV 72,100,68
MV 76,100,72
TR 36,204,36864
MV 80,100,76
MA 164,112,120
TR 38,204,37376
MV 84,100,80
MV 88,100,84
TR 40,207,36864
MV 92,100,88
MV 96,104,60
TR 42,207,37376
MV 100,104,64
MV 104,104,68
TR 44,208,36864
MV 108,104,72
MV 112,104,76
TR 46,208,37376
MV 116,104,80
MV 120,104,84
TR 48,209,36864
MV 124,104,88
MA 168,116,120
TR 50,209,37376
MV 128,108,60
MV 132,108,64
TR 52,240,28672
MV 136,108,68
MV 140,108,72
TR 54,240,28928
MV 144,108,76
MV 148,108,80
TR 56,241,28672
MV 152,108,84
MV 156,108,88
TR 58,241,28928
MV 160,112,60
MV 164,112,64
MV 168,112,68
MV 172,112,72
MV 176,112,76
MV 180,112,80
MV 184,112,84
MV 188,112,88
MA 128,116,60
MA 132,116,64
MA 136,116,68
MA 140,116,72
MA 144,116,76
MA 148,116,80
v_add_u32 v205, s46, v203
MA 152,116,84
s_add_u32 s49, s49, 1
MA 156,116,88
s_waitcnt lgkmcnt(0)
s_barrier
s_and_b32 s55, s49, 3
s_cmp_eq_u32 s55, 2
s_cbranch_scc0 k1_mlp_w3_b_nogrp
s_cmp_le_u32 s49, 18
s_cbranch_scc0 k1_mlp_w3_b_nogrp
v_add_u32 v252, s77, v252
buffer_load_dword v253, v252, s[4:7], 0 offen
k1_mlp_w3_b_nogrp:
s_cmp_eq_u32 s49, 26
s_cbranch_scc0 k1_mlp_w3_b_nocode26
s_getpc_b64 s[72:73]
k1_pc_k1_mlp_w3_b_26:
s_sub_u32 s72, s72, k1_pc_k1_mlp_w3_b_26-k1_code_start
s_subb_u32 s73, s73, 0
s_and_b32 s73, s73, 0xffff
s_mov_b32 s74, k1_code_end-k1_code_start
s_mov_b32 s75, 0x20000
s_lshr_b32 s76, s2, 3
s_lshl_b32 s76, s76, 13
v_lshlrev_b32 v255, 7, v206
v_add_u32 v255, s76, v255
buffer_load_dword v253, v255, s[72:75], 0 offen
k1_mlp_w3_b_nocode26:
s_cmp_lt_u32 s49, 20
s_cbranch_scc1 k1_mlp_w3_b_nopf
s_cmp_ge_u32 s49, 30
s_cbranch_scc1 k1_mlp_w3_b_nopf
s_sub_u32 s56, s49, 20
s_lshl_b32 s56, s56, 7
s_add_u32 s56, s56, s2
s_cmp_ge_u32 s49, 28
s_cbranch_scc1 k1_mlp_w3_b_pfo
s_mov_b32 s72, s30
s_and_b32 s73, s31, 0xffff
s_mov_b32 s74, 7340032
s_mov_b32 s75, 0x20000
s_lshl_b32 s76, s56, 13
v_lshlrev_b32 v255, 7, v206
v_add_u32 v255, s76, v255
buffer_load_dword v253, v255, s[72:75], 0 offen
s_branch k1_mlp_w3_b_nopf
k1_mlp_w3_b_pfo:
s_sub_u32 s56, s56, 1024
s_mov_b32 s72, s22
s_and_b32 s73, s23, 0xffff
s_mov_b32 s74, 2097152
s_mov_b32 s75, 0x20000
s_lshl_b32 s76, s56, 13
v_lshlrev_b32 v255, 7, v206
v_add_u32 v255, s76, v255
buffer_load_dword v253, v255, s[72:75], 0 offen
k1_mlp_w3_b_nopf:
s_cmp_lt_u32 s49, 30
s_cbranch_scc1 k1_mlp_w3_loop
MV 0,32,0
TR 92,209,47104
MV 4,32,4
MV 8,32,8
TR 94,209,47616
MV 12,32,12
MV 16,32,16
RB 60,205,0
MV 20,32,20
MV 24,32,24
RB 64,205,2048
MV 28,32,28
MV 32,36,0
RB 68,205,4096
MV 36,36,4
MA 160,48,120
RB 72,205,6144
MV 40,36,8
MV 44,36,12
RB 76,205,8192
MV 48,36,16
MV 52,36,20
RB 80,205,10240
MV 56,36,24
MV 60,36,28
RB 84,205,12288
MV 64,40,0
MV 68,40,4
RB 88,205,14336
MV 72,40,8
MV 76,40,12
TR 96,204,51200
MV 80,40,16
MA 164,52,120
TR 98,204,51712
MV 84,40,20
MV 88,40,24
TR 100,207,51200
MV 92,40,28
MV 96,44,0
TR 102,207,51712
MV 100,44,4
MV 104,44,8
TR 104,208,51200
MV 108,44,12
MV 112,44,16
TR 106,208,51712
MV 116,44,20
MV 120,44,24
TR 108,209,51200
MV 124,44,28
MA 168,56,120
TR 110,209,51712
MV 128,48,0
MV 132,48,4
TR 112,240,43008
MV 136,48,8
MV 140,48,12
TR 114,240,43264
MV 144,48,16
MV 148,48,20
TR 116,241,43008
MV 152,48,24
MV 156,48,28
TR 118,241,43264
MV 160,52,0
MV 164,52,4
MV 168,52,8
MV 172,52,12
MV 176,52,16
MV 180,52,20
MV 184,52,24
MV 188,52,28
MA 128,56,0
MA 132,56,4
MA 136,56,8
s_mov_b32 s47, s46
MA 140,56,12
s_add_u32 s46, s46, 32768
MA 144,56,16
s_cmp_eq_u32 s46, 98304
s_cselect_b32 s46, 0, s46
MA 148,56,20
v_add_u32 v205, s46, v202
MA 152,56,24
s_add_u32 s49, s49, 1
MA 156,56,28
s_waitcnt lgkmcnt(0)
s_barrier
s_add_u32 s12, s40, 20971520
s_addc_u32 s13, s41, 0
s_and_b32 s13, s13, 0xffff
s_mov_b32 s14, 16384
s_mov_b32 s15, 0x20000
v_and_b32 v210, 15, v206
s_lshl_b32 s55, s44, 8
s_add_u32 s55, s55, 128
v_add_u32 v210, s55, v210
v_lshlrev_b32 v210, 3, v210
buffer_load_dwordx2 a[176:177], v210, s[12:15], 0 offen offset:0 sc1
buffer_load_dwordx2 a[178:179], v210, s[12:15], 0 offen offset:128 sc1
buffer_load_dwordx2 a[180:181], v210, s[12:15], 0 offen offset:256 sc1
buffer_load_dwordx2 a[182:183], v210, s[12:15], 0 offen offset:384 sc1
buffer_load_dwordx2 a[184:185], v210, s[12:15], 0 offen offset:512 sc1
buffer_load_dwordx2 a[186:187], v210, s[12:15], 0 offen offset:640 sc1
buffer_load_dwordx2 a[188:189], v210, s[12:15], 0 offen offset:768 sc1
buffer_load_dwordx2 a[190:191], v210, s[12:15], 0 offen offset:896 sc1
s_mov_b32 s12, s28
s_and_b32 s13, s29, 0xffff
s_mov_b32 s14, 7168
s_mov_b32 s15, 0x20000
v_lshrrev_b32 v211, 4, v206
v_lshlrev_b32 v212, 3, v211
s_mul_i32 s55, s45, 448
s_add_u32 s56, s55, s67
s_add_u32 s55, s55, s66
buffer_load_dwordx2 a[192:193], v212, s[12:15], s55 offen offset:224
buffer_load_dwordx2 a[194:195], v212, s[12:15], s55 offen offset:256
buffer_load_dwordx2 a[196:197], v212, s[12:15], s55 offen offset:288
buffer_load_dwordx2 a[198:199], v212, s[12:15], s55 offen offset:320
buffer_load_dwordx2 a[200:201], v212, s[12:15], s55 offen offset:352
buffer_load_dwordx2 a[202:203], v212, s[12:15], s56 offen offset:0
buffer_load_dwordx2 a[204:205], v212, s[12:15], s56 offen offset:32
MV 0,92,60
MV 4,92,64
MV 8,92,68
MV 12,92,72
MV 16,92,76
MV 20,92,80
MV 24,92,84
MV 28,92,88
MV 32,96,60
MV 36,96,64
MA 160,108,120
MV 40,96,68
MV 44,96,72
MV 48,96,76
MV 52,96,80
MV 56,96,84
MV 60,96,88
MV 64,100,60
MV 68,100,64
MV 72,100,68
MV 76,100,72
MV 80,100,76
MA 164,112,120
MV 84,100,80
MV 88,100,84
MV 92,100,88
MV 96,104,60
MV 100,104,64
MV 104,104,68
MV 108,104,72
MV 112,104,76
MV 116,104,80
MV 120,104,84
MV 124,104,88
MA 168,116,120
MV 128,108,60
MV 132,108,64
MV 136,108,68
MV 140,108,72
MV 144,108,76
MV 148,108,80
MV 152,108,84
MV 156,108,88
MV 160,112,60
MV 164,112,64
MV 168,112,68
MV 172,112,72
MV 176,112,76
MV 180,112,80
MV 184,112,84
MV 188,112,88
MA 128,116,60
MA 132,116,64
MA 136,116,68
MA 140,116,72
MA 144,116,76
MA 148,116,80
MA 152,116,84
MA 156,116,88
v_lshrrev_b32 v210, 4, v206
v_lshlrev_b32 v210, 4, v210
v_add_u32 v210, 156096, v210
s_mov_b32 exec_lo, 0x00010001
s_mov_b32 exec_hi, 0x00010001
ds_write_b128 v210, a[160:163] offset:256
ds_write_b128 v210, a[164:167] offset:320
ds_write_b128 v210, a[168:171] offset:384
s_mov_b64 exec, -1
s_waitcnt lgkmcnt(0)
s_barrier
RB 208,210,0
RB 212,210,64
RB 216,210,128
RB 220,210,192
RB 224,210,256
RB 228,210,320
RB 232,210,384
s_waitcnt vmcnt(0) lgkmcnt(0)
s_branch k1_mlp_epi1
k1_qkv_w0:
s_mov_b32 s52, 0
s_mov_b32 s53, 0
s_lshl_b32 s54, s44, 4
s_add_u32 s54, s54, s45
v_lshrrev_b32 v210, 3, v206
v_lshrrev_b32 v211, 4, v206
v_and_b32 v212, 7, v206
v_add_u32 v213, 0, v211
v_xor_b32 v213, v213, v212
v_lshlrev_b32 v213, 4, v213
v_lshl_add_u32 v213, v210, 11, v213
v_add_u32 v196, 0, v213
v_add_u32 v198, 32768, v213
v_add_u32 v200, 65536, v213
v_add_u32 v213, 4, v211
v_xor_b32 v213, v213, v212
v_lshlrev_b32 v213, 4, v213
v_lshl_add_u32 v213, v210, 11, v213
v_add_u32 v197, 16384, v213
v_add_u32 v199, 49152, v213
v_add_u32 v201, 81920, v213
s_mov_b32 s3, 6144
v_mul_lo_u32 v214, v210, s3
v_and_b32 v215, 1, v211
v_or_b32 v213, 0, v215
v_lshlrev_b32 v213, 1, v213
v_xor_b32 v213, v213, v212
v_lshl_add_u32 v213, v213, 4, v214
v_add_u32 v192, 0, v213
v_add_u32 v194, 98304, v213
v_or_b32 v213, 2, v215
v_lshlrev_b32 v213, 1, v213
v_xor_b32 v213, v213, v212
v_lshl_add_u32 v213, v213, 4, v214
v_add_u32 v193, 49152, v213
v_add_u32 v195, 147456, v213
s_waitcnt lgkmcnt(0)
s_lshr_b32 s74, s2, 3
s_lshl_b32 s74, s74, 2
s_add_u32 s74, s74, s42
s_and_b32 s75, s2, 1
s_lshl_b32 s75, s75, 2
s_bfe_u32 s76, s2, 0x20001
s_lshl_b32 s76, s76, 2
s_cmp_lt_u32 s74, 48
s_cbranch_scc0 k1_qkv_w0_k1_st_w
s_mul_i32 s3, s74, 43691
s_lshr_b32 s3, s3, 19
s_mul_i32 s77, s3, 12
s_sub_u32 s77, s74, s77
s_add_u32 s3, s3, s75
s_lshl_b32 s3, s3, 19
s_and_b32 s75, s77, 3
s_lshl_b32 s75, s75, 17
s_add_u32 s3, s3, s75
s_lshr_b32 s77, s77, 2
s_cmp_ge_u32 s77, 1
s_cbranch_scc1 k1_qkv_w0_k1_st_done
s_lshl_b32 s77, s77, 7
s_add_u32 s3, s3, s77
v_lshlrev_b32 v255, 11, v206
v_add_u32 v255, s3, v255
s_mov_b32 s72, s16
s_and_b32 s73, s17, 0xffff
s_mov_b32 s74, 4194304
s_mov_b32 s75, 0x20000
s_branch k1_qkv_w0_k1_st_go
k1_qkv_w0_k1_st_w:
s_cmp_lt_u32 s74, 88
s_cselect_b32 s77, 48, 88
s_cselect_b32 s75, 1, 0
s_sub_u32 s74, s74, s77
s_mul_i32 s3, s74, 52429
s_lshr_b32 s3, s3, 19
s_mul_i32 s77, s3, 10
s_sub_u32 s77, s74, s77
s_cmp_ge_u32 s77, 4
s_cbranch_scc1 k1_qkv_w0_k1_st_done
s_add_u32 s76, s76, s3
s_lshl_b32 s77, s77, 4
v_lshrrev_b32 v255, 2, v206
v_add_u32 v255, s77, v255
v_and_b32 v254, 3, v206
s_cmp_eq_u32 s75, 1
s_cbranch_scc0 k1_qkv_w0_k1_st_q
s_mul_i32 s3, s76, 448
s_and_b32 s3, s3, 0xffffff80
s_mov_b32 s77, 7168
v_mul_lo_u32 v255, v255, s77
v_lshl_add_u32 v255, v254, 7, v255
v_add_u32 v255, s3, v255
s_mov_b32 s72, s26
s_and_b32 s73, s27, 0xffff
s_mov_b32 s74, 7340032
s_mov_b32 s75, 0x20000
s_branch k1_qkv_w0_k1_st_go
k1_qkv_w0_k1_st_q:
s_lshl_b32 s3, s76, 7
s_mov_b32 s77, 6144
v_mul_lo_u32 v255, v255, s77
v_min_u32 v254, 2, v254
v_lshl_add_u32 v255, v254, 11, v255
v_add_u32 v255, s3, v255
s_mov_b32 s72, s18
s_and_b32 s73, s19, 0xffff
s_mov_b32 s74, 6291456
s_mov_b32 s75, 0x20000
k1_qkv_w0_k1_st_go:
buffer_load_dword v254, v255, s[72:75], 0 offen
k1_qkv_w0_k1_st_done:
s_lshl_b32 s3, s44, 19
s_add_u32 s4, s16, s3
s_addc_u32 s5, s17, 0
s_and_b32 s5, s5, 0xffff
s_mov_b32 s50, 524288
s_mov_b32 s6, s50
s_mov_b32 s7, 0x20000
s_mul_i32 s3, s45, 128
s_add_u32 s8, s18, s3
s_addc_u32 s9, s19, 0
s_and_b32 s9, s9, 0xffff
s_sub_u32 s70, 6291456, s3
s_mov_b32 s10, s70
s_mov_b32 s11, 0x20000
s_mov_b32 s51, 196608
s_mov_b32 s48, 0
s_mov_b32 s64, 262144
s_mov_b32 s69, 0
s_mov_b32 s12, s34
s_and_b32 s13, s35, 0xffff
s_mov_b32 s14, 2048
s_mov_b32 s15, 0x20000
v_lshlrev_b32 v213, 4, v206
s_mov_b32 m0, 151552
s_mov_b32 s55, 0
buffer_load_dwordx4 v213, s[12:15], s55 offen lds
s_mov_b32 m0, 152576
s_mov_b32 s55, 1024
buffer_load_dwordx4 v213, s[12:15], s55 offen lds
s_mov_b32 m0, 98304
s_nop 0
buffer_load_dwordx4 v192, s[8:11], s69 offen lds
s_mov_b32 m0, 99328
s_nop 0
buffer_load_dwordx4 v193, s[8:11], s69 offen lds
s_mov_b32 m0, 100352
s_nop 0
buffer_load_dwordx4 v194, s[8:11], s69 offen lds
s_mov_b32 m0, 101376
s_nop 0
buffer_load_dwordx4 v195, s[8:11], s69 offen lds
s_add_u32 s69, s69, s51
s_mov_b32 m0, 0
s_nop 0
DL 196,48
s_mov_b32 m0, 1024
s_nop 0
DL 197,48
s_mov_b32 m0, 2048
s_nop 0
DL 198,48
s_mov_b32 m0, 3072
s_nop 0
DL 199,48
s_mov_b32 m0, 4096
s_nop 0
DL 200,48
s_mov_b32 m0, 5120
s_nop 0
DL 201,48
s_mov_b32 m0, 16384
s_nop 0
DL 196,64
s_mov_b32 m0, 17408
s_nop 0
DL 197,64
s_mov_b32 m0, 18432
s_nop 0
DL 198,64
s_mov_b32 m0, 19456
s_nop 0
DL 199,64
s_mov_b32 m0, 20480
s_nop 0
DL 200,64
s_mov_b32 m0, 21504
s_nop 0
DL 201,64
s_add_u32 s48, s48, 128
s_add_u32 s64, s64, 128
s_mov_b32 m0, 110592
s_nop 0
buffer_load_dwordx4 v192, s[8:11], s69 offen lds
s_mov_b32 m0, 111616
s_nop 0
buffer_load_dwordx4 v193, s[8:11], s69 offen lds
s_mov_b32 m0, 112640
s_nop 0
buffer_load_dwordx4 v194, s[8:11], s69 offen lds
s_mov_b32 m0, 113664
s_nop 0
buffer_load_dwordx4 v195, s[8:11], s69 offen lds
s_add_u32 s69, s69, s51
s_mov_b32 s72, s20
s_and_b32 s73, s21, 0xffff
s_mov_b32 s74, 65536
s_mov_b32 s75, 0x20000
v_lshlrev_b32 v249, 4, v206
s_lshl_b32 s76, s45, 12
s_add_u32 s76, s76, 0
v_and_b32 v210, 15, v206
v_lshrrev_b32 v213, 4, v206
v_lshrrev_b32 v211, 1, v210
v_add_u32 v212, 0, v213
v_xor_b32 v212, v212, v211
v_lshlrev_b32 v212, 4, v212
v_lshl_add_u32 v212, v210, 7, v212
v_add_u32 v202, 0, v212
v_add_u32 v212, 4, v213
v_xor_b32 v212, v212, v211
v_lshlrev_b32 v212, 4, v212
v_lshl_add_u32 v212, v210, 7, v212
v_add_u32 v203, 0, v212
v_bfe_u32 v211, v206, 2, 2
v_lshl_add_u32 v214, v213, 3, v211
v_and_b32 v215, 3, v206
v_lshlrev_b32 v215, 3, v215
v_lshrrev_b32 v216, 1, v211
v_and_b32 v217, 1, v213
v_lshl_or_b32 v216, v217, 1, v216
v_lshl_add_u32 v218, v214, 7, v215
v_add_u32 v218, 98304, v218
v_xor_b32 v219, 0, v216
v_lshl_add_u32 v204, v219, 5, v218
v_xor_b32 v219, 1, v216
v_lshl_add_u32 v207, v219, 5, v218
v_mov_b32 v205, v202
s_mov_b32 s12, s16
s_and_b32 s13, s17, 0xffff
s_mov_b32 s14, 4194304
s_mov_b32 s15, 0x20000
v_lshrrev_b32 v250, 4, v206
s_lshl_b32 s55, s54, 4
s_add_u32 s55, s55, 0
v_add_u32 v250, s55, v250
v_lshlrev_b32 v250, 11, v250
v_and_b32 v251, 15, v206
v_lshl_add_u32 v250, v251, 4, v250
s_waitcnt vmcnt(0) lgkmcnt(0)
s_barrier
TR 32,204,0
TR 34,204,512
RB 0,205,0
RB 4,205,2048
RB 8,205,4096
RB 12,205,6144
RB 16,205,8192
RB 20,205,10240
RB 24,205,12288
RB 28,205,14336
TR 36,207,0
TR 38,207,512
TR 40,204,4096
TR 42,204,4608
TR 44,207,4096
TR 46,207,4608
TR 48,204,8192
TR 50,204,8704
TR 52,207,8192
TR 54,207,8704
s_mov_b32 s46, 0
s_mov_b32 s47, 65536
s_mov_b32 s49, 0
v_mov_b32 v205, v203
s_waitcnt lgkmcnt(0)
s_barrier
MVZ 0,32,0
TR 92,204,12288
s_mov_b32 m0, 32768
MVZ 4,32,4
TR 94,204,12800
DL 196,48
s_mov_b32 m0, 33792
MVZ 8,32,8
DL 197,48
s_mov_b32 m0, 34816
MVZ 12,32,12
RB 60,205,0
DL 198,48
s_mov_b32 m0, 35840
MVZ 16,32,16
DL 199,48
s_mov_b32 m0, 36864
MVZ 20,32,20
RB 64,205,2048
DL 200,48
MVZ 24,32,24
RB 68,205,4096
s_mov_b32 m0, 37888
MVZ 28,32,28
DL 201,48
s_mov_b32 m0, 49152
MVZ 32,36,0
RB 72,205,6144
DL 196,64
s_mov_b32 m0, 50176
MVZ 36,36,4
DL 197,64
s_mov_b32 m0, 51200
MVZ 40,36,8
RB 76,205,8192
DL 198,64
s_mov_b32 m0, 52224
MVZ 44,36,12
RB 80,205,10240
DL 199,64
MVZ 48,36,16
s_mov_b32 m0, 53248
MVZ 52,36,20
RB 84,205,12288
DL 200,64
s_mov_b32 m0, 54272
MVZ 56,36,24
DL 201,64
s_mov_b32 m0, 122880
MVZ 60,36,28
RB 88,205,14336
buffer_load_dwordx4 v192, s[8:11], s69 offen lds
s_mov_b32 m0, 123904
MVZ 64,40,0
buffer_load_dwordx4 v193, s[8:11], s69 offen lds
s_mov_b32 m0, 124928
MVZ 68,40,4
TR 96,207,12288
buffer_load_dwordx4 v194, s[8:11], s69 offen lds
MVZ 72,40,8
TR 98,207,12800
s_mov_b32 m0, 125952
MVZ 76,40,12
buffer_load_dwordx4 v195, s[8:11], s69 offen lds
s_add_u32 s69, s69, s51
s_mov_b32 m0, 135168
MVZ 80,40,16
TR 100,204,16384
buffer_load_dwordx4 v192, s[8:11], s69 offen lds
s_mov_b32 m0, 136192
MVZ 84,40,20
buffer_load_dwordx4 v193, s[8:11], s69 offen lds
s_mov_b32 m0, 137216
MVZ 88,40,24
TR 102,204,16896
buffer_load_dwordx4 v194, s[8:11], s69 offen lds
s_mov_b32 m0, 138240
MVZ 92,40,28
TR 104,207,16384
buffer_load_dwordx4 v195, s[8:11], s69 offen lds
MVZ 96,44,0
s_mov_b32 m0, 147456
MVZ 100,44,4
TR 106,207,16896
buffer_load_dwordx4 v249, s[72:75], s76 offen lds
s_nop 0
MVZ 104,44,8
buffer_load_dwordx4 v[210:213], v250, s[12:15], 0 offen offset:0
s_nop 0
MVZ 108,44,12
TR 108,204,20480
buffer_load_dwordx4 v[214:217], v250, s[12:15], 0 offen offset:256
s_nop 0
MVZ 112,44,16
TR 110,204,20992
buffer_load_dwordx4 v[218:221], v250, s[12:15], 0 offen offset:512
s_nop 0
MVZ 116,44,20
buffer_load_dwordx4 v[222:225], v250, s[12:15], 0 offen offset:768
MVZ 120,44,24
TR 112,207,20480
s_nop 0
MVZ 124,44,28
buffer_load_dwordx4 v[226:229], v250, s[12:15], 0 offen offset:1024
s_nop 0
MVZ 128,48,0
TR 114,207,20992
buffer_load_dwordx4 v[230:233], v250, s[12:15], 0 offen offset:1280
s_nop 0
MVZ 132,48,4
buffer_load_dwordx4 v[234:237], v250, s[12:15], 0 offen offset:1536
s_nop 0
MVZ 136,48,8
buffer_load_dwordx4 v[238:241], v250, s[12:15], 0 offen offset:1792
MVZ 140,48,12
MVZ 144,48,16
MVZ 148,48,20
s_mov_b32 s47, s46
MVZ 152,48,24
s_add_u32 s46, s46, 32768
MVZ 156,48,28
s_cmp_eq_u32 s46, 98304
s_cselect_b32 s46, 0, s46
MVZ 160,52,0
v_add_u32 v205, s46, v202
MVZ 164,52,4
s_add_u32 s49, s49, 1
MVZ 168,52,8
s_add_u32 s69, s69, s51
MVZ 172,52,12
s_add_u32 s48, s48, 128
MVZ 176,52,16
s_add_u32 s64, s64, 128
MVZ 180,52,20
s_cmp_lt_u32 s49, 27
s_cselect_b32 s6, s50, 0
MVZ 184,52,24
s_cmp_lt_u32 s49, 28
s_cselect_b32 s10, s70, 0
MVZ 188,52,28
s_waitcnt vmcnt(13) lgkmcnt(0)
s_barrier
MV 0,92,60
TR 32,204,24576
s_mov_b32 m0, 98304
MV 4,92,64
TR 34,204,25088
buffer_load_dwordx4 v192, s[8:11], s69 offen lds
s_mov_b32 m0, 99328
MV 8,92,68
buffer_load_dwordx4 v193, s[8:11], s69 offen lds
s_mov_b32 m0, 100352
MV 12,92,72
RB 0,205,0
buffer_load_dwordx4 v194, s[8:11], s69 offen lds
MV 16,92,76
s_mov_b32 m0, 101376
MV 20,92,80
RB 4,205,2048
buffer_load_dwordx4 v195, s[8:11], s69 offen lds
s_add_u32 s69, s69, s51
s_mov_b32 m0, 65536
MV 24,92,84
RB 8,205,4096
DL 196,48
s_mov_b32 m0, 66560
MV 28,92,88
DL 197,48
MV 32,96,60
RB 12,205,6144
s_mov_b32 m0, 67584
MV 36,96,64
DL 198,48
s_mov_b32 m0, 68608
MV 40,96,68
RB 16,205,8192
DL 199,48
s_mov_b32 m0, 69632
MV 44,96,72
RB 20,205,10240
DL 200,48
MV 48,96,76
s_mov_b32 m0, 70656
MV 52,96,80
RB 24,205,12288
DL 201,48
s_mov_b32 m0, 81920
MV 56,96,84
DL 196,64
s_mov_b32 m0, 82944
MV 60,96,88
RB 28,205,14336
DL 197,64
MV 64,100,60
s_mov_b32 m0, 83968
MV 68,100,64
TR 36,207,24576
DL 198,64
s_mov_b32 m0, 84992
MV 72,100,68
TR 38,207,25088
DL 199,64
s_mov_b32 m0, 86016
MV 76,100,72
DL 200,64
MV 80,100,76
TR 40,204,28672
s_mov_b32 m0, 87040
MV 84,100,80
DL 201,64
s_add_u32 s48, s48, 128
s_add_u32 s64, s64, 128
s_mov_b32 m0, 110592
MV 88,100,84
TR 42,204,29184
buffer_load_dwordx4 v192, s[8:11], s69 offen lds
s_mov_b32 m0, 111616
MV 92,100,88
TR 44,207,28672
buffer_load_dwordx4 v193, s[8:11], s69 offen lds
MV 96,104,60
s_mov_b32 m0, 112640
MV 100,104,64
TR 46,207,29184
buffer_load_dwordx4 v194, s[8:11], s69 offen lds
s_mov_b32 m0, 113664
MV 104,104,68
buffer_load_dwordx4 v195, s[8:11], s69 offen lds
s_mov_b32 m0, 0
MV 108,104,72
TR 48,204,32768
DL 196,48
MV 112,104,76
TR 50,204,33280
s_mov_b32 m0, 1024
MV 116,104,80
DL 197,48
s_mov_b32 m0, 2048
MV 120,104,84
TR 52,207,32768
DL 198,48
s_mov_b32 m0, 3072
MV 124,104,88
DL 199,48
MV 128,108,60
TR 54,207,33280
s_mov_b32 m0, 4096
MV 132,108,64
DL 200,48
s_mov_b32 m0, 5120
MV 136,108,68
DL 201,48
MV 140,108,72
MV 144,108,76
MV 148,108,80
MV 152,108,84
MV 156,108,88
MV 160,112,60
MV 164,112,64
MV 168,112,68
v_add_u32 v205, s46, v203
MV 172,112,72
s_add_u32 s49, s49, 1
MV 176,112,76
s_add_u32 s69, s69, s51
MV 180,112,80
s_cmp_lt_u32 s49, 27
s_cselect_b32 s6, s50, 0
MV 184,112,84
s_cmp_lt_u32 s49, 28
s_cselect_b32 s10, s70, 0
MV 188,112,88
s_waitcnt vmcnt(26) lgkmcnt(0)
s_barrier
v_and_b32 v250, 15, v206
v_lshlrev_b32 v250, 4, v250
v_add_u32 v251, 151552, v250
s_mov_b32 s60, 0x3f803f80
ds_read_b128 v[242:245], v251 offset:0
ds_read_b128 v[246:249], v251 offset:256
v_mov_b32 v253, v251
s_waitcnt lgkmcnt(1)
D2 v250,v210,v242,0
D2 v251,v210,s60,0
D2 v209,v210,v210,0
D2 v250,v211,v243,v250
D2 v251,v211,s60,v251
D2 v209,v211,v211,v209
D2 v250,v212,v244,v250
D2 v251,v212,s60,v251
D2 v209,v212,v212,v209
D2 v250,v213,v245,v250
D2 v251,v213,s60,v251
D2 v209,v213,v213,v209
ds_read_b128 v[242:245], v253 offset:512
s_waitcnt lgkmcnt(1)
D2 v250,v214,v246,v250
D2 v251,v214,s60,v251
D2 v209,v214,v214,v209
D2 v250,v215,v247,v250
D2 v251,v215,s60,v251
D2 v209,v215,v215,v209
D2 v250,v216,v248,v250
D2 v251,v216,s60,v251
D2 v209,v216,v216,v209
D2 v250,v217,v249,v250
D2 v251,v217,s60,v251
D2 v209,v217,v217,v209
ds_read_b128 v[246:249], v253 offset:768
s_waitcnt lgkmcnt(1)
D2 v250,v218,v242,v250
D2 v251,v218,s60,v251
D2 v209,v218,v218,v209
D2 v250,v219,v243,v250
D2 v251,v219,s60,v251
D2 v209,v219,v219,v209
D2 v250,v220,v244,v250
D2 v251,v220,s60,v251
D2 v209,v220,v220,v209
D2 v250,v221,v245,v250
D2 v251,v221,s60,v251
D2 v209,v221,v221,v209
ds_read_b128 v[242:245], v253 offset:1024
s_waitcnt lgkmcnt(1)
D2 v250,v222,v246,v250
D2 v251,v222,s60,v251
D2 v209,v222,v222,v209
D2 v250,v223,v247,v250
D2 v251,v223,s60,v251
D2 v209,v223,v223,v209
D2 v250,v224,v248,v250
D2 v251,v224,s60,v251
D2 v209,v224,v224,v209
D2 v250,v225,v249,v250
D2 v251,v225,s60,v251
D2 v209,v225,v225,v209
ds_read_b128 v[246:249], v253 offset:1280
s_waitcnt lgkmcnt(1)
D2 v250,v226,v242,v250
D2 v251,v226,s60,v251
D2 v209,v226,v226,v209
D2 v250,v227,v243,v250
D2 v251,v227,s60,v251
D2 v209,v227,v227,v209
D2 v250,v228,v244,v250
D2 v251,v228,s60,v251
D2 v209,v228,v228,v209
D2 v250,v229,v245,v250
D2 v251,v229,s60,v251
D2 v209,v229,v229,v209
ds_read_b128 v[242:245], v253 offset:1536
s_waitcnt lgkmcnt(1)
D2 v250,v230,v246,v250
D2 v251,v230,s60,v251
D2 v209,v230,v230,v209
D2 v250,v231,v247,v250
D2 v251,v231,s60,v251
D2 v209,v231,v231,v209
D2 v250,v232,v248,v250
D2 v251,v232,s60,v251
D2 v209,v232,v232,v209
D2 v250,v233,v249,v250
D2 v251,v233,s60,v251
D2 v209,v233,v233,v209
ds_read_b128 v[246:249], v253 offset:1792
s_waitcnt lgkmcnt(1)
D2 v250,v234,v242,v250
D2 v251,v234,s60,v251
D2 v209,v234,v234,v209
D2 v250,v235,v243,v250
D2 v251,v235,s60,v251
D2 v209,v235,v235,v209
D2 v250,v236,v244,v250
D2 v251,v236,s60,v251
D2 v209,v236,v236,v209
D2 v250,v237,v245,v250
D2 v251,v237,s60,v251
D2 v209,v237,v237,v209
s_waitcnt lgkmcnt(0)
D2 v250,v238,v246,v250
D2 v251,v238,s60,v251
D2 v209,v238,v238,v209
D2 v250,v239,v247,v250
D2 v251,v239,s60,v251
D2 v209,v239,v239,v209
D2 v250,v240,v248,v250
D2 v251,v240,s60,v251
D2 v209,v240,v240,v209
D2 v250,v241,v249,v250
D2 v251,v241,s60,v251
D2 v209,v241,v241,v209
v_lshrrev_b32 v210, 4, v206
s_lshl_b32 s55, s54, 4
s_add_u32 s55, s55, 0
v_add_u32 v210, s55, v210
v_lshlrev_b32 v211, 3, v210
v_lshlrev_b32 v212, 2, v210
v_add_f32_dpp v250, v250, v250 row_ror:8 row_mask:0xf bank_mask:0xf
v_add_f32_dpp v251, v251, v251 row_ror:8 row_mask:0xf bank_mask:0xf
v_add_f32_dpp v209, v209, v209 row_ror:8 row_mask:0xf bank_mask:0xf
v_add_f32_dpp v250, v250, v250 row_ror:4 row_mask:0xf bank_mask:0xf
v_add_f32_dpp v251, v251, v251 row_ror:4 row_mask:0xf bank_mask:0xf
v_add_f32_dpp v209, v209, v209 row_ror:4 row_mask:0xf bank_mask:0xf
v_add_f32_dpp v250, v250, v250 row_ror:2 row_mask:0xf bank_mask:0xf
v_add_f32_dpp v251, v251, v251 row_ror:2 row_mask:0xf bank_mask:0xf
v_add_f32_dpp v209, v209, v209 row_ror:2 row_mask:0xf bank_mask:0xf
v_add_f32_dpp v250, v250, v250 row_ror:1 row_mask:0xf bank_mask:0xf
v_add_f32_dpp v251, v251, v251 row_ror:1 row_mask:0xf bank_mask:0xf
v_add_f32_dpp v209, v209, v209 row_ror:1 row_mask:0xf bank_mask:0xf
v_mul_f32 v250, 0xbfb8aa3b, v250
v_mul_f32 v251, 0xba800000, v251
v_exp_f32 v250, v250
v_mul_f32 v209, 0x3a800000, v209
v_fma_f32 v209, -v251, v251, v209
v_add_f32 v250, 1.0, v250
v_max_f32 v209, 0, v209
v_rcp_f32 v250, v250
v_add_f32 v209, 0x3727c5ac, v209
v_rsq_f32 v214, v209
s_nop 0
v_mul_f32 v215, v251, v214
s_add_u32 s12, s40, 20971520
s_addc_u32 s13, s41, 0
s_and_b32 s13, s13, 0xffff
s_mov_b32 s14, 16384
s_mov_b32 s15, 0x20000
s_mov_b32 exec_lo, 0x00010001
s_mov_b32 exec_hi, 0x00010001
buffer_store_dwordx2 v[214:215], v211, s[12:15], 0 offen sc1
s_add_u32 s12, s40, 22020096
s_addc_u32 s13, s41, 0
s_and_b32 s13, s13, 0xffff
s_mov_b32 s14, 8192
s_mov_b32 s15, 0x20000
buffer_store_dword v250, v212, s[12:15], 0 offen sc1
s_mov_b64 exec, -1
k1_qkv_w0_loop:
MV 0,32,0
TR 92,204,36864
s_mov_b32 m0, 122880
MV 4,32,4
TR 94,204,37376
buffer_load_dwordx4 v192, s[8:11], s69 offen lds
MV 8,32,8
MV 12,32,12
RB 60,205,0
s_mov_b32 m0, 123904
MV 16,32,16
buffer_load_dwordx4 v193, s[8:11], s69 offen lds
MV 20,32,20
RB 64,205,2048
MV 24,32,24
RB 68,205,4096
MV 28,32,28
s_mov_b32 m0, 124928
MV 32,36,0
RB 72,205,6144
buffer_load_dwordx4 v194, s[8:11], s69 offen lds
MV 36,36,4
MV 40,36,8
RB 76,205,8192
s_mov_b32 m0, 125952
MV 44,36,12
RB 80,205,10240
buffer_load_dwordx4 v195, s[8:11], s69 offen lds
MV 48,36,16
MV 52,36,20
RB 84,205,12288
MV 56,36,24
s_add_u32 m0, s47, 16384
MV 60,36,28
RB 88,205,14336
DL 196,64
MV 64,40,0
MV 68,40,4
TR 96,207,36864
s_add_u32 m0, s47, 17408
MV 72,40,8
TR 98,207,37376
DL 197,64
MV 76,40,12
MV 80,40,16
TR 100,204,40960
MV 84,40,20
s_add_u32 m0, s47, 18432
MV 88,40,24
TR 102,204,41472
DL 198,64
MV 92,40,28
TR 104,207,40960
MV 96,44,0
s_add_u32 m0, s47, 19456
MV 100,44,4
TR 106,207,41472
DL 199,64
MV 104,44,8
MV 108,44,12
TR 108,204,45056
MV 112,44,16
TR 110,204,45568
s_add_u32 m0, s47, 20480
MV 116,44,20
DL 200,64
MV 120,44,24
TR 112,207,45056
MV 124,44,28
s_add_u32 m0, s47, 21504
MV 128,48,0
TR 114,207,45568
DL 201,64
MV 132,48,4
MV 136,48,8
MV 140,48,12
MV 144,48,16
MV 148,48,20
s_mov_b32 s47, s46
MV 152,48,24
s_add_u32 s46, s46, 32768
MV 156,48,28
s_cmp_eq_u32 s46, 98304
s_cselect_b32 s46, 0, s46
MV 160,52,0
v_add_u32 v205, s46, v202
MV 164,52,4
s_add_u32 s49, s49, 1
MV 168,52,8
s_add_u32 s69, s69, s51
MV 172,52,12
s_add_u32 s48, s48, 128
MV 176,52,16
s_add_u32 s64, s64, 128
MV 180,52,20
s_cmp_lt_u32 s49, 27
s_cselect_b32 s6, s50, 0
MV 184,52,24
s_cmp_lt_u32 s49, 28
s_cselect_b32 s10, s70, 0
MV 188,52,28
s_waitcnt vmcnt(20) lgkmcnt(0)
s_barrier
MV 0,92,60
TR 32,204,0
s_mov_b32 m0, 135168
MV 4,92,64
TR 34,204,512
buffer_load_dwordx4 v192, s[8:11], s69 offen lds
MV 8,92,68
MV 12,92,72
RB 0,205,0
s_mov_b32 m0, 136192
MV 16,92,76
buffer_load_dwordx4 v193, s[8:11], s69 offen lds
MV 20,92,80
RB 4,205,2048
MV 24,92,84
RB 8,205,4096
MV 28,92,88
s_mov_b32 m0, 137216
MV 32,96,60
RB 12,205,6144
buffer_load_dwordx4 v194, s[8:11], s69 offen lds
MV 36,96,64
MV 40,96,68
RB 16,205,8192
s_mov_b32 m0, 138240
MV 44,96,72
RB 20,205,10240
buffer_load_dwordx4 v195, s[8:11], s69 offen lds
MV 48,96,76
MV 52,96,80
RB 24,205,12288
MV 56,96,84
s_add_u32 m0, s47, 0
MV 60,96,88
RB 28,205,14336
DL 196,48
MV 64,100,60
MV 68,100,64
TR 36,207,0
s_add_u32 m0, s47, 1024
MV 72,100,68
TR 38,207,512
DL 197,48
MV 76,100,72
MV 80,100,76
TR 40,204,4096
MV 84,100,80
s_add_u32 m0, s47, 2048
MV 88,100,84
TR 42,204,4608
DL 198,48
MV 92,100,88
TR 44,207,4096
MV 96,104,60
s_add_u32 m0, s47, 3072
MV 100,104,64
TR 46,207,4608
DL 199,48
MV 104,104,68
MV 108,104,72
TR 48,204,8192
MV 112,104,76
TR 50,204,8704
s_add_u32 m0, s47, 4096
MV 116,104,80
DL 200,48
MV 120,104,84
TR 52,207,8192
MV 124,104,88
s_add_u32 m0, s47, 5120
MV 128,108,60
TR 54,207,8704
DL 201,48
MV 132,108,64
MV 136,108,68
MV 140,108,72
MV 144,108,76
MV 148,108,80
MV 152,108,84
MV 156,108,88
MV 160,112,60
MV 164,112,64
MV 168,112,68
v_add_u32 v205, s46, v203
MV 172,112,72
s_add_u32 s49, s49, 1
MV 176,112,76
s_add_u32 s69, s69, s51
MV 180,112,80
s_cmp_lt_u32 s49, 27
s_cselect_b32 s6, s50, 0
MV 184,112,84
s_cmp_lt_u32 s49, 28
s_cselect_b32 s10, s70, 0
MV 188,112,88
s_waitcnt vmcnt(20) lgkmcnt(0)
s_barrier
s_cmp_eq_u32 s49, 8
s_cbranch_scc0 k1_qkv_w0_a_norep
s_mov_b64 exec, 1
v_mov_b32 v210, 0
v_mov_b32 v211, 1
global_atomic_add v210, v211, s[38:39] sc1
s_mov_b64 exec, -1
k1_qkv_w0_a_norep:
MV 0,32,0
TR 92,204,12288
s_mov_b32 m0, 98304
MV 4,32,4
TR 94,204,12800
buffer_load_dwordx4 v192, s[8:11], s69 offen lds
MV 8,32,8
MV 12,32,12
RB 60,205,0
s_mov_b32 m0, 99328
MV 16,32,16
buffer_load_dwordx4 v193, s[8:11], s69 offen lds
MV 20,32,20
RB 64,205,2048
MV 24,32,24
RB 68,205,4096
MV 28,32,28
s_mov_b32 m0, 100352
MV 32,36,0
RB 72,205,6144
buffer_load_dwordx4 v194, s[8:11], s69 offen lds
MV 36,36,4
MV 40,36,8
RB 76,205,8192
s_mov_b32 m0, 101376
MV 44,36,12
RB 80,205,10240
buffer_load_dwordx4 v195, s[8:11], s69 offen lds
MV 48,36,16
MV 52,36,20
RB 84,205,12288
MV 56,36,24
s_add_u32 m0, s47, 16384
MV 60,36,28
RB 88,205,14336
DL 196,64
MV 64,40,0
MV 68,40,4
TR 96,207,12288
s_add_u32 m0, s47, 17408
MV 72,40,8
TR 98,207,12800
DL 197,64
MV 76,40,12
MV 80,40,16
TR 100,204,16384
MV 84,40,20
s_add_u32 m0, s47, 18432
MV 88,40,24
TR 102,204,16896
DL 198,64
MV 92,40,28
TR 104,207,16384
MV 96,44,0
s_add_u32 m0, s47, 19456
MV 100,44,4
TR 106,207,16896
DL 199,64
MV 104,44,8
MV 108,44,12
TR 108,204,20480
MV 112,44,16
TR 110,204,20992
s_add_u32 m0, s47, 20480
MV 116,44,20
DL 200,64
MV 120,44,24
TR 112,207,20480
MV 124,44,28
s_add_u32 m0, s47, 21504
MV 128,48,0
TR 114,207,20992
DL 201,64
MV 132,48,4
MV 136,48,8
MV 140,48,12
MV 144,48,16
MV 148,48,20
s_mov_b32 s47, s46
MV 152,48,24
s_add_u32 s46, s46, 32768
MV 156,48,28
s_cmp_eq_u32 s46, 98304
s_cselect_b32 s46, 0, s46
MV 160,52,0
v_add_u32 v205, s46, v202
MV 164,52,4
s_add_u32 s49, s49, 1
MV 168,52,8
s_add_u32 s69, s69, s51
MV 172,52,12
s_add_u32 s48, s48, 128
MV 176,52,16
s_add_u32 s64, s64, 128
MV 180,52,20
s_cmp_lt_u32 s49, 27
s_cselect_b32 s6, s50, 0
MV 184,52,24
s_cmp_lt_u32 s49, 28
s_cselect_b32 s10, s70, 0
MV 188,52,28
s_waitcnt vmcnt(20) lgkmcnt(0)
s_barrier
MV 0,92,60
TR 32,204,24576
s_mov_b32 m0, 110592
MV 4,92,64
TR 34,204,25088
buffer_load_dwordx4 v192, s[8:11], s69 offen lds
MV 8,92,68
MV 12,92,72
RB 0,205,0
s_mov_b32 m0, 111616
MV 16,92,76
buffer_load_dwordx4 v193, s[8:11], s69 offen lds
MV 20,92,80
RB 4,205,2048
MV 24,92,84
RB 8,205,4096
MV 28,92,88
s_mov_b32 m0, 112640
MV 32,96,60
RB 12,205,6144
buffer_load_dwordx4 v194, s[8:11], s69 offen lds
MV 36,96,64
MV 40,96,68
RB 16,205,8192
s_mov_b32 m0, 113664
MV 44,96,72
RB 20,205,10240
buffer_load_dwordx4 v195, s[8:11], s69 offen lds
MV 48,96,76
MV 52,96,80
RB 24,205,12288
MV 56,96,84
s_add_u32 m0, s47, 0
MV 60,96,88
RB 28,205,14336
DL 196,48
MV 64,100,60
MV 68,100,64
TR 36,207,24576
s_add_u32 m0, s47, 1024
MV 72,100,68
TR 38,207,25088
DL 197,48
MV 76,100,72
MV 80,100,76
TR 40,204,28672
MV 84,100,80
s_add_u32 m0, s47, 2048
MV 88,100,84
TR 42,204,29184
DL 198,48
MV 92,100,88
TR 44,207,28672
MV 96,104,60
s_add_u32 m0, s47, 3072
MV 100,104,64
TR 46,207,29184
DL 199,48
MV 104,104,68
MV 108,104,72
TR 48,204,32768
MV 112,104,76
TR 50,204,33280
s_add_u32 m0, s47, 4096
MV 116,104,80
DL 200,48
MV 120,104,84
TR 52,207,32768
MV 124,104,88
s_add_u32 m0, s47, 5120
MV 128,108,60
TR 54,207,33280
DL 201,48
MV 132,108,64
MV 136,108,68
MV 140,108,72
MV 144,108,76
MV 148,108,80
MV 152,108,84
MV 156,108,88
MV 160,112,60
MV 164,112,64
MV 168,112,68
v_add_u32 v205, s46, v203
MV 172,112,72
s_add_u32 s49, s49, 1
MV 176,112,76
s_add_u32 s69, s69, s51
MV 180,112,80
s_cmp_lt_u32 s49, 27
s_cselect_b32 s6, s50, 0
MV 184,112,84
s_cmp_lt_u32 s49, 28
s_cselect_b32 s10, s70, 0
MV 188,112,88
s_waitcnt vmcnt(20) lgkmcnt(0)
s_barrier
s_cmp_eq_u32 s49, 8
s_cbranch_scc0 k1_qkv_w0_b_norep
s_mov_b64 exec, 1
v_mov_b32 v210, 0
v_mov_b32 v211, 1
global_atomic_add v210, v211, s[38:39] sc1
s_mov_b64 exec, -1
k1_qkv_w0_b_norep:
s_cmp_lt_u32 s49, 30
s_cbranch_scc1 k1_qkv_w0_loop
MV 0,32,0
TR 92,204,36864
s_mov_b32 m0, 122880
MV 4,32,4
TR 94,204,37376
buffer_load_dwordx4 v192, s[8:11], s69 offen lds
MV 8,32,8
MV 12,32,12
RB 60,205,0
s_mov_b32 m0, 123904
MV 16,32,16
buffer_load_dwordx4 v193, s[8:11], s69 offen lds
MV 20,32,20
RB 64,205,2048
MV 24,32,24
RB 68,205,4096
MV 28,32,28
s_mov_b32 m0, 124928
MV 32,36,0
RB 72,205,6144
buffer_load_dwordx4 v194, s[8:11], s69 offen lds
MV 36,36,4
MV 40,36,8
RB 76,205,8192
s_mov_b32 m0, 125952
MV 44,36,12
RB 80,205,10240
buffer_load_dwordx4 v195, s[8:11], s69 offen lds
MV 48,36,16
MV 52,36,20
RB 84,205,12288
MV 56,36,24
s_add_u32 m0, s47, 16384
MV 60,36,28
RB 88,205,14336
DL 196,64
MV 64,40,0
MV 68,40,4
TR 96,207,36864
s_add_u32 m0, s47, 17408
MV 72,40,8
TR 98,207,37376
DL 197,64
MV 76,40,12
MV 80,40,16
TR 100,204,40960
MV 84,40,20
s_add_u32 m0, s47, 18432
MV 88,40,24
TR 102,204,41472
DL 198,64
MV 92,40,28
TR 104,207,40960
MV 96,44,0
s_add_u32 m0, s47, 19456
MV 100,44,4
TR 106,207,41472
DL 199,64
MV 104,44,8
MV 108,44,12
TR 108,204,45056
MV 112,44,16
TR 110,204,45568
s_add_u32 m0, s47, 20480
MV 116,44,20
DL 200,64
MV 120,44,24
TR 112,207,45056
MV 124,44,28
s_add_u32 m0, s47, 21504
MV 128,48,0
TR 114,207,45568
DL 201,64
MV 132,48,4
MV 136,48,8
MV 140,48,12
MV 144,48,16
MV 148,48,20
s_mov_b32 s47, s46
MV 152,48,24
s_add_u32 s46, s46, 32768
MV 156,48,28
s_cmp_eq_u32 s46, 98304
s_cselect_b32 s46, 0, s46
MV 160,52,0
v_add_u32 v205, s46, v202
MV 164,52,4
s_add_u32 s49, s49, 1
MV 168,52,8
s_add_u32 s69, s69, s51
MV 172,52,12
s_add_u32 s48, s48, 128
MV 176,52,16
s_add_u32 s64, s64, 128
MV 180,52,20
s_cmp_lt_u32 s49, 27
s_cselect_b32 s6, s50, 0
MV 184,52,24
s_cmp_lt_u32 s49, 28
s_cselect_b32 s10, s70, 0
MV 188,52,28
s_waitcnt vmcnt(20) lgkmcnt(0)
s_barrier
MV 0,92,60
MV 4,92,64
MV 8,92,68
MV 12,92,72
MV 16,92,76
MV 20,92,80
MV 24,92,84
MV 28,92,88
MV 32,96,60
MV 36,96,64
MV 40,96,68
MV 44,96,72
MV 48,96,76
MV 52,96,80
MV 56,96,84
MV 60,96,88
MV 64,100,60
MV 68,100,64
MV 72,100,68
MV 76,100,72
MV 80,100,76
MV 84,100,80
MV 88,100,84
MV 92,100,88
MV 96,104,60
MV 100,104,64
MV 104,104,68
MV 108,104,72
MV 112,104,76
MV 116,104,80
MV 120,104,84
MV 124,104,88
MV 128,108,60
MV 132,108,64
MV 136,108,68
MV 140,108,72
MV 144,108,76
MV 148,108,80
MV 152,108,84
MV 156,108,88
MV 160,112,60
MV 164,112,64
MV 168,112,68
MV 172,112,72
MV 176,112,76
MV 180,112,80
MV 184,112,84
MV 188,112,88
s_waitcnt vmcnt(0) lgkmcnt(0)
s_barrier
s_branch k1_qkv_epi
k1_qkv_w1:
s_mov_b32 s52, 0
s_mov_b32 s53, 1
s_lshl_b32 s54, s44, 4
s_add_u32 s54, s54, s45
v_lshrrev_b32 v210, 3, v206
v_lshrrev_b32 v211, 4, v206
v_and_b32 v212, 7, v206
v_add_u32 v213, 0, v211
v_xor_b32 v213, v213, v212
v_lshlrev_b32 v213, 4, v213
v_lshl_add_u32 v213, v210, 11, v213
v_add_u32 v196, 98304, v213
v_add_u32 v198, 131072, v213
v_add_u32 v200, 163840, v213
v_add_u32 v213, 4, v211
v_xor_b32 v213, v213, v212
v_lshlrev_b32 v213, 4, v213
v_lshl_add_u32 v213, v210, 11, v213
v_add_u32 v197, 114688, v213
v_add_u32 v199, 147456, v213
s_mov_b32 s3, 6144
v_mul_lo_u32 v214, v210, s3
v_and_b32 v215, 1, v211
v_or_b32 v213, 0, v215
v_lshlrev_b32 v213, 1, v213
v_xor_b32 v213, v213, v212
v_lshl_add_u32 v213, v213, 4, v214
v_add_u32 v192, 2048, v213
v_add_u32 v194, 100352, v213
v_or_b32 v213, 2, v215
v_lshlrev_b32 v213, 1, v213
v_xor_b32 v213, v213, v212
v_lshl_add_u32 v213, v213, 4, v214
v_add_u32 v193, 51200, v213
v_add_u32 v195, 149504, v213
s_waitcnt lgkmcnt(0)
s_lshr_b32 s74, s2, 3
s_lshl_b32 s74, s74, 2
s_add_u32 s74, s74, s42
s_and_b32 s75, s2, 1
s_lshl_b32 s75, s75, 2
s_bfe_u32 s76, s2, 0x20001
s_lshl_b32 s76, s76, 2
s_cmp_lt_u32 s74, 48
s_cbranch_scc0 k1_qkv_w1_k1_st_w
s_mul_i32 s3, s74, 43691
s_lshr_b32 s3, s3, 19
s_mul_i32 s77, s3, 12
s_sub_u32 s77, s74, s77
s_add_u32 s3, s3, s75
s_lshl_b32 s3, s3, 19
s_and_b32 s75, s77, 3
s_lshl_b32 s75, s75, 17
s_add_u32 s3, s3, s75
s_lshr_b32 s77, s77, 2
s_cmp_ge_u32 s77, 1
s_cbranch_scc1 k1_qkv_w1_k1_st_done
s_lshl_b32 s77, s77, 7
s_add_u32 s3, s3, s77
v_lshlrev_b32 v255, 11, v206
v_add_u32 v255, s3, v255
s_mov_b32 s72, s16
s_and_b32 s73, s17, 0xffff
s_mov_b32 s74, 4194304
s_mov_b32 s75, 0x20000
s_branch k1_qkv_w1_k1_st_go
k1_qkv_w1_k1_st_w:
s_cmp_lt_u32 s74, 88
s_cselect_b32 s77, 48, 88
s_cselect_b32 s75, 1, 0
s_sub_u32 s74, s74, s77
s_mul_i32 s3, s74, 52429
s_lshr_b32 s3, s3, 19
s_mul_i32 s77, s3, 10
s_sub_u32 s77, s74, s77
s_cmp_ge_u32 s77, 4
s_cbranch_scc1 k1_qkv_w1_k1_st_done
s_add_u32 s76, s76, s3
s_lshl_b32 s77, s77, 4
v_lshrrev_b32 v255, 2, v206
v_add_u32 v255, s77, v255
v_and_b32 v254, 3, v206
s_cmp_eq_u32 s75, 1
s_cbranch_scc0 k1_qkv_w1_k1_st_q
s_mul_i32 s3, s76, 448
s_and_b32 s3, s3, 0xffffff80
s_mov_b32 s77, 7168
v_mul_lo_u32 v255, v255, s77
v_lshl_add_u32 v255, v254, 7, v255
v_add_u32 v255, s3, v255
s_mov_b32 s72, s26
s_and_b32 s73, s27, 0xffff
s_mov_b32 s74, 7340032
s_mov_b32 s75, 0x20000
s_branch k1_qkv_w1_k1_st_go
k1_qkv_w1_k1_st_q:
s_lshl_b32 s3, s76, 7
s_mov_b32 s77, 6144
v_mul_lo_u32 v255, v255, s77
v_min_u32 v254, 2, v254
v_lshl_add_u32 v255, v254, 11, v255
v_add_u32 v255, s3, v255
s_mov_b32 s72, s18
s_and_b32 s73, s19, 0xffff
s_mov_b32 s74, 6291456
s_mov_b32 s75, 0x20000
k1_qkv_w1_k1_st_go:
buffer_load_dword v254, v255, s[72:75], 0 offen
k1_qkv_w1_k1_st_done:
s_lshl_b32 s3, s44, 19
s_add_u32 s4, s16, s3
s_addc_u32 s5, s17, 0
s_and_b32 s5, s5, 0xffff
s_mov_b32 s50, 524288
s_mov_b32 s6, s50
s_mov_b32 s7, 0x20000
s_mul_i32 s3, s45, 128
s_add_u32 s8, s18, s3
s_addc_u32 s9, s19, 0
s_and_b32 s9, s9, 0xffff
s_sub_u32 s70, 6291456, s3
s_mov_b32 s10, s70
s_mov_b32 s11, 0x20000
s_mov_b32 s51, 196608
s_mov_b32 s48, 0
s_mov_b32 s64, 262144
s_mov_b32 s69, 0
s_mov_b32 m0, 102400
s_nop 0
buffer_load_dwordx4 v192, s[8:11], s69 offen lds
s_mov_b32 m0, 103424
s_nop 0
buffer_load_dwordx4 v193, s[8:11], s69 offen lds
s_mov_b32 m0, 104448
s_nop 0
buffer_load_dwordx4 v194, s[8:11], s69 offen lds
s_mov_b32 m0, 105472
s_nop 0
buffer_load_dwordx4 v195, s[8:11], s69 offen lds
s_add_u32 s69, s69, s51
s_mov_b32 m0, 6144
s_nop 0
DL 196,48
s_mov_b32 m0, 7168
s_nop 0
DL 197,48
s_mov_b32 m0, 8192
s_nop 0
DL 198,48
s_mov_b32 m0, 9216
s_nop 0
DL 199,48
s_mov_b32 m0, 10240
s_nop 0
DL 200,48
s_mov_b32 m0, 22528
s_nop 0
DL 196,64
s_mov_b32 m0, 23552
s_nop 0
DL 197,64
s_mov_b32 m0, 24576
s_nop 0
DL 198,64
s_mov_b32 m0, 25600
s_nop 0
DL 199,64
s_mov_b32 m0, 26624
s_nop 0
DL 200,64
s_add_u32 s48, s48, 128
s_add_u32 s64, s64, 128
s_mov_b32 m0, 114688
s_nop 0
buffer_load_dwordx4 v192, s[8:11], s69 offen lds
s_mov_b32 m0, 115712
s_nop 0
buffer_load_dwordx4 v193, s[8:11], s69 offen lds
s_mov_b32 m0, 116736
s_nop 0
buffer_load_dwordx4 v194, s[8:11], s69 offen lds
s_mov_b32 m0, 117760
s_nop 0
buffer_load_dwordx4 v195, s[8:11], s69 offen lds
s_add_u32 s69, s69, s51
s_mov_b32 s72, s20
s_and_b32 s73, s21, 0xffff
s_mov_b32 s74, 65536
s_mov_b32 s75, 0x20000
v_lshlrev_b32 v249, 4, v206
s_lshl_b32 s76, s45, 12
s_add_u32 s76, s76, 1024
v_and_b32 v210, 15, v206
v_lshrrev_b32 v213, 4, v206
v_lshrrev_b32 v211, 1, v210
v_add_u32 v212, 0, v213
v_xor_b32 v212, v212, v211
v_lshlrev_b32 v212, 4, v212
v_lshl_add_u32 v212, v210, 7, v212
v_add_u32 v202, 0, v212
v_add_u32 v212, 4, v213
v_xor_b32 v212, v212, v211
v_lshlrev_b32 v212, 4, v212
v_lshl_add_u32 v212, v210, 7, v212
v_add_u32 v203, 0, v212
v_bfe_u32 v211, v206, 2, 2
v_lshl_add_u32 v214, v213, 3, v211
v_and_b32 v215, 3, v206
v_lshlrev_b32 v215, 3, v215
v_lshrrev_b32 v216, 1, v211
v_and_b32 v217, 1, v213
v_lshl_or_b32 v216, v217, 1, v216
v_lshl_add_u32 v218, v214, 7, v215
v_add_u32 v218, 98304, v218
v_xor_b32 v219, 2, v216
v_lshl_add_u32 v204, v219, 5, v218
v_xor_b32 v219, 3, v216
v_lshl_add_u32 v207, v219, 5, v218
v_mov_b32 v205, v202
s_mov_b32 s12, s16
s_and_b32 s13, s17, 0xffff
s_mov_b32 s14, 4194304
s_mov_b32 s15, 0x20000
v_lshrrev_b32 v250, 4, v206
s_lshl_b32 s55, s54, 4
s_add_u32 s55, s55, 4
v_add_u32 v250, s55, v250
v_lshlrev_b32 v250, 11, v250
v_and_b32 v251, 15, v206
v_lshl_add_u32 v250, v251, 4, v250
s_waitcnt vmcnt(0) lgkmcnt(0)
s_barrier
TR 32,204,0
TR 34,204,512
RB 0,205,0
RB 4,205,2048
RB 8,205,4096
RB 12,205,6144
RB 16,205,8192
RB 20,205,10240
RB 24,205,12288
RB 28,205,14336
TR 36,207,0
TR 38,207,512
TR 40,204,4096
TR 42,204,4608
TR 44,207,4096
TR 46,207,4608
TR 48,204,8192
TR 50,204,8704
TR 52,207,8192
TR 54,207,8704
s_mov_b32 s46, 0
s_mov_b32 s47, 65536
s_mov_b32 s49, 0
v_mov_b32 v205, v203
s_waitcnt lgkmcnt(0)
s_barrier
MVZ 0,32,0
TR 92,204,12288
MVZ 4,32,4
TR 94,204,12800
s_mov_b32 m0, 38912
MVZ 8,32,8
DL 196,48
s_mov_b32 m0, 39936
MVZ 12,32,12
RB 60,205,0
DL 197,48
s_mov_b32 m0, 40960
MVZ 16,32,16
DL 198,48
s_mov_b32 m0, 41984
MVZ 20,32,20
RB 64,205,2048
DL 199,48
MVZ 24,32,24
RB 68,205,4096
s_mov_b32 m0, 43008
MVZ 28,32,28
DL 200,48
s_mov_b32 m0, 55296
MVZ 32,36,0
RB 72,205,6144
DL 196,64
s_mov_b32 m0, 56320
MVZ 36,36,4
DL 197,64
s_mov_b32 m0, 57344
MVZ 40,36,8
RB 76,205,8192
DL 198,64
MVZ 44,36,12
RB 80,205,10240
s_mov_b32 m0, 58368
MVZ 48,36,16
DL 199,64
s_mov_b32 m0, 59392
MVZ 52,36,20
RB 84,205,12288
DL 200,64
s_mov_b32 m0, 126976
MVZ 56,36,24
buffer_load_dwordx4 v192, s[8:11], s69 offen lds
s_mov_b32 m0, 128000
MVZ 60,36,28
RB 88,205,14336
buffer_load_dwordx4 v193, s[8:11], s69 offen lds
MVZ 64,40,0
s_mov_b32 m0, 129024
MVZ 68,40,4
TR 96,207,12288
buffer_load_dwordx4 v194, s[8:11], s69 offen lds
s_mov_b32 m0, 130048
MVZ 72,40,8
TR 98,207,12800
buffer_load_dwordx4 v195, s[8:11], s69 offen lds
s_add_u32 s69, s69, s51
s_mov_b32 m0, 139264
MVZ 76,40,12
buffer_load_dwordx4 v192, s[8:11], s69 offen lds
s_mov_b32 m0, 140288
MVZ 80,40,16
TR 100,204,16384
buffer_load_dwordx4 v193, s[8:11], s69 offen lds
MVZ 84,40,20
s_mov_b32 m0, 141312
MVZ 88,40,24
TR 102,204,16896
buffer_load_dwordx4 v194, s[8:11], s69 offen lds
s_mov_b32 m0, 142336
MVZ 92,40,28
TR 104,207,16384
buffer_load_dwordx4 v195, s[8:11], s69 offen lds
s_mov_b32 m0, 148480
MVZ 96,44,0
buffer_load_dwordx4 v249, s[72:75], s76 offen lds
s_nop 0
MVZ 100,44,4
TR 106,207,16896
buffer_load_dwordx4 v[210:213], v250, s[12:15], 0 offen offset:0
MVZ 104,44,8
s_nop 0
MVZ 108,44,12
TR 108,204,20480
buffer_load_dwordx4 v[214:217], v250, s[12:15], 0 offen offset:256
s_nop 0
MVZ 112,44,16
TR 110,204,20992
buffer_load_dwordx4 v[218:221], v250, s[12:15], 0 offen offset:512
s_nop 0
MVZ 116,44,20
buffer_load_dwordx4 v[222:225], v250, s[12:15], 0 offen offset:768
s_nop 0
MVZ 120,44,24
TR 112,207,20480
buffer_load_dwordx4 v[226:229], v250, s[12:15], 0 offen offset:1024
MVZ 124,44,28
s_nop 0
MVZ 128,48,0
TR 114,207,20992
buffer_load_dwordx4 v[230:233], v250, s[12:15], 0 offen offset:1280
s_nop 0
MVZ 132,48,4
buffer_load_dwordx4 v[234:237], v250, s[12:15], 0 offen offset:1536
s_nop 0
MVZ 136,48,8
buffer_load_dwordx4 v[238:241], v250, s[12:15], 0 offen offset:1792
MVZ 140,48,12
MVZ 144,48,16
MVZ 148,48,20
s_mov_b32 s47, s46
MVZ 152,48,24
s_add_u32 s46, s46, 32768
MVZ 156,48,28
s_cmp_eq_u32 s46, 98304
s_cselect_b32 s46, 0, s46
MVZ 160,52,0
v_add_u32 v205, s46, v202
MVZ 164,52,4
s_add_u32 s49, s49, 1
MVZ 168,52,8
s_add_u32 s69, s69, s51
MVZ 172,52,12
s_add_u32 s48, s48, 128
MVZ 176,52,16
s_add_u32 s64, s64, 128
MVZ 180,52,20
s_cmp_lt_u32 s49, 27
s_cselect_b32 s6, s50, 0
MVZ 184,52,24
s_cmp_lt_u32 s49, 28
s_cselect_b32 s10, s70, 0
MVZ 188,52,28
s_waitcnt vmcnt(13) lgkmcnt(0)
s_barrier
MV 0,92,60
TR 32,204,24576
MV 4,92,64
TR 34,204,25088
s_mov_b32 m0, 102400
MV 8,92,68
buffer_load_dwordx4 v192, s[8:11], s69 offen lds
s_mov_b32 m0, 103424
MV 12,92,72
RB 0,205,0
buffer_load_dwordx4 v193, s[8:11], s69 offen lds
s_mov_b32 m0, 104448
MV 16,92,76
buffer_load_dwordx4 v194, s[8:11], s69 offen lds
MV 20,92,80
RB 4,205,2048
s_mov_b32 m0, 105472
MV 24,92,84
RB 8,205,4096
buffer_load_dwordx4 v195, s[8:11], s69 offen lds
s_add_u32 s69, s69, s51
s_mov_b32 m0, 71680
MV 28,92,88
DL 196,48
MV 32,96,60
RB 12,205,6144
s_mov_b32 m0, 72704
MV 36,96,64
DL 197,48
s_mov_b32 m0, 73728
MV 40,96,68
RB 16,205,8192
DL 198,48
MV 44,96,72
RB 20,205,10240
s_mov_b32 m0, 74752
MV 48,96,76
DL 199,48
s_mov_b32 m0, 75776
MV 52,96,80
RB 24,205,12288
DL 200,48
MV 56,96,84
s_mov_b32 m0, 88064
MV 60,96,88
RB 28,205,14336
DL 196,64
s_mov_b32 m0, 89088
MV 64,100,60
DL 197,64
MV 68,100,64
TR 36,207,24576
s_mov_b32 m0, 90112
MV 72,100,68
TR 38,207,25088
DL 198,64
s_mov_b32 m0, 91136
MV 76,100,72
DL 199,64
MV 80,100,76
TR 40,204,28672
s_mov_b32 m0, 92160
MV 84,100,80
DL 200,64
s_add_u32 s48, s48, 128
s_add_u32 s64, s64, 128
s_mov_b32 m0, 114688
MV 88,100,84
TR 42,204,29184
buffer_load_dwordx4 v192, s[8:11], s69 offen lds
MV 92,100,88
TR 44,207,28672
s_mov_b32 m0, 115712
MV 96,104,60
buffer_load_dwordx4 v193, s[8:11], s69 offen lds
s_mov_b32 m0, 116736
MV 100,104,64
TR 46,207,29184
buffer_load_dwordx4 v194, s[8:11], s69 offen lds
MV 104,104,68
s_mov_b32 m0, 117760
MV 108,104,72
TR 48,204,32768
buffer_load_dwordx4 v195, s[8:11], s69 offen lds
s_mov_b32 m0, 6144
MV 112,104,76
TR 50,204,33280
DL 196,48
MV 116,104,80
s_mov_b32 m0, 7168
MV 120,104,84
TR 52,207,32768
DL 197,48
s_mov_b32 m0, 8192
MV 124,104,88
DL 198,48
MV 128,108,60
TR 54,207,33280
s_mov_b32 m0, 9216
MV 132,108,64
DL 199,48
s_mov_b32 m0, 10240
MV 136,108,68
DL 200,48
MV 140,108,72
MV 144,108,76
MV 148,108,80
MV 152,108,84
MV 156,108,88
MV 160,112,60
MV 164,112,64
MV 168,112,68
v_add_u32 v205, s46, v203
MV 172,112,72
s_add_u32 s49, s49, 1
MV 176,112,76
s_add_u32 s69, s69, s51
MV 180,112,80
s_cmp_lt_u32 s49, 27
s_cselect_b32 s6, s50, 0
MV 184,112,84
s_cmp_lt_u32 s49, 28
s_cselect_b32 s10, s70, 0
MV 188,112,88
s_waitcnt vmcnt(23) lgkmcnt(0)
s_barrier
v_and_b32 v250, 15, v206
v_lshlrev_b32 v250, 4, v250
v_add_u32 v251, 151552, v250
s_mov_b32 s60, 0x3f803f80
ds_read_b128 v[242:245], v251 offset:0
ds_read_b128 v[246:249], v251 offset:256
v_mov_b32 v253, v251
s_waitcnt lgkmcnt(1)
D2 v250,v210,v242,0
D2 v251,v210,s60,0
D2 v209,v210,v210,0
D2 v250,v211,v243,v250
D2 v251,v211,s60,v251
D2 v209,v211,v211,v209
D2 v250,v212,v244,v250
D2 v251,v212,s60,v251
D2 v209,v212,v212,v209
D2 v250,v213,v245,v250
D2 v251,v213,s60,v251
D2 v209,v213,v213,v209
ds_read_b128 v[242:245], v253 offset:512
s_waitcnt lgkmcnt(1)
D2 v250,v214,v246,v250
D2 v251,v214,s60,v251
D2 v209,v214,v214,v209
D2 v250,v215,v247,v250
D2 v251,v215,s60,v251
D2 v209,v215,v215,v209
D2 v250,v216,v248,v250
D2 v251,v216,s60,v251
D2 v209,v216,v216,v209
D2 v250,v217,v249,v250
D2 v251,v217,s60,v251
D2 v209,v217,v217,v209
ds_read_b128 v[246:249], v253 offset:768
s_waitcnt lgkmcnt(1)
D2 v250,v218,v242,v250
D2 v251,v218,s60,v251
D2 v209,v218,v218,v209
D2 v250,v219,v243,v250
D2 v251,v219,s60,v251
D2 v209,v219,v219,v209
D2 v250,v220,v244,v250
D2 v251,v220,s60,v251
D2 v209,v220,v220,v209
D2 v250,v221,v245,v250
D2 v251,v221,s60,v251
D2 v209,v221,v221,v209
ds_read_b128 v[242:245], v253 offset:1024
s_waitcnt lgkmcnt(1)
D2 v250,v222,v246,v250
D2 v251,v222,s60,v251
D2 v209,v222,v222,v209
D2 v250,v223,v247,v250
D2 v251,v223,s60,v251
D2 v209,v223,v223,v209
D2 v250,v224,v248,v250
D2 v251,v224,s60,v251
D2 v209,v224,v224,v209
D2 v250,v225,v249,v250
D2 v251,v225,s60,v251
D2 v209,v225,v225,v209
ds_read_b128 v[246:249], v253 offset:1280
s_waitcnt lgkmcnt(1)
D2 v250,v226,v242,v250
D2 v251,v226,s60,v251
D2 v209,v226,v226,v209
D2 v250,v227,v243,v250
D2 v251,v227,s60,v251
D2 v209,v227,v227,v209
D2 v250,v228,v244,v250
D2 v251,v228,s60,v251
D2 v209,v228,v228,v209
D2 v250,v229,v245,v250
D2 v251,v229,s60,v251
D2 v209,v229,v229,v209
ds_read_b128 v[242:245], v253 offset:1536
s_waitcnt lgkmcnt(1)
D2 v250,v230,v246,v250
D2 v251,v230,s60,v251
D2 v209,v230,v230,v209
D2 v250,v231,v247,v250
D2 v251,v231,s60,v251
D2 v209,v231,v231,v209
D2 v250,v232,v248,v250
D2 v251,v232,s60,v251
D2 v209,v232,v232,v209
D2 v250,v233,v249,v250
D2 v251,v233,s60,v251
D2 v209,v233,v233,v209
ds_read_b128 v[246:249], v253 offset:1792
s_waitcnt lgkmcnt(1)
D2 v250,v234,v242,v250
D2 v251,v234,s60,v251
D2 v209,v234,v234,v209
D2 v250,v235,v243,v250
D2 v251,v235,s60,v251
D2 v209,v235,v235,v209
D2 v250,v236,v244,v250
D2 v251,v236,s60,v251
D2 v209,v236,v236,v209
D2 v250,v237,v245,v250
D2 v251,v237,s60,v251
D2 v209,v237,v237,v209
s_waitcnt lgkmcnt(0)
D2 v250,v238,v246,v250
D2 v251,v238,s60,v251
D2 v209,v238,v238,v209
D2 v250,v239,v247,v250
D2 v251,v239,s60,v251
D2 v209,v239,v239,v209
D2 v250,v240,v248,v250
D2 v251,v240,s60,v251
D2 v209,v240,v240,v209
D2 v250,v241,v249,v250
D2 v251,v241,s60,v251
D2 v209,v241,v241,v209
v_lshrrev_b32 v210, 4, v206
s_lshl_b32 s55, s54, 4
s_add_u32 s55, s55, 4
v_add_u32 v210, s55, v210
v_lshlrev_b32 v211, 3, v210
v_lshlrev_b32 v212, 2, v210
v_add_f32_dpp v250, v250, v250 row_ror:8 row_mask:0xf bank_mask:0xf
v_add_f32_dpp v251, v251, v251 row_ror:8 row_mask:0xf bank_mask:0xf
v_add_f32_dpp v209, v209, v209 row_ror:8 row_mask:0xf bank_mask:0xf
v_add_f32_dpp v250, v250, v250 row_ror:4 row_mask:0xf bank_mask:0xf
v_add_f32_dpp v251, v251, v251 row_ror:4 row_mask:0xf bank_mask:0xf
v_add_f32_dpp v209, v209, v209 row_ror:4 row_mask:0xf bank_mask:0xf
v_add_f32_dpp v250, v250, v250 row_ror:2 row_mask:0xf bank_mask:0xf
v_add_f32_dpp v251, v251, v251 row_ror:2 row_mask:0xf bank_mask:0xf
v_add_f32_dpp v209, v209, v209 row_ror:2 row_mask:0xf bank_mask:0xf
v_add_f32_dpp v250, v250, v250 row_ror:1 row_mask:0xf bank_mask:0xf
v_add_f32_dpp v251, v251, v251 row_ror:1 row_mask:0xf bank_mask:0xf
v_add_f32_dpp v209, v209, v209 row_ror:1 row_mask:0xf bank_mask:0xf
v_mul_f32 v250, 0xbfb8aa3b, v250
v_mul_f32 v251, 0xba800000, v251
v_exp_f32 v250, v250
v_mul_f32 v209, 0x3a800000, v209
v_fma_f32 v209, -v251, v251, v209
v_add_f32 v250, 1.0, v250
v_max_f32 v209, 0, v209
v_rcp_f32 v250, v250
v_add_f32 v209, 0x3727c5ac, v209
v_rsq_f32 v214, v209
s_nop 0
v_mul_f32 v215, v251, v214
s_add_u32 s12, s40, 20971520
s_addc_u32 s13, s41, 0
s_and_b32 s13, s13, 0xffff
s_mov_b32 s14, 16384
s_mov_b32 s15, 0x20000
s_mov_b32 exec_lo, 0x00010001
s_mov_b32 exec_hi, 0x00010001
buffer_store_dwordx2 v[214:215], v211, s[12:15], 0 offen sc1
s_add_u32 s12, s40, 22020096
s_addc_u32 s13, s41, 0
s_and_b32 s13, s13, 0xffff
s_mov_b32 s14, 8192
s_mov_b32 s15, 0x20000
buffer_store_dword v250, v212, s[12:15], 0 offen sc1
s_mov_b64 exec, -1
k1_qkv_w1_loop:
MV 0,32,0
TR 92,204,36864
MV 4,32,4
TR 94,204,37376
MV 8,32,8
s_mov_b32 m0, 126976
MV 12,32,12
RB 60,205,0
buffer_load_dwordx4 v192, s[8:11], s69 offen lds
MV 16,32,16
MV 20,32,20
RB 64,205,2048
s_mov_b32 m0, 128000
MV 24,32,24
RB 68,205,4096
buffer_load_dwordx4 v193, s[8:11], s69 offen lds
MV 28,32,28
MV 32,36,0
RB 72,205,6144
MV 36,36,4
s_mov_b32 m0, 129024
MV 40,36,8
RB 76,205,8192
buffer_load_dwordx4 v194, s[8:11], s69 offen lds
MV 44,36,12
RB 80,205,10240
MV 48,36,16
MV 52,36,20
RB 84,205,12288
s_mov_b32 m0, 130048
MV 56,36,24
buffer_load_dwordx4 v195, s[8:11], s69 offen lds
MV 60,36,28
RB 88,205,14336
MV 64,40,0
s_add_u32 m0, s47, 22528
MV 68,40,4
TR 96,207,36864
DL 196,64
MV 72,40,8
TR 98,207,37376
MV 76,40,12
MV 80,40,16
TR 100,204,40960
s_add_u32 m0, s47, 23552
MV 84,40,20
DL 197,64
MV 88,40,24
TR 102,204,41472
MV 92,40,28
TR 104,207,40960
MV 96,44,0
s_add_u32 m0, s47, 24576
MV 100,44,4
TR 106,207,41472
DL 198,64
MV 104,44,8
MV 108,44,12
TR 108,204,45056
s_add_u32 m0, s47, 25600
MV 112,44,16
TR 110,204,45568
DL 199,64
MV 116,44,20
MV 120,44,24
TR 112,207,45056
MV 124,44,28
s_add_u32 m0, s47, 26624
MV 128,48,0
TR 114,207,45568
DL 200,64
MV 132,48,4
MV 136,48,8
MV 140,48,12
MV 144,48,16
MV 148,48,20
s_mov_b32 s47, s46
MV 152,48,24
s_add_u32 s46, s46, 32768
MV 156,48,28
s_cmp_eq_u32 s46, 98304
s_cselect_b32 s46, 0, s46
MV 160,52,0
v_add_u32 v205, s46, v202
MV 164,52,4
s_add_u32 s49, s49, 1
MV 168,52,8
s_add_u32 s69, s69, s51
MV 172,52,12
s_add_u32 s48, s48, 128
MV 176,52,16
s_add_u32 s64, s64, 128
MV 180,52,20
s_cmp_lt_u32 s49, 27
s_cselect_b32 s6, s50, 0
MV 184,52,24
s_cmp_lt_u32 s49, 28
s_cselect_b32 s10, s70, 0
MV 188,52,28
s_waitcnt vmcnt(18) lgkmcnt(0)
s_barrier
MV 0,92,60
TR 32,204,0
MV 4,92,64
TR 34,204,512
MV 8,92,68
s_mov_b32 m0, 139264
MV 12,92,72
RB 0,205,0
buffer_load_dwordx4 v192, s[8:11], s69 offen lds
MV 16,92,76
MV 20,92,80
RB 4,205,2048
s_mov_b32 m0, 140288
MV 24,92,84
RB 8,205,4096
buffer_load_dwordx4 v193, s[8:11], s69 offen lds
MV 28,92,88
MV 32,96,60
RB 12,205,6144
MV 36,96,64
s_mov_b32 m0, 141312
MV 40,96,68
RB 16,205,8192
buffer_load_dwordx4 v194, s[8:11], s69 offen lds
MV 44,96,72
RB 20,205,10240
MV 48,96,76
MV 52,96,80
RB 24,205,12288
s_mov_b32 m0, 142336
MV 56,96,84
buffer_load_dwordx4 v195, s[8:11], s69 offen lds
MV 60,96,88
RB 28,205,14336
MV 64,100,60
s_add_u32 m0, s47, 6144
MV 68,100,64
TR 36,207,0
DL 196,48
MV 72,100,68
TR 38,207,512
MV 76,100,72
MV 80,100,76
TR 40,204,4096
s_add_u32 m0, s47, 7168
MV 84,100,80
DL 197,48
MV 88,100,84
TR 42,204,4608
MV 92,100,88
TR 44,207,4096
MV 96,104,60
s_add_u32 m0, s47, 8192
MV 100,104,64
TR 46,207,4608
DL 198,48
MV 104,104,68
MV 108,104,72
TR 48,204,8192
s_add_u32 m0, s47, 9216
MV 112,104,76
TR 50,204,8704
DL 199,48
MV 116,104,80
MV 120,104,84
TR 52,207,8192
MV 124,104,88
s_add_u32 m0, s47, 10240
MV 128,108,60
TR 54,207,8704
DL 200,48
MV 132,108,64
MV 136,108,68
MV 140,108,72
MV 144,108,76
MV 148,108,80
MV 152,108,84
MV 156,108,88
MV 160,112,60
MV 164,112,64
MV 168,112,68
v_add_u32 v205, s46, v203
MV 172,112,72
s_add_u32 s49, s49, 1
MV 176,112,76
s_add_u32 s69, s69, s51
MV 180,112,80
s_cmp_lt_u32 s49, 27
s_cselect_b32 s6, s50, 0
MV 184,112,84
s_cmp_lt_u32 s49, 28
s_cselect_b32 s10, s70, 0
MV 188,112,88
s_waitcnt vmcnt(18) lgkmcnt(0)
s_barrier
MV 0,32,0
TR 92,204,12288
MV 4,32,4
TR 94,204,12800
MV 8,32,8
s_mov_b32 m0, 102400
MV 12,32,12
RB 60,205,0
buffer_load_dwordx4 v192, s[8:11], s69 offen lds
MV 16,32,16
MV 20,32,20
RB 64,205,2048
s_mov_b32 m0, 103424
MV 24,32,24
RB 68,205,4096
buffer_load_dwordx4 v193, s[8:11], s69 offen lds
MV 28,32,28
MV 32,36,0
RB 72,205,6144
MV 36,36,4
s_mov_b32 m0, 104448
MV 40,36,8
RB 76,205,8192
buffer_load_dwordx4 v194, s[8:11], s69 offen lds
MV 44,36,12
RB 80,205,10240
MV 48,36,16
MV 52,36,20
RB 84,205,12288
s_mov_b32 m0, 105472
MV 56,36,24
buffer_load_dwordx4 v195, s[8:11], s69 offen lds
MV 60,36,28
RB 88,205,14336
MV 64,40,0
s_add_u32 m0, s47, 22528
MV 68,40,4
TR 96,207,12288
DL 196,64
MV 72,40,8
TR 98,207,12800
MV 76,40,12
MV 80,40,16
TR 100,204,16384
s_add_u32 m0, s47, 23552
MV 84,40,20
DL 197,64
MV 88,40,24
TR 102,204,16896
MV 92,40,28
TR 104,207,16384
MV 96,44,0
s_add_u32 m0, s47, 24576
MV 100,44,4
TR 106,207,16896
DL 198,64
MV 104,44,8
MV 108,44,12
TR 108,204,20480
s_add_u32 m0, s47, 25600
MV 112,44,16
TR 110,204,20992
DL 199,64
MV 116,44,20
MV 120,44,24
TR 112,207,20480
MV 124,44,28
s_add_u32 m0, s47, 26624
MV 128,48,0
TR 114,207,20992
DL 200,64
MV 132,48,4
MV 136,48,8
MV 140,48,12
MV 144,48,16
MV 148,48,20
s_mov_b32 s47, s46
MV 152,48,24
s_add_u32 s46, s46, 32768
MV 156,48,28
s_cmp_eq_u32 s46, 98304
s_cselect_b32 s46, 0, s46
MV 160,52,0
v_add_u32 v205, s46, v202
MV 164,52,4
s_add_u32 s49, s49, 1
MV 168,52,8
s_add_u32 s69, s69, s51
MV 172,52,12
s_add_u32 s48, s48, 128
MV 176,52,16
s_add_u32 s64, s64, 128
MV 180,52,20
s_cmp_lt_u32 s49, 27
s_cselect_b32 s6, s50, 0
MV 184,52,24
s_cmp_lt_u32 s49, 28
s_cselect_b32 s10, s70, 0
MV 188,52,28
s_waitcnt vmcnt(18) lgkmcnt(0)
s_barrier
MV 0,92,60
TR 32,204,24576
MV 4,92,64
TR 34,204,25088
MV 8,92,68
s_mov_b32 m0, 114688
MV 12,92,72
RB 0,205,0
buffer_load_dwordx4 v192, s[8:11], s69 offen lds
MV 16,92,76
MV 20,92,80
RB 4,205,2048
s_mov_b32 m0, 115712
MV 24,92,84
RB 8,205,4096
buffer_load_dwordx4 v193, s[8:11], s69 offen lds
MV 28,92,88
MV 32,96,60
RB 12,205,6144
MV 36,96,64
s_mov_b32 m0, 116736
MV 40,96,68
RB 16,205,8192
buffer_load_dwordx4 v194, s[8:11], s69 offen lds
MV 44,96,72
RB 20,205,10240
MV 48,96,76
MV 52,96,80
RB 24,205,12288
s_mov_b32 m0, 117760
MV 56,96,84
buffer_load_dwordx4 v195, s[8:11], s69 offen lds
MV 60,96,88
RB 28,205,14336
MV 64,100,60
s_add_u32 m0, s47, 6144
MV 68,100,64
TR 36,207,24576
DL 196,48
MV 72,100,68
TR 38,207,25088
MV 76,100,72
MV 80,100,76
TR 40,204,28672
s_add_u32 m0, s47, 7168
MV 84,100,80
DL 197,48
MV 88,100,84
TR 42,204,29184
MV 92,100,88
TR 44,207,28672
MV 96,104,60
s_add_u32 m0, s47, 8192
MV 100,104,64
TR 46,207,29184
DL 198,48
MV 104,104,68
MV 108,104,72
TR 48,204,32768
s_add_u32 m0, s47, 9216
MV 112,104,76
TR 50,204,33280
DL 199,48
MV 116,104,80
MV 120,104,84
TR 52,207,32768
MV 124,104,88
s_add_u32 m0, s47, 10240
MV 128,108,60
TR 54,207,33280
DL 200,48
MV 132,108,64
MV 136,108,68
MV 140,108,72
MV 144,108,76
MV 148,108,80
MV 152,108,84
MV 156,108,88
MV 160,112,60
MV 164,112,64
MV 168,112,68
v_add_u32 v205, s46, v203
MV 172,112,72
s_add_u32 s49, s49, 1
MV 176,112,76
s_add_u32 s69, s69, s51
MV 180,112,80
s_cmp_lt_u32 s49, 27
s_cselect_b32 s6, s50, 0
MV 184,112,84
s_cmp_lt_u32 s49, 28
s_cselect_b32 s10, s70, 0
MV 188,112,88
s_waitcnt vmcnt(18) lgkmcnt(0)
s_barrier
s_cmp_lt_u32 s49, 30
s_cbranch_scc1 k1_qkv_w1_loop
MV 0,32,0
TR 92,204,36864
MV 4,32,4
TR 94,204,37376
MV 8,32,8
s_mov_b32 m0, 126976
MV 12,32,12
RB 60,205,0
buffer_load_dwordx4 v192, s[8:11], s69 offen lds
MV 16,32,16
MV 20,32,20
RB 64,205,2048
s_mov_b32 m0, 128000
MV 24,32,24
RB 68,205,4096
buffer_load_dwordx4 v193, s[8:11], s69 offen lds
MV 28,32,28
MV 32,36,0
RB 72,205,6144
MV 36,36,4
s_mov_b32 m0, 129024
MV 40,36,8
RB 76,205,8192
buffer_load_dwordx4 v194, s[8:11], s69 offen lds
MV 44,36,12
RB 80,205,10240
MV 48,36,16
MV 52,36,20
RB 84,205,12288
s_mov_b32 m0, 130048
MV 56,36,24
buffer_load_dwordx4 v195, s[8:11], s69 offen lds
MV 60,36,28
RB 88,205,14336
MV 64,40,0
s_add_u32 m0, s47, 22528
MV 68,40,4
TR 96,207,36864
DL 196,64
MV 72,40,8
TR 98,207,37376
MV 76,40,12
MV 80,40,16
TR 100,204,40960
s_add_u32 m0, s47, 23552
MV 84,40,20
DL 197,64
MV 88,40,24
TR 102,204,41472
MV 92,40,28
TR 104,207,40960
MV 96,44,0
s_add_u32 m0, s47, 24576
MV 100,44,4
TR 106,207,41472
DL 198,64
MV 104,44,8
MV 108,44,12
TR 108,204,45056
s_add_u32 m0, s47, 25600
MV 112,44,16
TR 110,204,45568
DL 199,64
MV 116,44,20
MV 120,44,24
TR 112,207,45056
MV 124,44,28
s_add_u32 m0, s47, 26624
MV 128,48,0
TR 114,207,45568
DL 200,64
MV 132,48,4
MV 136,48,8
MV 140,48,12
MV 144,48,16
MV 148,48,20
s_mov_b32 s47, s46
MV 152,48,24
s_add_u32 s46, s46, 32768
MV 156,48,28
s_cmp_eq_u32 s46, 98304
s_cselect_b32 s46, 0, s46
MV 160,52,0
v_add_u32 v205, s46, v202
MV 164,52,4
s_add_u32 s49, s49, 1
MV 168,52,8
s_add_u32 s69, s69, s51
MV 172,52,12
s_add_u32 s48, s48, 128
MV 176,52,16
s_add_u32 s64, s64, 128
MV 180,52,20
s_cmp_lt_u32 s49, 27
s_cselect_b32 s6, s50, 0
MV 184,52,24
s_cmp_lt_u32 s49, 28
s_cselect_b32 s10, s70, 0
MV 188,52,28
s_waitcnt vmcnt(18) lgkmcnt(0)
s_barrier
MV 0,92,60
MV 4,92,64
MV 8,92,68
MV 12,92,72
MV 16,92,76
MV 20,92,80
MV 24,92,84
MV 28,92,88
MV 32,96,60
MV 36,96,64
MV 40,96,68
MV 44,96,72
MV 48,96,76
MV 52,96,80
MV 56,96,84
MV 60,96,88
MV 64,100,60
MV 68,100,64
MV 72,100,68
MV 76,100,72
MV 80,100,76
MV 84,100,80
MV 88,100,84
MV 92,100,88
MV 96,104,60
MV 100,104,64
MV 104,104,68
MV 108,104,72
MV 112,104,76
MV 116,104,80
MV 120,104,84
MV 124,104,88
MV 128,108,60
MV 132,108,64
MV 136,108,68
MV 140,108,72
MV 144,108,76
MV 148,108,80
MV 152,108,84
MV 156,108,88
MV 160,112,60
MV 164,112,64
MV 168,112,68
MV 172,112,72
MV 176,112,76
MV 180,112,80
MV 184,112,84
MV 188,112,88
s_waitcnt vmcnt(0) lgkmcnt(0)
s_barrier
s_branch k1_qkv_epi
k1_qkv_w2:
s_mov_b32 s52, 1
s_mov_b32 s53, 0
s_lshl_b32 s54, s44, 4
s_add_u32 s54, s54, s45
v_lshrrev_b32 v210, 3, v206
v_lshrrev_b32 v211, 4, v206
v_and_b32 v212, 7, v206
v_add_u32 v213, 0, v211
v_xor_b32 v213, v213, v212
v_lshlrev_b32 v213, 4, v213
v_lshl_add_u32 v213, v210, 11, v213
v_add_u32 v197, 196608, v213
v_add_u32 v199, 229376, v213
v_add_u32 v213, 4, v211
v_xor_b32 v213, v213, v212
v_lshlrev_b32 v213, 4, v213
v_lshl_add_u32 v213, v210, 11, v213
v_add_u32 v196, 180224, v213
v_add_u32 v198, 212992, v213
v_add_u32 v200, 245760, v213
s_mov_b32 s3, 6144
v_mul_lo_u32 v214, v210, s3
v_and_b32 v215, 1, v211
v_or_b32 v213, 0, v215
v_lshlrev_b32 v213, 1, v213
v_xor_b32 v213, v213, v212
v_lshl_add_u32 v213, v213, 4, v214
v_add_u32 v192, 4096, v213
v_add_u32 v194, 102400, v213
v_or_b32 v213, 2, v215
v_lshlrev_b32 v213, 1, v213
v_xor_b32 v213, v213, v212
v_lshl_add_u32 v213, v213, 4, v214
v_add_u32 v193, 53248, v213
v_add_u32 v195, 151552, v213
s_waitcnt lgkmcnt(0)
s_lshr_b32 s74, s2, 3
s_lshl_b32 s74, s74, 2
s_add_u32 s74, s74, s42
s_and_b32 s75, s2, 1
s_lshl_b32 s75, s75, 2
s_bfe_u32 s76, s2, 0x20001
s_lshl_b32 s76, s76, 2
s_cmp_lt_u32 s74, 48
s_cbranch_scc0 k1_qkv_w2_k1_st_w
s_mul_i32 s3, s74, 43691
s_lshr_b32 s3, s3, 19
s_mul_i32 s77, s3, 12
s_sub_u32 s77, s74, s77
s_add_u32 s3, s3, s75
s_lshl_b32 s3, s3, 19
s_and_b32 s75, s77, 3
s_lshl_b32 s75, s75, 17
s_add_u32 s3, s3, s75
s_lshr_b32 s77, s77, 2
s_cmp_ge_u32 s77, 1
s_cbranch_scc1 k1_qkv_w2_k1_st_done
s_lshl_b32 s77, s77, 7
s_add_u32 s3, s3, s77
v_lshlrev_b32 v255, 11, v206
v_add_u32 v255, s3, v255
s_mov_b32 s72, s16
s_and_b32 s73, s17, 0xffff
s_mov_b32 s74, 4194304
s_mov_b32 s75, 0x20000
s_branch k1_qkv_w2_k1_st_go
k1_qkv_w2_k1_st_w:
s_cmp_lt_u32 s74, 88
s_cselect_b32 s77, 48, 88
s_cselect_b32 s75, 1, 0
s_sub_u32 s74, s74, s77
s_mul_i32 s3, s74, 52429
s_lshr_b32 s3, s3, 19
s_mul_i32 s77, s3, 10
s_sub_u32 s77, s74, s77
s_cmp_ge_u32 s77, 4
s_cbranch_scc1 k1_qkv_w2_k1_st_done
s_add_u32 s76, s76, s3
s_lshl_b32 s77, s77, 4
v_lshrrev_b32 v255, 2, v206
v_add_u32 v255, s77, v255
v_and_b32 v254, 3, v206
s_cmp_eq_u32 s75, 1
s_cbranch_scc0 k1_qkv_w2_k1_st_q
s_mul_i32 s3, s76, 448
s_and_b32 s3, s3, 0xffffff80
s_mov_b32 s77, 7168
v_mul_lo_u32 v255, v255, s77
v_lshl_add_u32 v255, v254, 7, v255
v_add_u32 v255, s3, v255
s_mov_b32 s72, s26
s_and_b32 s73, s27, 0xffff
s_mov_b32 s74, 7340032
s_mov_b32 s75, 0x20000
s_branch k1_qkv_w2_k1_st_go
k1_qkv_w2_k1_st_q:
s_lshl_b32 s3, s76, 7
s_mov_b32 s77, 6144
v_mul_lo_u32 v255, v255, s77
v_min_u32 v254, 2, v254
v_lshl_add_u32 v255, v254, 11, v255
v_add_u32 v255, s3, v255
s_mov_b32 s72, s18
s_and_b32 s73, s19, 0xffff
s_mov_b32 s74, 6291456
s_mov_b32 s75, 0x20000
k1_qkv_w2_k1_st_go:
buffer_load_dword v254, v255, s[72:75], 0 offen
k1_qkv_w2_k1_st_done:
s_lshl_b32 s3, s44, 19
s_add_u32 s4, s16, s3
s_addc_u32 s5, s17, 0
s_and_b32 s5, s5, 0xffff
s_mov_b32 s50, 524288
s_mov_b32 s6, s50
s_mov_b32 s7, 0x20000
s_mul_i32 s3, s45, 128
s_add_u32 s8, s18, s3
s_addc_u32 s9, s19, 0
s_and_b32 s9, s9, 0xffff
s_sub_u32 s70, 6291456, s3
s_mov_b32 s10, s70
s_mov_b32 s11, 0x20000
s_mov_b32 s51, 196608
s_mov_b32 s48, 0
s_mov_b32 s64, 262144
s_mov_b32 s69, 0
s_mov_b32 m0, 106496
s_nop 0
buffer_load_dwordx4 v192, s[8:11], s69 offen lds
s_mov_b32 m0, 107520
s_nop 0
buffer_load_dwordx4 v193, s[8:11], s69 offen lds
s_mov_b32 m0, 108544
s_nop 0
buffer_load_dwordx4 v194, s[8:11], s69 offen lds
s_mov_b32 m0, 109568
s_nop 0
buffer_load_dwordx4 v195, s[8:11], s69 offen lds
s_add_u32 s69, s69, s51
s_mov_b32 m0, 11264
s_nop 0
DL 196,48
s_mov_b32 m0, 12288
s_nop 0
DL 197,48
s_mov_b32 m0, 13312
s_nop 0
DL 198,48
s_mov_b32 m0, 14336
s_nop 0
DL 199,48
s_mov_b32 m0, 15360
s_nop 0
DL 200,48
s_mov_b32 m0, 27648
s_nop 0
DL 196,64
s_mov_b32 m0, 28672
s_nop 0
DL 197,64
s_mov_b32 m0, 29696
s_nop 0
DL 198,64
s_mov_b32 m0, 30720
s_nop 0
DL 199,64
s_mov_b32 m0, 31744
s_nop 0
DL 200,64
s_add_u32 s48, s48, 128
s_add_u32 s64, s64, 128
s_mov_b32 m0, 118784
s_nop 0
buffer_load_dwordx4 v192, s[8:11], s69 offen lds
s_mov_b32 m0, 119808
s_nop 0
buffer_load_dwordx4 v193, s[8:11], s69 offen lds
s_mov_b32 m0, 120832
s_nop 0
buffer_load_dwordx4 v194, s[8:11], s69 offen lds
s_mov_b32 m0, 121856
s_nop 0
buffer_load_dwordx4 v195, s[8:11], s69 offen lds
s_add_u32 s69, s69, s51
s_mov_b32 s72, s20
s_and_b32 s73, s21, 0xffff
s_mov_b32 s74, 65536
s_mov_b32 s75, 0x20000
v_lshlrev_b32 v249, 4, v206
s_lshl_b32 s76, s45, 12
s_add_u32 s76, s76, 2048
v_and_b32 v210, 15, v206
v_lshrrev_b32 v213, 4, v206
v_lshrrev_b32 v211, 1, v210
v_add_u32 v212, 0, v213
v_xor_b32 v212, v212, v211
v_lshlrev_b32 v212, 4, v212
v_lshl_add_u32 v212, v210, 7, v212
v_add_u32 v202, 16384, v212
v_add_u32 v212, 4, v213
v_xor_b32 v212, v212, v211
v_lshlrev_b32 v212, 4, v212
v_lshl_add_u32 v212, v210, 7, v212
v_add_u32 v203, 16384, v212
v_bfe_u32 v211, v206, 2, 2
v_lshl_add_u32 v214, v213, 3, v211
v_and_b32 v215, 3, v206
v_lshlrev_b32 v215, 3, v215
v_lshrrev_b32 v216, 1, v211
v_and_b32 v217, 1, v213
v_lshl_or_b32 v216, v217, 1, v216
v_lshl_add_u32 v218, v214, 7, v215
v_add_u32 v218, 98304, v218
v_xor_b32 v219, 0, v216
v_lshl_add_u32 v204, v219, 5, v218
v_xor_b32 v219, 1, v216
v_lshl_add_u32 v207, v219, 5, v218
v_mov_b32 v205, v202
s_mov_b32 s12, s16
s_and_b32 s13, s17, 0xffff
s_mov_b32 s14, 4194304
s_mov_b32 s15, 0x20000
v_lshrrev_b32 v250, 4, v206
s_lshl_b32 s55, s54, 4
s_add_u32 s55, s55, 8
v_add_u32 v250, s55, v250
v_lshlrev_b32 v250, 11, v250
v_and_b32 v251, 15, v206
v_lshl_add_u32 v250, v251, 4, v250
s_waitcnt vmcnt(0) lgkmcnt(0)
s_barrier
TR 32,204,0
TR 34,204,512
RB 0,205,0
RB 4,205,2048
RB 8,205,4096
RB 12,205,6144
RB 16,205,8192
RB 20,205,10240
RB 24,205,12288
RB 28,205,14336
TR 36,207,0
TR 38,207,512
TR 40,204,4096
TR 42,204,4608
TR 44,207,4096
TR 46,207,4608
TR 48,204,8192
TR 50,204,8704
TR 52,207,8192
TR 54,207,8704
s_mov_b32 s46, 0
s_mov_b32 s47, 65536
s_mov_b32 s49, 0
v_mov_b32 v205, v203
s_waitcnt lgkmcnt(0)
s_barrier
MVZ 0,32,0
TR 92,204,12288
s_mov_b32 m0, 44032
MVZ 4,32,4
TR 94,204,12800
DL 196,48
s_mov_b32 m0, 45056
MVZ 8,32,8
DL 197,48
s_mov_b32 m0, 46080
MVZ 12,32,12
RB 60,205,0
DL 198,48
s_mov_b32 m0, 47104
MVZ 16,32,16
DL 199,48
MVZ 20,32,20
RB 64,205,2048
s_mov_b32 m0, 48128
MVZ 24,32,24
RB 68,205,4096
DL 200,48
s_mov_b32 m0, 60416
MVZ 28,32,28
DL 196,64
s_mov_b32 m0, 61440
MVZ 32,36,0
RB 72,205,6144
DL 197,64
s_mov_b32 m0, 62464
MVZ 36,36,4
DL 198,64
MVZ 40,36,8
RB 76,205,8192
s_mov_b32 m0, 63488
MVZ 44,36,12
RB 80,205,10240
DL 199,64
s_mov_b32 m0, 64512
MVZ 48,36,16
DL 200,64
s_mov_b32 m0, 131072
MVZ 52,36,20
RB 84,205,12288
buffer_load_dwordx4 v192, s[8:11], s69 offen lds
s_mov_b32 m0, 132096
MVZ 56,36,24
buffer_load_dwordx4 v193, s[8:11], s69 offen lds
MVZ 60,36,28
RB 88,205,14336
s_mov_b32 m0, 133120
MVZ 64,40,0
buffer_load_dwordx4 v194, s[8:11], s69 offen lds
s_mov_b32 m0, 134144
MVZ 68,40,4
TR 96,207,12288
buffer_load_dwordx4 v195, s[8:11], s69 offen lds
s_add_u32 s69, s69, s51
s_mov_b32 m0, 143360
MVZ 72,40,8
TR 98,207,12800
buffer_load_dwordx4 v192, s[8:11], s69 offen lds
s_mov_b32 m0, 144384
MVZ 76,40,12
buffer_load_dwordx4 v193, s[8:11], s69 offen lds
MVZ 80,40,16
TR 100,204,16384
s_mov_b32 m0, 145408
MVZ 84,40,20
buffer_load_dwordx4 v194, s[8:11], s69 offen lds
s_mov_b32 m0, 146432
MVZ 88,40,24
TR 102,204,16896
buffer_load_dwordx4 v195, s[8:11], s69 offen lds
s_mov_b32 m0, 149504
MVZ 92,40,28
TR 104,207,16384
buffer_load_dwordx4 v249, s[72:75], s76 offen lds
s_mov_b32 m0, 149504
MVZ 96,44,0
buffer_load_dwordx4 v249, s[72:75], s76 offen offset:1024 lds
MVZ 100,44,4
TR 106,207,16896
s_nop 0
MVZ 104,44,8
buffer_load_dwordx4 v[210:213], v250, s[12:15], 0 offen offset:0
s_nop 0
MVZ 108,44,12
TR 108,204,20480
buffer_load_dwordx4 v[214:217], v250, s[12:15], 0 offen offset:256
s_nop 0
MVZ 112,44,16
TR 110,204,20992
buffer_load_dwordx4 v[218:221], v250, s[12:15], 0 offen offset:512
s_nop 0
MVZ 116,44,20
buffer_load_dwordx4 v[222:225], v250, s[12:15], 0 offen offset:768
MVZ 120,44,24
TR 112,207,20480
s_nop 0
MVZ 124,44,28
buffer_load_dwordx4 v[226:229], v250, s[12:15], 0 offen offset:1024
s_nop 0
MVZ 128,48,0
TR 114,207,20992
buffer_load_dwordx4 v[230:233], v250, s[12:15], 0 offen offset:1280
s_nop 0
MVZ 132,48,4
buffer_load_dwordx4 v[234:237], v250, s[12:15], 0 offen offset:1536
s_nop 0
MVZ 136,48,8
buffer_load_dwordx4 v[238:241], v250, s[12:15], 0 offen offset:1792
MVZ 140,48,12
MVZ 144,48,16
MVZ 148,48,20
s_mov_b32 s47, s46
MVZ 152,48,24
s_add_u32 s46, s46, 32768
MVZ 156,48,28
s_cmp_eq_u32 s46, 98304
s_cselect_b32 s46, 0, s46
MVZ 160,52,0
v_add_u32 v205, s46, v202
MVZ 164,52,4
s_add_u32 s49, s49, 1
MVZ 168,52,8
s_add_u32 s69, s69, s51
MVZ 172,52,12
s_add_u32 s48, s48, 128
MVZ 176,52,16
s_add_u32 s64, s64, 128
MVZ 180,52,20
s_cmp_lt_u32 s49, 27
s_cselect_b32 s6, s50, 0
MVZ 184,52,24
s_cmp_lt_u32 s49, 28
s_cselect_b32 s10, s70, 0
MVZ 188,52,28
s_waitcnt vmcnt(14) lgkmcnt(0)
s_barrier
MV 0,92,60
TR 32,204,24576
s_mov_b32 m0, 106496
MV 4,92,64
TR 34,204,25088
buffer_load_dwordx4 v192, s[8:11], s69 offen lds
s_mov_b32 m0, 107520
MV 8,92,68
buffer_load_dwordx4 v193, s[8:11], s69 offen lds
MV 12,92,72
RB 0,205,0
s_mov_b32 m0, 108544
MV 16,92,76
buffer_load_dwordx4 v194, s[8:11], s69 offen lds
s_mov_b32 m0, 109568
MV 20,92,80
RB 4,205,2048
buffer_load_dwordx4 v195, s[8:11], s69 offen lds
s_add_u32 s69, s69, s51
MV 24,92,84
RB 8,205,4096
s_mov_b32 m0, 76800
MV 28,92,88
DL 196,48
s_mov_b32 m0, 77824
MV 32,96,60
RB 12,205,6144
DL 197,48
MV 36,96,64
s_mov_b32 m0, 78848
MV 40,96,68
RB 16,205,8192
DL 198,48
s_mov_b32 m0, 79872
MV 44,96,72
RB 20,205,10240
DL 199,48
MV 48,96,76
s_mov_b32 m0, 80896
MV 52,96,80
RB 24,205,12288
DL 200,48
s_mov_b32 m0, 93184
MV 56,96,84
DL 196,64
MV 60,96,88
RB 28,205,14336
s_mov_b32 m0, 94208
MV 64,100,60
DL 197,64
s_mov_b32 m0, 95232
MV 68,100,64
TR 36,207,24576
DL 198,64
MV 72,100,68
TR 38,207,25088
s_mov_b32 m0, 96256
MV 76,100,72
DL 199,64
s_mov_b32 m0, 97280
MV 80,100,76
TR 40,204,28672
DL 200,64
s_add_u32 s48, s48, 128
s_add_u32 s64, s64, 128
MV 84,100,80
s_mov_b32 m0, 118784
MV 88,100,84
TR 42,204,29184
buffer_load_dwordx4 v192, s[8:11], s69 offen lds
s_mov_b32 m0, 119808
MV 92,100,88
TR 44,207,28672
buffer_load_dwordx4 v193, s[8:11], s69 offen lds
MV 96,104,60
s_mov_b32 m0, 120832
MV 100,104,64
TR 46,207,29184
buffer_load_dwordx4 v194, s[8:11], s69 offen lds
s_mov_b32 m0, 121856
MV 104,104,68
buffer_load_dwordx4 v195, s[8:11], s69 offen lds
MV 108,104,72
TR 48,204,32768
s_mov_b32 m0, 11264
MV 112,104,76
TR 50,204,33280
DL 196,48
s_mov_b32 m0, 12288
MV 116,104,80
DL 197,48
MV 120,104,84
TR 52,207,32768
s_mov_b32 m0, 13312
MV 124,104,88
DL 198,48
s_mov_b32 m0, 14336
MV 128,108,60
TR 54,207,33280
DL 199,48
MV 132,108,64
s_mov_b32 m0, 15360
MV 136,108,68
DL 200,48
MV 140,108,72
MV 144,108,76
MV 148,108,80
MV 152,108,84
MV 156,108,88
MV 160,112,60
MV 164,112,64
MV 168,112,68
v_add_u32 v205, s46, v203
MV 172,112,72
s_add_u32 s49, s49, 1
MV 176,112,76
s_add_u32 s69, s69, s51
MV 180,112,80
s_cmp_lt_u32 s49, 27
s_cselect_b32 s6, s50, 0
MV 184,112,84
s_cmp_lt_u32 s49, 28
s_cselect_b32 s10, s70, 0
MV 188,112,88
s_waitcnt vmcnt(23) lgkmcnt(0)
s_barrier
v_and_b32 v250, 15, v206
v_lshlrev_b32 v250, 4, v250
v_add_u32 v251, 151552, v250
s_mov_b32 s60, 0x3f803f80
ds_read_b128 v[242:245], v251 offset:0
ds_read_b128 v[246:249], v251 offset:256
v_mov_b32 v253, v251
s_waitcnt lgkmcnt(1)
D2 v250,v210,v242,0
D2 v251,v210,s60,0
D2 v209,v210,v210,0
D2 v250,v211,v243,v250
D2 v251,v211,s60,v251
D2 v209,v211,v211,v209
D2 v250,v212,v244,v250
D2 v251,v212,s60,v251
D2 v209,v212,v212,v209
D2 v250,v213,v245,v250
D2 v251,v213,s60,v251
D2 v209,v213,v213,v209
ds_read_b128 v[242:245], v253 offset:512
s_waitcnt lgkmcnt(1)
D2 v250,v214,v246,v250
D2 v251,v214,s60,v251
D2 v209,v214,v214,v209
D2 v250,v215,v247,v250
D2 v251,v215,s60,v251
D2 v209,v215,v215,v209
D2 v250,v216,v248,v250
D2 v251,v216,s60,v251
D2 v209,v216,v216,v209
D2 v250,v217,v249,v250
D2 v251,v217,s60,v251
D2 v209,v217,v217,v209
ds_read_b128 v[246:249], v253 offset:768
s_waitcnt lgkmcnt(1)
D2 v250,v218,v242,v250
D2 v251,v218,s60,v251
D2 v209,v218,v218,v209
D2 v250,v219,v243,v250
D2 v251,v219,s60,v251
D2 v209,v219,v219,v209
D2 v250,v220,v244,v250
D2 v251,v220,s60,v251
D2 v209,v220,v220,v209
D2 v250,v221,v245,v250
D2 v251,v221,s60,v251
D2 v209,v221,v221,v209
ds_read_b128 v[242:245], v253 offset:1024
s_waitcnt lgkmcnt(1)
D2 v250,v222,v246,v250
D2 v251,v222,s60,v251
D2 v209,v222,v222,v209
D2 v250,v223,v247,v250
D2 v251,v223,s60,v251
D2 v209,v223,v223,v209
D2 v250,v224,v248,v250
D2 v251,v224,s60,v251
D2 v209,v224,v224,v209
D2 v250,v225,v249,v250
D2 v251,v225,s60,v251
D2 v209,v225,v225,v209
ds_read_b128 v[246:249], v253 offset:1280
s_waitcnt lgkmcnt(1)
D2 v250,v226,v242,v250
D2 v251,v226,s60,v251
D2 v209,v226,v226,v209
D2 v250,v227,v243,v250
D2 v251,v227,s60,v251
D2 v209,v227,v227,v209
D2 v250,v228,v244,v250
D2 v251,v228,s60,v251
D2 v209,v228,v228,v209
D2 v250,v229,v245,v250
D2 v251,v229,s60,v251
D2 v209,v229,v229,v209
ds_read_b128 v[242:245], v253 offset:1536
s_waitcnt lgkmcnt(1)
D2 v250,v230,v246,v250
D2 v251,v230,s60,v251
D2 v209,v230,v230,v209
D2 v250,v231,v247,v250
D2 v251,v231,s60,v251
D2 v209,v231,v231,v209
D2 v250,v232,v248,v250
D2 v251,v232,s60,v251
D2 v209,v232,v232,v209
D2 v250,v233,v249,v250
D2 v251,v233,s60,v251
D2 v209,v233,v233,v209
ds_read_b128 v[246:249], v253 offset:1792
s_waitcnt lgkmcnt(1)
D2 v250,v234,v242,v250
D2 v251,v234,s60,v251
D2 v209,v234,v234,v209
D2 v250,v235,v243,v250
D2 v251,v235,s60,v251
D2 v209,v235,v235,v209
D2 v250,v236,v244,v250
D2 v251,v236,s60,v251
D2 v209,v236,v236,v209
D2 v250,v237,v245,v250
D2 v251,v237,s60,v251
D2 v209,v237,v237,v209
s_waitcnt lgkmcnt(0)
D2 v250,v238,v246,v250
D2 v251,v238,s60,v251
D2 v209,v238,v238,v209
D2 v250,v239,v247,v250
D2 v251,v239,s60,v251
D2 v209,v239,v239,v209
D2 v250,v240,v248,v250
D2 v251,v240,s60,v251
D2 v209,v240,v240,v209
D2 v250,v241,v249,v250
D2 v251,v241,s60,v251
D2 v209,v241,v241,v209
v_lshrrev_b32 v210, 4, v206
s_lshl_b32 s55, s54, 4
s_add_u32 s55, s55, 8
v_add_u32 v210, s55, v210
v_lshlrev_b32 v211, 3, v210
v_lshlrev_b32 v212, 2, v210
v_add_f32_dpp v250, v250, v250 row_ror:8 row_mask:0xf bank_mask:0xf
v_add_f32_dpp v251, v251, v251 row_ror:8 row_mask:0xf bank_mask:0xf
v_add_f32_dpp v209, v209, v209 row_ror:8 row_mask:0xf bank_mask:0xf
v_add_f32_dpp v250, v250, v250 row_ror:4 row_mask:0xf bank_mask:0xf
v_add_f32_dpp v251, v251, v251 row_ror:4 row_mask:0xf bank_mask:0xf
v_add_f32_dpp v209, v209, v209 row_ror:4 row_mask:0xf bank_mask:0xf
v_add_f32_dpp v250, v250, v250 row_ror:2 row_mask:0xf bank_mask:0xf
v_add_f32_dpp v251, v251, v251 row_ror:2 row_mask:0xf bank_mask:0xf
v_add_f32_dpp v209, v209, v209 row_ror:2 row_mask:0xf bank_mask:0xf
v_add_f32_dpp v250, v250, v250 row_ror:1 row_mask:0xf bank_mask:0xf
v_add_f32_dpp v251, v251, v251 row_ror:1 row_mask:0xf bank_mask:0xf
v_add_f32_dpp v209, v209, v209 row_ror:1 row_mask:0xf bank_mask:0xf
v_mul_f32 v250, 0xbfb8aa3b, v250
v_mul_f32 v251, 0xba800000, v251
v_exp_f32 v250, v250
v_mul_f32 v209, 0x3a800000, v209
v_fma_f32 v209, -v251, v251, v209
v_add_f32 v250, 1.0, v250
v_max_f32 v209, 0, v209
v_rcp_f32 v250, v250
v_add_f32 v209, 0x3727c5ac, v209
v_rsq_f32 v214, v209
s_nop 0
v_mul_f32 v215, v251, v214
s_add_u32 s12, s40, 20971520
s_addc_u32 s13, s41, 0
s_and_b32 s13, s13, 0xffff
s_mov_b32 s14, 16384
s_mov_b32 s15, 0x20000
s_mov_b32 exec_lo, 0x00010001
s_mov_b32 exec_hi, 0x00010001
buffer_store_dwordx2 v[214:215], v211, s[12:15], 0 offen sc1
s_add_u32 s12, s40, 22020096
s_addc_u32 s13, s41, 0
s_and_b32 s13, s13, 0xffff
s_mov_b32 s14, 8192
s_mov_b32 s15, 0x20000
buffer_store_dword v250, v212, s[12:15], 0 offen sc1
s_mov_b64 exec, -1
k1_qkv_w2_loop:
MV 0,32,0
TR 92,204,36864
MV 4,32,4
TR 94,204,37376
MV 8,32,8
MV 12,32,12
RB 60,205,0
MV 16,32,16
s_mov_b32 m0, 131072
MV 20,32,20
RB 64,205,2048
buffer_load_dwordx4 v192, s[8:11], s69 offen lds
MV 24,32,24
RB 68,205,4096
MV 28,32,28
s_mov_b32 m0, 132096
MV 32,36,0
RB 72,205,6144
buffer_load_dwordx4 v193, s[8:11], s69 offen lds
MV 36,36,4
MV 40,36,8
RB 76,205,8192
s_mov_b32 m0, 133120
MV 44,36,12
RB 80,205,10240
buffer_load_dwordx4 v194, s[8:11], s69 offen lds
MV 48,36,16
MV 52,36,20
RB 84,205,12288
MV 56,36,24
s_mov_b32 m0, 134144
MV 60,36,28
RB 88,205,14336
buffer_load_dwordx4 v195, s[8:11], s69 offen lds
MV 64,40,0
MV 68,40,4
TR 96,207,36864
s_add_u32 m0, s47, 27648
MV 72,40,8
TR 98,207,37376
DL 196,64
MV 76,40,12
MV 80,40,16
TR 100,204,40960
MV 84,40,20
s_add_u32 m0, s47, 28672
MV 88,40,24
TR 102,204,41472
DL 197,64
MV 92,40,28
TR 104,207,40960
MV 96,44,0
s_add_u32 m0, s47, 29696
MV 100,44,4
TR 106,207,41472
DL 198,64
MV 104,44,8
MV 108,44,12
TR 108,204,45056
MV 112,44,16
TR 110,204,45568
s_add_u32 m0, s47, 30720
MV 116,44,20
DL 199,64
MV 120,44,24
TR 112,207,45056
MV 124,44,28
s_add_u32 m0, s47, 31744
MV 128,48,0
TR 114,207,45568
DL 200,64
MV 132,48,4
MV 136,48,8
MV 140,48,12
MV 144,48,16
MV 148,48,20
s_mov_b32 s47, s46
MV 152,48,24
s_add_u32 s46, s46, 32768
MV 156,48,28
s_cmp_eq_u32 s46, 98304
s_cselect_b32 s46, 0, s46
MV 160,52,0
v_add_u32 v205, s46, v202
MV 164,52,4
s_add_u32 s49, s49, 1
MV 168,52,8
s_add_u32 s69, s69, s51
MV 172,52,12
s_add_u32 s48, s48, 128
MV 176,52,16
s_add_u32 s64, s64, 128
MV 180,52,20
s_cmp_lt_u32 s49, 27
s_cselect_b32 s6, s50, 0
MV 184,52,24
s_cmp_lt_u32 s49, 28
s_cselect_b32 s10, s70, 0
MV 188,52,28
s_waitcnt vmcnt(18) lgkmcnt(0)
s_barrier
MV 0,92,60
TR 32,204,0
MV 4,92,64
TR 34,204,512
MV 8,92,68
MV 12,92,72
RB 0,205,0
MV 16,92,76
s_mov_b32 m0, 143360
MV 20,92,80
RB 4,205,2048
buffer_load_dwordx4 v192, s[8:11], s69 offen lds
MV 24,92,84
RB 8,205,4096
MV 28,92,88
s_mov_b32 m0, 144384
MV 32,96,60
RB 12,205,6144
buffer_load_dwordx4 v193, s[8:11], s69 offen lds
MV 36,96,64
MV 40,96,68
RB 16,205,8192
s_mov_b32 m0, 145408
MV 44,96,72
RB 20,205,10240
buffer_load_dwordx4 v194, s[8:11], s69 offen lds
MV 48,96,76
MV 52,96,80
RB 24,205,12288
MV 56,96,84
s_mov_b32 m0, 146432
MV 60,96,88
RB 28,205,14336
buffer_load_dwordx4 v195, s[8:11], s69 offen lds
MV 64,100,60
MV 68,100,64
TR 36,207,0
s_add_u32 m0, s47, 11264
MV 72,100,68
TR 38,207,512
DL 196,48
MV 76,100,72
MV 80,100,76
TR 40,204,4096
MV 84,100,80
s_add_u32 m0, s47, 12288
MV 88,100,84
TR 42,204,4608
DL 197,48
MV 92,100,88
TR 44,207,4096
MV 96,104,60
s_add_u32 m0, s47, 13312
MV 100,104,64
TR 46,207,4608
DL 198,48
MV 104,104,68
MV 108,104,72
TR 48,204,8192
MV 112,104,76
TR 50,204,8704
s_add_u32 m0, s47, 14336
MV 116,104,80
DL 199,48
MV 120,104,84
TR 52,207,8192
MV 124,104,88
s_add_u32 m0, s47, 15360
MV 128,108,60
TR 54,207,8704
DL 200,48
MV 132,108,64
MV 136,108,68
MV 140,108,72
MV 144,108,76
MV 148,108,80
MV 152,108,84
MV 156,108,88
MV 160,112,60
MV 164,112,64
MV 168,112,68
v_add_u32 v205, s46, v203
MV 172,112,72
s_add_u32 s49, s49, 1
MV 176,112,76
s_add_u32 s69, s69, s51
MV 180,112,80
s_cmp_lt_u32 s49, 27
s_cselect_b32 s6, s50, 0
MV 184,112,84
s_cmp_lt_u32 s49, 28
s_cselect_b32 s10, s70, 0
MV 188,112,88
s_waitcnt vmcnt(18) lgkmcnt(0)
s_barrier
MV 0,32,0
TR 92,204,12288
MV 4,32,4
TR 94,204,12800
MV 8,32,8
MV 12,32,12
RB 60,205,0
MV 16,32,16
s_mov_b32 m0, 106496
MV 20,32,20
RB 64,205,2048
buffer_load_dwordx4 v192, s[8:11], s69 offen lds
MV 24,32,24
RB 68,205,4096
MV 28,32,28
s_mov_b32 m0, 107520
MV 32,36,0
RB 72,205,6144
buffer_load_dwordx4 v193, s[8:11], s69 offen lds
MV 36,36,4
MV 40,36,8
RB 76,205,8192
s_mov_b32 m0, 108544
MV 44,36,12
RB 80,205,10240
buffer_load_dwordx4 v194, s[8:11], s69 offen lds
MV 48,36,16
MV 52,36,20
RB 84,205,12288
MV 56,36,24
s_mov_b32 m0, 109568
MV 60,36,28
RB 88,205,14336
buffer_load_dwordx4 v195, s[8:11], s69 offen lds
MV 64,40,0
MV 68,40,4
TR 96,207,12288
s_add_u32 m0, s47, 27648
MV 72,40,8
TR 98,207,12800
DL 196,64
MV 76,40,12
MV 80,40,16
TR 100,204,16384
MV 84,40,20
s_add_u32 m0, s47, 28672
MV 88,40,24
TR 102,204,16896
DL 197,64
MV 92,40,28
TR 104,207,16384
MV 96,44,0
s_add_u32 m0, s47, 29696
MV 100,44,4
TR 106,207,16896
DL 198,64
MV 104,44,8
MV 108,44,12
TR 108,204,20480
MV 112,44,16
TR 110,204,20992
s_add_u32 m0, s47, 30720
MV 116,44,20
DL 199,64
MV 120,44,24
TR 112,207,20480
MV 124,44,28
s_add_u32 m0, s47, 31744
MV 128,48,0
TR 114,207,20992
DL 200,64
MV 132,48,4
MV 136,48,8
MV 140,48,12
MV 144,48,16
MV 148,48,20
s_mov_b32 s47, s46
MV 152,48,24
s_add_u32 s46, s46, 32768
MV 156,48,28
s_cmp_eq_u32 s46, 98304
s_cselect_b32 s46, 0, s46
MV 160,52,0
v_add_u32 v205, s46, v202
MV 164,52,4
s_add_u32 s49, s49, 1
MV 168,52,8
s_add_u32 s69, s69, s51
MV 172,52,12
s_add_u32 s48, s48, 128
MV 176,52,16
s_add_u32 s64, s64, 128
MV 180,52,20
s_cmp_lt_u32 s49, 27
s_cselect_b32 s6, s50, 0
MV 184,52,24
s_cmp_lt_u32 s49, 28
s_cselect_b32 s10, s70, 0
MV 188,52,28
s_waitcnt vmcnt(18) lgkmcnt(0)
s_barrier
MV 0,92,60
TR 32,204,24576
MV 4,92,64
TR 34,204,25088
MV 8,92,68
MV 12,92,72
RB 0,205,0
MV 16,92,76
s_mov_b32 m0, 118784
MV 20,92,80
RB 4,205,2048
buffer_load_dwordx4 v192, s[8:11], s69 offen lds
MV 24,92,84
RB 8,205,4096
MV 28,92,88
s_mov_b32 m0, 119808
MV 32,96,60
RB 12,205,6144
buffer_load_dwordx4 v193, s[8:11], s69 offen lds
MV 36,96,64
MV 40,96,68
RB 16,205,8192
s_mov_b32 m0, 120832
MV 44,96,72
RB 20,205,10240
buffer_load_dwordx4 v194, s[8:11], s69 offen lds
MV 48,96,76
MV 52,96,80
RB 24,205,12288
MV 56,96,84
s_mov_b32 m0, 121856
MV 60,96,88
RB 28,205,14336
buffer_load_dwordx4 v195, s[8:11], s69 offen lds
MV 64,100,60
MV 68,100,64
TR 36,207,24576
s_add_u32 m0, s47, 11264
MV 72,100,68
TR 38,207,25088
DL 196,48
MV 76,100,72
MV 80,100,76
TR 40,204,28672
MV 84,100,80
s_add_u32 m0, s47, 12288
MV 88,100,84
TR 42,204,29184
DL 197,48
MV 92,100,88
TR 44,207,28672
MV 96,104,60
s_add_u32 m0, s47, 13312
MV 100,104,64
TR 46,207,29184
DL 198,48
MV 104,104,68
MV 108,104,72
TR 48,204,32768
MV 112,104,76
TR 50,204,33280
s_add_u32 m0, s47, 14336
MV 116,104,80
DL 199,48
MV 120,104,84
TR 52,207,32768
MV 124,104,88
s_add_u32 m0, s47, 15360
MV 128,108,60
TR 54,207,33280
DL 200,48
MV 132,108,64
MV 136,108,68
MV 140,108,72
MV 144,108,76
MV 148,108,80
MV 152,108,84
MV 156,108,88
MV 160,112,60
MV 164,112,64
MV 168,112,68
v_add_u32 v205, s46, v203
MV 172,112,72
s_add_u32 s49, s49, 1
MV 176,112,76
s_add_u32 s69, s69, s51
MV 180,112,80
s_cmp_lt_u32 s49, 27
s_cselect_b32 s6, s50, 0
MV 184,112,84
s_cmp_lt_u32 s49, 28
s_cselect_b32 s10, s70, 0
MV 188,112,88
s_waitcnt vmcnt(18) lgkmcnt(0)
s_barrier
s_cmp_lt_u32 s49, 30
s_cbranch_scc1 k1_qkv_w2_loop
MV 0,32,0
TR 92,204,36864
MV 4,32,4
TR 94,204,37376
MV 8,32,8
MV 12,32,12
RB 60,205,0
MV 16,32,16
s_mov_b32 m0, 131072
MV 20,32,20
RB 64,205,2048
buffer_load_dwordx4 v192, s[8:11], s69 offen lds
MV 24,32,24
RB 68,205,4096
MV 28,32,28
s_mov_b32 m0, 132096
MV 32,36,0
RB 72,205,6144
buffer_load_dwordx4 v193, s[8:11], s69 offen lds
MV 36,36,4
MV 40,36,8
RB 76,205,8192
s_mov_b32 m0, 133120
MV 44,36,12
RB 80,205,10240
buffer_load_dwordx4 v194, s[8:11], s69 offen lds
MV 48,36,16
MV 52,36,20
RB 84,205,12288
MV 56,36,24
s_mov_b32 m0, 134144
MV 60,36,28
RB 88,205,14336
buffer_load_dwordx4 v195, s[8:11], s69 offen lds
MV 64,40,0
MV 68,40,4
TR 96,207,36864
s_add_u32 m0, s47, 27648
MV 72,40,8
TR 98,207,37376
DL 196,64
MV 76,40,12
MV 80,40,16
TR 100,204,40960
MV 84,40,20
s_add_u32 m0, s47, 28672
MV 88,40,24
TR 102,204,41472
DL 197,64
MV 92,40,28
TR 104,207,40960
MV 96,44,0
s_add_u32 m0, s47, 29696
MV 100,44,4
TR 106,207,41472
DL 198,64
MV 104,44,8
MV 108,44,12
TR 108,204,45056
MV 112,44,16
TR 110,204,45568
s_add_u32 m0, s47, 30720
MV 116,44,20
DL 199,64
MV 120,44,24
TR 112,207,45056
MV 124,44,28
s_add_u32 m0, s47, 31744
MV 128,48,0
TR 114,207,45568
DL 200,64
MV 132,48,4
MV 136,48,8
MV 140,48,12
MV 144,48,16
MV 148,48,20
s_mov_b32 s47, s46
MV 152,48,24
s_add_u32 s46, s46, 32768
MV 156,48,28
s_cmp_eq_u32 s46, 98304
s_cselect_b32 s46, 0, s46
MV 160,52,0
v_add_u32 v205, s46, v202
MV 164,52,4
s_add_u32 s49, s49, 1
MV 168,52,8
s_add_u32 s69, s69, s51
MV 172,52,12
s_add_u32 s48, s48, 128
MV 176,52,16
s_add_u32 s64, s64, 128
MV 180,52,20
s_cmp_lt_u32 s49, 27
s_cselect_b32 s6, s50, 0
MV 184,52,24
s_cmp_lt_u32 s49, 28
s_cselect_b32 s10, s70, 0
MV 188,52,28
s_waitcnt vmcnt(18) lgkmcnt(0)
s_barrier
MV 0,92,60
MV 4,92,64
MV 8,92,68
MV 12,92,72
MV 16,92,76
MV 20,92,80
MV 24,92,84
MV 28,92,88
MV 32,96,60
MV 36,96,64
MV 40,96,68
MV 44,96,72
MV 48,96,76
MV 52,96,80
MV 56,96,84
MV 60,96,88
MV 64,100,60
MV 68,100,64
MV 72,100,68
MV 76,100,72
MV 80,100,76
MV 84,100,80
MV 88,100,84
MV 92,100,88
MV 96,104,60
MV 100,104,64
MV 104,104,68
MV 108,104,72
MV 112,104,76
MV 116,104,80
MV 120,104,84
MV 124,104,88
MV 128,108,60
MV 132,108,64
MV 136,108,68
MV 140,108,72
MV 144,108,76
MV 148,108,80
MV 152,108,84
MV 156,108,88
MV 160,112,60
MV 164,112,64
MV 168,112,68
MV 172,112,72
MV 176,112,76
MV 180,112,80
MV 184,112,84
MV 188,112,88
s_waitcnt vmcnt(0) lgkmcnt(0)
s_barrier
s_branch k1_qkv_epi
k1_qkv_w3:
s_mov_b32 s52, 1
s_mov_b32 s53, 1
s_lshl_b32 s54, s44, 4
s_add_u32 s54, s54, s45
s_waitcnt lgkmcnt(0)
s_lshr_b32 s74, s2, 3
s_lshl_b32 s74, s74, 2
s_add_u32 s74, s74, s42
s_and_b32 s75, s2, 1
s_lshl_b32 s75, s75, 2
s_bfe_u32 s76, s2, 0x20001
s_lshl_b32 s76, s76, 2
s_cmp_lt_u32 s74, 48
s_cbranch_scc0 k1_qkv_w3_k1_st_w
s_mul_i32 s3, s74, 43691
s_lshr_b32 s3, s3, 19
s_mul_i32 s77, s3, 12
s_sub_u32 s77, s74, s77
s_add_u32 s3, s3, s75
s_lshl_b32 s3, s3, 19
s_and_b32 s75, s77, 3
s_lshl_b32 s75, s75, 17
s_add_u32 s3, s3, s75
s_lshr_b32 s77, s77, 2
s_cmp_ge_u32 s77, 1
s_cbranch_scc1 k1_qkv_w3_k1_st_done
s_lshl_b32 s77, s77, 7
s_add_u32 s3, s3, s77
v_lshlrev_b32 v255, 11, v206
v_add_u32 v255, s3, v255
s_mov_b32 s72, s16
s_and_b32 s73, s17, 0xffff
s_mov_b32 s74, 4194304
s_mov_b32 s75, 0x20000
s_branch k1_qkv_w3_k1_st_go
k1_qkv_w3_k1_st_w:
s_cmp_lt_u32 s74, 88
s_cselect_b32 s77, 48, 88
s_cselect_b32 s75, 1, 0
s_sub_u32 s74, s74, s77
s_mul_i32 s3, s74, 52429
s_lshr_b32 s3, s3, 19
s_mul_i32 s77, s3, 10
s_sub_u32 s77, s74, s77
s_cmp_ge_u32 s77, 4
s_cbranch_scc1 k1_qkv_w3_k1_st_done
s_add_u32 s76, s76, s3
s_lshl_b32 s77, s77, 4
v_lshrrev_b32 v255, 2, v206
v_add_u32 v255, s77, v255
v_and_b32 v254, 3, v206
s_cmp_eq_u32 s75, 1
s_cbranch_scc0 k1_qkv_w3_k1_st_q
s_mul_i32 s3, s76, 448
s_and_b32 s3, s3, 0xffffff80
s_mov_b32 s77, 7168
v_mul_lo_u32 v255, v255, s77
v_lshl_add_u32 v255, v254, 7, v255
v_add_u32 v255, s3, v255
s_mov_b32 s72, s26
s_and_b32 s73, s27, 0xffff
s_mov_b32 s74, 7340032
s_mov_b32 s75, 0x20000
s_branch k1_qkv_w3_k1_st_go
k1_qkv_w3_k1_st_q:
s_lshl_b32 s3, s76, 7
s_mov_b32 s77, 6144
v_mul_lo_u32 v255, v255, s77
v_min_u32 v254, 2, v254
v_lshl_add_u32 v255, v254, 11, v255
v_add_u32 v255, s3, v255
s_mov_b32 s72, s18
s_and_b32 s73, s19, 0xffff
s_mov_b32 s74, 6291456
s_mov_b32 s75, 0x20000
k1_qkv_w3_k1_st_go:
buffer_load_dword v254, v255, s[72:75], 0 offen
k1_qkv_w3_k1_st_done:
s_add_u32 s12, s40, 29360128
s_addc_u32 s13, s41, 0
s_and_b32 s13, s13, 0xffff
s_mov_b32 s14, 65536
s_mov_b32 s15, 0x20000
v_lshlrev_b32 v210, 3, v206
v_mov_b32 v212, 0
v_mov_b32 v213, 0
s_lshl_b32 s55, s54, 9
buffer_store_dwordx2 v[212:213], v210, s[12:15], s55 offen sc1
s_add_u32 s12, s40, 28311552
s_addc_u32 s13, s41, 0
s_and_b32 s13, s13, 0xffff
s_mov_b32 s14, 4096
s_mov_b32 s15, 0x20000
s_lshl_b32 s55, s45, 7
s_cmp_eq_u32 s44, 0
s_cselect_b32 s14, s14, 0
v_lshlrev_b32 v211, 1, v206
buffer_store_short v212, v211, s[12:15], s55 offen sc1
buffer_store_short v212, v211, s[12:15], s55 offen offset:2048 sc1
s_add_u32 s12, s40, 27262976
s_addc_u32 s13, s41, 0
s_and_b32 s13, s13, 0xffff
s_mov_b32 s14, 8192
s_mov_b32 s15, 0x20000
s_lshl_b32 s55, s45, 9
s_cmp_eq_u32 s44, 0
s_cselect_b32 s14, s14, 0
buffer_store_dwordx2 v[212:213], v210, s[12:15], s55 offen sc1
s_add_u32 s12, s40, 24117248
s_addc_u32 s13, s41, 0
s_and_b32 s13, s13, 0xffff
s_mov_b32 s14, 262144
s_mov_b32 s15, 0x20000
s_lshl_b32 s55, s45, 14
s_lshl_b32 s56, s44, 11
s_add_u32 s55, s55, s56
v_mov_b32 v214, 0
v_mov_b32 v215, 0
v_mov_b32 v216, 0
v_mov_b32 v217, 0
v_lshlrev_b32 v218, 4, v206
buffer_store_dwordx4 v[214:217], v218, s[12:15], s55 offen sc1
buffer_store_dwordx4 v[214:217], v218, s[12:15], s55 offen offset:1024 sc1
v_and_b32 v210, 15, v206
v_lshrrev_b32 v213, 4, v206
v_lshrrev_b32 v211, 1, v210
v_add_u32 v212, 0, v213
v_xor_b32 v212, v212, v211
v_lshlrev_b32 v212, 4, v212
v_lshl_add_u32 v212, v210, 7, v212
v_add_u32 v202, 16384, v212
v_add_u32 v212, 4, v213
v_xor_b32 v212, v212, v211
v_lshlrev_b32 v212, 4, v212
v_lshl_add_u32 v212, v210, 7, v212
v_add_u32 v203, 16384, v212
v_bfe_u32 v211, v206, 2, 2
v_lshl_add_u32 v214, v213, 3, v211
v_and_b32 v215, 3, v206
v_lshlrev_b32 v215, 3, v215
v_lshrrev_b32 v216, 1, v211
v_and_b32 v217, 1, v213
v_lshl_or_b32 v216, v217, 1, v216
v_lshl_add_u32 v218, v214, 7, v215
v_add_u32 v218, 98304, v218
v_xor_b32 v219, 2, v216
v_lshl_add_u32 v204, v219, 5, v218
v_xor_b32 v219, 3, v216
v_lshl_add_u32 v207, v219, 5, v218
v_mov_b32 v205, v202
s_mov_b32 s12, s16
s_and_b32 s13, s17, 0xffff
s_mov_b32 s14, 4194304
s_mov_b32 s15, 0x20000
v_lshrrev_b32 v250, 4, v206
s_lshl_b32 s55, s54, 4
s_add_u32 s55, s55, 12
v_add_u32 v250, s55, v250
v_lshlrev_b32 v250, 11, v250
v_and_b32 v251, 15, v206
v_lshl_add_u32 v250, v251, 4, v250
s_cmp_lt_u32 s2, 96
s_cbranch_scc1 k1_qkv_w3_tsq
s_mov_b32 s4, s26
s_and_b32 s5, s27, 0xffff
s_mov_b32 s6, 7340032
s_mov_b32 s7, 0x20000
s_sub_u32 s55, s2, 96
s_lshl_b32 s55, s55, 13
s_mov_b32 s77, 917504
s_cmp_lt_u32 s2, 208
s_cselect_b32 s6, s6, 0
s_branch k1_qkv_w3_tsd
k1_qkv_w3_tsq:
s_mov_b32 s4, s18
s_and_b32 s5, s19, 0xffff
s_mov_b32 s6, 6291456
s_mov_b32 s7, 0x20000
s_lshl_b32 s55, s2, 13
s_mov_b32 s77, 786432
k1_qkv_w3_tsd:
v_lshlrev_b32 v252, 7, v206
v_add_u32 v252, s55, v252
v_add_u32 v252, s77, v252
buffer_load_dword v253, v252, s[4:7], 0 offen
v_add_u32 v252, s77, v252
buffer_load_dword v253, v252, s[4:7], 0 offen
s_waitcnt lgkmcnt(0)
s_barrier
TR 32,204,0
TR 34,204,512
RB 0,205,0
RB 4,205,2048
RB 8,205,4096
RB 12,205,6144
RB 16,205,8192
RB 20,205,10240
RB 24,205,12288
RB 28,205,14336
TR 36,207,0
TR 38,207,512
TR 40,204,4096
TR 42,204,4608
TR 44,207,4096
TR 46,207,4608
TR 48,204,8192
TR 50,204,8704
TR 52,207,8192
TR 54,207,8704
s_mov_b32 s46, 0
s_mov_b32 s47, 65536
s_mov_b32 s49, 0
v_mov_b32 v205, v203
s_waitcnt lgkmcnt(0)
s_barrier
MVZ 0,32,0
TR 92,204,12288
MVZ 4,32,4
TR 94,204,12800
MVZ 8,32,8
buffer_load_dwordx4 v[210:213], v250, s[12:15], 0 offen offset:0
MVZ 12,32,12
RB 60,205,0
MVZ 16,32,16
MVZ 20,32,20
RB 64,205,2048
MVZ 24,32,24
RB 68,205,4096
buffer_load_dwordx4 v[214:217], v250, s[12:15], 0 offen offset:256
MVZ 28,32,28
MVZ 32,36,0
RB 72,205,6144
MVZ 36,36,4
MVZ 40,36,8
RB 76,205,8192
buffer_load_dwordx4 v[218:221], v250, s[12:15], 0 offen offset:512
MVZ 44,36,12
RB 80,205,10240
MVZ 48,36,16
MVZ 52,36,20
RB 84,205,12288
MVZ 56,36,24
buffer_load_dwordx4 v[222:225], v250, s[12:15], 0 offen offset:768
MVZ 60,36,28
RB 88,205,14336
MVZ 64,40,0
MVZ 68,40,4
TR 96,207,12288
MVZ 72,40,8
TR 98,207,12800
buffer_load_dwordx4 v[226:229], v250, s[12:15], 0 offen offset:1024
MVZ 76,40,12
MVZ 80,40,16
TR 100,204,16384
MVZ 84,40,20
MVZ 88,40,24
TR 102,204,16896
buffer_load_dwordx4 v[230:233], v250, s[12:15], 0 offen offset:1280
MVZ 92,40,28
TR 104,207,16384
MVZ 96,44,0
MVZ 100,44,4
TR 106,207,16896
MVZ 104,44,8
buffer_load_dwordx4 v[234:237], v250, s[12:15], 0 offen offset:1536
MVZ 108,44,12
TR 108,204,20480
MVZ 112,44,16
TR 110,204,20992
MVZ 116,44,20
MVZ 120,44,24
TR 112,207,20480
buffer_load_dwordx4 v[238:241], v250, s[12:15], 0 offen offset:1792
MVZ 124,44,28
MVZ 128,48,0
TR 114,207,20992
MVZ 132,48,4
MVZ 136,48,8
MVZ 140,48,12
MVZ 144,48,16
MVZ 148,48,20
MVZ 152,48,24
MVZ 156,48,28
MVZ 160,52,0
MVZ 164,52,4
MVZ 168,52,8
s_mov_b32 s47, s46
MVZ 172,52,12
s_add_u32 s46, s46, 32768
MVZ 176,52,16
s_cmp_eq_u32 s46, 98304
s_cselect_b32 s46, 0, s46
MVZ 180,52,20
v_add_u32 v205, s46, v202
MVZ 184,52,24
s_add_u32 s49, s49, 1
MVZ 188,52,28
s_waitcnt lgkmcnt(0)
s_barrier
MV 0,92,60
TR 32,204,24576
MV 4,92,64
TR 34,204,25088
MV 8,92,68
MV 12,92,72
RB 0,205,0
MV 16,92,76
MV 20,92,80
RB 4,205,2048
MV 24,92,84
RB 8,205,4096
MV 28,92,88
MV 32,96,60
RB 12,205,6144
MV 36,96,64
MV 40,96,68
RB 16,205,8192
MV 44,96,72
RB 20,205,10240
MV 48,96,76
MV 52,96,80
RB 24,205,12288
MV 56,96,84
MV 60,96,88
RB 28,205,14336
MV 64,100,60
MV 68,100,64
TR 36,207,24576
MV 72,100,68
TR 38,207,25088
MV 76,100,72
MV 80,100,76
TR 40,204,28672
MV 84,100,80
MV 88,100,84
TR 42,204,29184
MV 92,100,88
TR 44,207,28672
MV 96,104,60
MV 100,104,64
TR 46,207,29184
MV 104,104,68
MV 108,104,72
TR 48,204,32768
MV 112,104,76
TR 50,204,33280
MV 116,104,80
MV 120,104,84
TR 52,207,32768
MV 124,104,88
MV 128,108,60
TR 54,207,33280
MV 132,108,64
MV 136,108,68
MV 140,108,72
MV 144,108,76
MV 148,108,80
MV 152,108,84
MV 156,108,88
MV 160,112,60
MV 164,112,64
MV 168,112,68
MV 172,112,72
MV 176,112,76
MV 180,112,80
v_add_u32 v205, s46, v203
MV 184,112,84
s_add_u32 s49, s49, 1
MV 188,112,88
s_waitcnt lgkmcnt(0)
s_barrier
s_waitcnt vmcnt(0)
v_and_b32 v250, 15, v206
v_lshlrev_b32 v250, 4, v250
v_add_u32 v251, 151552, v250
s_mov_b32 s60, 0x3f803f80
ds_read_b128 v[242:245], v251 offset:0
ds_read_b128 v[246:249], v251 offset:256
v_mov_b32 v255, v251
s_waitcnt lgkmcnt(1)
D2 v250,v210,v242,0
D2 v251,v210,s60,0
D2 v209,v210,v210,0
D2 v250,v211,v243,v250
D2 v251,v211,s60,v251
D2 v209,v211,v211,v209
D2 v250,v212,v244,v250
D2 v251,v212,s60,v251
D2 v209,v212,v212,v209
D2 v250,v213,v245,v250
D2 v251,v213,s60,v251
D2 v209,v213,v213,v209
ds_read_b128 v[242:245], v255 offset:512
s_waitcnt lgkmcnt(1)
D2 v250,v214,v246,v250
D2 v251,v214,s60,v251
D2 v209,v214,v214,v209
D2 v250,v215,v247,v250
D2 v251,v215,s60,v251
D2 v209,v215,v215,v209
D2 v250,v216,v248,v250
D2 v251,v216,s60,v251
D2 v209,v216,v216,v209
D2 v250,v217,v249,v250
D2 v251,v217,s60,v251
D2 v209,v217,v217,v209
ds_read_b128 v[246:249], v255 offset:768
s_waitcnt lgkmcnt(1)
D2 v250,v218,v242,v250
D2 v251,v218,s60,v251
D2 v209,v218,v218,v209
D2 v250,v219,v243,v250
D2 v251,v219,s60,v251
D2 v209,v219,v219,v209
D2 v250,v220,v244,v250
D2 v251,v220,s60,v251
D2 v209,v220,v220,v209
D2 v250,v221,v245,v250
D2 v251,v221,s60,v251
D2 v209,v221,v221,v209
ds_read_b128 v[242:245], v255 offset:1024
s_waitcnt lgkmcnt(1)
D2 v250,v222,v246,v250
D2 v251,v222,s60,v251
D2 v209,v222,v222,v209
D2 v250,v223,v247,v250
D2 v251,v223,s60,v251
D2 v209,v223,v223,v209
D2 v250,v224,v248,v250
D2 v251,v224,s60,v251
D2 v209,v224,v224,v209
D2 v250,v225,v249,v250
D2 v251,v225,s60,v251
D2 v209,v225,v225,v209
ds_read_b128 v[246:249], v255 offset:1280
s_waitcnt lgkmcnt(1)
D2 v250,v226,v242,v250
D2 v251,v226,s60,v251
D2 v209,v226,v226,v209
D2 v250,v227,v243,v250
D2 v251,v227,s60,v251
D2 v209,v227,v227,v209
D2 v250,v228,v244,v250
D2 v251,v228,s60,v251
D2 v209,v228,v228,v209
D2 v250,v229,v245,v250
D2 v251,v229,s60,v251
D2 v209,v229,v229,v209
ds_read_b128 v[242:245], v255 offset:1536
s_waitcnt lgkmcnt(1)
D2 v250,v230,v246,v250
D2 v251,v230,s60,v251
D2 v209,v230,v230,v209
D2 v250,v231,v247,v250
D2 v251,v231,s60,v251
D2 v209,v231,v231,v209
D2 v250,v232,v248,v250
D2 v251,v232,s60,v251
D2 v209,v232,v232,v209
D2 v250,v233,v249,v250
D2 v251,v233,s60,v251
D2 v209,v233,v233,v209
ds_read_b128 v[246:249], v255 offset:1792
s_waitcnt lgkmcnt(1)
D2 v250,v234,v242,v250
D2 v251,v234,s60,v251
D2 v209,v234,v234,v209
D2 v250,v235,v243,v250
D2 v251,v235,s60,v251
D2 v209,v235,v235,v209
D2 v250,v236,v244,v250
D2 v251,v236,s60,v251
D2 v209,v236,v236,v209
D2 v250,v237,v245,v250
D2 v251,v237,s60,v251
D2 v209,v237,v237,v209
s_waitcnt lgkmcnt(0)
D2 v250,v238,v246,v250
D2 v251,v238,s60,v251
D2 v209,v238,v238,v209
D2 v250,v239,v247,v250
D2 v251,v239,s60,v251
D2 v209,v239,v239,v209
D2 v250,v240,v248,v250
D2 v251,v240,s60,v251
D2 v209,v240,v240,v209
D2 v250,v241,v249,v250
D2 v251,v241,s60,v251
D2 v209,v241,v241,v209
v_lshrrev_b32 v210, 4, v206
s_lshl_b32 s55, s54, 4
s_add_u32 s55, s55, 12
v_add_u32 v210, s55, v210
v_lshlrev_b32 v211, 3, v210
v_lshlrev_b32 v212, 2, v210
v_add_f32_dpp v250, v250, v250 row_ror:8 row_mask:0xf bank_mask:0xf
v_add_f32_dpp v251, v251, v251 row_ror:8 row_mask:0xf bank_mask:0xf
v_add_f32_dpp v209, v209, v209 row_ror:8 row_mask:0xf bank_mask:0xf
v_add_f32_dpp v250, v250, v250 row_ror:4 row_mask:0xf bank_mask:0xf
v_add_f32_dpp v251, v251, v251 row_ror:4 row_mask:0xf bank_mask:0xf
v_add_f32_dpp v209, v209, v209 row_ror:4 row_mask:0xf bank_mask:0xf
v_add_f32_dpp v250, v250, v250 row_ror:2 row_mask:0xf bank_mask:0xf
v_add_f32_dpp v251, v251, v251 row_ror:2 row_mask:0xf bank_mask:0xf
v_add_f32_dpp v209, v209, v209 row_ror:2 row_mask:0xf bank_mask:0xf
v_add_f32_dpp v250, v250, v250 row_ror:1 row_mask:0xf bank_mask:0xf
v_add_f32_dpp v251, v251, v251 row_ror:1 row_mask:0xf bank_mask:0xf
v_add_f32_dpp v209, v209, v209 row_ror:1 row_mask:0xf bank_mask:0xf
v_mul_f32 v250, 0xbfb8aa3b, v250
v_mul_f32 v251, 0xba800000, v251
v_exp_f32 v250, v250
v_mul_f32 v209, 0x3a800000, v209
v_fma_f32 v209, -v251, v251, v209
v_add_f32 v250, 1.0, v250
v_max_f32 v209, 0, v209
v_rcp_f32 v250, v250
v_add_f32 v209, 0x3727c5ac, v209
v_rsq_f32 v214, v209
s_nop 0
v_mul_f32 v215, v251, v214
s_add_u32 s12, s40, 20971520
s_addc_u32 s13, s41, 0
s_and_b32 s13, s13, 0xffff
s_mov_b32 s14, 16384
s_mov_b32 s15, 0x20000
s_mov_b32 exec_lo, 0x00010001
s_mov_b32 exec_hi, 0x00010001
buffer_store_dwordx2 v[214:215], v211, s[12:15], 0 offen sc1
s_add_u32 s12, s40, 22020096
s_addc_u32 s13, s41, 0
s_and_b32 s13, s13, 0xffff
s_mov_b32 s14, 8192
s_mov_b32 s15, 0x20000
buffer_store_dword v250, v212, s[12:15], 0 offen sc1
s_mov_b64 exec, -1
v_add_u32 v252, s77, v252
buffer_load_dword v253, v252, s[4:7], 0 offen
k1_qkv_w3_loop:
MV 0,32,0
TR 92,204,36864
MV 4,32,4
TR 94,204,37376
MV 8,32,8
MV 12,32,12
RB 60,205,0
MV 16,32,16
MV 20,32,20
RB 64,205,2048
MV 24,32,24
RB 68,205,4096
MV 28,32,28
MV 32,36,0
RB 72,205,6144
MV 36,36,4
MV 40,36,8
RB 76,205,8192
MV 44,36,12
RB 80,205,10240
MV 48,36,16
MV 52,36,20
RB 84,205,12288
MV 56,36,24
MV 60,36,28
RB 88,205,14336
MV 64,40,0
MV 68,40,4
TR 96,207,36864
MV 72,40,8
TR 98,207,37376
MV 76,40,12
MV 80,40,16
TR 100,204,40960
MV 84,40,20
MV 88,40,24
TR 102,204,41472
MV 92,40,28
TR 104,207,40960
MV 96,44,0
MV 100,44,4
TR 106,207,41472
MV 104,44,8
MV 108,44,12
TR 108,204,45056
MV 112,44,16
TR 110,204,45568
MV 116,44,20
MV 120,44,24
TR 112,207,45056
MV 124,44,28
MV 128,48,0
TR 114,207,45568
MV 132,48,4
MV 136,48,8
MV 140,48,12
MV 144,48,16
MV 148,48,20
MV 152,48,24
MV 156,48,28
MV 160,52,0
MV 164,52,4
MV 168,52,8
s_mov_b32 s47, s46
MV 172,52,12
s_add_u32 s46, s46, 32768
MV 176,52,16
s_cmp_eq_u32 s46, 98304
s_cselect_b32 s46, 0, s46
MV 180,52,20
v_add_u32 v205, s46, v202
MV 184,52,24
s_add_u32 s49, s49, 1
MV 188,52,28
s_waitcnt lgkmcnt(0)
s_barrier
MV 0,92,60
TR 32,204,0
MV 4,92,64
TR 34,204,512
MV 8,92,68
MV 12,92,72
RB 0,205,0
MV 16,92,76
MV 20,92,80
RB 4,205,2048
MV 24,92,84
RB 8,205,4096
MV 28,92,88
MV 32,96,60
RB 12,205,6144
MV 36,96,64
MV 40,96,68
RB 16,205,8192
MV 44,96,72
RB 20,205,10240
MV 48,96,76
MV 52,96,80
RB 24,205,12288
MV 56,96,84
MV 60,96,88
RB 28,205,14336
MV 64,100,60
MV 68,100,64
TR 36,207,0
MV 72,100,68
TR 38,207,512
MV 76,100,72
MV 80,100,76
TR 40,204,4096
MV 84,100,80
MV 88,100,84
TR 42,204,4608
MV 92,100,88
TR 44,207,4096
MV 96,104,60
MV 100,104,64
TR 46,207,4608
MV 104,104,68
MV 108,104,72
TR 48,204,8192
MV 112,104,76
TR 50,204,8704
MV 116,104,80
MV 120,104,84
TR 52,207,8192
MV 124,104,88
MV 128,108,60
TR 54,207,8704
MV 132,108,64
MV 136,108,68
MV 140,108,72
MV 144,108,76
MV 148,108,80
MV 152,108,84
MV 156,108,88
MV 160,112,60
MV 164,112,64
MV 168,112,68
MV 172,112,72
MV 176,112,76
MV 180,112,80
v_add_u32 v205, s46, v203
MV 184,112,84
s_add_u32 s49, s49, 1
MV 188,112,88
s_waitcnt lgkmcnt(0)
s_barrier
s_and_b32 s55, s49, 3
s_cmp_eq_u32 s55, 2
s_cbranch_scc0 k1_qkv_w3_a_nogrp
s_cmp_le_u32 s49, 18
s_cbranch_scc0 k1_qkv_w3_a_nogrp
v_add_u32 v252, s77, v252
buffer_load_dword v253, v252, s[4:7], 0 offen
k1_qkv_w3_a_nogrp:
s_cmp_eq_u32 s49, 4
s_cbranch_scc0 k1_qkv_w3_a_nozero
s_waitcnt vmcnt(1)
k1_qkv_w3_a_nozero:
s_cmp_lt_u32 s49, 20
s_cbranch_scc1 k1_qkv_w3_a_nopf
s_cmp_ge_u32 s49, 30
s_cbranch_scc1 k1_qkv_w3_a_nopf
s_sub_u32 s56, s49, 20
s_lshl_b32 s56, s56, 7
s_add_u32 s56, s56, s2
s_cmp_ge_u32 s49, 28
s_cbranch_scc1 k1_qkv_w3_a_pfo
s_mov_b32 s72, s30
s_and_b32 s73, s31, 0xffff
s_mov_b32 s74, 7340032
s_mov_b32 s75, 0x20000
s_lshl_b32 s76, s56, 13
v_lshlrev_b32 v255, 7, v206
v_add_u32 v255, s76, v255
buffer_load_dword v253, v255, s[72:75], 0 offen
s_branch k1_qkv_w3_a_nopf
k1_qkv_w3_a_pfo:
s_sub_u32 s56, s56, 1024
s_mov_b32 s72, s22
s_and_b32 s73, s23, 0xffff
s_mov_b32 s74, 2097152
s_mov_b32 s75, 0x20000
s_lshl_b32 s76, s56, 13
v_lshlrev_b32 v255, 7, v206
v_add_u32 v255, s76, v255
buffer_load_dword v253, v255, s[72:75], 0 offen
k1_qkv_w3_a_nopf:
MV 0,32,0
TR 92,204,12288
MV 4,32,4
TR 94,204,12800
MV 8,32,8
MV 12,32,12
RB 60,205,0
MV 16,32,16
MV 20,32,20
RB 64,205,2048
MV 24,32,24
RB 68,205,4096
MV 28,32,28
MV 32,36,0
RB 72,205,6144
MV 36,36,4
MV 40,36,8
RB 76,205,8192
MV 44,36,12
RB 80,205,10240
MV 48,36,16
MV 52,36,20
RB 84,205,12288
MV 56,36,24
MV 60,36,28
RB 88,205,14336
MV 64,40,0
MV 68,40,4
TR 96,207,12288
MV 72,40,8
TR 98,207,12800
MV 76,40,12
MV 80,40,16
TR 100,204,16384
MV 84,40,20
MV 88,40,24
TR 102,204,16896
MV 92,40,28
TR 104,207,16384
MV 96,44,0
MV 100,44,4
TR 106,207,16896
MV 104,44,8
MV 108,44,12
TR 108,204,20480
MV 112,44,16
TR 110,204,20992
MV 116,44,20
MV 120,44,24
TR 112,207,20480
MV 124,44,28
MV 128,48,0
TR 114,207,20992
MV 132,48,4
MV 136,48,8
MV 140,48,12
MV 144,48,16
MV 148,48,20
MV 152,48,24
MV 156,48,28
MV 160,52,0
MV 164,52,4
MV 168,52,8
s_mov_b32 s47, s46
MV 172,52,12
s_add_u32 s46, s46, 32768
MV 176,52,16
s_cmp_eq_u32 s46, 98304
s_cselect_b32 s46, 0, s46
MV 180,52,20
v_add_u32 v205, s46, v202
MV 184,52,24
s_add_u32 s49, s49, 1
MV 188,52,28
s_waitcnt lgkmcnt(0)
s_barrier
MV 0,92,60
TR 32,204,24576
MV 4,92,64
TR 34,204,25088
MV 8,92,68
MV 12,92,72
RB 0,205,0
MV 16,92,76
MV 20,92,80
RB 4,205,2048
MV 24,92,84
RB 8,205,4096
MV 28,92,88
MV 32,96,60
RB 12,205,6144
MV 36,96,64
MV 40,96,68
RB 16,205,8192
MV 44,96,72
RB 20,205,10240
MV 48,96,76
MV 52,96,80
RB 24,205,12288
MV 56,96,84
MV 60,96,88
RB 28,205,14336
MV 64,100,60
MV 68,100,64
TR 36,207,24576
MV 72,100,68
TR 38,207,25088
MV 76,100,72
MV 80,100,76
TR 40,204,28672
MV 84,100,80
MV 88,100,84
TR 42,204,29184
MV 92,100,88
TR 44,207,28672
MV 96,104,60
MV 100,104,64
TR 46,207,29184
MV 104,104,68
MV 108,104,72
TR 48,204,32768
MV 112,104,76
TR 50,204,33280
MV 116,104,80
MV 120,104,84
TR 52,207,32768
MV 124,104,88
MV 128,108,60
TR 54,207,33280
MV 132,108,64
MV 136,108,68
MV 140,108,72
MV 144,108,76
MV 148,108,80
MV 152,108,84
MV 156,108,88
MV 160,112,60
MV 164,112,64
MV 168,112,68
MV 172,112,72
MV 176,112,76
MV 180,112,80
v_add_u32 v205, s46, v203
MV 184,112,84
s_add_u32 s49, s49, 1
MV 188,112,88
s_waitcnt lgkmcnt(0)
s_barrier
s_and_b32 s55, s49, 3
s_cmp_eq_u32 s55, 2
s_cbranch_scc0 k1_qkv_w3_b_nogrp
s_cmp_le_u32 s49, 18
s_cbranch_scc0 k1_qkv_w3_b_nogrp
v_add_u32 v252, s77, v252
buffer_load_dword v253, v252, s[4:7], 0 offen
k1_qkv_w3_b_nogrp:
s_cmp_eq_u32 s49, 4
s_cbranch_scc0 k1_qkv_w3_b_nozero
s_waitcnt vmcnt(1)
k1_qkv_w3_b_nozero:
s_cmp_eq_u32 s49, 26
s_cbranch_scc0 k1_qkv_w3_b_nocode26
s_getpc_b64 s[72:73]
k1_pc_k1_qkv_w3_b_26:
s_sub_u32 s72, s72, k1_pc_k1_qkv_w3_b_26-k1_code_start
s_subb_u32 s73, s73, 0
s_and_b32 s73, s73, 0xffff
s_mov_b32 s74, k1_code_end-k1_code_start
s_mov_b32 s75, 0x20000
s_lshr_b32 s76, s2, 3
s_lshl_b32 s76, s76, 13
v_lshlrev_b32 v255, 7, v206
v_add_u32 v255, s76, v255
buffer_load_dword v253, v255, s[72:75], 0 offen
k1_qkv_w3_b_nocode26:
s_cmp_lt_u32 s49, 20
s_cbranch_scc1 k1_qkv_w3_b_nopf
s_cmp_ge_u32 s49, 30
s_cbranch_scc1 k1_qkv_w3_b_nopf
s_sub_u32 s56, s49, 20
s_lshl_b32 s56, s56, 7
s_add_u32 s56, s56, s2
s_cmp_ge_u32 s49, 28
s_cbranch_scc1 k1_qkv_w3_b_pfo
s_mov_b32 s72, s30
s_and_b32 s73, s31, 0xffff
s_mov_b32 s74, 7340032
s_mov_b32 s75, 0x20000
s_lshl_b32 s76, s56, 13
v_lshlrev_b32 v255, 7, v206
v_add_u32 v255, s76, v255
buffer_load_dword v253, v255, s[72:75], 0 offen
s_branch k1_qkv_w3_b_nopf
k1_qkv_w3_b_pfo:
s_sub_u32 s56, s56, 1024
s_mov_b32 s72, s22
s_and_b32 s73, s23, 0xffff
s_mov_b32 s74, 2097152
s_mov_b32 s75, 0x20000
s_lshl_b32 s76, s56, 13
v_lshlrev_b32 v255, 7, v206
v_add_u32 v255, s76, v255
buffer_load_dword v253, v255, s[72:75], 0 offen
k1_qkv_w3_b_nopf:
s_cmp_lt_u32 s49, 30
s_cbranch_scc1 k1_qkv_w3_loop
MV 0,32,0
TR 92,204,36864
MV 4,32,4
TR 94,204,37376
MV 8,32,8
MV 12,32,12
RB 60,205,0
MV 16,32,16
MV 20,32,20
RB 64,205,2048
MV 24,32,24
RB 68,205,4096
MV 28,32,28
MV 32,36,0
RB 72,205,6144
MV 36,36,4
MV 40,36,8
RB 76,205,8192
MV 44,36,12
RB 80,205,10240
MV 48,36,16
MV 52,36,20
RB 84,205,12288
MV 56,36,24
MV 60,36,28
RB 88,205,14336
MV 64,40,0
MV 68,40,4
TR 96,207,36864
MV 72,40,8
TR 98,207,37376
MV 76,40,12
MV 80,40,16
TR 100,204,40960
MV 84,40,20
MV 88,40,24
TR 102,204,41472
MV 92,40,28
TR 104,207,40960
MV 96,44,0
MV 100,44,4
TR 106,207,41472
MV 104,44,8
MV 108,44,12
TR 108,204,45056
MV 112,44,16
TR 110,204,45568
MV 116,44,20
MV 120,44,24
TR 112,207,45056
MV 124,44,28
MV 128,48,0
TR 114,207,45568
MV 132,48,4
MV 136,48,8
MV 140,48,12
MV 144,48,16
MV 148,48,20
MV 152,48,24
MV 156,48,28
MV 160,52,0
MV 164,52,4
MV 168,52,8
s_mov_b32 s47, s46
MV 172,52,12
s_add_u32 s46, s46, 32768
MV 176,52,16
s_cmp_eq_u32 s46, 98304
s_cselect_b32 s46, 0, s46
MV 180,52,20
v_add_u32 v205, s46, v202
MV 184,52,24
s_add_u32 s49, s49, 1
MV 188,52,28
s_waitcnt lgkmcnt(0)
s_barrier
MV 0,92,60
MV 4,92,64
MV 8,92,68
MV 12,92,72
MV 16,92,76
MV 20,92,80
MV 24,92,84
MV 28,92,88
MV 32,96,60
MV 36,96,64
MV 40,96,68
MV 44,96,72
MV 48,96,76
MV 52,96,80
MV 56,96,84
MV 60,96,88
MV 64,100,60
MV 68,100,64
MV 72,100,68
MV 76,100,72
MV 80,100,76
MV 84,100,80
MV 88,100,84
MV 92,100,88
MV 96,104,60
MV 100,104,64
MV 104,104,68
MV 108,104,72
MV 112,104,76
MV 116,104,80
MV 120,104,84
MV 124,104,88
MV 128,108,60
MV 132,108,64
MV 136,108,68
MV 140,108,72
MV 144,108,76
MV 148,108,80
MV 152,108,84
MV 156,108,88
MV 160,112,60
MV 164,112,64
MV 168,112,68
MV 172,112,72
MV 176,112,76
MV 180,112,80
MV 184,112,84
MV 188,112,88
s_waitcnt vmcnt(0) lgkmcnt(0)
s_barrier
s_branch k1_qkv_epi
k1_mlp_epi0:
v_lshlrev_b32 v208, 4, v206
AR 192,176
AR 193,177
AR 194,178
AR 195,179
AR 196,180
AR 197,181
AR 198,182
AR 199,183
AR 200,184
AR 201,185
AR 202,186
AR 203,187
AR 204,188
AR 205,189
AR 206,190
AR 207,191
v_mov_b32 v209, 0xc0135761
s_mov_b32 s60, 0xbdd2d3e8
s_mov_b32 s61, 0xbdd2d3e8
s_add_u32 s8, s40, 0
s_addc_u32 s9, s41, 0
s_and_b32 s9, s9, 0xffff
s_mov_b32 s10, 18874368
s_mov_b32 s11, 0x20000
s_lshl_b32 s55, s44, 4
s_lshl_b32 s3, s52, 3
s_add_u32 s55, s55, s3
s_mul_i32 s55, s55, 147456
s_mul_i32 s3, s45, 7168
s_add_u32 s55, s55, s3
s_cmp_eq_u32 s65, 0
s_cselect_b32 s3, 6144, 0
s_add_u32 s56, s55, s3
s_lshl_b32 s3, s65, 10
s_add_u32 s55, s55, s3
AR 210,208
AR 211,209
AR 212,210
AR 213,211
AR 215,192
AR 217,193
v_lshlrev_b32 v214, 16, v215
v_and_b32 v215, 0xffff0000, v215
v_lshlrev_b32 v216, 16, v217
v_and_b32 v217, 0xffff0000, v217
v_pk_fma_f32 v[236:237], v[210:211], v[192:193], v[214:215] op_sel:[0,1,0] op_sel_hi:[1,1,1]
v_pk_fma_f32 v[238:239], v[212:213], v[192:193], v[216:217] op_sel:[0,1,0] op_sel_hi:[1,1,1]
v_pk_fma_f32 v[240:241], v[210:211], v[194:195], v[214:215] op_sel:[0,1,0] op_sel_hi:[1,1,1]
v_pk_fma_f32 v[242:243], v[212:213], v[194:195], v[216:217] op_sel:[0,1,0] op_sel_hi:[1,1,1]
v_pk_fma_f32 v[0:1], v[0:1], v[192:193], v[236:237] op_sel_hi:[1,0,1]
v_pk_fma_f32 v[2:3], v[2:3], v[192:193], v[238:239] op_sel_hi:[1,0,1]
v_pk_fma_f32 v[4:5], v[4:5], v[194:195], v[240:241] op_sel_hi:[1,0,1]
v_pk_fma_f32 v[6:7], v[6:7], v[194:195], v[242:243] op_sel_hi:[1,0,1]
v_pk_mul_f32 v[236:237], v[0:1], v[0:1]
v_pk_mul_f32 v[238:239], v[2:3], v[2:3]
v_pk_mul_f32 v[240:241], v[4:5], v[4:5]
v_pk_mul_f32 v[242:243], v[6:7], v[6:7]
v_pk_fma_f32 v[236:237], v[236:237], s[60:61], v[208:209] op_sel:[0,0,1] op_sel_hi:[1,1,1]
v_pk_fma_f32 v[238:239], v[238:239], s[60:61], v[208:209] op_sel:[0,0,1] op_sel_hi:[1,1,1]
v_pk_fma_f32 v[240:241], v[240:241], s[60:61], v[208:209] op_sel:[0,0,1] op_sel_hi:[1,1,1]
v_pk_fma_f32 v[242:243], v[242:243], s[60:61], v[208:209] op_sel:[0,0,1] op_sel_hi:[1,1,1]
v_pk_mul_f32 v[236:237], v[236:237], v[0:1]
v_pk_mul_f32 v[238:239], v[238:239], v[2:3]
v_pk_mul_f32 v[240:241], v[240:241], v[4:5]
v_pk_mul_f32 v[242:243], v[242:243], v[6:7]
v_exp_f32 v236, v236
v_exp_f32 v238, v238
v_exp_f32 v240, v240
v_exp_f32 v242, v242
v_exp_f32 v237, v237
v_exp_f32 v239, v239
v_exp_f32 v241, v241
v_exp_f32 v243, v243
v_pk_add_f32 v[236:237], v[236:237], 1.0 op_sel_hi:[1,0]
v_pk_add_f32 v[238:239], v[238:239], 1.0 op_sel_hi:[1,0]
v_pk_add_f32 v[240:241], v[240:241], 1.0 op_sel_hi:[1,0]
v_pk_add_f32 v[242:243], v[242:243], 1.0 op_sel_hi:[1,0]
v_rcp_f32 v236, v236
v_rcp_f32 v238, v238
v_rcp_f32 v240, v240
v_rcp_f32 v242, v242
v_rcp_f32 v237, v237
v_rcp_f32 v239, v239
v_rcp_f32 v241, v241
v_rcp_f32 v243, v243
v_pk_mul_f32 v[0:1], v[0:1], v[236:237]
v_pk_mul_f32 v[2:3], v[2:3], v[238:239]
v_pk_mul_f32 v[4:5], v[4:5], v[240:241]
v_pk_mul_f32 v[6:7], v[6:7], v[242:243]
CP 0,0,1
CP 1,2,3
CP 4,4,5
CP 5,6,7
v_pk_fma_f32 v[236:237], v[210:211], v[196:197], v[214:215] op_sel:[0,1,0] op_sel_hi:[1,1,1]
v_pk_fma_f32 v[238:239], v[212:213], v[196:197], v[216:217] op_sel:[0,1,0] op_sel_hi:[1,1,1]
v_pk_fma_f32 v[240:241], v[210:211], v[198:199], v[214:215] op_sel:[0,1,0] op_sel_hi:[1,1,1]
v_pk_fma_f32 v[242:243], v[212:213], v[198:199], v[216:217] op_sel:[0,1,0] op_sel_hi:[1,1,1]
v_pk_fma_f32 v[8:9], v[8:9], v[196:197], v[236:237] op_sel_hi:[1,0,1]
v_pk_fma_f32 v[10:11], v[10:11], v[196:197], v[238:239] op_sel_hi:[1,0,1]
v_pk_fma_f32 v[12:13], v[12:13], v[198:199], v[240:241] op_sel_hi:[1,0,1]
v_pk_fma_f32 v[14:15], v[14:15], v[198:199], v[242:243] op_sel_hi:[1,0,1]
v_pk_mul_f32 v[236:237], v[8:9], v[8:9]
v_pk_mul_f32 v[238:239], v[10:11], v[10:11]
v_pk_mul_f32 v[240:241], v[12:13], v[12:13]
v_pk_mul_f32 v[242:243], v[14:15], v[14:15]
v_pk_fma_f32 v[236:237], v[236:237], s[60:61], v[208:209] op_sel:[0,0,1] op_sel_hi:[1,1,1]
v_pk_fma_f32 v[238:239], v[238:239], s[60:61], v[208:209] op_sel:[0,0,1] op_sel_hi:[1,1,1]
v_pk_fma_f32 v[240:241], v[240:241], s[60:61], v[208:209] op_sel:[0,0,1] op_sel_hi:[1,1,1]
v_pk_fma_f32 v[242:243], v[242:243], s[60:61], v[208:209] op_sel:[0,0,1] op_sel_hi:[1,1,1]
v_pk_mul_f32 v[236:237], v[236:237], v[8:9]
v_pk_mul_f32 v[238:239], v[238:239], v[10:11]
v_pk_mul_f32 v[240:241], v[240:241], v[12:13]
v_pk_mul_f32 v[242:243], v[242:243], v[14:15]
v_exp_f32 v236, v236
v_exp_f32 v238, v238
v_exp_f32 v240, v240
v_exp_f32 v242, v242
v_exp_f32 v237, v237
v_exp_f32 v239, v239
v_exp_f32 v241, v241
v_exp_f32 v243, v243
v_pk_add_f32 v[236:237], v[236:237], 1.0 op_sel_hi:[1,0]
v_pk_add_f32 v[238:239], v[238:239], 1.0 op_sel_hi:[1,0]
v_pk_add_f32 v[240:241], v[240:241], 1.0 op_sel_hi:[1,0]
v_pk_add_f32 v[242:243], v[242:243], 1.0 op_sel_hi:[1,0]
v_rcp_f32 v236, v236
v_rcp_f32 v238, v238
v_rcp_f32 v240, v240
v_rcp_f32 v242, v242
v_rcp_f32 v237, v237
v_rcp_f32 v239, v239
v_rcp_f32 v241, v241
v_rcp_f32 v243, v243
v_pk_mul_f32 v[8:9], v[8:9], v[236:237]
v_pk_mul_f32 v[10:11], v[10:11], v[238:239]
v_pk_mul_f32 v[12:13], v[12:13], v[240:241]
v_pk_mul_f32 v[14:15], v[14:15], v[242:243]
CP 8,8,9
CP 9,10,11
CP 12,12,13
CP 13,14,15
v_pk_fma_f32 v[236:237], v[210:211], v[200:201], v[214:215] op_sel:[0,1,0] op_sel_hi:[1,1,1]
v_pk_fma_f32 v[238:239], v[212:213], v[200:201], v[216:217] op_sel:[0,1,0] op_sel_hi:[1,1,1]
v_pk_fma_f32 v[240:241], v[210:211], v[202:203], v[214:215] op_sel:[0,1,0] op_sel_hi:[1,1,1]
v_pk_fma_f32 v[242:243], v[212:213], v[202:203], v[216:217] op_sel:[0,1,0] op_sel_hi:[1,1,1]
v_pk_fma_f32 v[16:17], v[16:17], v[200:201], v[236:237] op_sel_hi:[1,0,1]
v_pk_fma_f32 v[18:19], v[18:19], v[200:201], v[238:239] op_sel_hi:[1,0,1]
v_pk_fma_f32 v[20:21], v[20:21], v[202:203], v[240:241] op_sel_hi:[1,0,1]
v_pk_fma_f32 v[22:23], v[22:23], v[202:203], v[242:243] op_sel_hi:[1,0,1]
v_pk_mul_f32 v[236:237], v[16:17], v[16:17]
v_pk_mul_f32 v[238:239], v[18:19], v[18:19]
v_pk_mul_f32 v[240:241], v[20:21], v[20:21]
v_pk_mul_f32 v[242:243], v[22:23], v[22:23]
v_pk_fma_f32 v[236:237], v[236:237], s[60:61], v[208:209] op_sel:[0,0,1] op_sel_hi:[1,1,1]
v_pk_fma_f32 v[238:239], v[238:239], s[60:61], v[208:209] op_sel:[0,0,1] op_sel_hi:[1,1,1]
v_pk_fma_f32 v[240:241], v[240:241], s[60:61], v[208:209] op_sel:[0,0,1] op_sel_hi:[1,1,1]
v_pk_fma_f32 v[242:243], v[242:243], s[60:61], v[208:209] op_sel:[0,0,1] op_sel_hi:[1,1,1]
v_pk_mul_f32 v[236:237], v[236:237], v[16:17]
v_pk_mul_f32 v[238:239], v[238:239], v[18:19]
v_pk_mul_f32 v[240:241], v[240:241], v[20:21]
v_pk_mul_f32 v[242:243], v[242:243], v[22:23]
v_exp_f32 v236, v236
v_exp_f32 v238, v238
v_exp_f32 v240, v240
v_exp_f32 v242, v242
v_exp_f32 v237, v237
v_exp_f32 v239, v239
v_exp_f32 v241, v241
v_exp_f32 v243, v243
v_pk_add_f32 v[236:237], v[236:237], 1.0 op_sel_hi:[1,0]
v_pk_add_f32 v[238:239], v[238:239], 1.0 op_sel_hi:[1,0]
v_pk_add_f32 v[240:241], v[240:241], 1.0 op_sel_hi:[1,0]
v_pk_add_f32 v[242:243], v[242:243], 1.0 op_sel_hi:[1,0]
v_rcp_f32 v236, v236
v_rcp_f32 v238, v238
v_rcp_f32 v240, v240
v_rcp_f32 v242, v242
v_rcp_f32 v237, v237
v_rcp_f32 v239, v239
v_rcp_f32 v241, v241
v_rcp_f32 v243, v243
v_pk_mul_f32 v[16:17], v[16:17], v[236:237]
v_pk_mul_f32 v[18:19], v[18:19], v[238:239]
v_pk_mul_f32 v[20:21], v[20:21], v[240:241]
v_pk_mul_f32 v[22:23], v[22:23], v[242:243]
CP 16,16,17
CP 17,18,19
CP 20,20,21
CP 21,22,23
v_pk_fma_f32 v[236:237], v[210:211], v[204:205], v[214:215] op_sel:[0,1,0] op_sel_hi:[1,1,1]
v_pk_fma_f32 v[238:239], v[212:213], v[204:205], v[216:217] op_sel:[0,1,0] op_sel_hi:[1,1,1]
v_pk_fma_f32 v[240:241], v[210:211], v[206:207], v[214:215] op_sel:[0,1,0] op_sel_hi:[1,1,1]
v_pk_fma_f32 v[242:243], v[212:213], v[206:207], v[216:217] op_sel:[0,1,0] op_sel_hi:[1,1,1]
v_pk_fma_f32 v[24:25], v[24:25], v[204:205], v[236:237] op_sel_hi:[1,0,1]
v_pk_fma_f32 v[26:27], v[26:27], v[204:205], v[238:239] op_sel_hi:[1,0,1]
v_pk_fma_f32 v[28:29], v[28:29], v[206:207], v[240:241] op_sel_hi:[1,0,1]
v_pk_fma_f32 v[30:31], v[30:31], v[206:207], v[242:243] op_sel_hi:[1,0,1]
v_pk_mul_f32 v[236:237], v[24:25], v[24:25]
v_pk_mul_f32 v[238:239], v[26:27], v[26:27]
v_pk_mul_f32 v[240:241], v[28:29], v[28:29]
v_pk_mul_f32 v[242:243], v[30:31], v[30:31]
v_pk_fma_f32 v[236:237], v[236:237], s[60:61], v[208:209] op_sel:[0,0,1] op_sel_hi:[1,1,1]
v_pk_fma_f32 v[238:239], v[238:239], s[60:61], v[208:209] op_sel:[0,0,1] op_sel_hi:[1,1,1]
v_pk_fma_f32 v[240:241], v[240:241], s[60:61], v[208:209] op_sel:[0,0,1] op_sel_hi:[1,1,1]
v_pk_fma_f32 v[242:243], v[242:243], s[60:61], v[208:209] op_sel:[0,0,1] op_sel_hi:[1,1,1]
v_pk_mul_f32 v[236:237], v[236:237], v[24:25]
v_pk_mul_f32 v[238:239], v[238:239], v[26:27]
v_pk_mul_f32 v[240:241], v[240:241], v[28:29]
v_pk_mul_f32 v[242:243], v[242:243], v[30:31]
v_exp_f32 v236, v236
v_exp_f32 v238, v238
v_exp_f32 v240, v240
v_exp_f32 v242, v242
v_exp_f32 v237, v237
v_exp_f32 v239, v239
v_exp_f32 v241, v241
v_exp_f32 v243, v243
v_pk_add_f32 v[236:237], v[236:237], 1.0 op_sel_hi:[1,0]
v_pk_add_f32 v[238:239], v[238:239], 1.0 op_sel_hi:[1,0]
v_pk_add_f32 v[240:241], v[240:241], 1.0 op_sel_hi:[1,0]
v_pk_add_f32 v[242:243], v[242:243], 1.0 op_sel_hi:[1,0]
v_rcp_f32 v236, v236
v_rcp_f32 v238, v238
v_rcp_f32 v240, v240
v_rcp_f32 v242, v242
v_rcp_f32 v237, v237
v_rcp_f32 v239, v239
v_rcp_f32 v241, v241
v_rcp_f32 v243, v243
v_pk_mul_f32 v[24:25], v[24:25], v[236:237]
v_pk_mul_f32 v[26:27], v[26:27], v[238:239]
v_pk_mul_f32 v[28:29], v[28:29], v[240:241]
v_pk_mul_f32 v[30:31], v[30:31], v[242:243]
CP 24,24,25
CP 25,26,27
CP 28,28,29
CP 29,30,31
AR 210,212
AR 211,213
AR 212,214
AR 213,215
AR 215,194
AR 217,195
v_lshlrev_b32 v214, 16, v215
v_and_b32 v215, 0xffff0000, v215
v_lshlrev_b32 v216, 16, v217
v_and_b32 v217, 0xffff0000, v217
v_pk_fma_f32 v[236:237], v[210:211], v[192:193], v[214:215] op_sel:[0,1,0] op_sel_hi:[1,1,1]
v_pk_fma_f32 v[238:239], v[212:213], v[192:193], v[216:217] op_sel:[0,1,0] op_sel_hi:[1,1,1]
v_pk_fma_f32 v[240:241], v[210:211], v[194:195], v[214:215] op_sel:[0,1,0] op_sel_hi:[1,1,1]
v_pk_fma_f32 v[242:243], v[212:213], v[194:195], v[216:217] op_sel:[0,1,0] op_sel_hi:[1,1,1]
v_pk_fma_f32 v[32:33], v[32:33], v[192:193], v[236:237] op_sel_hi:[1,0,1]
v_pk_fma_f32 v[34:35], v[34:35], v[192:193], v[238:239] op_sel_hi:[1,0,1]
v_pk_fma_f32 v[36:37], v[36:37], v[194:195], v[240:241] op_sel_hi:[1,0,1]
v_pk_fma_f32 v[38:39], v[38:39], v[194:195], v[242:243] op_sel_hi:[1,0,1]
v_pk_mul_f32 v[236:237], v[32:33], v[32:33]
v_pk_mul_f32 v[238:239], v[34:35], v[34:35]
v_pk_mul_f32 v[240:241], v[36:37], v[36:37]
v_pk_mul_f32 v[242:243], v[38:39], v[38:39]
v_pk_fma_f32 v[236:237], v[236:237], s[60:61], v[208:209] op_sel:[0,0,1] op_sel_hi:[1,1,1]
v_pk_fma_f32 v[238:239], v[238:239], s[60:61], v[208:209] op_sel:[0,0,1] op_sel_hi:[1,1,1]
v_pk_fma_f32 v[240:241], v[240:241], s[60:61], v[208:209] op_sel:[0,0,1] op_sel_hi:[1,1,1]
v_pk_fma_f32 v[242:243], v[242:243], s[60:61], v[208:209] op_sel:[0,0,1] op_sel_hi:[1,1,1]
v_pk_mul_f32 v[236:237], v[236:237], v[32:33]
v_pk_mul_f32 v[238:239], v[238:239], v[34:35]
v_pk_mul_f32 v[240:241], v[240:241], v[36:37]
v_pk_mul_f32 v[242:243], v[242:243], v[38:39]
v_exp_f32 v236, v236
v_exp_f32 v238, v238
v_exp_f32 v240, v240
v_exp_f32 v242, v242
v_exp_f32 v237, v237
v_exp_f32 v239, v239
v_exp_f32 v241, v241
v_exp_f32 v243, v243
v_pk_add_f32 v[236:237], v[236:237], 1.0 op_sel_hi:[1,0]
v_pk_add_f32 v[238:239], v[238:239], 1.0 op_sel_hi:[1,0]
v_pk_add_f32 v[240:241], v[240:241], 1.0 op_sel_hi:[1,0]
v_pk_add_f32 v[242:243], v[242:243], 1.0 op_sel_hi:[1,0]
v_rcp_f32 v236, v236
v_rcp_f32 v238, v238
v_rcp_f32 v240, v240
v_rcp_f32 v242, v242
v_rcp_f32 v237, v237
v_rcp_f32 v239, v239
v_rcp_f32 v241, v241
v_rcp_f32 v243, v243
v_pk_mul_f32 v[32:33], v[32:33], v[236:237]
v_pk_mul_f32 v[34:35], v[34:35], v[238:239]
v_pk_mul_f32 v[36:37], v[36:37], v[240:241]
v_pk_mul_f32 v[38:39], v[38:39], v[242:243]
CP 2,32,33
CP 3,34,35
CP 6,36,37
CP 7,38,39
s_add_u32 s3, s55, 0
buffer_store_dwordx4 v[0:3], v208, s[8:11], s3 offen sc1
s_add_u32 s3, s55, 147456
buffer_store_dwordx4 v[4:7], v208, s[8:11], s3 offen sc1
v_pk_fma_f32 v[236:237], v[210:211], v[196:197], v[214:215] op_sel:[0,1,0] op_sel_hi:[1,1,1]
v_pk_fma_f32 v[238:239], v[212:213], v[196:197], v[216:217] op_sel:[0,1,0] op_sel_hi:[1,1,1]
v_pk_fma_f32 v[240:241], v[210:211], v[198:199], v[214:215] op_sel:[0,1,0] op_sel_hi:[1,1,1]
v_pk_fma_f32 v[242:243], v[212:213], v[198:199], v[216:217] op_sel:[0,1,0] op_sel_hi:[1,1,1]
v_pk_fma_f32 v[40:41], v[40:41], v[196:197], v[236:237] op_sel_hi:[1,0,1]
v_pk_fma_f32 v[42:43], v[42:43], v[196:197], v[238:239] op_sel_hi:[1,0,1]
v_pk_fma_f32 v[44:45], v[44:45], v[198:199], v[240:241] op_sel_hi:[1,0,1]
v_pk_fma_f32 v[46:47], v[46:47], v[198:199], v[242:243] op_sel_hi:[1,0,1]
v_pk_mul_f32 v[236:237], v[40:41], v[40:41]
v_pk_mul_f32 v[238:239], v[42:43], v[42:43]
v_pk_mul_f32 v[240:241], v[44:45], v[44:45]
v_pk_mul_f32 v[242:243], v[46:47], v[46:47]
v_pk_fma_f32 v[236:237], v[236:237], s[60:61], v[208:209] op_sel:[0,0,1] op_sel_hi:[1,1,1]
v_pk_fma_f32 v[238:239], v[238:239], s[60:61], v[208:209] op_sel:[0,0,1] op_sel_hi:[1,1,1]
v_pk_fma_f32 v[240:241], v[240:241], s[60:61], v[208:209] op_sel:[0,0,1] op_sel_hi:[1,1,1]
v_pk_fma_f32 v[242:243], v[242:243], s[60:61], v[208:209] op_sel:[0,0,1] op_sel_hi:[1,1,1]
v_pk_mul_f32 v[236:237], v[236:237], v[40:41]
v_pk_mul_f32 v[238:239], v[238:239], v[42:43]
v_pk_mul_f32 v[240:241], v[240:241], v[44:45]
v_pk_mul_f32 v[242:243], v[242:243], v[46:47]
v_exp_f32 v236, v236
v_exp_f32 v238, v238
v_exp_f32 v240, v240
v_exp_f32 v242, v242
v_exp_f32 v237, v237
v_exp_f32 v239, v239
v_exp_f32 v241, v241
v_exp_f32 v243, v243
v_pk_add_f32 v[236:237], v[236:237], 1.0 op_sel_hi:[1,0]
v_pk_add_f32 v[238:239], v[238:239], 1.0 op_sel_hi:[1,0]
v_pk_add_f32 v[240:241], v[240:241], 1.0 op_sel_hi:[1,0]
v_pk_add_f32 v[242:243], v[242:243], 1.0 op_sel_hi:[1,0]
v_rcp_f32 v236, v236
v_rcp_f32 v238, v238
v_rcp_f32 v240, v240
v_rcp_f32 v242, v242
v_rcp_f32 v237, v237
v_rcp_f32 v239, v239
v_rcp_f32 v241, v241
v_rcp_f32 v243, v243
v_pk_mul_f32 v[40:41], v[40:41], v[236:237]
v_pk_mul_f32 v[42:43], v[42:43], v[238:239]
v_pk_mul_f32 v[44:45], v[44:45], v[240:241]
v_pk_mul_f32 v[46:47], v[46:47], v[242:243]
CP 10,40,41
CP 11,42,43
CP 14,44,45
CP 15,46,47
s_add_u32 s3, s55, 294912
buffer_store_dwordx4 v[8:11], v208, s[8:11], s3 offen sc1
s_add_u32 s3, s55, 442368
buffer_store_dwordx4 v[12:15], v208, s[8:11], s3 offen sc1
v_pk_fma_f32 v[236:237], v[210:211], v[200:201], v[214:215] op_sel:[0,1,0] op_sel_hi:[1,1,1]
v_pk_fma_f32 v[238:239], v[212:213], v[200:201], v[216:217] op_sel:[0,1,0] op_sel_hi:[1,1,1]
v_pk_fma_f32 v[240:241], v[210:211], v[202:203], v[214:215] op_sel:[0,1,0] op_sel_hi:[1,1,1]
v_pk_fma_f32 v[242:243], v[212:213], v[202:203], v[216:217] op_sel:[0,1,0] op_sel_hi:[1,1,1]
v_pk_fma_f32 v[48:49], v[48:49], v[200:201], v[236:237] op_sel_hi:[1,0,1]
v_pk_fma_f32 v[50:51], v[50:51], v[200:201], v[238:239] op_sel_hi:[1,0,1]
v_pk_fma_f32 v[52:53], v[52:53], v[202:203], v[240:241] op_sel_hi:[1,0,1]
v_pk_fma_f32 v[54:55], v[54:55], v[202:203], v[242:243] op_sel_hi:[1,0,1]
v_pk_mul_f32 v[236:237], v[48:49], v[48:49]
v_pk_mul_f32 v[238:239], v[50:51], v[50:51]
v_pk_mul_f32 v[240:241], v[52:53], v[52:53]
v_pk_mul_f32 v[242:243], v[54:55], v[54:55]
v_pk_fma_f32 v[236:237], v[236:237], s[60:61], v[208:209] op_sel:[0,0,1] op_sel_hi:[1,1,1]
v_pk_fma_f32 v[238:239], v[238:239], s[60:61], v[208:209] op_sel:[0,0,1] op_sel_hi:[1,1,1]
v_pk_fma_f32 v[240:241], v[240:241], s[60:61], v[208:209] op_sel:[0,0,1] op_sel_hi:[1,1,1]
v_pk_fma_f32 v[242:243], v[242:243], s[60:61], v[208:209] op_sel:[0,0,1] op_sel_hi:[1,1,1]
v_pk_mul_f32 v[236:237], v[236:237], v[48:49]
v_pk_mul_f32 v[238:239], v[238:239], v[50:51]
v_pk_mul_f32 v[240:241], v[240:241], v[52:53]
v_pk_mul_f32 v[242:243], v[242:243], v[54:55]
v_exp_f32 v236, v236
v_exp_f32 v238, v238
v_exp_f32 v240, v240
v_exp_f32 v242, v242
v_exp_f32 v237, v237
v_exp_f32 v239, v239
v_exp_f32 v241, v241
v_exp_f32 v243, v243
v_pk_add_f32 v[236:237], v[236:237], 1.0 op_sel_hi:[1,0]
v_pk_add_f32 v[238:239], v[238:239], 1.0 op_sel_hi:[1,0]
v_pk_add_f32 v[240:241], v[240:241], 1.0 op_sel_hi:[1,0]
v_pk_add_f32 v[242:243], v[242:243], 1.0 op_sel_hi:[1,0]
v_rcp_f32 v236, v236
v_rcp_f32 v238, v238
v_rcp_f32 v240, v240
v_rcp_f32 v242, v242
v_rcp_f32 v237, v237
v_rcp_f32 v239, v239
v_rcp_f32 v241, v241
v_rcp_f32 v243, v243
v_pk_mul_f32 v[48:49], v[48:49], v[236:237]
v_pk_mul_f32 v[50:51], v[50:51], v[238:239]
v_pk_mul_f32 v[52:53], v[52:53], v[240:241]
v_pk_mul_f32 v[54:55], v[54:55], v[242:243]
CP 18,48,49
CP 19,50,51
CP 22,52,53
CP 23,54,55
s_add_u32 s3, s55, 589824
buffer_store_dwordx4 v[16:19], v208, s[8:11], s3 offen sc1
s_add_u32 s3, s55, 737280
buffer_store_dwordx4 v[20:23], v208, s[8:11], s3 offen sc1
v_pk_fma_f32 v[236:237], v[210:211], v[204:205], v[214:215] op_sel:[0,1,0] op_sel_hi:[1,1,1]
v_pk_fma_f32 v[238:239], v[212:213], v[204:205], v[216:217] op_sel:[0,1,0] op_sel_hi:[1,1,1]
v_pk_fma_f32 v[240:241], v[210:211], v[206:207], v[214:215] op_sel:[0,1,0] op_sel_hi:[1,1,1]
v_pk_fma_f32 v[242:243], v[212:213], v[206:207], v[216:217] op_sel:[0,1,0] op_sel_hi:[1,1,1]
v_pk_fma_f32 v[56:57], v[56:57], v[204:205], v[236:237] op_sel_hi:[1,0,1]
v_pk_fma_f32 v[58:59], v[58:59], v[204:205], v[238:239] op_sel_hi:[1,0,1]
v_pk_fma_f32 v[60:61], v[60:61], v[206:207], v[240:241] op_sel_hi:[1,0,1]
v_pk_fma_f32 v[62:63], v[62:63], v[206:207], v[242:243] op_sel_hi:[1,0,1]
v_pk_mul_f32 v[236:237], v[56:57], v[56:57]
v_pk_mul_f32 v[238:239], v[58:59], v[58:59]
v_pk_mul_f32 v[240:241], v[60:61], v[60:61]
v_pk_mul_f32 v[242:243], v[62:63], v[62:63]
v_pk_fma_f32 v[236:237], v[236:237], s[60:61], v[208:209] op_sel:[0,0,1] op_sel_hi:[1,1,1]
v_pk_fma_f32 v[238:239], v[238:239], s[60:61], v[208:209] op_sel:[0,0,1] op_sel_hi:[1,1,1]
v_pk_fma_f32 v[240:241], v[240:241], s[60:61], v[208:209] op_sel:[0,0,1] op_sel_hi:[1,1,1]
v_pk_fma_f32 v[242:243], v[242:243], s[60:61], v[208:209] op_sel:[0,0,1] op_sel_hi:[1,1,1]
v_pk_mul_f32 v[236:237], v[236:237], v[56:57]
v_pk_mul_f32 v[238:239], v[238:239], v[58:59]
v_pk_mul_f32 v[240:241], v[240:241], v[60:61]
v_pk_mul_f32 v[242:243], v[242:243], v[62:63]
v_exp_f32 v236, v236
v_exp_f32 v238, v238
v_exp_f32 v240, v240
v_exp_f32 v242, v242
v_exp_f32 v237, v237
v_exp_f32 v239, v239
v_exp_f32 v241, v241
v_exp_f32 v243, v243
v_pk_add_f32 v[236:237], v[236:237], 1.0 op_sel_hi:[1,0]
v_pk_add_f32 v[238:239], v[238:239], 1.0 op_sel_hi:[1,0]
v_pk_add_f32 v[240:241], v[240:241], 1.0 op_sel_hi:[1,0]
v_pk_add_f32 v[242:243], v[242:243], 1.0 op_sel_hi:[1,0]
v_rcp_f32 v236, v236
v_rcp_f32 v238, v238
v_rcp_f32 v240, v240
v_rcp_f32 v242, v242
v_rcp_f32 v237, v237
v_rcp_f32 v239, v239
v_rcp_f32 v241, v241
v_rcp_f32 v243, v243
v_pk_mul_f32 v[56:57], v[56:57], v[236:237]
v_pk_mul_f32 v[58:59], v[58:59], v[238:239]
v_pk_mul_f32 v[60:61], v[60:61], v[240:241]
v_pk_mul_f32 v[62:63], v[62:63], v[242:243]
CP 26,56,57
CP 27,58,59
CP 30,60,61
CP 31,62,63
s_add_u32 s3, s55, 884736
buffer_store_dwordx4 v[24:27], v208, s[8:11], s3 offen sc1
s_add_u32 s3, s55, 1032192
buffer_store_dwordx4 v[28:31], v208, s[8:11], s3 offen sc1
AR 210,216
AR 211,217
AR 212,218
AR 213,219
AR 215,196
AR 217,197
v_lshlrev_b32 v214, 16, v215
v_and_b32 v215, 0xffff0000, v215
v_lshlrev_b32 v216, 16, v217
v_and_b32 v217, 0xffff0000, v217
v_pk_fma_f32 v[236:237], v[210:211], v[192:193], v[214:215] op_sel:[0,1,0] op_sel_hi:[1,1,1]
v_pk_fma_f32 v[238:239], v[212:213], v[192:193], v[216:217] op_sel:[0,1,0] op_sel_hi:[1,1,1]
v_pk_fma_f32 v[240:241], v[210:211], v[194:195], v[214:215] op_sel:[0,1,0] op_sel_hi:[1,1,1]
v_pk_fma_f32 v[242:243], v[212:213], v[194:195], v[216:217] op_sel:[0,1,0] op_sel_hi:[1,1,1]
v_pk_fma_f32 v[64:65], v[64:65], v[192:193], v[236:237] op_sel_hi:[1,0,1]
v_pk_fma_f32 v[66:67], v[66:67], v[192:193], v[238:239] op_sel_hi:[1,0,1]
v_pk_fma_f32 v[68:69], v[68:69], v[194:195], v[240:241] op_sel_hi:[1,0,1]
v_pk_fma_f32 v[70:71], v[70:71], v[194:195], v[242:243] op_sel_hi:[1,0,1]
v_pk_mul_f32 v[236:237], v[64:65], v[64:65]
v_pk_mul_f32 v[238:239], v[66:67], v[66:67]
v_pk_mul_f32 v[240:241], v[68:69], v[68:69]
v_pk_mul_f32 v[242:243], v[70:71], v[70:71]
v_pk_fma_f32 v[236:237], v[236:237], s[60:61], v[208:209] op_sel:[0,0,1] op_sel_hi:[1,1,1]
v_pk_fma_f32 v[238:239], v[238:239], s[60:61], v[208:209] op_sel:[0,0,1] op_sel_hi:[1,1,1]
v_pk_fma_f32 v[240:241], v[240:241], s[60:61], v[208:209] op_sel:[0,0,1] op_sel_hi:[1,1,1]
v_pk_fma_f32 v[242:243], v[242:243], s[60:61], v[208:209] op_sel:[0,0,1] op_sel_hi:[1,1,1]
v_pk_mul_f32 v[236:237], v[236:237], v[64:65]
v_pk_mul_f32 v[238:239], v[238:239], v[66:67]
v_pk_mul_f32 v[240:241], v[240:241], v[68:69]
v_pk_mul_f32 v[242:243], v[242:243], v[70:71]
v_exp_f32 v236, v236
v_exp_f32 v238, v238
v_exp_f32 v240, v240
v_exp_f32 v242, v242
v_exp_f32 v237, v237
v_exp_f32 v239, v239
v_exp_f32 v241, v241
v_exp_f32 v243, v243
v_pk_add_f32 v[236:237], v[236:237], 1.0 op_sel_hi:[1,0]
v_pk_add_f32 v[238:239], v[238:239], 1.0 op_sel_hi:[1,0]
v_pk_add_f32 v[240:241], v[240:241], 1.0 op_sel_hi:[1,0]
v_pk_add_f32 v[242:243], v[242:243], 1.0 op_sel_hi:[1,0]
v_rcp_f32 v236, v236
v_rcp_f32 v238, v238
v_rcp_f32 v240, v240
v_rcp_f32 v242, v242
v_rcp_f32 v237, v237
v_rcp_f32 v239, v239
v_rcp_f32 v241, v241
v_rcp_f32 v243, v243
v_pk_mul_f32 v[64:65], v[64:65], v[236:237]
v_pk_mul_f32 v[66:67], v[66:67], v[238:239]
v_pk_mul_f32 v[68:69], v[68:69], v[240:241]
v_pk_mul_f32 v[70:71], v[70:71], v[242:243]
CP 64,64,65
CP 65,66,67
CP 68,68,69
CP 69,70,71
v_pk_fma_f32 v[236:237], v[210:211], v[196:197], v[214:215] op_sel:[0,1,0] op_sel_hi:[1,1,1]
v_pk_fma_f32 v[238:239], v[212:213], v[196:197], v[216:217] op_sel:[0,1,0] op_sel_hi:[1,1,1]
v_pk_fma_f32 v[240:241], v[210:211], v[198:199], v[214:215] op_sel:[0,1,0] op_sel_hi:[1,1,1]
v_pk_fma_f32 v[242:243], v[212:213], v[198:199], v[216:217] op_sel:[0,1,0] op_sel_hi:[1,1,1]
v_pk_fma_f32 v[72:73], v[72:73], v[196:197], v[236:237] op_sel_hi:[1,0,1]
v_pk_fma_f32 v[74:75], v[74:75], v[196:197], v[238:239] op_sel_hi:[1,0,1]
v_pk_fma_f32 v[76:77], v[76:77], v[198:199], v[240:241] op_sel_hi:[1,0,1]
v_pk_fma_f32 v[78:79], v[78:79], v[198:199], v[242:243] op_sel_hi:[1,0,1]
v_pk_mul_f32 v[236:237], v[72:73], v[72:73]
v_pk_mul_f32 v[238:239], v[74:75], v[74:75]
v_pk_mul_f32 v[240:241], v[76:77], v[76:77]
v_pk_mul_f32 v[242:243], v[78:79], v[78:79]
v_pk_fma_f32 v[236:237], v[236:237], s[60:61], v[208:209] op_sel:[0,0,1] op_sel_hi:[1,1,1]
v_pk_fma_f32 v[238:239], v[238:239], s[60:61], v[208:209] op_sel:[0,0,1] op_sel_hi:[1,1,1]
v_pk_fma_f32 v[240:241], v[240:241], s[60:61], v[208:209] op_sel:[0,0,1] op_sel_hi:[1,1,1]
v_pk_fma_f32 v[242:243], v[242:243], s[60:61], v[208:209] op_sel:[0,0,1] op_sel_hi:[1,1,1]
v_pk_mul_f32 v[236:237], v[236:237], v[72:73]
v_pk_mul_f32 v[238:239], v[238:239], v[74:75]
v_pk_mul_f32 v[240:241], v[240:241], v[76:77]
v_pk_mul_f32 v[242:243], v[242:243], v[78:79]
v_exp_f32 v236, v236
v_exp_f32 v238, v238
v_exp_f32 v240, v240
v_exp_f32 v242, v242
v_exp_f32 v237, v237
v_exp_f32 v239, v239
v_exp_f32 v241, v241
v_exp_f32 v243, v243
v_pk_add_f32 v[236:237], v[236:237], 1.0 op_sel_hi:[1,0]
v_pk_add_f32 v[238:239], v[238:239], 1.0 op_sel_hi:[1,0]
v_pk_add_f32 v[240:241], v[240:241], 1.0 op_sel_hi:[1,0]
v_pk_add_f32 v[242:243], v[242:243], 1.0 op_sel_hi:[1,0]
v_rcp_f32 v236, v236
v_rcp_f32 v238, v238
v_rcp_f32 v240, v240
v_rcp_f32 v242, v242
v_rcp_f32 v237, v237
v_rcp_f32 v239, v239
v_rcp_f32 v241, v241
v_rcp_f32 v243, v243
v_pk_mul_f32 v[72:73], v[72:73], v[236:237]
v_pk_mul_f32 v[74:75], v[74:75], v[238:239]
v_pk_mul_f32 v[76:77], v[76:77], v[240:241]
v_pk_mul_f32 v[78:79], v[78:79], v[242:243]
CP 72,72,73
CP 73,74,75
CP 76,76,77
CP 77,78,79
v_pk_fma_f32 v[236:237], v[210:211], v[200:201], v[214:215] op_sel:[0,1,0] op_sel_hi:[1,1,1]
v_pk_fma_f32 v[238:239], v[212:213], v[200:201], v[216:217] op_sel:[0,1,0] op_sel_hi:[1,1,1]
v_pk_fma_f32 v[240:241], v[210:211], v[202:203], v[214:215] op_sel:[0,1,0] op_sel_hi:[1,1,1]
v_pk_fma_f32 v[242:243], v[212:213], v[202:203], v[216:217] op_sel:[0,1,0] op_sel_hi:[1,1,1]
v_pk_fma_f32 v[80:81], v[80:81], v[200:201], v[236:237] op_sel_hi:[1,0,1]
v_pk_fma_f32 v[82:83], v[82:83], v[200:201], v[238:239] op_sel_hi:[1,0,1]
v_pk_fma_f32 v[84:85], v[84:85], v[202:203], v[240:241] op_sel_hi:[1,0,1]
v_pk_fma_f32 v[86:87], v[86:87], v[202:203], v[242:243] op_sel_hi:[1,0,1]
v_pk_mul_f32 v[236:237], v[80:81], v[80:81]
v_pk_mul_f32 v[238:239], v[82:83], v[82:83]
v_pk_mul_f32 v[240:241], v[84:85], v[84:85]
v_pk_mul_f32 v[242:243], v[86:87], v[86:87]
v_pk_fma_f32 v[236:237], v[236:237], s[60:61], v[208:209] op_sel:[0,0,1] op_sel_hi:[1,1,1]
v_pk_fma_f32 v[238:239], v[238:239], s[60:61], v[208:209] op_sel:[0,0,1] op_sel_hi:[1,1,1]
v_pk_fma_f32 v[240:241], v[240:241], s[60:61], v[208:209] op_sel:[0,0,1] op_sel_hi:[1,1,1]
v_pk_fma_f32 v[242:243], v[242:243], s[60:61], v[208:209] op_sel:[0,0,1] op_sel_hi:[1,1,1]
v_pk_mul_f32 v[236:237], v[236:237], v[80:81]
v_pk_mul_f32 v[238:239], v[238:239], v[82:83]
v_pk_mul_f32 v[240:241], v[240:241], v[84:85]
v_pk_mul_f32 v[242:243], v[242:243], v[86:87]
v_exp_f32 v236, v236
v_exp_f32 v238, v238
v_exp_f32 v240, v240
v_exp_f32 v242, v242
v_exp_f32 v237, v237
v_exp_f32 v239, v239
v_exp_f32 v241, v241
v_exp_f32 v243, v243
v_pk_add_f32 v[236:237], v[236:237], 1.0 op_sel_hi:[1,0]
v_pk_add_f32 v[238:239], v[238:239], 1.0 op_sel_hi:[1,0]
v_pk_add_f32 v[240:241], v[240:241], 1.0 op_sel_hi:[1,0]
v_pk_add_f32 v[242:243], v[242:243], 1.0 op_sel_hi:[1,0]
v_rcp_f32 v236, v236
v_rcp_f32 v238, v238
v_rcp_f32 v240, v240
v_rcp_f32 v242, v242
v_rcp_f32 v237, v237
v_rcp_f32 v239, v239
v_rcp_f32 v241, v241
v_rcp_f32 v243, v243
v_pk_mul_f32 v[80:81], v[80:81], v[236:237]
v_pk_mul_f32 v[82:83], v[82:83], v[238:239]
v_pk_mul_f32 v[84:85], v[84:85], v[240:241]
v_pk_mul_f32 v[86:87], v[86:87], v[242:243]
CP 80,80,81
CP 81,82,83
CP 84,84,85
CP 85,86,87
v_pk_fma_f32 v[236:237], v[210:211], v[204:205], v[214:215] op_sel:[0,1,0] op_sel_hi:[1,1,1]
v_pk_fma_f32 v[238:239], v[212:213], v[204:205], v[216:217] op_sel:[0,1,0] op_sel_hi:[1,1,1]
v_pk_fma_f32 v[240:241], v[210:211], v[206:207], v[214:215] op_sel:[0,1,0] op_sel_hi:[1,1,1]
v_pk_fma_f32 v[242:243], v[212:213], v[206:207], v[216:217] op_sel:[0,1,0] op_sel_hi:[1,1,1]
v_pk_fma_f32 v[88:89], v[88:89], v[204:205], v[236:237] op_sel_hi:[1,0,1]
v_pk_fma_f32 v[90:91], v[90:91], v[204:205], v[238:239] op_sel_hi:[1,0,1]
v_pk_fma_f32 v[92:93], v[92:93], v[206:207], v[240:241] op_sel_hi:[1,0,1]
v_pk_fma_f32 v[94:95], v[94:95], v[206:207], v[242:243] op_sel_hi:[1,0,1]
v_pk_mul_f32 v[236:237], v[88:89], v[88:89]
v_pk_mul_f32 v[238:239], v[90:91], v[90:91]
v_pk_mul_f32 v[240:241], v[92:93], v[92:93]
v_pk_mul_f32 v[242:243], v[94:95], v[94:95]
v_pk_fma_f32 v[236:237], v[236:237], s[60:61], v[208:209] op_sel:[0,0,1] op_sel_hi:[1,1,1]
v_pk_fma_f32 v[238:239], v[238:239], s[60:61], v[208:209] op_sel:[0,0,1] op_sel_hi:[1,1,1]
v_pk_fma_f32 v[240:241], v[240:241], s[60:61], v[208:209] op_sel:[0,0,1] op_sel_hi:[1,1,1]
v_pk_fma_f32 v[242:243], v[242:243], s[60:61], v[208:209] op_sel:[0,0,1] op_sel_hi:[1,1,1]
v_pk_mul_f32 v[236:237], v[236:237], v[88:89]
v_pk_mul_f32 v[238:239], v[238:239], v[90:91]
v_pk_mul_f32 v[240:241], v[240:241], v[92:93]
v_pk_mul_f32 v[242:243], v[242:243], v[94:95]
v_exp_f32 v236, v236
v_exp_f32 v238, v238
v_exp_f32 v240, v240
v_exp_f32 v242, v242
v_exp_f32 v237, v237
v_exp_f32 v239, v239
v_exp_f32 v241, v241
v_exp_f32 v243, v243
v_pk_add_f32 v[236:237], v[236:237], 1.0 op_sel_hi:[1,0]
v_pk_add_f32 v[238:239], v[238:239], 1.0 op_sel_hi:[1,0]
v_pk_add_f32 v[240:241], v[240:241], 1.0 op_sel_hi:[1,0]
v_pk_add_f32 v[242:243], v[242:243], 1.0 op_sel_hi:[1,0]
v_rcp_f32 v236, v236
v_rcp_f32 v238, v238
v_rcp_f32 v240, v240
v_rcp_f32 v242, v242
v_rcp_f32 v237, v237
v_rcp_f32 v239, v239
v_rcp_f32 v241, v241
v_rcp_f32 v243, v243
v_pk_mul_f32 v[88:89], v[88:89], v[236:237]
v_pk_mul_f32 v[90:91], v[90:91], v[238:239]
v_pk_mul_f32 v[92:93], v[92:93], v[240:241]
v_pk_mul_f32 v[94:95], v[94:95], v[242:243]
CP 88,88,89
CP 89,90,91
CP 92,92,93
CP 93,94,95
AR 210,220
AR 211,221
AR 212,222
AR 213,223
AR 215,198
AR 217,199
v_lshlrev_b32 v214, 16, v215
v_and_b32 v215, 0xffff0000, v215
v_lshlrev_b32 v216, 16, v217
v_and_b32 v217, 0xffff0000, v217
v_pk_fma_f32 v[236:237], v[210:211], v[192:193], v[214:215] op_sel:[0,1,0] op_sel_hi:[1,1,1]
v_pk_fma_f32 v[238:239], v[212:213], v[192:193], v[216:217] op_sel:[0,1,0] op_sel_hi:[1,1,1]
v_pk_fma_f32 v[240:241], v[210:211], v[194:195], v[214:215] op_sel:[0,1,0] op_sel_hi:[1,1,1]
v_pk_fma_f32 v[242:243], v[212:213], v[194:195], v[216:217] op_sel:[0,1,0] op_sel_hi:[1,1,1]
v_pk_fma_f32 v[96:97], v[96:97], v[192:193], v[236:237] op_sel_hi:[1,0,1]
v_pk_fma_f32 v[98:99], v[98:99], v[192:193], v[238:239] op_sel_hi:[1,0,1]
v_pk_fma_f32 v[100:101], v[100:101], v[194:195], v[240:241] op_sel_hi:[1,0,1]
v_pk_fma_f32 v[102:103], v[102:103], v[194:195], v[242:243] op_sel_hi:[1,0,1]
v_pk_mul_f32 v[236:237], v[96:97], v[96:97]
v_pk_mul_f32 v[238:239], v[98:99], v[98:99]
v_pk_mul_f32 v[240:241], v[100:101], v[100:101]
v_pk_mul_f32 v[242:243], v[102:103], v[102:103]
v_pk_fma_f32 v[236:237], v[236:237], s[60:61], v[208:209] op_sel:[0,0,1] op_sel_hi:[1,1,1]
v_pk_fma_f32 v[238:239], v[238:239], s[60:61], v[208:209] op_sel:[0,0,1] op_sel_hi:[1,1,1]
v_pk_fma_f32 v[240:241], v[240:241], s[60:61], v[208:209] op_sel:[0,0,1] op_sel_hi:[1,1,1]
v_pk_fma_f32 v[242:243], v[242:243], s[60:61], v[208:209] op_sel:[0,0,1] op_sel_hi:[1,1,1]
v_pk_mul_f32 v[236:237], v[236:237], v[96:97]
v_pk_mul_f32 v[238:239], v[238:239], v[98:99]
v_pk_mul_f32 v[240:241], v[240:241], v[100:101]
v_pk_mul_f32 v[242:243], v[242:243], v[102:103]
v_exp_f32 v236, v236
v_exp_f32 v238, v238
v_exp_f32 v240, v240
v_exp_f32 v242, v242
v_exp_f32 v237, v237
v_exp_f32 v239, v239
v_exp_f32 v241, v241
v_exp_f32 v243, v243
v_pk_add_f32 v[236:237], v[236:237], 1.0 op_sel_hi:[1,0]
v_pk_add_f32 v[238:239], v[238:239], 1.0 op_sel_hi:[1,0]
v_pk_add_f32 v[240:241], v[240:241], 1.0 op_sel_hi:[1,0]
v_pk_add_f32 v[242:243], v[242:243], 1.0 op_sel_hi:[1,0]
v_rcp_f32 v236, v236
v_rcp_f32 v238, v238
v_rcp_f32 v240, v240
v_rcp_f32 v242, v242
v_rcp_f32 v237, v237
v_rcp_f32 v239, v239
v_rcp_f32 v241, v241
v_rcp_f32 v243, v243
v_pk_mul_f32 v[96:97], v[96:97], v[236:237]
v_pk_mul_f32 v[98:99], v[98:99], v[238:239]
v_pk_mul_f32 v[100:101], v[100:101], v[240:241]
v_pk_mul_f32 v[102:103], v[102:103], v[242:243]
CP 66,96,97
CP 67,98,99
CP 70,100,101
CP 71,102,103
s_add_u32 s3, s55, 1024
buffer_store_dwordx4 v[64:67], v208, s[8:11], s3 offen sc1
s_add_u32 s3, s55, 148480
buffer_store_dwordx4 v[68:71], v208, s[8:11], s3 offen sc1
v_pk_fma_f32 v[236:237], v[210:211], v[196:197], v[214:215] op_sel:[0,1,0] op_sel_hi:[1,1,1]
v_pk_fma_f32 v[238:239], v[212:213], v[196:197], v[216:217] op_sel:[0,1,0] op_sel_hi:[1,1,1]
v_pk_fma_f32 v[240:241], v[210:211], v[198:199], v[214:215] op_sel:[0,1,0] op_sel_hi:[1,1,1]
v_pk_fma_f32 v[242:243], v[212:213], v[198:199], v[216:217] op_sel:[0,1,0] op_sel_hi:[1,1,1]
v_pk_fma_f32 v[104:105], v[104:105], v[196:197], v[236:237] op_sel_hi:[1,0,1]
v_pk_fma_f32 v[106:107], v[106:107], v[196:197], v[238:239] op_sel_hi:[1,0,1]
v_pk_fma_f32 v[108:109], v[108:109], v[198:199], v[240:241] op_sel_hi:[1,0,1]
v_pk_fma_f32 v[110:111], v[110:111], v[198:199], v[242:243] op_sel_hi:[1,0,1]
v_pk_mul_f32 v[236:237], v[104:105], v[104:105]
v_pk_mul_f32 v[238:239], v[106:107], v[106:107]
v_pk_mul_f32 v[240:241], v[108:109], v[108:109]
v_pk_mul_f32 v[242:243], v[110:111], v[110:111]
v_pk_fma_f32 v[236:237], v[236:237], s[60:61], v[208:209] op_sel:[0,0,1] op_sel_hi:[1,1,1]
v_pk_fma_f32 v[238:239], v[238:239], s[60:61], v[208:209] op_sel:[0,0,1] op_sel_hi:[1,1,1]
v_pk_fma_f32 v[240:241], v[240:241], s[60:61], v[208:209] op_sel:[0,0,1] op_sel_hi:[1,1,1]
v_pk_fma_f32 v[242:243], v[242:243], s[60:61], v[208:209] op_sel:[0,0,1] op_sel_hi:[1,1,1]
v_pk_mul_f32 v[236:237], v[236:237], v[104:105]
v_pk_mul_f32 v[238:239], v[238:239], v[106:107]
v_pk_mul_f32 v[240:241], v[240:241], v[108:109]
v_pk_mul_f32 v[242:243], v[242:243], v[110:111]
v_exp_f32 v236, v236
v_exp_f32 v238, v238
v_exp_f32 v240, v240
v_exp_f32 v242, v242
v_exp_f32 v237, v237
v_exp_f32 v239, v239
v_exp_f32 v241, v241
v_exp_f32 v243, v243
v_pk_add_f32 v[236:237], v[236:237], 1.0 op_sel_hi:[1,0]
v_pk_add_f32 v[238:239], v[238:239], 1.0 op_sel_hi:[1,0]
v_pk_add_f32 v[240:241], v[240:241], 1.0 op_sel_hi:[1,0]
v_pk_add_f32 v[242:243], v[242:243], 1.0 op_sel_hi:[1,0]
v_rcp_f32 v236, v236
v_rcp_f32 v238, v238
v_rcp_f32 v240, v240
v_rcp_f32 v242, v242
v_rcp_f32 v237, v237
v_rcp_f32 v239, v239
v_rcp_f32 v241, v241
v_rcp_f32 v243, v243
v_pk_mul_f32 v[104:105], v[104:105], v[236:237]
v_pk_mul_f32 v[106:107], v[106:107], v[238:239]
v_pk_mul_f32 v[108:109], v[108:109], v[240:241]
v_pk_mul_f32 v[110:111], v[110:111], v[242:243]
CP 74,104,105
CP 75,106,107
CP 78,108,109
CP 79,110,111
s_add_u32 s3, s55, 295936
buffer_store_dwordx4 v[72:75], v208, s[8:11], s3 offen sc1
s_add_u32 s3, s55, 443392
buffer_store_dwordx4 v[76:79], v208, s[8:11], s3 offen sc1
v_pk_fma_f32 v[236:237], v[210:211], v[200:201], v[214:215] op_sel:[0,1,0] op_sel_hi:[1,1,1]
v_pk_fma_f32 v[238:239], v[212:213], v[200:201], v[216:217] op_sel:[0,1,0] op_sel_hi:[1,1,1]
v_pk_fma_f32 v[240:241], v[210:211], v[202:203], v[214:215] op_sel:[0,1,0] op_sel_hi:[1,1,1]
v_pk_fma_f32 v[242:243], v[212:213], v[202:203], v[216:217] op_sel:[0,1,0] op_sel_hi:[1,1,1]
v_pk_fma_f32 v[112:113], v[112:113], v[200:201], v[236:237] op_sel_hi:[1,0,1]
v_pk_fma_f32 v[114:115], v[114:115], v[200:201], v[238:239] op_sel_hi:[1,0,1]
v_pk_fma_f32 v[116:117], v[116:117], v[202:203], v[240:241] op_sel_hi:[1,0,1]
v_pk_fma_f32 v[118:119], v[118:119], v[202:203], v[242:243] op_sel_hi:[1,0,1]
v_pk_mul_f32 v[236:237], v[112:113], v[112:113]
v_pk_mul_f32 v[238:239], v[114:115], v[114:115]
v_pk_mul_f32 v[240:241], v[116:117], v[116:117]
v_pk_mul_f32 v[242:243], v[118:119], v[118:119]
v_pk_fma_f32 v[236:237], v[236:237], s[60:61], v[208:209] op_sel:[0,0,1] op_sel_hi:[1,1,1]
v_pk_fma_f32 v[238:239], v[238:239], s[60:61], v[208:209] op_sel:[0,0,1] op_sel_hi:[1,1,1]
v_pk_fma_f32 v[240:241], v[240:241], s[60:61], v[208:209] op_sel:[0,0,1] op_sel_hi:[1,1,1]
v_pk_fma_f32 v[242:243], v[242:243], s[60:61], v[208:209] op_sel:[0,0,1] op_sel_hi:[1,1,1]
v_pk_mul_f32 v[236:237], v[236:237], v[112:113]
v_pk_mul_f32 v[238:239], v[238:239], v[114:115]
v_pk_mul_f32 v[240:241], v[240:241], v[116:117]
v_pk_mul_f32 v[242:243], v[242:243], v[118:119]
v_exp_f32 v236, v236
v_exp_f32 v238, v238
v_exp_f32 v240, v240
v_exp_f32 v242, v242
v_exp_f32 v237, v237
v_exp_f32 v239, v239
v_exp_f32 v241, v241
v_exp_f32 v243, v243
v_pk_add_f32 v[236:237], v[236:237], 1.0 op_sel_hi:[1,0]
v_pk_add_f32 v[238:239], v[238:239], 1.0 op_sel_hi:[1,0]
v_pk_add_f32 v[240:241], v[240:241], 1.0 op_sel_hi:[1,0]
v_pk_add_f32 v[242:243], v[242:243], 1.0 op_sel_hi:[1,0]
v_rcp_f32 v236, v236
v_rcp_f32 v238, v238
v_rcp_f32 v240, v240
v_rcp_f32 v242, v242
v_rcp_f32 v237, v237
v_rcp_f32 v239, v239
v_rcp_f32 v241, v241
v_rcp_f32 v243, v243
v_pk_mul_f32 v[112:113], v[112:113], v[236:237]
v_pk_mul_f32 v[114:115], v[114:115], v[238:239]
v_pk_mul_f32 v[116:117], v[116:117], v[240:241]
v_pk_mul_f32 v[118:119], v[118:119], v[242:243]
CP 82,112,113
CP 83,114,115
CP 86,116,117
CP 87,118,119
s_add_u32 s3, s55, 590848
buffer_store_dwordx4 v[80:83], v208, s[8:11], s3 offen sc1
s_add_u32 s3, s55, 738304
buffer_store_dwordx4 v[84:87], v208, s[8:11], s3 offen sc1
v_pk_fma_f32 v[236:237], v[210:211], v[204:205], v[214:215] op_sel:[0,1,0] op_sel_hi:[1,1,1]
v_pk_fma_f32 v[238:239], v[212:213], v[204:205], v[216:217] op_sel:[0,1,0] op_sel_hi:[1,1,1]
v_pk_fma_f32 v[240:241], v[210:211], v[206:207], v[214:215] op_sel:[0,1,0] op_sel_hi:[1,1,1]
v_pk_fma_f32 v[242:243], v[212:213], v[206:207], v[216:217] op_sel:[0,1,0] op_sel_hi:[1,1,1]
v_pk_fma_f32 v[120:121], v[120:121], v[204:205], v[236:237] op_sel_hi:[1,0,1]
v_pk_fma_f32 v[122:123], v[122:123], v[204:205], v[238:239] op_sel_hi:[1,0,1]
v_pk_fma_f32 v[124:125], v[124:125], v[206:207], v[240:241] op_sel_hi:[1,0,1]
v_pk_fma_f32 v[126:127], v[126:127], v[206:207], v[242:243] op_sel_hi:[1,0,1]
v_pk_mul_f32 v[236:237], v[120:121], v[120:121]
v_pk_mul_f32 v[238:239], v[122:123], v[122:123]
v_pk_mul_f32 v[240:241], v[124:125], v[124:125]
v_pk_mul_f32 v[242:243], v[126:127], v[126:127]
v_pk_fma_f32 v[236:237], v[236:237], s[60:61], v[208:209] op_sel:[0,0,1] op_sel_hi:[1,1,1]
v_pk_fma_f32 v[238:239], v[238:239], s[60:61], v[208:209] op_sel:[0,0,1] op_sel_hi:[1,1,1]
v_pk_fma_f32 v[240:241], v[240:241], s[60:61], v[208:209] op_sel:[0,0,1] op_sel_hi:[1,1,1]
v_pk_fma_f32 v[242:243], v[242:243], s[60:61], v[208:209] op_sel:[0,0,1] op_sel_hi:[1,1,1]
v_pk_mul_f32 v[236:237], v[236:237], v[120:121]
v_pk_mul_f32 v[238:239], v[238:239], v[122:123]
v_pk_mul_f32 v[240:241], v[240:241], v[124:125]
v_pk_mul_f32 v[242:243], v[242:243], v[126:127]
v_exp_f32 v236, v236
v_exp_f32 v238, v238
v_exp_f32 v240, v240
v_exp_f32 v242, v242
v_exp_f32 v237, v237
v_exp_f32 v239, v239
v_exp_f32 v241, v241
v_exp_f32 v243, v243
v_pk_add_f32 v[236:237], v[236:237], 1.0 op_sel_hi:[1,0]
v_pk_add_f32 v[238:239], v[238:239], 1.0 op_sel_hi:[1,0]
v_pk_add_f32 v[240:241], v[240:241], 1.0 op_sel_hi:[1,0]
v_pk_add_f32 v[242:243], v[242:243], 1.0 op_sel_hi:[1,0]
v_rcp_f32 v236, v236
v_rcp_f32 v238, v238
v_rcp_f32 v240, v240
v_rcp_f32 v242, v242
v_rcp_f32 v237, v237
v_rcp_f32 v239, v239
v_rcp_f32 v241, v241
v_rcp_f32 v243, v243
v_pk_mul_f32 v[120:121], v[120:121], v[236:237]
v_pk_mul_f32 v[122:123], v[122:123], v[238:239]
v_pk_mul_f32 v[124:125], v[124:125], v[240:241]
v_pk_mul_f32 v[126:127], v[126:127], v[242:243]
CP 90,120,121
CP 91,122,123
CP 94,124,125
CP 95,126,127
s_add_u32 s3, s55, 885760
buffer_store_dwordx4 v[88:91], v208, s[8:11], s3 offen sc1
s_add_u32 s3, s55, 1033216
buffer_store_dwordx4 v[92:95], v208, s[8:11], s3 offen sc1
AR 210,224
AR 211,225
AR 212,226
AR 213,227
AR 215,200
AR 217,201
v_lshlrev_b32 v214, 16, v215
v_and_b32 v215, 0xffff0000, v215
v_lshlrev_b32 v216, 16, v217
v_and_b32 v217, 0xffff0000, v217
v_pk_fma_f32 v[236:237], v[210:211], v[192:193], v[214:215] op_sel:[0,1,0] op_sel_hi:[1,1,1]
v_pk_fma_f32 v[238:239], v[212:213], v[192:193], v[216:217] op_sel:[0,1,0] op_sel_hi:[1,1,1]
v_pk_fma_f32 v[240:241], v[210:211], v[194:195], v[214:215] op_sel:[0,1,0] op_sel_hi:[1,1,1]
v_pk_fma_f32 v[242:243], v[212:213], v[194:195], v[216:217] op_sel:[0,1,0] op_sel_hi:[1,1,1]
v_pk_fma_f32 v[128:129], v[128:129], v[192:193], v[236:237] op_sel_hi:[1,0,1]
v_pk_fma_f32 v[130:131], v[130:131], v[192:193], v[238:239] op_sel_hi:[1,0,1]
v_pk_fma_f32 v[132:133], v[132:133], v[194:195], v[240:241] op_sel_hi:[1,0,1]
v_pk_fma_f32 v[134:135], v[134:135], v[194:195], v[242:243] op_sel_hi:[1,0,1]
v_pk_mul_f32 v[236:237], v[128:129], v[128:129]
v_pk_mul_f32 v[238:239], v[130:131], v[130:131]
v_pk_mul_f32 v[240:241], v[132:133], v[132:133]
v_pk_mul_f32 v[242:243], v[134:135], v[134:135]
v_pk_fma_f32 v[236:237], v[236:237], s[60:61], v[208:209] op_sel:[0,0,1] op_sel_hi:[1,1,1]
v_pk_fma_f32 v[238:239], v[238:239], s[60:61], v[208:209] op_sel:[0,0,1] op_sel_hi:[1,1,1]
v_pk_fma_f32 v[240:241], v[240:241], s[60:61], v[208:209] op_sel:[0,0,1] op_sel_hi:[1,1,1]
v_pk_fma_f32 v[242:243], v[242:243], s[60:61], v[208:209] op_sel:[0,0,1] op_sel_hi:[1,1,1]
v_pk_mul_f32 v[236:237], v[236:237], v[128:129]
v_pk_mul_f32 v[238:239], v[238:239], v[130:131]
v_pk_mul_f32 v[240:241], v[240:241], v[132:133]
v_pk_mul_f32 v[242:243], v[242:243], v[134:135]
v_exp_f32 v236, v236
v_exp_f32 v238, v238
v_exp_f32 v240, v240
v_exp_f32 v242, v242
v_exp_f32 v237, v237
v_exp_f32 v239, v239
v_exp_f32 v241, v241
v_exp_f32 v243, v243
v_pk_add_f32 v[236:237], v[236:237], 1.0 op_sel_hi:[1,0]
v_pk_add_f32 v[238:239], v[238:239], 1.0 op_sel_hi:[1,0]
v_pk_add_f32 v[240:241], v[240:241], 1.0 op_sel_hi:[1,0]
v_pk_add_f32 v[242:243], v[242:243], 1.0 op_sel_hi:[1,0]
v_rcp_f32 v236, v236
v_rcp_f32 v238, v238
v_rcp_f32 v240, v240
v_rcp_f32 v242, v242
v_rcp_f32 v237, v237
v_rcp_f32 v239, v239
v_rcp_f32 v241, v241
v_rcp_f32 v243, v243
v_pk_mul_f32 v[128:129], v[128:129], v[236:237]
v_pk_mul_f32 v[130:131], v[130:131], v[238:239]
v_pk_mul_f32 v[132:133], v[132:133], v[240:241]
v_pk_mul_f32 v[134:135], v[134:135], v[242:243]
CP 128,128,129
CP 129,130,131
CP 132,132,133
CP 133,134,135
v_pk_fma_f32 v[236:237], v[210:211], v[196:197], v[214:215] op_sel:[0,1,0] op_sel_hi:[1,1,1]
v_pk_fma_f32 v[238:239], v[212:213], v[196:197], v[216:217] op_sel:[0,1,0] op_sel_hi:[1,1,1]
v_pk_fma_f32 v[240:241], v[210:211], v[198:199], v[214:215] op_sel:[0,1,0] op_sel_hi:[1,1,1]
v_pk_fma_f32 v[242:243], v[212:213], v[198:199], v[216:217] op_sel:[0,1,0] op_sel_hi:[1,1,1]
v_pk_fma_f32 v[136:137], v[136:137], v[196:197], v[236:237] op_sel_hi:[1,0,1]
v_pk_fma_f32 v[138:139], v[138:139], v[196:197], v[238:239] op_sel_hi:[1,0,1]
v_pk_fma_f32 v[140:141], v[140:141], v[198:199], v[240:241] op_sel_hi:[1,0,1]
v_pk_fma_f32 v[142:143], v[142:143], v[198:199], v[242:243] op_sel_hi:[1,0,1]
v_pk_mul_f32 v[236:237], v[136:137], v[136:137]
v_pk_mul_f32 v[238:239], v[138:139], v[138:139]
v_pk_mul_f32 v[240:241], v[140:141], v[140:141]
v_pk_mul_f32 v[242:243], v[142:143], v[142:143]
v_pk_fma_f32 v[236:237], v[236:237], s[60:61], v[208:209] op_sel:[0,0,1] op_sel_hi:[1,1,1]
v_pk_fma_f32 v[238:239], v[238:239], s[60:61], v[208:209] op_sel:[0,0,1] op_sel_hi:[1,1,1]
v_pk_fma_f32 v[240:241], v[240:241], s[60:61], v[208:209] op_sel:[0,0,1] op_sel_hi:[1,1,1]
v_pk_fma_f32 v[242:243], v[242:243], s[60:61], v[208:209] op_sel:[0,0,1] op_sel_hi:[1,1,1]
v_pk_mul_f32 v[236:237], v[236:237], v[136:137]
v_pk_mul_f32 v[238:239], v[238:239], v[138:139]
v_pk_mul_f32 v[240:241], v[240:241], v[140:141]
v_pk_mul_f32 v[242:243], v[242:243], v[142:143]
v_exp_f32 v236, v236
v_exp_f32 v238, v238
v_exp_f32 v240, v240
v_exp_f32 v242, v242
v_exp_f32 v237, v237
v_exp_f32 v239, v239
v_exp_f32 v241, v241
v_exp_f32 v243, v243
v_pk_add_f32 v[236:237], v[236:237], 1.0 op_sel_hi:[1,0]
v_pk_add_f32 v[238:239], v[238:239], 1.0 op_sel_hi:[1,0]
v_pk_add_f32 v[240:241], v[240:241], 1.0 op_sel_hi:[1,0]
v_pk_add_f32 v[242:243], v[242:243], 1.0 op_sel_hi:[1,0]
v_rcp_f32 v236, v236
v_rcp_f32 v238, v238
v_rcp_f32 v240, v240
v_rcp_f32 v242, v242
v_rcp_f32 v237, v237
v_rcp_f32 v239, v239
v_rcp_f32 v241, v241
v_rcp_f32 v243, v243
v_pk_mul_f32 v[136:137], v[136:137], v[236:237]
v_pk_mul_f32 v[138:139], v[138:139], v[238:239]
v_pk_mul_f32 v[140:141], v[140:141], v[240:241]
v_pk_mul_f32 v[142:143], v[142:143], v[242:243]
CP 136,136,137
CP 137,138,139
CP 140,140,141
CP 141,142,143
v_pk_fma_f32 v[236:237], v[210:211], v[200:201], v[214:215] op_sel:[0,1,0] op_sel_hi:[1,1,1]
v_pk_fma_f32 v[238:239], v[212:213], v[200:201], v[216:217] op_sel:[0,1,0] op_sel_hi:[1,1,1]
v_pk_fma_f32 v[240:241], v[210:211], v[202:203], v[214:215] op_sel:[0,1,0] op_sel_hi:[1,1,1]
v_pk_fma_f32 v[242:243], v[212:213], v[202:203], v[216:217] op_sel:[0,1,0] op_sel_hi:[1,1,1]
v_pk_fma_f32 v[144:145], v[144:145], v[200:201], v[236:237] op_sel_hi:[1,0,1]
v_pk_fma_f32 v[146:147], v[146:147], v[200:201], v[238:239] op_sel_hi:[1,0,1]
v_pk_fma_f32 v[148:149], v[148:149], v[202:203], v[240:241] op_sel_hi:[1,0,1]
v_pk_fma_f32 v[150:151], v[150:151], v[202:203], v[242:243] op_sel_hi:[1,0,1]
v_pk_mul_f32 v[236:237], v[144:145], v[144:145]
v_pk_mul_f32 v[238:239], v[146:147], v[146:147]
v_pk_mul_f32 v[240:241], v[148:149], v[148:149]
v_pk_mul_f32 v[242:243], v[150:151], v[150:151]
v_pk_fma_f32 v[236:237], v[236:237], s[60:61], v[208:209] op_sel:[0,0,1] op_sel_hi:[1,1,1]
v_pk_fma_f32 v[238:239], v[238:239], s[60:61], v[208:209] op_sel:[0,0,1] op_sel_hi:[1,1,1]
v_pk_fma_f32 v[240:241], v[240:241], s[60:61], v[208:209] op_sel:[0,0,1] op_sel_hi:[1,1,1]
v_pk_fma_f32 v[242:243], v[242:243], s[60:61], v[208:209] op_sel:[0,0,1] op_sel_hi:[1,1,1]
v_pk_mul_f32 v[236:237], v[236:237], v[144:145]
v_pk_mul_f32 v[238:239], v[238:239], v[146:147]
v_pk_mul_f32 v[240:241], v[240:241], v[148:149]
v_pk_mul_f32 v[242:243], v[242:243], v[150:151]
v_exp_f32 v236, v236
v_exp_f32 v238, v238
v_exp_f32 v240, v240
v_exp_f32 v242, v242
v_exp_f32 v237, v237
v_exp_f32 v239, v239
v_exp_f32 v241, v241
v_exp_f32 v243, v243
v_pk_add_f32 v[236:237], v[236:237], 1.0 op_sel_hi:[1,0]
v_pk_add_f32 v[238:239], v[238:239], 1.0 op_sel_hi:[1,0]
v_pk_add_f32 v[240:241], v[240:241], 1.0 op_sel_hi:[1,0]
v_pk_add_f32 v[242:243], v[242:243], 1.0 op_sel_hi:[1,0]
v_rcp_f32 v236, v236
v_rcp_f32 v238, v238
v_rcp_f32 v240, v240
v_rcp_f32 v242, v242
v_rcp_f32 v237, v237
v_rcp_f32 v239, v239
v_rcp_f32 v241, v241
v_rcp_f32 v243, v243
v_pk_mul_f32 v[144:145], v[144:145], v[236:237]
v_pk_mul_f32 v[146:147], v[146:147], v[238:239]
v_pk_mul_f32 v[148:149], v[148:149], v[240:241]
v_pk_mul_f32 v[150:151], v[150:151], v[242:243]
CP 144,144,145
CP 145,146,147
CP 148,148,149
CP 149,150,151
v_pk_fma_f32 v[236:237], v[210:211], v[204:205], v[214:215] op_sel:[0,1,0] op_sel_hi:[1,1,1]
v_pk_fma_f32 v[238:239], v[212:213], v[204:205], v[216:217] op_sel:[0,1,0] op_sel_hi:[1,1,1]
v_pk_fma_f32 v[240:241], v[210:211], v[206:207], v[214:215] op_sel:[0,1,0] op_sel_hi:[1,1,1]
v_pk_fma_f32 v[242:243], v[212:213], v[206:207], v[216:217] op_sel:[0,1,0] op_sel_hi:[1,1,1]
v_pk_fma_f32 v[152:153], v[152:153], v[204:205], v[236:237] op_sel_hi:[1,0,1]
v_pk_fma_f32 v[154:155], v[154:155], v[204:205], v[238:239] op_sel_hi:[1,0,1]
v_pk_fma_f32 v[156:157], v[156:157], v[206:207], v[240:241] op_sel_hi:[1,0,1]
v_pk_fma_f32 v[158:159], v[158:159], v[206:207], v[242:243] op_sel_hi:[1,0,1]
v_pk_mul_f32 v[236:237], v[152:153], v[152:153]
v_pk_mul_f32 v[238:239], v[154:155], v[154:155]
v_pk_mul_f32 v[240:241], v[156:157], v[156:157]
v_pk_mul_f32 v[242:243], v[158:159], v[158:159]
v_pk_fma_f32 v[236:237], v[236:237], s[60:61], v[208:209] op_sel:[0,0,1] op_sel_hi:[1,1,1]
v_pk_fma_f32 v[238:239], v[238:239], s[60:61], v[208:209] op_sel:[0,0,1] op_sel_hi:[1,1,1]
v_pk_fma_f32 v[240:241], v[240:241], s[60:61], v[208:209] op_sel:[0,0,1] op_sel_hi:[1,1,1]
v_pk_fma_f32 v[242:243], v[242:243], s[60:61], v[208:209] op_sel:[0,0,1] op_sel_hi:[1,1,1]
v_pk_mul_f32 v[236:237], v[236:237], v[152:153]
v_pk_mul_f32 v[238:239], v[238:239], v[154:155]
v_pk_mul_f32 v[240:241], v[240:241], v[156:157]
v_pk_mul_f32 v[242:243], v[242:243], v[158:159]
v_exp_f32 v236, v236
v_exp_f32 v238, v238
v_exp_f32 v240, v240
v_exp_f32 v242, v242
v_exp_f32 v237, v237
v_exp_f32 v239, v239
v_exp_f32 v241, v241
v_exp_f32 v243, v243
v_pk_add_f32 v[236:237], v[236:237], 1.0 op_sel_hi:[1,0]
v_pk_add_f32 v[238:239], v[238:239], 1.0 op_sel_hi:[1,0]
v_pk_add_f32 v[240:241], v[240:241], 1.0 op_sel_hi:[1,0]
v_pk_add_f32 v[242:243], v[242:243], 1.0 op_sel_hi:[1,0]
v_rcp_f32 v236, v236
v_rcp_f32 v238, v238
v_rcp_f32 v240, v240
v_rcp_f32 v242, v242
v_rcp_f32 v237, v237
v_rcp_f32 v239, v239
v_rcp_f32 v241, v241
v_rcp_f32 v243, v243
v_pk_mul_f32 v[152:153], v[152:153], v[236:237]
v_pk_mul_f32 v[154:155], v[154:155], v[238:239]
v_pk_mul_f32 v[156:157], v[156:157], v[240:241]
v_pk_mul_f32 v[158:159], v[158:159], v[242:243]
CP 152,152,153
CP 153,154,155
CP 156,156,157
CP 157,158,159
AR 210,228
AR 211,229
AR 212,230
AR 213,231
AR 215,202
AR 217,203
v_lshlrev_b32 v214, 16, v215
v_and_b32 v215, 0xffff0000, v215
v_lshlrev_b32 v216, 16, v217
v_and_b32 v217, 0xffff0000, v217
v_pk_fma_f32 v[236:237], v[210:211], v[192:193], v[214:215] op_sel:[0,1,0] op_sel_hi:[1,1,1]
v_pk_fma_f32 v[238:239], v[212:213], v[192:193], v[216:217] op_sel:[0,1,0] op_sel_hi:[1,1,1]
v_pk_fma_f32 v[240:241], v[210:211], v[194:195], v[214:215] op_sel:[0,1,0] op_sel_hi:[1,1,1]
v_pk_fma_f32 v[242:243], v[212:213], v[194:195], v[216:217] op_sel:[0,1,0] op_sel_hi:[1,1,1]
v_pk_fma_f32 v[160:161], v[160:161], v[192:193], v[236:237] op_sel_hi:[1,0,1]
v_pk_fma_f32 v[162:163], v[162:163], v[192:193], v[238:239] op_sel_hi:[1,0,1]
v_pk_fma_f32 v[164:165], v[164:165], v[194:195], v[240:241] op_sel_hi:[1,0,1]
v_pk_fma_f32 v[166:167], v[166:167], v[194:195], v[242:243] op_sel_hi:[1,0,1]
v_pk_mul_f32 v[236:237], v[160:161], v[160:161]
v_pk_mul_f32 v[238:239], v[162:163], v[162:163]
v_pk_mul_f32 v[240:241], v[164:165], v[164:165]
v_pk_mul_f32 v[242:243], v[166:167], v[166:167]
v_pk_fma_f32 v[236:237], v[236:237], s[60:61], v[208:209] op_sel:[0,0,1] op_sel_hi:[1,1,1]
v_pk_fma_f32 v[238:239], v[238:239], s[60:61], v[208:209] op_sel:[0,0,1] op_sel_hi:[1,1,1]
v_pk_fma_f32 v[240:241], v[240:241], s[60:61], v[208:209] op_sel:[0,0,1] op_sel_hi:[1,1,1]
v_pk_fma_f32 v[242:243], v[242:243], s[60:61], v[208:209] op_sel:[0,0,1] op_sel_hi:[1,1,1]
v_pk_mul_f32 v[236:237], v[236:237], v[160:161]
v_pk_mul_f32 v[238:239], v[238:239], v[162:163]
v_pk_mul_f32 v[240:241], v[240:241], v[164:165]
v_pk_mul_f32 v[242:243], v[242:243], v[166:167]
v_exp_f32 v236, v236
v_exp_f32 v238, v238
v_exp_f32 v240, v240
v_exp_f32 v242, v242
v_exp_f32 v237, v237
v_exp_f32 v239, v239
v_exp_f32 v241, v241
v_exp_f32 v243, v243
v_pk_add_f32 v[236:237], v[236:237], 1.0 op_sel_hi:[1,0]
v_pk_add_f32 v[238:239], v[238:239], 1.0 op_sel_hi:[1,0]
v_pk_add_f32 v[240:241], v[240:241], 1.0 op_sel_hi:[1,0]
v_pk_add_f32 v[242:243], v[242:243], 1.0 op_sel_hi:[1,0]
v_rcp_f32 v236, v236
v_rcp_f32 v238, v238
v_rcp_f32 v240, v240
v_rcp_f32 v242, v242
v_rcp_f32 v237, v237
v_rcp_f32 v239, v239
v_rcp_f32 v241, v241
v_rcp_f32 v243, v243
v_pk_mul_f32 v[160:161], v[160:161], v[236:237]
v_pk_mul_f32 v[162:163], v[162:163], v[238:239]
v_pk_mul_f32 v[164:165], v[164:165], v[240:241]
v_pk_mul_f32 v[166:167], v[166:167], v[242:243]
CP 130,160,161
CP 131,162,163
CP 134,164,165
CP 135,166,167
s_add_u32 s3, s55, 2048
buffer_store_dwordx4 v[128:131], v208, s[8:11], s3 offen sc1
s_add_u32 s3, s55, 149504
buffer_store_dwordx4 v[132:135], v208, s[8:11], s3 offen sc1
v_pk_fma_f32 v[236:237], v[210:211], v[196:197], v[214:215] op_sel:[0,1,0] op_sel_hi:[1,1,1]
v_pk_fma_f32 v[238:239], v[212:213], v[196:197], v[216:217] op_sel:[0,1,0] op_sel_hi:[1,1,1]
v_pk_fma_f32 v[240:241], v[210:211], v[198:199], v[214:215] op_sel:[0,1,0] op_sel_hi:[1,1,1]
v_pk_fma_f32 v[242:243], v[212:213], v[198:199], v[216:217] op_sel:[0,1,0] op_sel_hi:[1,1,1]
v_pk_fma_f32 v[168:169], v[168:169], v[196:197], v[236:237] op_sel_hi:[1,0,1]
v_pk_fma_f32 v[170:171], v[170:171], v[196:197], v[238:239] op_sel_hi:[1,0,1]
v_pk_fma_f32 v[172:173], v[172:173], v[198:199], v[240:241] op_sel_hi:[1,0,1]
v_pk_fma_f32 v[174:175], v[174:175], v[198:199], v[242:243] op_sel_hi:[1,0,1]
v_pk_mul_f32 v[236:237], v[168:169], v[168:169]
v_pk_mul_f32 v[238:239], v[170:171], v[170:171]
v_pk_mul_f32 v[240:241], v[172:173], v[172:173]
v_pk_mul_f32 v[242:243], v[174:175], v[174:175]
v_pk_fma_f32 v[236:237], v[236:237], s[60:61], v[208:209] op_sel:[0,0,1] op_sel_hi:[1,1,1]
v_pk_fma_f32 v[238:239], v[238:239], s[60:61], v[208:209] op_sel:[0,0,1] op_sel_hi:[1,1,1]
v_pk_fma_f32 v[240:241], v[240:241], s[60:61], v[208:209] op_sel:[0,0,1] op_sel_hi:[1,1,1]
v_pk_fma_f32 v[242:243], v[242:243], s[60:61], v[208:209] op_sel:[0,0,1] op_sel_hi:[1,1,1]
v_pk_mul_f32 v[236:237], v[236:237], v[168:169]
v_pk_mul_f32 v[238:239], v[238:239], v[170:171]
v_pk_mul_f32 v[240:241], v[240:241], v[172:173]
v_pk_mul_f32 v[242:243], v[242:243], v[174:175]
v_exp_f32 v236, v236
v_exp_f32 v238, v238
v_exp_f32 v240, v240
v_exp_f32 v242, v242
v_exp_f32 v237, v237
v_exp_f32 v239, v239
v_exp_f32 v241, v241
v_exp_f32 v243, v243
v_pk_add_f32 v[236:237], v[236:237], 1.0 op_sel_hi:[1,0]
v_pk_add_f32 v[238:239], v[238:239], 1.0 op_sel_hi:[1,0]
v_pk_add_f32 v[240:241], v[240:241], 1.0 op_sel_hi:[1,0]
v_pk_add_f32 v[242:243], v[242:243], 1.0 op_sel_hi:[1,0]
v_rcp_f32 v236, v236
v_rcp_f32 v238, v238
v_rcp_f32 v240, v240
v_rcp_f32 v242, v242
v_rcp_f32 v237, v237
v_rcp_f32 v239, v239
v_rcp_f32 v241, v241
v_rcp_f32 v243, v243
v_pk_mul_f32 v[168:169], v[168:169], v[236:237]
v_pk_mul_f32 v[170:171], v[170:171], v[238:239]
v_pk_mul_f32 v[172:173], v[172:173], v[240:241]
v_pk_mul_f32 v[174:175], v[174:175], v[242:243]
CP 138,168,169
CP 139,170,171
CP 142,172,173
CP 143,174,175
s_add_u32 s3, s55, 296960
buffer_store_dwordx4 v[136:139], v208, s[8:11], s3 offen sc1
s_add_u32 s3, s55, 444416
buffer_store_dwordx4 v[140:143], v208, s[8:11], s3 offen sc1
v_pk_fma_f32 v[236:237], v[210:211], v[200:201], v[214:215] op_sel:[0,1,0] op_sel_hi:[1,1,1]
v_pk_fma_f32 v[238:239], v[212:213], v[200:201], v[216:217] op_sel:[0,1,0] op_sel_hi:[1,1,1]
v_pk_fma_f32 v[240:241], v[210:211], v[202:203], v[214:215] op_sel:[0,1,0] op_sel_hi:[1,1,1]
v_pk_fma_f32 v[242:243], v[212:213], v[202:203], v[216:217] op_sel:[0,1,0] op_sel_hi:[1,1,1]
v_pk_fma_f32 v[176:177], v[176:177], v[200:201], v[236:237] op_sel_hi:[1,0,1]
v_pk_fma_f32 v[178:179], v[178:179], v[200:201], v[238:239] op_sel_hi:[1,0,1]
v_pk_fma_f32 v[180:181], v[180:181], v[202:203], v[240:241] op_sel_hi:[1,0,1]
v_pk_fma_f32 v[182:183], v[182:183], v[202:203], v[242:243] op_sel_hi:[1,0,1]
v_pk_mul_f32 v[236:237], v[176:177], v[176:177]
v_pk_mul_f32 v[238:239], v[178:179], v[178:179]
v_pk_mul_f32 v[240:241], v[180:181], v[180:181]
v_pk_mul_f32 v[242:243], v[182:183], v[182:183]
v_pk_fma_f32 v[236:237], v[236:237], s[60:61], v[208:209] op_sel:[0,0,1] op_sel_hi:[1,1,1]
v_pk_fma_f32 v[238:239], v[238:239], s[60:61], v[208:209] op_sel:[0,0,1] op_sel_hi:[1,1,1]
v_pk_fma_f32 v[240:241], v[240:241], s[60:61], v[208:209] op_sel:[0,0,1] op_sel_hi:[1,1,1]
v_pk_fma_f32 v[242:243], v[242:243], s[60:61], v[208:209] op_sel:[0,0,1] op_sel_hi:[1,1,1]
v_pk_mul_f32 v[236:237], v[236:237], v[176:177]
v_pk_mul_f32 v[238:239], v[238:239], v[178:179]
v_pk_mul_f32 v[240:241], v[240:241], v[180:181]
v_pk_mul_f32 v[242:243], v[242:243], v[182:183]
v_exp_f32 v236, v236
v_exp_f32 v238, v238
v_exp_f32 v240, v240
v_exp_f32 v242, v242
v_exp_f32 v237, v237
v_exp_f32 v239, v239
v_exp_f32 v241, v241
v_exp_f32 v243, v243
v_pk_add_f32 v[236:237], v[236:237], 1.0 op_sel_hi:[1,0]
v_pk_add_f32 v[238:239], v[238:239], 1.0 op_sel_hi:[1,0]
v_pk_add_f32 v[240:241], v[240:241], 1.0 op_sel_hi:[1,0]
v_pk_add_f32 v[242:243], v[242:243], 1.0 op_sel_hi:[1,0]
v_rcp_f32 v236, v236
v_rcp_f32 v238, v238
v_rcp_f32 v240, v240
v_rcp_f32 v242, v242
v_rcp_f32 v237, v237
v_rcp_f32 v239, v239
v_rcp_f32 v241, v241
v_rcp_f32 v243, v243
v_pk_mul_f32 v[176:177], v[176:177], v[236:237]
v_pk_mul_f32 v[178:179], v[178:179], v[238:239]
v_pk_mul_f32 v[180:181], v[180:181], v[240:241]
v_pk_mul_f32 v[182:183], v[182:183], v[242:243]
CP 146,176,177
CP 147,178,179
CP 150,180,181
CP 151,182,183
s_add_u32 s3, s55, 591872
buffer_store_dwordx4 v[144:147], v208, s[8:11], s3 offen sc1
s_add_u32 s3, s55, 739328
buffer_store_dwordx4 v[148:151], v208, s[8:11], s3 offen sc1
v_pk_fma_f32 v[236:237], v[210:211], v[204:205], v[214:215] op_sel:[0,1,0] op_sel_hi:[1,1,1]
v_pk_fma_f32 v[238:239], v[212:213], v[204:205], v[216:217] op_sel:[0,1,0] op_sel_hi:[1,1,1]
v_pk_fma_f32 v[240:241], v[210:211], v[206:207], v[214:215] op_sel:[0,1,0] op_sel_hi:[1,1,1]
v_pk_fma_f32 v[242:243], v[212:213], v[206:207], v[216:217] op_sel:[0,1,0] op_sel_hi:[1,1,1]
v_pk_fma_f32 v[184:185], v[184:185], v[204:205], v[236:237] op_sel_hi:[1,0,1]
v_pk_fma_f32 v[186:187], v[186:187], v[204:205], v[238:239] op_sel_hi:[1,0,1]
v_pk_fma_f32 v[188:189], v[188:189], v[206:207], v[240:241] op_sel_hi:[1,0,1]
v_pk_fma_f32 v[190:191], v[190:191], v[206:207], v[242:243] op_sel_hi:[1,0,1]
v_pk_mul_f32 v[236:237], v[184:185], v[184:185]
v_pk_mul_f32 v[238:239], v[186:187], v[186:187]
v_pk_mul_f32 v[240:241], v[188:189], v[188:189]
v_pk_mul_f32 v[242:243], v[190:191], v[190:191]
v_pk_fma_f32 v[236:237], v[236:237], s[60:61], v[208:209] op_sel:[0,0,1] op_sel_hi:[1,1,1]
v_pk_fma_f32 v[238:239], v[238:239], s[60:61], v[208:209] op_sel:[0,0,1] op_sel_hi:[1,1,1]
v_pk_fma_f32 v[240:241], v[240:241], s[60:61], v[208:209] op_sel:[0,0,1] op_sel_hi:[1,1,1]
v_pk_fma_f32 v[242:243], v[242:243], s[60:61], v[208:209] op_sel:[0,0,1] op_sel_hi:[1,1,1]
v_pk_mul_f32 v[236:237], v[236:237], v[184:185]
v_pk_mul_f32 v[238:239], v[238:239], v[186:187]
v_pk_mul_f32 v[240:241], v[240:241], v[188:189]
v_pk_mul_f32 v[242:243], v[242:243], v[190:191]
v_exp_f32 v236, v236
v_exp_f32 v238, v238
v_exp_f32 v240, v240
v_exp_f32 v242, v242
v_exp_f32 v237, v237
v_exp_f32 v239, v239
v_exp_f32 v241, v241
v_exp_f32 v243, v243
v_pk_add_f32 v[236:237], v[236:237], 1.0 op_sel_hi:[1,0]
v_pk_add_f32 v[238:239], v[238:239], 1.0 op_sel_hi:[1,0]
v_pk_add_f32 v[240:241], v[240:241], 1.0 op_sel_hi:[1,0]
v_pk_add_f32 v[242:243], v[242:243], 1.0 op_sel_hi:[1,0]
v_rcp_f32 v236, v236
v_rcp_f32 v238, v238
v_rcp_f32 v240, v240
v_rcp_f32 v242, v242
v_rcp_f32 v237, v237
v_rcp_f32 v239, v239
v_rcp_f32 v241, v241
v_rcp_f32 v243, v243
v_pk_mul_f32 v[184:185], v[184:185], v[236:237]
v_pk_mul_f32 v[186:187], v[186:187], v[238:239]
v_pk_mul_f32 v[188:189], v[188:189], v[240:241]
v_pk_mul_f32 v[190:191], v[190:191], v[242:243]
CP 154,184,185
CP 155,186,187
CP 158,188,189
CP 159,190,191
s_add_u32 s3, s55, 886784
buffer_store_dwordx4 v[152:155], v208, s[8:11], s3 offen sc1
s_add_u32 s3, s55, 1034240
buffer_store_dwordx4 v[156:159], v208, s[8:11], s3 offen sc1
AR 210,232
AR 211,233
AR 212,234
AR 213,235
AR 215,204
AR 217,205
v_lshlrev_b32 v214, 16, v215
v_and_b32 v215, 0xffff0000, v215
v_lshlrev_b32 v216, 16, v217
v_and_b32 v217, 0xffff0000, v217
AR 244,128
AR 245,129
AR 246,130
AR 247,131
AR 248,132
AR 249,133
AR 250,134
AR 251,135
v_pk_fma_f32 v[236:237], v[210:211], v[192:193], v[214:215] op_sel:[0,1,0] op_sel_hi:[1,1,1]
v_pk_fma_f32 v[238:239], v[212:213], v[192:193], v[216:217] op_sel:[0,1,0] op_sel_hi:[1,1,1]
v_pk_fma_f32 v[240:241], v[210:211], v[194:195], v[214:215] op_sel:[0,1,0] op_sel_hi:[1,1,1]
v_pk_fma_f32 v[242:243], v[212:213], v[194:195], v[216:217] op_sel:[0,1,0] op_sel_hi:[1,1,1]
v_pk_fma_f32 v[244:245], v[244:245], v[192:193], v[236:237] op_sel_hi:[1,0,1]
v_pk_fma_f32 v[246:247], v[246:247], v[192:193], v[238:239] op_sel_hi:[1,0,1]
v_pk_fma_f32 v[248:249], v[248:249], v[194:195], v[240:241] op_sel_hi:[1,0,1]
v_pk_fma_f32 v[250:251], v[250:251], v[194:195], v[242:243] op_sel_hi:[1,0,1]
v_pk_mul_f32 v[236:237], v[244:245], v[244:245]
v_pk_mul_f32 v[238:239], v[246:247], v[246:247]
v_pk_mul_f32 v[240:241], v[248:249], v[248:249]
v_pk_mul_f32 v[242:243], v[250:251], v[250:251]
v_pk_fma_f32 v[236:237], v[236:237], s[60:61], v[208:209] op_sel:[0,0,1] op_sel_hi:[1,1,1]
v_pk_fma_f32 v[238:239], v[238:239], s[60:61], v[208:209] op_sel:[0,0,1] op_sel_hi:[1,1,1]
v_pk_fma_f32 v[240:241], v[240:241], s[60:61], v[208:209] op_sel:[0,0,1] op_sel_hi:[1,1,1]
v_pk_fma_f32 v[242:243], v[242:243], s[60:61], v[208:209] op_sel:[0,0,1] op_sel_hi:[1,1,1]
v_pk_mul_f32 v[236:237], v[236:237], v[244:245]
v_pk_mul_f32 v[238:239], v[238:239], v[246:247]
v_pk_mul_f32 v[240:241], v[240:241], v[248:249]
v_pk_mul_f32 v[242:243], v[242:243], v[250:251]
v_exp_f32 v236, v236
v_exp_f32 v238, v238
v_exp_f32 v240, v240
v_exp_f32 v242, v242
v_exp_f32 v237, v237
v_exp_f32 v239, v239
v_exp_f32 v241, v241
v_exp_f32 v243, v243
v_pk_add_f32 v[236:237], v[236:237], 1.0 op_sel_hi:[1,0]
v_pk_add_f32 v[238:239], v[238:239], 1.0 op_sel_hi:[1,0]
v_pk_add_f32 v[240:241], v[240:241], 1.0 op_sel_hi:[1,0]
v_pk_add_f32 v[242:243], v[242:243], 1.0 op_sel_hi:[1,0]
v_rcp_f32 v236, v236
v_rcp_f32 v238, v238
v_rcp_f32 v240, v240
v_rcp_f32 v242, v242
v_rcp_f32 v237, v237
v_rcp_f32 v239, v239
v_rcp_f32 v241, v241
v_rcp_f32 v243, v243
v_pk_mul_f32 v[244:245], v[244:245], v[236:237]
v_pk_mul_f32 v[246:247], v[246:247], v[238:239]
v_pk_mul_f32 v[248:249], v[248:249], v[240:241]
v_pk_mul_f32 v[250:251], v[250:251], v[242:243]
CP 220,244,245
CP 221,246,247
CP 222,248,249
CP 223,250,251
s_add_u32 s3, s55, 3072
buffer_store_dwordx2 v[220:221], v208, s[8:11], s3 offen offset:0 sc1
s_add_u32 s3, s55, 150528
buffer_store_dwordx2 v[222:223], v208, s[8:11], s3 offen offset:0 sc1
AR 244,136
AR 245,137
AR 246,138
AR 247,139
AR 248,140
AR 249,141
AR 250,142
AR 251,143
v_pk_fma_f32 v[236:237], v[210:211], v[196:197], v[214:215] op_sel:[0,1,0] op_sel_hi:[1,1,1]
v_pk_fma_f32 v[238:239], v[212:213], v[196:197], v[216:217] op_sel:[0,1,0] op_sel_hi:[1,1,1]
v_pk_fma_f32 v[240:241], v[210:211], v[198:199], v[214:215] op_sel:[0,1,0] op_sel_hi:[1,1,1]
v_pk_fma_f32 v[242:243], v[212:213], v[198:199], v[216:217] op_sel:[0,1,0] op_sel_hi:[1,1,1]
v_pk_fma_f32 v[244:245], v[244:245], v[196:197], v[236:237] op_sel_hi:[1,0,1]
v_pk_fma_f32 v[246:247], v[246:247], v[196:197], v[238:239] op_sel_hi:[1,0,1]
v_pk_fma_f32 v[248:249], v[248:249], v[198:199], v[240:241] op_sel_hi:[1,0,1]
v_pk_fma_f32 v[250:251], v[250:251], v[198:199], v[242:243] op_sel_hi:[1,0,1]
v_pk_mul_f32 v[236:237], v[244:245], v[244:245]
v_pk_mul_f32 v[238:239], v[246:247], v[246:247]
v_pk_mul_f32 v[240:241], v[248:249], v[248:249]
v_pk_mul_f32 v[242:243], v[250:251], v[250:251]
v_pk_fma_f32 v[236:237], v[236:237], s[60:61], v[208:209] op_sel:[0,0,1] op_sel_hi:[1,1,1]
v_pk_fma_f32 v[238:239], v[238:239], s[60:61], v[208:209] op_sel:[0,0,1] op_sel_hi:[1,1,1]
v_pk_fma_f32 v[240:241], v[240:241], s[60:61], v[208:209] op_sel:[0,0,1] op_sel_hi:[1,1,1]
v_pk_fma_f32 v[242:243], v[242:243], s[60:61], v[208:209] op_sel:[0,0,1] op_sel_hi:[1,1,1]
v_pk_mul_f32 v[236:237], v[236:237], v[244:245]
v_pk_mul_f32 v[238:239], v[238:239], v[246:247]
v_pk_mul_f32 v[240:241], v[240:241], v[248:249]
v_pk_mul_f32 v[242:243], v[242:243], v[250:251]
v_exp_f32 v236, v236
v_exp_f32 v238, v238
v_exp_f32 v240, v240
v_exp_f32 v242, v242
v_exp_f32 v237, v237
v_exp_f32 v239, v239
v_exp_f32 v241, v241
v_exp_f32 v243, v243
v_pk_add_f32 v[236:237], v[236:237], 1.0 op_sel_hi:[1,0]
v_pk_add_f32 v[238:239], v[238:239], 1.0 op_sel_hi:[1,0]
v_pk_add_f32 v[240:241], v[240:241], 1.0 op_sel_hi:[1,0]
v_pk_add_f32 v[242:243], v[242:243], 1.0 op_sel_hi:[1,0]
v_rcp_f32 v236, v236
v_rcp_f32 v238, v238
v_rcp_f32 v240, v240
v_rcp_f32 v242, v242
v_rcp_f32 v237, v237
v_rcp_f32 v239, v239
v_rcp_f32 v241, v241
v_rcp_f32 v243, v243
v_pk_mul_f32 v[244:245], v[244:245], v[236:237]
v_pk_mul_f32 v[246:247], v[246:247], v[238:239]
v_pk_mul_f32 v[248:249], v[248:249], v[240:241]
v_pk_mul_f32 v[250:251], v[250:251], v[242:243]
CP 220,244,245
CP 221,246,247
CP 222,248,249
CP 223,250,251
s_add_u32 s3, s55, 297984
buffer_store_dwordx2 v[220:221], v208, s[8:11], s3 offen offset:0 sc1
s_add_u32 s3, s55, 445440
buffer_store_dwordx2 v[222:223], v208, s[8:11], s3 offen offset:0 sc1
AR 244,144
AR 245,145
AR 246,146
AR 247,147
AR 248,148
AR 249,149
AR 250,150
AR 251,151
v_pk_fma_f32 v[236:237], v[210:211], v[200:201], v[214:215] op_sel:[0,1,0] op_sel_hi:[1,1,1]
v_pk_fma_f32 v[238:239], v[212:213], v[200:201], v[216:217] op_sel:[0,1,0] op_sel_hi:[1,1,1]
v_pk_fma_f32 v[240:241], v[210:211], v[202:203], v[214:215] op_sel:[0,1,0] op_sel_hi:[1,1,1]
v_pk_fma_f32 v[242:243], v[212:213], v[202:203], v[216:217] op_sel:[0,1,0] op_sel_hi:[1,1,1]
v_pk_fma_f32 v[244:245], v[244:245], v[200:201], v[236:237] op_sel_hi:[1,0,1]
v_pk_fma_f32 v[246:247], v[246:247], v[200:201], v[238:239] op_sel_hi:[1,0,1]
v_pk_fma_f32 v[248:249], v[248:249], v[202:203], v[240:241] op_sel_hi:[1,0,1]
v_pk_fma_f32 v[250:251], v[250:251], v[202:203], v[242:243] op_sel_hi:[1,0,1]
v_pk_mul_f32 v[236:237], v[244:245], v[244:245]
v_pk_mul_f32 v[238:239], v[246:247], v[246:247]
v_pk_mul_f32 v[240:241], v[248:249], v[248:249]
v_pk_mul_f32 v[242:243], v[250:251], v[250:251]
v_pk_fma_f32 v[236:237], v[236:237], s[60:61], v[208:209] op_sel:[0,0,1] op_sel_hi:[1,1,1]
v_pk_fma_f32 v[238:239], v[238:239], s[60:61], v[208:209] op_sel:[0,0,1] op_sel_hi:[1,1,1]
v_pk_fma_f32 v[240:241], v[240:241], s[60:61], v[208:209] op_sel:[0,0,1] op_sel_hi:[1,1,1]
v_pk_fma_f32 v[242:243], v[242:243], s[60:61], v[208:209] op_sel:[0,0,1] op_sel_hi:[1,1,1]
v_pk_mul_f32 v[236:237], v[236:237], v[244:245]
v_pk_mul_f32 v[238:239], v[238:239], v[246:247]
v_pk_mul_f32 v[240:241], v[240:241], v[248:249]
v_pk_mul_f32 v[242:243], v[242:243], v[250:251]
v_exp_f32 v236, v236
v_exp_f32 v238, v238
v_exp_f32 v240, v240
v_exp_f32 v242, v242
v_exp_f32 v237, v237
v_exp_f32 v239, v239
v_exp_f32 v241, v241
v_exp_f32 v243, v243
v_pk_add_f32 v[236:237], v[236:237], 1.0 op_sel_hi:[1,0]
v_pk_add_f32 v[238:239], v[238:239], 1.0 op_sel_hi:[1,0]
v_pk_add_f32 v[240:241], v[240:241], 1.0 op_sel_hi:[1,0]
v_pk_add_f32 v[242:243], v[242:243], 1.0 op_sel_hi:[1,0]
v_rcp_f32 v236, v236
v_rcp_f32 v238, v238
v_rcp_f32 v240, v240
v_rcp_f32 v242, v242
v_rcp_f32 v237, v237
v_rcp_f32 v239, v239
v_rcp_f32 v241, v241
v_rcp_f32 v243, v243
v_pk_mul_f32 v[244:245], v[244:245], v[236:237]
v_pk_mul_f32 v[246:247], v[246:247], v[238:239]
v_pk_mul_f32 v[248:249], v[248:249], v[240:241]
v_pk_mul_f32 v[250:251], v[250:251], v[242:243]
CP 220,244,245
CP 221,246,247
CP 222,248,249
CP 223,250,251
s_add_u32 s3, s55, 592896
buffer_store_dwordx2 v[220:221], v208, s[8:11], s3 offen offset:0 sc1
s_add_u32 s3, s55, 740352
buffer_store_dwordx2 v[222:223], v208, s[8:11], s3 offen offset:0 sc1
AR 244,152
AR 245,153
AR 246,154
AR 247,155
AR 248,156
AR 249,157
AR 250,158
AR 251,159
v_pk_fma_f32 v[236:237], v[210:211], v[204:205], v[214:215] op_sel:[0,1,0] op_sel_hi:[1,1,1]
v_pk_fma_f32 v[238:239], v[212:213], v[204:205], v[216:217] op_sel:[0,1,0] op_sel_hi:[1,1,1]
v_pk_fma_f32 v[240:241], v[210:211], v[206:207], v[214:215] op_sel:[0,1,0] op_sel_hi:[1,1,1]
v_pk_fma_f32 v[242:243], v[212:213], v[206:207], v[216:217] op_sel:[0,1,0] op_sel_hi:[1,1,1]
v_pk_fma_f32 v[244:245], v[244:245], v[204:205], v[236:237] op_sel_hi:[1,0,1]
v_pk_fma_f32 v[246:247], v[246:247], v[204:205], v[238:239] op_sel_hi:[1,0,1]
v_pk_fma_f32 v[248:249], v[248:249], v[206:207], v[240:241] op_sel_hi:[1,0,1]
v_pk_fma_f32 v[250:251], v[250:251], v[206:207], v[242:243] op_sel_hi:[1,0,1]
v_pk_mul_f32 v[236:237], v[244:245], v[244:245]
v_pk_mul_f32 v[238:239], v[246:247], v[246:247]
v_pk_mul_f32 v[240:241], v[248:249], v[248:249]
v_pk_mul_f32 v[242:243], v[250:251], v[250:251]
v_pk_fma_f32 v[236:237], v[236:237], s[60:61], v[208:209] op_sel:[0,0,1] op_sel_hi:[1,1,1]
v_pk_fma_f32 v[238:239], v[238:239], s[60:61], v[208:209] op_sel:[0,0,1] op_sel_hi:[1,1,1]
v_pk_fma_f32 v[240:241], v[240:241], s[60:61], v[208:209] op_sel:[0,0,1] op_sel_hi:[1,1,1]
v_pk_fma_f32 v[242:243], v[242:243], s[60:61], v[208:209] op_sel:[0,0,1] op_sel_hi:[1,1,1]
v_pk_mul_f32 v[236:237], v[236:237], v[244:245]
v_pk_mul_f32 v[238:239], v[238:239], v[246:247]
v_pk_mul_f32 v[240:241], v[240:241], v[248:249]
v_pk_mul_f32 v[242:243], v[242:243], v[250:251]
v_exp_f32 v236, v236
v_exp_f32 v238, v238
v_exp_f32 v240, v240
v_exp_f32 v242, v242
v_exp_f32 v237, v237
v_exp_f32 v239, v239
v_exp_f32 v241, v241
v_exp_f32 v243, v243
v_pk_add_f32 v[236:237], v[236:237], 1.0 op_sel_hi:[1,0]
v_pk_add_f32 v[238:239], v[238:239], 1.0 op_sel_hi:[1,0]
v_pk_add_f32 v[240:241], v[240:241], 1.0 op_sel_hi:[1,0]
v_pk_add_f32 v[242:243], v[242:243], 1.0 op_sel_hi:[1,0]
v_rcp_f32 v236, v236
v_rcp_f32 v238, v238
v_rcp_f32 v240, v240
v_rcp_f32 v242, v242
v_rcp_f32 v237, v237
v_rcp_f32 v239, v239
v_rcp_f32 v241, v241
v_rcp_f32 v243, v243
v_pk_mul_f32 v[244:245], v[244:245], v[236:237]
v_pk_mul_f32 v[246:247], v[246:247], v[238:239]
v_pk_mul_f32 v[248:249], v[248:249], v[240:241]
v_pk_mul_f32 v[250:251], v[250:251], v[242:243]
CP 220,244,245
CP 221,246,247
CP 222,248,249
CP 223,250,251
s_add_u32 s3, s55, 887808
buffer_store_dwordx2 v[220:221], v208, s[8:11], s3 offen offset:0 sc1
s_add_u32 s3, s55, 1035264
buffer_store_dwordx2 v[222:223], v208, s[8:11], s3 offen offset:0 sc1
s_add_u32 s72, s44, 16
s_lshl_b32 s72, s72, 7
s_branch k1_done
k1_mlp_epi1:
v_lshlrev_b32 v208, 4, v206
AR 192,176
AR 193,177
AR 194,178
AR 195,179
AR 196,180
AR 197,181
AR 198,182
AR 199,183
AR 200,184
AR 201,185
AR 202,186
AR 203,187
AR 204,188
AR 205,189
AR 206,190
AR 207,191
v_mov_b32 v209, 0xc0135761
s_mov_b32 s60, 0xbdd2d3e8
s_mov_b32 s61, 0xbdd2d3e8
s_add_u32 s8, s40, 0
s_addc_u32 s9, s41, 0
s_and_b32 s9, s9, 0xffff
s_mov_b32 s10, 18874368
s_mov_b32 s11, 0x20000
s_lshl_b32 s55, s44, 4
s_lshl_b32 s3, s52, 3
s_add_u32 s55, s55, s3
s_mul_i32 s55, s55, 147456
s_mul_i32 s3, s45, 7168
s_add_u32 s55, s55, s3
s_cmp_eq_u32 s65, 0
s_cselect_b32 s3, 6144, 0
s_add_u32 s56, s55, s3
s_lshl_b32 s3, s65, 10
s_add_u32 s55, s55, s3
AR 210,208
AR 211,209
AR 212,210
AR 213,211
AR 215,192
AR 217,193
v_lshlrev_b32 v214, 16, v215
v_and_b32 v215, 0xffff0000, v215
v_lshlrev_b32 v216, 16, v217
v_and_b32 v217, 0xffff0000, v217
v_pk_fma_f32 v[236:237], v[210:211], v[192:193], v[214:215] op_sel:[0,1,0] op_sel_hi:[1,1,1]
v_pk_fma_f32 v[238:239], v[212:213], v[192:193], v[216:217] op_sel:[0,1,0] op_sel_hi:[1,1,1]
v_pk_fma_f32 v[240:241], v[210:211], v[194:195], v[214:215] op_sel:[0,1,0] op_sel_hi:[1,1,1]
v_pk_fma_f32 v[242:243], v[212:213], v[194:195], v[216:217] op_sel:[0,1,0] op_sel_hi:[1,1,1]
v_pk_fma_f32 v[0:1], v[0:1], v[192:193], v[236:237] op_sel_hi:[1,0,1]
v_pk_fma_f32 v[2:3], v[2:3], v[192:193], v[238:239] op_sel_hi:[1,0,1]
v_pk_fma_f32 v[4:5], v[4:5], v[194:195], v[240:241] op_sel_hi:[1,0,1]
v_pk_fma_f32 v[6:7], v[6:7], v[194:195], v[242:243] op_sel_hi:[1,0,1]
v_pk_mul_f32 v[236:237], v[0:1], v[0:1]
v_pk_mul_f32 v[238:239], v[2:3], v[2:3]
v_pk_mul_f32 v[240:241], v[4:5], v[4:5]
v_pk_mul_f32 v[242:243], v[6:7], v[6:7]
v_pk_fma_f32 v[236:237], v[236:237], s[60:61], v[208:209] op_sel:[0,0,1] op_sel_hi:[1,1,1]
v_pk_fma_f32 v[238:239], v[238:239], s[60:61], v[208:209] op_sel:[0,0,1] op_sel_hi:[1,1,1]
v_pk_fma_f32 v[240:241], v[240:241], s[60:61], v[208:209] op_sel:[0,0,1] op_sel_hi:[1,1,1]
v_pk_fma_f32 v[242:243], v[242:243], s[60:61], v[208:209] op_sel:[0,0,1] op_sel_hi:[1,1,1]
v_pk_mul_f32 v[236:237], v[236:237], v[0:1]
v_pk_mul_f32 v[238:239], v[238:239], v[2:3]
v_pk_mul_f32 v[240:241], v[240:241], v[4:5]
v_pk_mul_f32 v[242:243], v[242:243], v[6:7]
v_exp_f32 v236, v236
v_exp_f32 v238, v238
v_exp_f32 v240, v240
v_exp_f32 v242, v242
v_exp_f32 v237, v237
v_exp_f32 v239, v239
v_exp_f32 v241, v241
v_exp_f32 v243, v243
v_pk_add_f32 v[236:237], v[236:237], 1.0 op_sel_hi:[1,0]
v_pk_add_f32 v[238:239], v[238:239], 1.0 op_sel_hi:[1,0]
v_pk_add_f32 v[240:241], v[240:241], 1.0 op_sel_hi:[1,0]
v_pk_add_f32 v[242:243], v[242:243], 1.0 op_sel_hi:[1,0]
v_rcp_f32 v236, v236
v_rcp_f32 v238, v238
v_rcp_f32 v240, v240
v_rcp_f32 v242, v242
v_rcp_f32 v237, v237
v_rcp_f32 v239, v239
v_rcp_f32 v241, v241
v_rcp_f32 v243, v243
v_pk_mul_f32 v[0:1], v[0:1], v[236:237]
v_pk_mul_f32 v[2:3], v[2:3], v[238:239]
v_pk_mul_f32 v[4:5], v[4:5], v[240:241]
v_pk_mul_f32 v[6:7], v[6:7], v[242:243]
CP 220,0,1
CP 221,2,3
CP 222,4,5
CP 223,6,7
s_add_u32 s3, s55, 3072
buffer_store_dwordx2 v[220:221], v208, s[8:11], s3 offen offset:8 sc1
s_add_u32 s3, s55, 150528
buffer_store_dwordx2 v[222:223], v208, s[8:11], s3 offen offset:8 sc1
v_pk_fma_f32 v[236:237], v[210:211], v[196:197], v[214:215] op_sel:[0,1,0] op_sel_hi:[1,1,1]
v_pk_fma_f32 v[238:239], v[212:213], v[196:197], v[216:217] op_sel:[0,1,0] op_sel_hi:[1,1,1]
v_pk_fma_f32 v[240:241], v[210:211], v[198:199], v[214:215] op_sel:[0,1,0] op_sel_hi:[1,1,1]
v_pk_fma_f32 v[242:243], v[212:213], v[198:199], v[216:217] op_sel:[0,1,0] op_sel_hi:[1,1,1]
v_pk_fma_f32 v[8:9], v[8:9], v[196:197], v[236:237] op_sel_hi:[1,0,1]
v_pk_fma_f32 v[10:11], v[10:11], v[196:197], v[238:239] op_sel_hi:[1,0,1]
v_pk_fma_f32 v[12:13], v[12:13], v[198:199], v[240:241] op_sel_hi:[1,0,1]
v_pk_fma_f32 v[14:15], v[14:15], v[198:199], v[242:243] op_sel_hi:[1,0,1]
v_pk_mul_f32 v[236:237], v[8:9], v[8:9]
v_pk_mul_f32 v[238:239], v[10:11], v[10:11]
v_pk_mul_f32 v[240:241], v[12:13], v[12:13]
v_pk_mul_f32 v[242:243], v[14:15], v[14:15]
v_pk_fma_f32 v[236:237], v[236:237], s[60:61], v[208:209] op_sel:[0,0,1] op_sel_hi:[1,1,1]
v_pk_fma_f32 v[238:239], v[238:239], s[60:61], v[208:209] op_sel:[0,0,1] op_sel_hi:[1,1,1]
v_pk_fma_f32 v[240:241], v[240:241], s[60:61], v[208:209] op_sel:[0,0,1] op_sel_hi:[1,1,1]
v_pk_fma_f32 v[242:243], v[242:243], s[60:61], v[208:209] op_sel:[0,0,1] op_sel_hi:[1,1,1]
v_pk_mul_f32 v[236:237], v[236:237], v[8:9]
v_pk_mul_f32 v[238:239], v[238:239], v[10:11]
v_pk_mul_f32 v[240:241], v[240:241], v[12:13]
v_pk_mul_f32 v[242:243], v[242:243], v[14:15]
v_exp_f32 v236, v236
v_exp_f32 v238, v238
v_exp_f32 v240, v240
v_exp_f32 v242, v242
v_exp_f32 v237, v237
v_exp_f32 v239, v239
v_exp_f32 v241, v241
v_exp_f32 v243, v243
v_pk_add_f32 v[236:237], v[236:237], 1.0 op_sel_hi:[1,0]
v_pk_add_f32 v[238:239], v[238:239], 1.0 op_sel_hi:[1,0]
v_pk_add_f32 v[240:241], v[240:241], 1.0 op_sel_hi:[1,0]
v_pk_add_f32 v[242:243], v[242:243], 1.0 op_sel_hi:[1,0]
v_rcp_f32 v236, v236
v_rcp_f32 v238, v238
v_rcp_f32 v240, v240
v_rcp_f32 v242, v242
v_rcp_f32 v237, v237
v_rcp_f32 v239, v239
v_rcp_f32 v241, v241
v_rcp_f32 v243, v243
v_pk_mul_f32 v[8:9], v[8:9], v[236:237]
v_pk_mul_f32 v[10:11], v[10:11], v[238:239]
v_pk_mul_f32 v[12:13], v[12:13], v[240:241]
v_pk_mul_f32 v[14:15], v[14:15], v[242:243]
CP 220,8,9
CP 221,10,11
CP 222,12,13
CP 223,14,15
s_add_u32 s3, s55, 297984
buffer_store_dwordx2 v[220:221], v208, s[8:11], s3 offen offset:8 sc1
s_add_u32 s3, s55, 445440
buffer_store_dwordx2 v[222:223], v208, s[8:11], s3 offen offset:8 sc1
v_pk_fma_f32 v[236:237], v[210:211], v[200:201], v[214:215] op_sel:[0,1,0] op_sel_hi:[1,1,1]
v_pk_fma_f32 v[238:239], v[212:213], v[200:201], v[216:217] op_sel:[0,1,0] op_sel_hi:[1,1,1]
v_pk_fma_f32 v[240:241], v[210:211], v[202:203], v[214:215] op_sel:[0,1,0] op_sel_hi:[1,1,1]
v_pk_fma_f32 v[242:243], v[212:213], v[202:203], v[216:217] op_sel:[0,1,0] op_sel_hi:[1,1,1]
v_pk_fma_f32 v[16:17], v[16:17], v[200:201], v[236:237] op_sel_hi:[1,0,1]
v_pk_fma_f32 v[18:19], v[18:19], v[200:201], v[238:239] op_sel_hi:[1,0,1]
v_pk_fma_f32 v[20:21], v[20:21], v[202:203], v[240:241] op_sel_hi:[1,0,1]
v_pk_fma_f32 v[22:23], v[22:23], v[202:203], v[242:243] op_sel_hi:[1,0,1]
v_pk_mul_f32 v[236:237], v[16:17], v[16:17]
v_pk_mul_f32 v[238:239], v[18:19], v[18:19]
v_pk_mul_f32 v[240:241], v[20:21], v[20:21]
v_pk_mul_f32 v[242:243], v[22:23], v[22:23]
v_pk_fma_f32 v[236:237], v[236:237], s[60:61], v[208:209] op_sel:[0,0,1] op_sel_hi:[1,1,1]
v_pk_fma_f32 v[238:239], v[238:239], s[60:61], v[208:209] op_sel:[0,0,1] op_sel_hi:[1,1,1]
v_pk_fma_f32 v[240:241], v[240:241], s[60:61], v[208:209] op_sel:[0,0,1] op_sel_hi:[1,1,1]
v_pk_fma_f32 v[242:243], v[242:243], s[60:61], v[208:209] op_sel:[0,0,1] op_sel_hi:[1,1,1]
v_pk_mul_f32 v[236:237], v[236:237], v[16:17]
v_pk_mul_f32 v[238:239], v[238:239], v[18:19]
v_pk_mul_f32 v[240:241], v[240:241], v[20:21]
v_pk_mul_f32 v[242:243], v[242:243], v[22:23]
v_exp_f32 v236, v236
v_exp_f32 v238, v238
v_exp_f32 v240, v240
v_exp_f32 v242, v242
v_exp_f32 v237, v237
v_exp_f32 v239, v239
v_exp_f32 v241, v241
v_exp_f32 v243, v243
v_pk_add_f32 v[236:237], v[236:237], 1.0 op_sel_hi:[1,0]
v_pk_add_f32 v[238:239], v[238:239], 1.0 op_sel_hi:[1,0]
v_pk_add_f32 v[240:241], v[240:241], 1.0 op_sel_hi:[1,0]
v_pk_add_f32 v[242:243], v[242:243], 1.0 op_sel_hi:[1,0]
v_rcp_f32 v236, v236
v_rcp_f32 v238, v238
v_rcp_f32 v240, v240
v_rcp_f32 v242, v242
v_rcp_f32 v237, v237
v_rcp_f32 v239, v239
v_rcp_f32 v241, v241
v_rcp_f32 v243, v243
v_pk_mul_f32 v[16:17], v[16:17], v[236:237]
v_pk_mul_f32 v[18:19], v[18:19], v[238:239]
v_pk_mul_f32 v[20:21], v[20:21], v[240:241]
v_pk_mul_f32 v[22:23], v[22:23], v[242:243]
CP 220,16,17
CP 221,18,19
CP 222,20,21
CP 223,22,23
s_add_u32 s3, s55, 592896
buffer_store_dwordx2 v[220:221], v208, s[8:11], s3 offen offset:8 sc1
s_add_u32 s3, s55, 740352
buffer_store_dwordx2 v[222:223], v208, s[8:11], s3 offen offset:8 sc1
v_pk_fma_f32 v[236:237], v[210:211], v[204:205], v[214:215] op_sel:[0,1,0] op_sel_hi:[1,1,1]
v_pk_fma_f32 v[238:239], v[212:213], v[204:205], v[216:217] op_sel:[0,1,0] op_sel_hi:[1,1,1]
v_pk_fma_f32 v[240:241], v[210:211], v[206:207], v[214:215] op_sel:[0,1,0] op_sel_hi:[1,1,1]
v_pk_fma_f32 v[242:243], v[212:213], v[206:207], v[216:217] op_sel:[0,1,0] op_sel_hi:[1,1,1]
v_pk_fma_f32 v[24:25], v[24:25], v[204:205], v[236:237] op_sel_hi:[1,0,1]
v_pk_fma_f32 v[26:27], v[26:27], v[204:205], v[238:239] op_sel_hi:[1,0,1]
v_pk_fma_f32 v[28:29], v[28:29], v[206:207], v[240:241] op_sel_hi:[1,0,1]
v_pk_fma_f32 v[30:31], v[30:31], v[206:207], v[242:243] op_sel_hi:[1,0,1]
v_pk_mul_f32 v[236:237], v[24:25], v[24:25]
v_pk_mul_f32 v[238:239], v[26:27], v[26:27]
v_pk_mul_f32 v[240:241], v[28:29], v[28:29]
v_pk_mul_f32 v[242:243], v[30:31], v[30:31]
v_pk_fma_f32 v[236:237], v[236:237], s[60:61], v[208:209] op_sel:[0,0,1] op_sel_hi:[1,1,1]
v_pk_fma_f32 v[238:239], v[238:239], s[60:61], v[208:209] op_sel:[0,0,1] op_sel_hi:[1,1,1]
v_pk_fma_f32 v[240:241], v[240:241], s[60:61], v[208:209] op_sel:[0,0,1] op_sel_hi:[1,1,1]
v_pk_fma_f32 v[242:243], v[242:243], s[60:61], v[208:209] op_sel:[0,0,1] op_sel_hi:[1,1,1]
v_pk_mul_f32 v[236:237], v[236:237], v[24:25]
v_pk_mul_f32 v[238:239], v[238:239], v[26:27]
v_pk_mul_f32 v[240:241], v[240:241], v[28:29]
v_pk_mul_f32 v[242:243], v[242:243], v[30:31]
v_exp_f32 v236, v236
v_exp_f32 v238, v238
v_exp_f32 v240, v240
v_exp_f32 v242, v242
v_exp_f32 v237, v237
v_exp_f32 v239, v239
v_exp_f32 v241, v241
v_exp_f32 v243, v243
v_pk_add_f32 v[236:237], v[236:237], 1.0 op_sel_hi:[1,0]
v_pk_add_f32 v[238:239], v[238:239], 1.0 op_sel_hi:[1,0]
v_pk_add_f32 v[240:241], v[240:241], 1.0 op_sel_hi:[1,0]
v_pk_add_f32 v[242:243], v[242:243], 1.0 op_sel_hi:[1,0]
v_rcp_f32 v236, v236
v_rcp_f32 v238, v238
v_rcp_f32 v240, v240
v_rcp_f32 v242, v242
v_rcp_f32 v237, v237
v_rcp_f32 v239, v239
v_rcp_f32 v241, v241
v_rcp_f32 v243, v243
v_pk_mul_f32 v[24:25], v[24:25], v[236:237]
v_pk_mul_f32 v[26:27], v[26:27], v[238:239]
v_pk_mul_f32 v[28:29], v[28:29], v[240:241]
v_pk_mul_f32 v[30:31], v[30:31], v[242:243]
CP 220,24,25
CP 221,26,27
CP 222,28,29
CP 223,30,31
s_add_u32 s3, s55, 887808
buffer_store_dwordx2 v[220:221], v208, s[8:11], s3 offen offset:8 sc1
s_add_u32 s3, s55, 1035264
buffer_store_dwordx2 v[222:223], v208, s[8:11], s3 offen offset:8 sc1
AR 210,212
AR 211,213
AR 212,214
AR 213,215
AR 215,194
AR 217,195
v_lshlrev_b32 v214, 16, v215
v_and_b32 v215, 0xffff0000, v215
v_lshlrev_b32 v216, 16, v217
v_and_b32 v217, 0xffff0000, v217
v_pk_fma_f32 v[236:237], v[210:211], v[192:193], v[214:215] op_sel:[0,1,0] op_sel_hi:[1,1,1]
v_pk_fma_f32 v[238:239], v[212:213], v[192:193], v[216:217] op_sel:[0,1,0] op_sel_hi:[1,1,1]
v_pk_fma_f32 v[240:241], v[210:211], v[194:195], v[214:215] op_sel:[0,1,0] op_sel_hi:[1,1,1]
v_pk_fma_f32 v[242:243], v[212:213], v[194:195], v[216:217] op_sel:[0,1,0] op_sel_hi:[1,1,1]
v_pk_fma_f32 v[32:33], v[32:33], v[192:193], v[236:237] op_sel_hi:[1,0,1]
v_pk_fma_f32 v[34:35], v[34:35], v[192:193], v[238:239] op_sel_hi:[1,0,1]
v_pk_fma_f32 v[36:37], v[36:37], v[194:195], v[240:241] op_sel_hi:[1,0,1]
v_pk_fma_f32 v[38:39], v[38:39], v[194:195], v[242:243] op_sel_hi:[1,0,1]
v_pk_mul_f32 v[236:237], v[32:33], v[32:33]
v_pk_mul_f32 v[238:239], v[34:35], v[34:35]
v_pk_mul_f32 v[240:241], v[36:37], v[36:37]
v_pk_mul_f32 v[242:243], v[38:39], v[38:39]
v_pk_fma_f32 v[236:237], v[236:237], s[60:61], v[208:209] op_sel:[0,0,1] op_sel_hi:[1,1,1]
v_pk_fma_f32 v[238:239], v[238:239], s[60:61], v[208:209] op_sel:[0,0,1] op_sel_hi:[1,1,1]
v_pk_fma_f32 v[240:241], v[240:241], s[60:61], v[208:209] op_sel:[0,0,1] op_sel_hi:[1,1,1]
v_pk_fma_f32 v[242:243], v[242:243], s[60:61], v[208:209] op_sel:[0,0,1] op_sel_hi:[1,1,1]
v_pk_mul_f32 v[236:237], v[236:237], v[32:33]
v_pk_mul_f32 v[238:239], v[238:239], v[34:35]
v_pk_mul_f32 v[240:241], v[240:241], v[36:37]
v_pk_mul_f32 v[242:243], v[242:243], v[38:39]
v_exp_f32 v236, v236
v_exp_f32 v238, v238
v_exp_f32 v240, v240
v_exp_f32 v242, v242
v_exp_f32 v237, v237
v_exp_f32 v239, v239
v_exp_f32 v241, v241
v_exp_f32 v243, v243
v_pk_add_f32 v[236:237], v[236:237], 1.0 op_sel_hi:[1,0]
v_pk_add_f32 v[238:239], v[238:239], 1.0 op_sel_hi:[1,0]
v_pk_add_f32 v[240:241], v[240:241], 1.0 op_sel_hi:[1,0]
v_pk_add_f32 v[242:243], v[242:243], 1.0 op_sel_hi:[1,0]
v_rcp_f32 v236, v236
v_rcp_f32 v238, v238
v_rcp_f32 v240, v240
v_rcp_f32 v242, v242
v_rcp_f32 v237, v237
v_rcp_f32 v239, v239
v_rcp_f32 v241, v241
v_rcp_f32 v243, v243
v_pk_mul_f32 v[32:33], v[32:33], v[236:237]
v_pk_mul_f32 v[34:35], v[34:35], v[238:239]
v_pk_mul_f32 v[36:37], v[36:37], v[240:241]
v_pk_mul_f32 v[38:39], v[38:39], v[242:243]
CP 32,32,33
CP 33,34,35
CP 36,36,37
CP 37,38,39
v_pk_fma_f32 v[236:237], v[210:211], v[196:197], v[214:215] op_sel:[0,1,0] op_sel_hi:[1,1,1]
v_pk_fma_f32 v[238:239], v[212:213], v[196:197], v[216:217] op_sel:[0,1,0] op_sel_hi:[1,1,1]
v_pk_fma_f32 v[240:241], v[210:211], v[198:199], v[214:215] op_sel:[0,1,0] op_sel_hi:[1,1,1]
v_pk_fma_f32 v[242:243], v[212:213], v[198:199], v[216:217] op_sel:[0,1,0] op_sel_hi:[1,1,1]
v_pk_fma_f32 v[40:41], v[40:41], v[196:197], v[236:237] op_sel_hi:[1,0,1]
v_pk_fma_f32 v[42:43], v[42:43], v[196:197], v[238:239] op_sel_hi:[1,0,1]
v_pk_fma_f32 v[44:45], v[44:45], v[198:199], v[240:241] op_sel_hi:[1,0,1]
v_pk_fma_f32 v[46:47], v[46:47], v[198:199], v[242:243] op_sel_hi:[1,0,1]
v_pk_mul_f32 v[236:237], v[40:41], v[40:41]
v_pk_mul_f32 v[238:239], v[42:43], v[42:43]
v_pk_mul_f32 v[240:241], v[44:45], v[44:45]
v_pk_mul_f32 v[242:243], v[46:47], v[46:47]
v_pk_fma_f32 v[236:237], v[236:237], s[60:61], v[208:209] op_sel:[0,0,1] op_sel_hi:[1,1,1]
v_pk_fma_f32 v[238:239], v[238:239], s[60:61], v[208:209] op_sel:[0,0,1] op_sel_hi:[1,1,1]
v_pk_fma_f32 v[240:241], v[240:241], s[60:61], v[208:209] op_sel:[0,0,1] op_sel_hi:[1,1,1]
v_pk_fma_f32 v[242:243], v[242:243], s[60:61], v[208:209] op_sel:[0,0,1] op_sel_hi:[1,1,1]
v_pk_mul_f32 v[236:237], v[236:237], v[40:41]
v_pk_mul_f32 v[238:239], v[238:239], v[42:43]
v_pk_mul_f32 v[240:241], v[240:241], v[44:45]
v_pk_mul_f32 v[242:243], v[242:243], v[46:47]
v_exp_f32 v236, v236
v_exp_f32 v238, v238
v_exp_f32 v240, v240
v_exp_f32 v242, v242
v_exp_f32 v237, v237
v_exp_f32 v239, v239
v_exp_f32 v241, v241
v_exp_f32 v243, v243
v_pk_add_f32 v[236:237], v[236:237], 1.0 op_sel_hi:[1,0]
v_pk_add_f32 v[238:239], v[238:239], 1.0 op_sel_hi:[1,0]
v_pk_add_f32 v[240:241], v[240:241], 1.0 op_sel_hi:[1,0]
v_pk_add_f32 v[242:243], v[242:243], 1.0 op_sel_hi:[1,0]
v_rcp_f32 v236, v236
v_rcp_f32 v238, v238
v_rcp_f32 v240, v240
v_rcp_f32 v242, v242
v_rcp_f32 v237, v237
v_rcp_f32 v239, v239
v_rcp_f32 v241, v241
v_rcp_f32 v243, v243
v_pk_mul_f32 v[40:41], v[40:41], v[236:237]
v_pk_mul_f32 v[42:43], v[42:43], v[238:239]
v_pk_mul_f32 v[44:45], v[44:45], v[240:241]
v_pk_mul_f32 v[46:47], v[46:47], v[242:243]
CP 40,40,41
CP 41,42,43
CP 44,44,45
CP 45,46,47
v_pk_fma_f32 v[236:237], v[210:211], v[200:201], v[214:215] op_sel:[0,1,0] op_sel_hi:[1,1,1]
v_pk_fma_f32 v[238:239], v[212:213], v[200:201], v[216:217] op_sel:[0,1,0] op_sel_hi:[1,1,1]
v_pk_fma_f32 v[240:241], v[210:211], v[202:203], v[214:215] op_sel:[0,1,0] op_sel_hi:[1,1,1]
v_pk_fma_f32 v[242:243], v[212:213], v[202:203], v[216:217] op_sel:[0,1,0] op_sel_hi:[1,1,1]
v_pk_fma_f32 v[48:49], v[48:49], v[200:201], v[236:237] op_sel_hi:[1,0,1]
v_pk_fma_f32 v[50:51], v[50:51], v[200:201], v[238:239] op_sel_hi:[1,0,1]
v_pk_fma_f32 v[52:53], v[52:53], v[202:203], v[240:241] op_sel_hi:[1,0,1]
v_pk_fma_f32 v[54:55], v[54:55], v[202:203], v[242:243] op_sel_hi:[1,0,1]
v_pk_mul_f32 v[236:237], v[48:49], v[48:49]
v_pk_mul_f32 v[238:239], v[50:51], v[50:51]
v_pk_mul_f32 v[240:241], v[52:53], v[52:53]
v_pk_mul_f32 v[242:243], v[54:55], v[54:55]
v_pk_fma_f32 v[236:237], v[236:237], s[60:61], v[208:209] op_sel:[0,0,1] op_sel_hi:[1,1,1]
v_pk_fma_f32 v[238:239], v[238:239], s[60:61], v[208:209] op_sel:[0,0,1] op_sel_hi:[1,1,1]
v_pk_fma_f32 v[240:241], v[240:241], s[60:61], v[208:209] op_sel:[0,0,1] op_sel_hi:[1,1,1]
v_pk_fma_f32 v[242:243], v[242:243], s[60:61], v[208:209] op_sel:[0,0,1] op_sel_hi:[1,1,1]
v_pk_mul_f32 v[236:237], v[236:237], v[48:49]
v_pk_mul_f32 v[238:239], v[238:239], v[50:51]
v_pk_mul_f32 v[240:241], v[240:241], v[52:53]
v_pk_mul_f32 v[242:243], v[242:243], v[54:55]
v_exp_f32 v236, v236
v_exp_f32 v238, v238
v_exp_f32 v240, v240
v_exp_f32 v242, v242
v_exp_f32 v237, v237
v_exp_f32 v239, v239
v_exp_f32 v241, v241
v_exp_f32 v243, v243
v_pk_add_f32 v[236:237], v[236:237], 1.0 op_sel_hi:[1,0]
v_pk_add_f32 v[238:239], v[238:239], 1.0 op_sel_hi:[1,0]
v_pk_add_f32 v[240:241], v[240:241], 1.0 op_sel_hi:[1,0]
v_pk_add_f32 v[242:243], v[242:243], 1.0 op_sel_hi:[1,0]
v_rcp_f32 v236, v236
v_rcp_f32 v238, v238
v_rcp_f32 v240, v240
v_rcp_f32 v242, v242
v_rcp_f32 v237, v237
v_rcp_f32 v239, v239
v_rcp_f32 v241, v241
v_rcp_f32 v243, v243
v_pk_mul_f32 v[48:49], v[48:49], v[236:237]
v_pk_mul_f32 v[50:51], v[50:51], v[238:239]
v_pk_mul_f32 v[52:53], v[52:53], v[240:241]
v_pk_mul_f32 v[54:55], v[54:55], v[242:243]
CP 48,48,49
CP 49,50,51
CP 52,52,53
CP 53,54,55
v_pk_fma_f32 v[236:237], v[210:211], v[204:205], v[214:215] op_sel:[0,1,0] op_sel_hi:[1,1,1]
v_pk_fma_f32 v[238:239], v[212:213], v[204:205], v[216:217] op_sel:[0,1,0] op_sel_hi:[1,1,1]
v_pk_fma_f32 v[240:241], v[210:211], v[206:207], v[214:215] op_sel:[0,1,0] op_sel_hi:[1,1,1]
v_pk_fma_f32 v[242:243], v[212:213], v[206:207], v[216:217] op_sel:[0,1,0] op_sel_hi:[1,1,1]
v_pk_fma_f32 v[56:57], v[56:57], v[204:205], v[236:237] op_sel_hi:[1,0,1]
v_pk_fma_f32 v[58:59], v[58:59], v[204:205], v[238:239] op_sel_hi:[1,0,1]
v_pk_fma_f32 v[60:61], v[60:61], v[206:207], v[240:241] op_sel_hi:[1,0,1]
v_pk_fma_f32 v[62:63], v[62:63], v[206:207], v[242:243] op_sel_hi:[1,0,1]
v_pk_mul_f32 v[236:237], v[56:57], v[56:57]
v_pk_mul_f32 v[238:239], v[58:59], v[58:59]
v_pk_mul_f32 v[240:241], v[60:61], v[60:61]
v_pk_mul_f32 v[242:243], v[62:63], v[62:63]
v_pk_fma_f32 v[236:237], v[236:237], s[60:61], v[208:209] op_sel:[0,0,1] op_sel_hi:[1,1,1]
v_pk_fma_f32 v[238:239], v[238:239], s[60:61], v[208:209] op_sel:[0,0,1] op_sel_hi:[1,1,1]
v_pk_fma_f32 v[240:241], v[240:241], s[60:61], v[208:209] op_sel:[0,0,1] op_sel_hi:[1,1,1]
v_pk_fma_f32 v[242:243], v[242:243], s[60:61], v[208:209] op_sel:[0,0,1] op_sel_hi:[1,1,1]
v_pk_mul_f32 v[236:237], v[236:237], v[56:57]
v_pk_mul_f32 v[238:239], v[238:239], v[58:59]
v_pk_mul_f32 v[240:241], v[240:241], v[60:61]
v_pk_mul_f32 v[242:243], v[242:243], v[62:63]
v_exp_f32 v236, v236
v_exp_f32 v238, v238
v_exp_f32 v240, v240
v_exp_f32 v242, v242
v_exp_f32 v237, v237
v_exp_f32 v239, v239
v_exp_f32 v241, v241
v_exp_f32 v243, v243
v_pk_add_f32 v[236:237], v[236:237], 1.0 op_sel_hi:[1,0]
v_pk_add_f32 v[238:239], v[238:239], 1.0 op_sel_hi:[1,0]
v_pk_add_f32 v[240:241], v[240:241], 1.0 op_sel_hi:[1,0]
v_pk_add_f32 v[242:243], v[242:243], 1.0 op_sel_hi:[1,0]
v_rcp_f32 v236, v236
v_rcp_f32 v238, v238
v_rcp_f32 v240, v240
v_rcp_f32 v242, v242
v_rcp_f32 v237, v237
v_rcp_f32 v239, v239
v_rcp_f32 v241, v241
v_rcp_f32 v243, v243
v_pk_mul_f32 v[56:57], v[56:57], v[236:237]
v_pk_mul_f32 v[58:59], v[58:59], v[238:239]
v_pk_mul_f32 v[60:61], v[60:61], v[240:241]
v_pk_mul_f32 v[62:63], v[62:63], v[242:243]
CP 56,56,57
CP 57,58,59
CP 60,60,61
CP 61,62,63
AR 210,216
AR 211,217
AR 212,218
AR 213,219
AR 215,196
AR 217,197
v_lshlrev_b32 v214, 16, v215
v_and_b32 v215, 0xffff0000, v215
v_lshlrev_b32 v216, 16, v217
v_and_b32 v217, 0xffff0000, v217
v_pk_fma_f32 v[236:237], v[210:211], v[192:193], v[214:215] op_sel:[0,1,0] op_sel_hi:[1,1,1]
v_pk_fma_f32 v[238:239], v[212:213], v[192:193], v[216:217] op_sel:[0,1,0] op_sel_hi:[1,1,1]
v_pk_fma_f32 v[240:241], v[210:211], v[194:195], v[214:215] op_sel:[0,1,0] op_sel_hi:[1,1,1]
v_pk_fma_f32 v[242:243], v[212:213], v[194:195], v[216:217] op_sel:[0,1,0] op_sel_hi:[1,1,1]
v_pk_fma_f32 v[64:65], v[64:65], v[192:193], v[236:237] op_sel_hi:[1,0,1]
v_pk_fma_f32 v[66:67], v[66:67], v[192:193], v[238:239] op_sel_hi:[1,0,1]
v_pk_fma_f32 v[68:69], v[68:69], v[194:195], v[240:241] op_sel_hi:[1,0,1]
v_pk_fma_f32 v[70:71], v[70:71], v[194:195], v[242:243] op_sel_hi:[1,0,1]
v_pk_mul_f32 v[236:237], v[64:65], v[64:65]
v_pk_mul_f32 v[238:239], v[66:67], v[66:67]
v_pk_mul_f32 v[240:241], v[68:69], v[68:69]
v_pk_mul_f32 v[242:243], v[70:71], v[70:71]
v_pk_fma_f32 v[236:237], v[236:237], s[60:61], v[208:209] op_sel:[0,0,1] op_sel_hi:[1,1,1]
v_pk_fma_f32 v[238:239], v[238:239], s[60:61], v[208:209] op_sel:[0,0,1] op_sel_hi:[1,1,1]
v_pk_fma_f32 v[240:241], v[240:241], s[60:61], v[208:209] op_sel:[0,0,1] op_sel_hi:[1,1,1]
v_pk_fma_f32 v[242:243], v[242:243], s[60:61], v[208:209] op_sel:[0,0,1] op_sel_hi:[1,1,1]
v_pk_mul_f32 v[236:237], v[236:237], v[64:65]
v_pk_mul_f32 v[238:239], v[238:239], v[66:67]
v_pk_mul_f32 v[240:241], v[240:241], v[68:69]
v_pk_mul_f32 v[242:243], v[242:243], v[70:71]
v_exp_f32 v236, v236
v_exp_f32 v238, v238
v_exp_f32 v240, v240
v_exp_f32 v242, v242
v_exp_f32 v237, v237
v_exp_f32 v239, v239
v_exp_f32 v241, v241
v_exp_f32 v243, v243
v_pk_add_f32 v[236:237], v[236:237], 1.0 op_sel_hi:[1,0]
v_pk_add_f32 v[238:239], v[238:239], 1.0 op_sel_hi:[1,0]
v_pk_add_f32 v[240:241], v[240:241], 1.0 op_sel_hi:[1,0]
v_pk_add_f32 v[242:243], v[242:243], 1.0 op_sel_hi:[1,0]
v_rcp_f32 v236, v236
v_rcp_f32 v238, v238
v_rcp_f32 v240, v240
v_rcp_f32 v242, v242
v_rcp_f32 v237, v237
v_rcp_f32 v239, v239
v_rcp_f32 v241, v241
v_rcp_f32 v243, v243
v_pk_mul_f32 v[64:65], v[64:65], v[236:237]
v_pk_mul_f32 v[66:67], v[66:67], v[238:239]
v_pk_mul_f32 v[68:69], v[68:69], v[240:241]
v_pk_mul_f32 v[70:71], v[70:71], v[242:243]
CP 34,64,65
CP 35,66,67
CP 38,68,69
CP 39,70,71
s_add_u32 s3, s55, 4096
buffer_store_dwordx4 v[32:35], v208, s[8:11], s3 offen sc1
s_add_u32 s3, s55, 151552
buffer_store_dwordx4 v[36:39], v208, s[8:11], s3 offen sc1
v_pk_fma_f32 v[236:237], v[210:211], v[196:197], v[214:215] op_sel:[0,1,0] op_sel_hi:[1,1,1]
v_pk_fma_f32 v[238:239], v[212:213], v[196:197], v[216:217] op_sel:[0,1,0] op_sel_hi:[1,1,1]
v_pk_fma_f32 v[240:241], v[210:211], v[198:199], v[214:215] op_sel:[0,1,0] op_sel_hi:[1,1,1]
v_pk_fma_f32 v[242:243], v[212:213], v[198:199], v[216:217] op_sel:[0,1,0] op_sel_hi:[1,1,1]
v_pk_fma_f32 v[72:73], v[72:73], v[196:197], v[236:237] op_sel_hi:[1,0,1]
v_pk_fma_f32 v[74:75], v[74:75], v[196:197], v[238:239] op_sel_hi:[1,0,1]
v_pk_fma_f32 v[76:77], v[76:77], v[198:199], v[240:241] op_sel_hi:[1,0,1]
v_pk_fma_f32 v[78:79], v[78:79], v[198:199], v[242:243] op_sel_hi:[1,0,1]
v_pk_mul_f32 v[236:237], v[72:73], v[72:73]
v_pk_mul_f32 v[238:239], v[74:75], v[74:75]
v_pk_mul_f32 v[240:241], v[76:77], v[76:77]
v_pk_mul_f32 v[242:243], v[78:79], v[78:79]
v_pk_fma_f32 v[236:237], v[236:237], s[60:61], v[208:209] op_sel:[0,0,1] op_sel_hi:[1,1,1]
v_pk_fma_f32 v[238:239], v[238:239], s[60:61], v[208:209] op_sel:[0,0,1] op_sel_hi:[1,1,1]
v_pk_fma_f32 v[240:241], v[240:241], s[60:61], v[208:209] op_sel:[0,0,1] op_sel_hi:[1,1,1]
v_pk_fma_f32 v[242:243], v[242:243], s[60:61], v[208:209] op_sel:[0,0,1] op_sel_hi:[1,1,1]
v_pk_mul_f32 v[236:237], v[236:237], v[72:73]
v_pk_mul_f32 v[238:239], v[238:239], v[74:75]
v_pk_mul_f32 v[240:241], v[240:241], v[76:77]
v_pk_mul_f32 v[242:243], v[242:243], v[78:79]
v_exp_f32 v236, v236
v_exp_f32 v238, v238
v_exp_f32 v240, v240
v_exp_f32 v242, v242
v_exp_f32 v237, v237
v_exp_f32 v239, v239
v_exp_f32 v241, v241
v_exp_f32 v243, v243
v_pk_add_f32 v[236:237], v[236:237], 1.0 op_sel_hi:[1,0]
v_pk_add_f32 v[238:239], v[238:239], 1.0 op_sel_hi:[1,0]
v_pk_add_f32 v[240:241], v[240:241], 1.0 op_sel_hi:[1,0]
v_pk_add_f32 v[242:243], v[242:243], 1.0 op_sel_hi:[1,0]
v_rcp_f32 v236, v236
v_rcp_f32 v238, v238
v_rcp_f32 v240, v240
v_rcp_f32 v242, v242
v_rcp_f32 v237, v237
v_rcp_f32 v239, v239
v_rcp_f32 v241, v241
v_rcp_f32 v243, v243
v_pk_mul_f32 v[72:73], v[72:73], v[236:237]
v_pk_mul_f32 v[74:75], v[74:75], v[238:239]
v_pk_mul_f32 v[76:77], v[76:77], v[240:241]
v_pk_mul_f32 v[78:79], v[78:79], v[242:243]
CP 42,72,73
CP 43,74,75
CP 46,76,77
CP 47,78,79
s_add_u32 s3, s55, 299008
buffer_store_dwordx4 v[40:43], v208, s[8:11], s3 offen sc1
s_add_u32 s3, s55, 446464
buffer_store_dwordx4 v[44:47], v208, s[8:11], s3 offen sc1
v_pk_fma_f32 v[236:237], v[210:211], v[200:201], v[214:215] op_sel:[0,1,0] op_sel_hi:[1,1,1]
v_pk_fma_f32 v[238:239], v[212:213], v[200:201], v[216:217] op_sel:[0,1,0] op_sel_hi:[1,1,1]
v_pk_fma_f32 v[240:241], v[210:211], v[202:203], v[214:215] op_sel:[0,1,0] op_sel_hi:[1,1,1]
v_pk_fma_f32 v[242:243], v[212:213], v[202:203], v[216:217] op_sel:[0,1,0] op_sel_hi:[1,1,1]
v_pk_fma_f32 v[80:81], v[80:81], v[200:201], v[236:237] op_sel_hi:[1,0,1]
v_pk_fma_f32 v[82:83], v[82:83], v[200:201], v[238:239] op_sel_hi:[1,0,1]
v_pk_fma_f32 v[84:85], v[84:85], v[202:203], v[240:241] op_sel_hi:[1,0,1]
v_pk_fma_f32 v[86:87], v[86:87], v[202:203], v[242:243] op_sel_hi:[1,0,1]
v_pk_mul_f32 v[236:237], v[80:81], v[80:81]
v_pk_mul_f32 v[238:239], v[82:83], v[82:83]
v_pk_mul_f32 v[240:241], v[84:85], v[84:85]
v_pk_mul_f32 v[242:243], v[86:87], v[86:87]
v_pk_fma_f32 v[236:237], v[236:237], s[60:61], v[208:209] op_sel:[0,0,1] op_sel_hi:[1,1,1]
v_pk_fma_f32 v[238:239], v[238:239], s[60:61], v[208:209] op_sel:[0,0,1] op_sel_hi:[1,1,1]
v_pk_fma_f32 v[240:241], v[240:241], s[60:61], v[208:209] op_sel:[0,0,1] op_sel_hi:[1,1,1]
v_pk_fma_f32 v[242:243], v[242:243], s[60:61], v[208:209] op_sel:[0,0,1] op_sel_hi:[1,1,1]
v_pk_mul_f32 v[236:237], v[236:237], v[80:81]
v_pk_mul_f32 v[238:239], v[238:239], v[82:83]
v_pk_mul_f32 v[240:241], v[240:241], v[84:85]
v_pk_mul_f32 v[242:243], v[242:243], v[86:87]
v_exp_f32 v236, v236
v_exp_f32 v238, v238
v_exp_f32 v240, v240
v_exp_f32 v242, v242
v_exp_f32 v237, v237
v_exp_f32 v239, v239
v_exp_f32 v241, v241
v_exp_f32 v243, v243
v_pk_add_f32 v[236:237], v[236:237], 1.0 op_sel_hi:[1,0]
v_pk_add_f32 v[238:239], v[238:239], 1.0 op_sel_hi:[1,0]
v_pk_add_f32 v[240:241], v[240:241], 1.0 op_sel_hi:[1,0]
v_pk_add_f32 v[242:243], v[242:243], 1.0 op_sel_hi:[1,0]
v_rcp_f32 v236, v236
v_rcp_f32 v238, v238
v_rcp_f32 v240, v240
v_rcp_f32 v242, v242
v_rcp_f32 v237, v237
v_rcp_f32 v239, v239
v_rcp_f32 v241, v241
v_rcp_f32 v243, v243
v_pk_mul_f32 v[80:81], v[80:81], v[236:237]
v_pk_mul_f32 v[82:83], v[82:83], v[238:239]
v_pk_mul_f32 v[84:85], v[84:85], v[240:241]
v_pk_mul_f32 v[86:87], v[86:87], v[242:243]
CP 50,80,81
CP 51,82,83
CP 54,84,85
CP 55,86,87
s_add_u32 s3, s55, 593920
buffer_store_dwordx4 v[48:51], v208, s[8:11], s3 offen sc1
s_add_u32 s3, s55, 741376
buffer_store_dwordx4 v[52:55], v208, s[8:11], s3 offen sc1
v_pk_fma_f32 v[236:237], v[210:211], v[204:205], v[214:215] op_sel:[0,1,0] op_sel_hi:[1,1,1]
v_pk_fma_f32 v[238:239], v[212:213], v[204:205], v[216:217] op_sel:[0,1,0] op_sel_hi:[1,1,1]
v_pk_fma_f32 v[240:241], v[210:211], v[206:207], v[214:215] op_sel:[0,1,0] op_sel_hi:[1,1,1]
v_pk_fma_f32 v[242:243], v[212:213], v[206:207], v[216:217] op_sel:[0,1,0] op_sel_hi:[1,1,1]
v_pk_fma_f32 v[88:89], v[88:89], v[204:205], v[236:237] op_sel_hi:[1,0,1]
v_pk_fma_f32 v[90:91], v[90:91], v[204:205], v[238:239] op_sel_hi:[1,0,1]
v_pk_fma_f32 v[92:93], v[92:93], v[206:207], v[240:241] op_sel_hi:[1,0,1]
v_pk_fma_f32 v[94:95], v[94:95], v[206:207], v[242:243] op_sel_hi:[1,0,1]
v_pk_mul_f32 v[236:237], v[88:89], v[88:89]
v_pk_mul_f32 v[238:239], v[90:91], v[90:91]
v_pk_mul_f32 v[240:241], v[92:93], v[92:93]
v_pk_mul_f32 v[242:243], v[94:95], v[94:95]
v_pk_fma_f32 v[236:237], v[236:237], s[60:61], v[208:209] op_sel:[0,0,1] op_sel_hi:[1,1,1]
v_pk_fma_f32 v[238:239], v[238:239], s[60:61], v[208:209] op_sel:[0,0,1] op_sel_hi:[1,1,1]
v_pk_fma_f32 v[240:241], v[240:241], s[60:61], v[208:209] op_sel:[0,0,1] op_sel_hi:[1,1,1]
v_pk_fma_f32 v[242:243], v[242:243], s[60:61], v[208:209] op_sel:[0,0,1] op_sel_hi:[1,1,1]
v_pk_mul_f32 v[236:237], v[236:237], v[88:89]
v_pk_mul_f32 v[238:239], v[238:239], v[90:91]
v_pk_mul_f32 v[240:241], v[240:241], v[92:93]
v_pk_mul_f32 v[242:243], v[242:243], v[94:95]
v_exp_f32 v236, v236
v_exp_f32 v238, v238
v_exp_f32 v240, v240
v_exp_f32 v242, v242
v_exp_f32 v237, v237
v_exp_f32 v239, v239
v_exp_f32 v241, v241
v_exp_f32 v243, v243
v_pk_add_f32 v[236:237], v[236:237], 1.0 op_sel_hi:[1,0]
v_pk_add_f32 v[238:239], v[238:239], 1.0 op_sel_hi:[1,0]
v_pk_add_f32 v[240:241], v[240:241], 1.0 op_sel_hi:[1,0]
v_pk_add_f32 v[242:243], v[242:243], 1.0 op_sel_hi:[1,0]
v_rcp_f32 v236, v236
v_rcp_f32 v238, v238
v_rcp_f32 v240, v240
v_rcp_f32 v242, v242
v_rcp_f32 v237, v237
v_rcp_f32 v239, v239
v_rcp_f32 v241, v241
v_rcp_f32 v243, v243
v_pk_mul_f32 v[88:89], v[88:89], v[236:237]
v_pk_mul_f32 v[90:91], v[90:91], v[238:239]
v_pk_mul_f32 v[92:93], v[92:93], v[240:241]
v_pk_mul_f32 v[94:95], v[94:95], v[242:243]
CP 58,88,89
CP 59,90,91
CP 62,92,93
CP 63,94,95
s_add_u32 s3, s55, 888832
buffer_store_dwordx4 v[56:59], v208, s[8:11], s3 offen sc1
s_add_u32 s3, s55, 1036288
buffer_store_dwordx4 v[60:63], v208, s[8:11], s3 offen sc1
AR 210,220
AR 211,221
AR 212,222
AR 213,223
AR 215,198
AR 217,199
v_lshlrev_b32 v214, 16, v215
v_and_b32 v215, 0xffff0000, v215
v_lshlrev_b32 v216, 16, v217
v_and_b32 v217, 0xffff0000, v217
v_pk_fma_f32 v[236:237], v[210:211], v[192:193], v[214:215] op_sel:[0,1,0] op_sel_hi:[1,1,1]
v_pk_fma_f32 v[238:239], v[212:213], v[192:193], v[216:217] op_sel:[0,1,0] op_sel_hi:[1,1,1]
v_pk_fma_f32 v[240:241], v[210:211], v[194:195], v[214:215] op_sel:[0,1,0] op_sel_hi:[1,1,1]
v_pk_fma_f32 v[242:243], v[212:213], v[194:195], v[216:217] op_sel:[0,1,0] op_sel_hi:[1,1,1]
v_pk_fma_f32 v[96:97], v[96:97], v[192:193], v[236:237] op_sel_hi:[1,0,1]
v_pk_fma_f32 v[98:99], v[98:99], v[192:193], v[238:239] op_sel_hi:[1,0,1]
v_pk_fma_f32 v[100:101], v[100:101], v[194:195], v[240:241] op_sel_hi:[1,0,1]
v_pk_fma_f32 v[102:103], v[102:103], v[194:195], v[242:243] op_sel_hi:[1,0,1]
v_pk_mul_f32 v[236:237], v[96:97], v[96:97]
v_pk_mul_f32 v[238:239], v[98:99], v[98:99]
v_pk_mul_f32 v[240:241], v[100:101], v[100:101]
v_pk_mul_f32 v[242:243], v[102:103], v[102:103]
v_pk_fma_f32 v[236:237], v[236:237], s[60:61], v[208:209] op_sel:[0,0,1] op_sel_hi:[1,1,1]
v_pk_fma_f32 v[238:239], v[238:239], s[60:61], v[208:209] op_sel:[0,0,1] op_sel_hi:[1,1,1]
v_pk_fma_f32 v[240:241], v[240:241], s[60:61], v[208:209] op_sel:[0,0,1] op_sel_hi:[1,1,1]
v_pk_fma_f32 v[242:243], v[242:243], s[60:61], v[208:209] op_sel:[0,0,1] op_sel_hi:[1,1,1]
v_pk_mul_f32 v[236:237], v[236:237], v[96:97]
v_pk_mul_f32 v[238:239], v[238:239], v[98:99]
v_pk_mul_f32 v[240:241], v[240:241], v[100:101]
v_pk_mul_f32 v[242:243], v[242:243], v[102:103]
v_exp_f32 v236, v236
v_exp_f32 v238, v238
v_exp_f32 v240, v240
v_exp_f32 v242, v242
v_exp_f32 v237, v237
v_exp_f32 v239, v239
v_exp_f32 v241, v241
v_exp_f32 v243, v243
v_pk_add_f32 v[236:237], v[236:237], 1.0 op_sel_hi:[1,0]
v_pk_add_f32 v[238:239], v[238:239], 1.0 op_sel_hi:[1,0]
v_pk_add_f32 v[240:241], v[240:241], 1.0 op_sel_hi:[1,0]
v_pk_add_f32 v[242:243], v[242:243], 1.0 op_sel_hi:[1,0]
v_rcp_f32 v236, v236
v_rcp_f32 v238, v238
v_rcp_f32 v240, v240
v_rcp_f32 v242, v242
v_rcp_f32 v237, v237
v_rcp_f32 v239, v239
v_rcp_f32 v241, v241
v_rcp_f32 v243, v243
v_pk_mul_f32 v[96:97], v[96:97], v[236:237]
v_pk_mul_f32 v[98:99], v[98:99], v[238:239]
v_pk_mul_f32 v[100:101], v[100:101], v[240:241]
v_pk_mul_f32 v[102:103], v[102:103], v[242:243]
CP 96,96,97
CP 97,98,99
CP 100,100,101
CP 101,102,103
v_pk_fma_f32 v[236:237], v[210:211], v[196:197], v[214:215] op_sel:[0,1,0] op_sel_hi:[1,1,1]
v_pk_fma_f32 v[238:239], v[212:213], v[196:197], v[216:217] op_sel:[0,1,0] op_sel_hi:[1,1,1]
v_pk_fma_f32 v[240:241], v[210:211], v[198:199], v[214:215] op_sel:[0,1,0] op_sel_hi:[1,1,1]
v_pk_fma_f32 v[242:243], v[212:213], v[198:199], v[216:217] op_sel:[0,1,0] op_sel_hi:[1,1,1]
v_pk_fma_f32 v[104:105], v[104:105], v[196:197], v[236:237] op_sel_hi:[1,0,1]
v_pk_fma_f32 v[106:107], v[106:107], v[196:197], v[238:239] op_sel_hi:[1,0,1]
v_pk_fma_f32 v[108:109], v[108:109], v[198:199], v[240:241] op_sel_hi:[1,0,1]
v_pk_fma_f32 v[110:111], v[110:111], v[198:199], v[242:243] op_sel_hi:[1,0,1]
v_pk_mul_f32 v[236:237], v[104:105], v[104:105]
v_pk_mul_f32 v[238:239], v[106:107], v[106:107]
v_pk_mul_f32 v[240:241], v[108:109], v[108:109]
v_pk_mul_f32 v[242:243], v[110:111], v[110:111]
v_pk_fma_f32 v[236:237], v[236:237], s[60:61], v[208:209] op_sel:[0,0,1] op_sel_hi:[1,1,1]
v_pk_fma_f32 v[238:239], v[238:239], s[60:61], v[208:209] op_sel:[0,0,1] op_sel_hi:[1,1,1]
v_pk_fma_f32 v[240:241], v[240:241], s[60:61], v[208:209] op_sel:[0,0,1] op_sel_hi:[1,1,1]
v_pk_fma_f32 v[242:243], v[242:243], s[60:61], v[208:209] op_sel:[0,0,1] op_sel_hi:[1,1,1]
v_pk_mul_f32 v[236:237], v[236:237], v[104:105]
v_pk_mul_f32 v[238:239], v[238:239], v[106:107]
v_pk_mul_f32 v[240:241], v[240:241], v[108:109]
v_pk_mul_f32 v[242:243], v[242:243], v[110:111]
v_exp_f32 v236, v236
v_exp_f32 v238, v238
v_exp_f32 v240, v240
v_exp_f32 v242, v242
v_exp_f32 v237, v237
v_exp_f32 v239, v239
v_exp_f32 v241, v241
v_exp_f32 v243, v243
v_pk_add_f32 v[236:237], v[236:237], 1.0 op_sel_hi:[1,0]
v_pk_add_f32 v[238:239], v[238:239], 1.0 op_sel_hi:[1,0]
v_pk_add_f32 v[240:241], v[240:241], 1.0 op_sel_hi:[1,0]
v_pk_add_f32 v[242:243], v[242:243], 1.0 op_sel_hi:[1,0]
v_rcp_f32 v236, v236
v_rcp_f32 v238, v238
v_rcp_f32 v240, v240
v_rcp_f32 v242, v242
v_rcp_f32 v237, v237
v_rcp_f32 v239, v239
v_rcp_f32 v241, v241
v_rcp_f32 v243, v243
v_pk_mul_f32 v[104:105], v[104:105], v[236:237]
v_pk_mul_f32 v[106:107], v[106:107], v[238:239]
v_pk_mul_f32 v[108:109], v[108:109], v[240:241]
v_pk_mul_f32 v[110:111], v[110:111], v[242:243]
CP 104,104,105
CP 105,106,107
CP 108,108,109
CP 109,110,111
v_pk_fma_f32 v[236:237], v[210:211], v[200:201], v[214:215] op_sel:[0,1,0] op_sel_hi:[1,1,1]
v_pk_fma_f32 v[238:239], v[212:213], v[200:201], v[216:217] op_sel:[0,1,0] op_sel_hi:[1,1,1]
v_pk_fma_f32 v[240:241], v[210:211], v[202:203], v[214:215] op_sel:[0,1,0] op_sel_hi:[1,1,1]
v_pk_fma_f32 v[242:243], v[212:213], v[202:203], v[216:217] op_sel:[0,1,0] op_sel_hi:[1,1,1]
v_pk_fma_f32 v[112:113], v[112:113], v[200:201], v[236:237] op_sel_hi:[1,0,1]
v_pk_fma_f32 v[114:115], v[114:115], v[200:201], v[238:239] op_sel_hi:[1,0,1]
v_pk_fma_f32 v[116:117], v[116:117], v[202:203], v[240:241] op_sel_hi:[1,0,1]
v_pk_fma_f32 v[118:119], v[118:119], v[202:203], v[242:243] op_sel_hi:[1,0,1]
v_pk_mul_f32 v[236:237], v[112:113], v[112:113]
v_pk_mul_f32 v[238:239], v[114:115], v[114:115]
v_pk_mul_f32 v[240:241], v[116:117], v[116:117]
v_pk_mul_f32 v[242:243], v[118:119], v[118:119]
v_pk_fma_f32 v[236:237], v[236:237], s[60:61], v[208:209] op_sel:[0,0,1] op_sel_hi:[1,1,1]
v_pk_fma_f32 v[238:239], v[238:239], s[60:61], v[208:209] op_sel:[0,0,1] op_sel_hi:[1,1,1]
v_pk_fma_f32 v[240:241], v[240:241], s[60:61], v[208:209] op_sel:[0,0,1] op_sel_hi:[1,1,1]
v_pk_fma_f32 v[242:243], v[242:243], s[60:61], v[208:209] op_sel:[0,0,1] op_sel_hi:[1,1,1]
v_pk_mul_f32 v[236:237], v[236:237], v[112:113]
v_pk_mul_f32 v[238:239], v[238:239], v[114:115]
v_pk_mul_f32 v[240:241], v[240:241], v[116:117]
v_pk_mul_f32 v[242:243], v[242:243], v[118:119]
v_exp_f32 v236, v236
v_exp_f32 v238, v238
v_exp_f32 v240, v240
v_exp_f32 v242, v242
v_exp_f32 v237, v237
v_exp_f32 v239, v239
v_exp_f32 v241, v241
v_exp_f32 v243, v243
v_pk_add_f32 v[236:237], v[236:237], 1.0 op_sel_hi:[1,0]
v_pk_add_f32 v[238:239], v[238:239], 1.0 op_sel_hi:[1,0]
v_pk_add_f32 v[240:241], v[240:241], 1.0 op_sel_hi:[1,0]
v_pk_add_f32 v[242:243], v[242:243], 1.0 op_sel_hi:[1,0]
v_rcp_f32 v236, v236
v_rcp_f32 v238, v238
v_rcp_f32 v240, v240
v_rcp_f32 v242, v242
v_rcp_f32 v237, v237
v_rcp_f32 v239, v239
v_rcp_f32 v241, v241
v_rcp_f32 v243, v243
v_pk_mul_f32 v[112:113], v[112:113], v[236:237]
v_pk_mul_f32 v[114:115], v[114:115], v[238:239]
v_pk_mul_f32 v[116:117], v[116:117], v[240:241]
v_pk_mul_f32 v[118:119], v[118:119], v[242:243]
CP 112,112,113
CP 113,114,115
CP 116,116,117
CP 117,118,119
v_pk_fma_f32 v[236:237], v[210:211], v[204:205], v[214:215] op_sel:[0,1,0] op_sel_hi:[1,1,1]
v_pk_fma_f32 v[238:239], v[212:213], v[204:205], v[216:217] op_sel:[0,1,0] op_sel_hi:[1,1,1]
v_pk_fma_f32 v[240:241], v[210:211], v[206:207], v[214:215] op_sel:[0,1,0] op_sel_hi:[1,1,1]
v_pk_fma_f32 v[242:243], v[212:213], v[206:207], v[216:217] op_sel:[0,1,0] op_sel_hi:[1,1,1]
v_pk_fma_f32 v[120:121], v[120:121], v[204:205], v[236:237] op_sel_hi:[1,0,1]
v_pk_fma_f32 v[122:123], v[122:123], v[204:205], v[238:239] op_sel_hi:[1,0,1]
v_pk_fma_f32 v[124:125], v[124:125], v[206:207], v[240:241] op_sel_hi:[1,0,1]
v_pk_fma_f32 v[126:127], v[126:127], v[206:207], v[242:243] op_sel_hi:[1,0,1]
v_pk_mul_f32 v[236:237], v[120:121], v[120:121]
v_pk_mul_f32 v[238:239], v[122:123], v[122:123]
v_pk_mul_f32 v[240:241], v[124:125], v[124:125]
v_pk_mul_f32 v[242:243], v[126:127], v[126:127]
v_pk_fma_f32 v[236:237], v[236:237], s[60:61], v[208:209] op_sel:[0,0,1] op_sel_hi:[1,1,1]
v_pk_fma_f32 v[238:239], v[238:239], s[60:61], v[208:209] op_sel:[0,0,1] op_sel_hi:[1,1,1]
v_pk_fma_f32 v[240:241], v[240:241], s[60:61], v[208:209] op_sel:[0,0,1] op_sel_hi:[1,1,1]
v_pk_fma_f32 v[242:243], v[242:243], s[60:61], v[208:209] op_sel:[0,0,1] op_sel_hi:[1,1,1]
v_pk_mul_f32 v[236:237], v[236:237], v[120:121]
v_pk_mul_f32 v[238:239], v[238:239], v[122:123]
v_pk_mul_f32 v[240:241], v[240:241], v[124:125]
v_pk_mul_f32 v[242:243], v[242:243], v[126:127]
v_exp_f32 v236, v236
v_exp_f32 v238, v238
v_exp_f32 v240, v240
v_exp_f32 v242, v242
v_exp_f32 v237, v237
v_exp_f32 v239, v239
v_exp_f32 v241, v241
v_exp_f32 v243, v243
v_pk_add_f32 v[236:237], v[236:237], 1.0 op_sel_hi:[1,0]
v_pk_add_f32 v[238:239], v[238:239], 1.0 op_sel_hi:[1,0]
v_pk_add_f32 v[240:241], v[240:241], 1.0 op_sel_hi:[1,0]
v_pk_add_f32 v[242:243], v[242:243], 1.0 op_sel_hi:[1,0]
v_rcp_f32 v236, v236
v_rcp_f32 v238, v238
v_rcp_f32 v240, v240
v_rcp_f32 v242, v242
v_rcp_f32 v237, v237
v_rcp_f32 v239, v239
v_rcp_f32 v241, v241
v_rcp_f32 v243, v243
v_pk_mul_f32 v[120:121], v[120:121], v[236:237]
v_pk_mul_f32 v[122:123], v[122:123], v[238:239]
v_pk_mul_f32 v[124:125], v[124:125], v[240:241]
v_pk_mul_f32 v[126:127], v[126:127], v[242:243]
CP 120,120,121
CP 121,122,123
CP 124,124,125
CP 125,126,127
AR 210,224
AR 211,225
AR 212,226
AR 213,227
AR 215,200
AR 217,201
v_lshlrev_b32 v214, 16, v215
v_and_b32 v215, 0xffff0000, v215
v_lshlrev_b32 v216, 16, v217
v_and_b32 v217, 0xffff0000, v217
v_pk_fma_f32 v[236:237], v[210:211], v[192:193], v[214:215] op_sel:[0,1,0] op_sel_hi:[1,1,1]
v_pk_fma_f32 v[238:239], v[212:213], v[192:193], v[216:217] op_sel:[0,1,0] op_sel_hi:[1,1,1]
v_pk_fma_f32 v[240:241], v[210:211], v[194:195], v[214:215] op_sel:[0,1,0] op_sel_hi:[1,1,1]
v_pk_fma_f32 v[242:243], v[212:213], v[194:195], v[216:217] op_sel:[0,1,0] op_sel_hi:[1,1,1]
v_pk_fma_f32 v[128:129], v[128:129], v[192:193], v[236:237] op_sel_hi:[1,0,1]
v_pk_fma_f32 v[130:131], v[130:131], v[192:193], v[238:239] op_sel_hi:[1,0,1]
v_pk_fma_f32 v[132:133], v[132:133], v[194:195], v[240:241] op_sel_hi:[1,0,1]
v_pk_fma_f32 v[134:135], v[134:135], v[194:195], v[242:243] op_sel_hi:[1,0,1]
v_pk_mul_f32 v[236:237], v[128:129], v[128:129]
v_pk_mul_f32 v[238:239], v[130:131], v[130:131]
v_pk_mul_f32 v[240:241], v[132:133], v[132:133]
v_pk_mul_f32 v[242:243], v[134:135], v[134:135]
v_pk_fma_f32 v[236:237], v[236:237], s[60:61], v[208:209] op_sel:[0,0,1] op_sel_hi:[1,1,1]
v_pk_fma_f32 v[238:239], v[238:239], s[60:61], v[208:209] op_sel:[0,0,1] op_sel_hi:[1,1,1]
v_pk_fma_f32 v[240:241], v[240:241], s[60:61], v[208:209] op_sel:[0,0,1] op_sel_hi:[1,1,1]
v_pk_fma_f32 v[242:243], v[242:243], s[60:61], v[208:209] op_sel:[0,0,1] op_sel_hi:[1,1,1]
v_pk_mul_f32 v[236:237], v[236:237], v[128:129]
v_pk_mul_f32 v[238:239], v[238:239], v[130:131]
v_pk_mul_f32 v[240:241], v[240:241], v[132:133]
v_pk_mul_f32 v[242:243], v[242:243], v[134:135]
v_exp_f32 v236, v236
v_exp_f32 v238, v238
v_exp_f32 v240, v240
v_exp_f32 v242, v242
v_exp_f32 v237, v237
v_exp_f32 v239, v239
v_exp_f32 v241, v241
v_exp_f32 v243, v243
v_pk_add_f32 v[236:237], v[236:237], 1.0 op_sel_hi:[1,0]
v_pk_add_f32 v[238:239], v[238:239], 1.0 op_sel_hi:[1,0]
v_pk_add_f32 v[240:241], v[240:241], 1.0 op_sel_hi:[1,0]
v_pk_add_f32 v[242:243], v[242:243], 1.0 op_sel_hi:[1,0]
v_rcp_f32 v236, v236
v_rcp_f32 v238, v238
v_rcp_f32 v240, v240
v_rcp_f32 v242, v242
v_rcp_f32 v237, v237
v_rcp_f32 v239, v239
v_rcp_f32 v241, v241
v_rcp_f32 v243, v243
v_pk_mul_f32 v[128:129], v[128:129], v[236:237]
v_pk_mul_f32 v[130:131], v[130:131], v[238:239]
v_pk_mul_f32 v[132:133], v[132:133], v[240:241]
v_pk_mul_f32 v[134:135], v[134:135], v[242:243]
CP 98,128,129
CP 99,130,131
CP 102,132,133
CP 103,134,135
s_add_u32 s3, s55, 5120
buffer_store_dwordx4 v[96:99], v208, s[8:11], s3 offen sc1
s_add_u32 s3, s55, 152576
buffer_store_dwordx4 v[100:103], v208, s[8:11], s3 offen sc1
v_pk_fma_f32 v[236:237], v[210:211], v[196:197], v[214:215] op_sel:[0,1,0] op_sel_hi:[1,1,1]
v_pk_fma_f32 v[238:239], v[212:213], v[196:197], v[216:217] op_sel:[0,1,0] op_sel_hi:[1,1,1]
v_pk_fma_f32 v[240:241], v[210:211], v[198:199], v[214:215] op_sel:[0,1,0] op_sel_hi:[1,1,1]
v_pk_fma_f32 v[242:243], v[212:213], v[198:199], v[216:217] op_sel:[0,1,0] op_sel_hi:[1,1,1]
v_pk_fma_f32 v[136:137], v[136:137], v[196:197], v[236:237] op_sel_hi:[1,0,1]
v_pk_fma_f32 v[138:139], v[138:139], v[196:197], v[238:239] op_sel_hi:[1,0,1]
v_pk_fma_f32 v[140:141], v[140:141], v[198:199], v[240:241] op_sel_hi:[1,0,1]
v_pk_fma_f32 v[142:143], v[142:143], v[198:199], v[242:243] op_sel_hi:[1,0,1]
v_pk_mul_f32 v[236:237], v[136:137], v[136:137]
v_pk_mul_f32 v[238:239], v[138:139], v[138:139]
v_pk_mul_f32 v[240:241], v[140:141], v[140:141]
v_pk_mul_f32 v[242:243], v[142:143], v[142:143]
v_pk_fma_f32 v[236:237], v[236:237], s[60:61], v[208:209] op_sel:[0,0,1] op_sel_hi:[1,1,1]
v_pk_fma_f32 v[238:239], v[238:239], s[60:61], v[208:209] op_sel:[0,0,1] op_sel_hi:[1,1,1]
v_pk_fma_f32 v[240:241], v[240:241], s[60:61], v[208:209] op_sel:[0,0,1] op_sel_hi:[1,1,1]
v_pk_fma_f32 v[242:243], v[242:243], s[60:61], v[208:209] op_sel:[0,0,1] op_sel_hi:[1,1,1]
v_pk_mul_f32 v[236:237], v[236:237], v[136:137]
v_pk_mul_f32 v[238:239], v[238:239], v[138:139]
v_pk_mul_f32 v[240:241], v[240:241], v[140:141]
v_pk_mul_f32 v[242:243], v[242:243], v[142:143]
v_exp_f32 v236, v236
v_exp_f32 v238, v238
v_exp_f32 v240, v240
v_exp_f32 v242, v242
v_exp_f32 v237, v237
v_exp_f32 v239, v239
v_exp_f32 v241, v241
v_exp_f32 v243, v243
v_pk_add_f32 v[236:237], v[236:237], 1.0 op_sel_hi:[1,0]
v_pk_add_f32 v[238:239], v[238:239], 1.0 op_sel_hi:[1,0]
v_pk_add_f32 v[240:241], v[240:241], 1.0 op_sel_hi:[1,0]
v_pk_add_f32 v[242:243], v[242:243], 1.0 op_sel_hi:[1,0]
v_rcp_f32 v236, v236
v_rcp_f32 v238, v238
v_rcp_f32 v240, v240
v_rcp_f32 v242, v242
v_rcp_f32 v237, v237
v_rcp_f32 v239, v239
v_rcp_f32 v241, v241
v_rcp_f32 v243, v243
v_pk_mul_f32 v[136:137], v[136:137], v[236:237]
v_pk_mul_f32 v[138:139], v[138:139], v[238:239]
v_pk_mul_f32 v[140:141], v[140:141], v[240:241]
v_pk_mul_f32 v[142:143], v[142:143], v[242:243]
CP 106,136,137
CP 107,138,139
CP 110,140,141
CP 111,142,143
s_add_u32 s3, s55, 300032
buffer_store_dwordx4 v[104:107], v208, s[8:11], s3 offen sc1
s_add_u32 s3, s55, 447488
buffer_store_dwordx4 v[108:111], v208, s[8:11], s3 offen sc1
v_pk_fma_f32 v[236:237], v[210:211], v[200:201], v[214:215] op_sel:[0,1,0] op_sel_hi:[1,1,1]
v_pk_fma_f32 v[238:239], v[212:213], v[200:201], v[216:217] op_sel:[0,1,0] op_sel_hi:[1,1,1]
v_pk_fma_f32 v[240:241], v[210:211], v[202:203], v[214:215] op_sel:[0,1,0] op_sel_hi:[1,1,1]
v_pk_fma_f32 v[242:243], v[212:213], v[202:203], v[216:217] op_sel:[0,1,0] op_sel_hi:[1,1,1]
v_pk_fma_f32 v[144:145], v[144:145], v[200:201], v[236:237] op_sel_hi:[1,0,1]
v_pk_fma_f32 v[146:147], v[146:147], v[200:201], v[238:239] op_sel_hi:[1,0,1]
v_pk_fma_f32 v[148:149], v[148:149], v[202:203], v[240:241] op_sel_hi:[1,0,1]
v_pk_fma_f32 v[150:151], v[150:151], v[202:203], v[242:243] op_sel_hi:[1,0,1]
v_pk_mul_f32 v[236:237], v[144:145], v[144:145]
v_pk_mul_f32 v[238:239], v[146:147], v[146:147]
v_pk_mul_f32 v[240:241], v[148:149], v[148:149]
v_pk_mul_f32 v[242:243], v[150:151], v[150:151]
v_pk_fma_f32 v[236:237], v[236:237], s[60:61], v[208:209] op_sel:[0,0,1] op_sel_hi:[1,1,1]
v_pk_fma_f32 v[238:239], v[238:239], s[60:61], v[208:209] op_sel:[0,0,1] op_sel_hi:[1,1,1]
v_pk_fma_f32 v[240:241], v[240:241], s[60:61], v[208:209] op_sel:[0,0,1] op_sel_hi:[1,1,1]
v_pk_fma_f32 v[242:243], v[242:243], s[60:61], v[208:209] op_sel:[0,0,1] op_sel_hi:[1,1,1]
v_pk_mul_f32 v[236:237], v[236:237], v[144:145]
v_pk_mul_f32 v[238:239], v[238:239], v[146:147]
v_pk_mul_f32 v[240:241], v[240:241], v[148:149]
v_pk_mul_f32 v[242:243], v[242:243], v[150:151]
v_exp_f32 v236, v236
v_exp_f32 v238, v238
v_exp_f32 v240, v240
v_exp_f32 v242, v242
v_exp_f32 v237, v237
v_exp_f32 v239, v239
v_exp_f32 v241, v241
v_exp_f32 v243, v243
v_pk_add_f32 v[236:237], v[236:237], 1.0 op_sel_hi:[1,0]
v_pk_add_f32 v[238:239], v[238:239], 1.0 op_sel_hi:[1,0]
v_pk_add_f32 v[240:241], v[240:241], 1.0 op_sel_hi:[1,0]
v_pk_add_f32 v[242:243], v[242:243], 1.0 op_sel_hi:[1,0]
v_rcp_f32 v236, v236
v_rcp_f32 v238, v238
v_rcp_f32 v240, v240
v_rcp_f32 v242, v242
v_rcp_f32 v237, v237
v_rcp_f32 v239, v239
v_rcp_f32 v241, v241
v_rcp_f32 v243, v243
v_pk_mul_f32 v[144:145], v[144:145], v[236:237]
v_pk_mul_f32 v[146:147], v[146:147], v[238:239]
v_pk_mul_f32 v[148:149], v[148:149], v[240:241]
v_pk_mul_f32 v[150:151], v[150:151], v[242:243]
CP 114,144,145
CP 115,146,147
CP 118,148,149
CP 119,150,151
s_add_u32 s3, s55, 594944
buffer_store_dwordx4 v[112:115], v208, s[8:11], s3 offen sc1
s_add_u32 s3, s55, 742400
buffer_store_dwordx4 v[116:119], v208, s[8:11], s3 offen sc1
v_pk_fma_f32 v[236:237], v[210:211], v[204:205], v[214:215] op_sel:[0,1,0] op_sel_hi:[1,1,1]
v_pk_fma_f32 v[238:239], v[212:213], v[204:205], v[216:217] op_sel:[0,1,0] op_sel_hi:[1,1,1]
v_pk_fma_f32 v[240:241], v[210:211], v[206:207], v[214:215] op_sel:[0,1,0] op_sel_hi:[1,1,1]
v_pk_fma_f32 v[242:243], v[212:213], v[206:207], v[216:217] op_sel:[0,1,0] op_sel_hi:[1,1,1]
v_pk_fma_f32 v[152:153], v[152:153], v[204:205], v[236:237] op_sel_hi:[1,0,1]
v_pk_fma_f32 v[154:155], v[154:155], v[204:205], v[238:239] op_sel_hi:[1,0,1]
v_pk_fma_f32 v[156:157], v[156:157], v[206:207], v[240:241] op_sel_hi:[1,0,1]
v_pk_fma_f32 v[158:159], v[158:159], v[206:207], v[242:243] op_sel_hi:[1,0,1]
v_pk_mul_f32 v[236:237], v[152:153], v[152:153]
v_pk_mul_f32 v[238:239], v[154:155], v[154:155]
v_pk_mul_f32 v[240:241], v[156:157], v[156:157]
v_pk_mul_f32 v[242:243], v[158:159], v[158:159]
v_pk_fma_f32 v[236:237], v[236:237], s[60:61], v[208:209] op_sel:[0,0,1] op_sel_hi:[1,1,1]
v_pk_fma_f32 v[238:239], v[238:239], s[60:61], v[208:209] op_sel:[0,0,1] op_sel_hi:[1,1,1]
v_pk_fma_f32 v[240:241], v[240:241], s[60:61], v[208:209] op_sel:[0,0,1] op_sel_hi:[1,1,1]
v_pk_fma_f32 v[242:243], v[242:243], s[60:61], v[208:209] op_sel:[0,0,1] op_sel_hi:[1,1,1]
v_pk_mul_f32 v[236:237], v[236:237], v[152:153]
v_pk_mul_f32 v[238:239], v[238:239], v[154:155]
v_pk_mul_f32 v[240:241], v[240:241], v[156:157]
v_pk_mul_f32 v[242:243], v[242:243], v[158:159]
v_exp_f32 v236, v236
v_exp_f32 v238, v238
v_exp_f32 v240, v240
v_exp_f32 v242, v242
v_exp_f32 v237, v237
v_exp_f32 v239, v239
v_exp_f32 v241, v241
v_exp_f32 v243, v243
v_pk_add_f32 v[236:237], v[236:237], 1.0 op_sel_hi:[1,0]
v_pk_add_f32 v[238:239], v[238:239], 1.0 op_sel_hi:[1,0]
v_pk_add_f32 v[240:241], v[240:241], 1.0 op_sel_hi:[1,0]
v_pk_add_f32 v[242:243], v[242:243], 1.0 op_sel_hi:[1,0]
v_rcp_f32 v236, v236
v_rcp_f32 v238, v238
v_rcp_f32 v240, v240
v_rcp_f32 v242, v242
v_rcp_f32 v237, v237
v_rcp_f32 v239, v239
v_rcp_f32 v241, v241
v_rcp_f32 v243, v243
v_pk_mul_f32 v[152:153], v[152:153], v[236:237]
v_pk_mul_f32 v[154:155], v[154:155], v[238:239]
v_pk_mul_f32 v[156:157], v[156:157], v[240:241]
v_pk_mul_f32 v[158:159], v[158:159], v[242:243]
CP 122,152,153
CP 123,154,155
CP 126,156,157
CP 127,158,159
s_add_u32 s3, s55, 889856
buffer_store_dwordx4 v[120:123], v208, s[8:11], s3 offen sc1
s_add_u32 s3, s55, 1037312
buffer_store_dwordx4 v[124:127], v208, s[8:11], s3 offen sc1
AR 210,228
AR 211,229
AR 212,230
AR 213,231
AR 215,202
AR 217,203
v_lshlrev_b32 v214, 16, v215
v_and_b32 v215, 0xffff0000, v215
v_lshlrev_b32 v216, 16, v217
v_and_b32 v217, 0xffff0000, v217
v_pk_fma_f32 v[236:237], v[210:211], v[192:193], v[214:215] op_sel:[0,1,0] op_sel_hi:[1,1,1]
v_pk_fma_f32 v[238:239], v[212:213], v[192:193], v[216:217] op_sel:[0,1,0] op_sel_hi:[1,1,1]
v_pk_fma_f32 v[240:241], v[210:211], v[194:195], v[214:215] op_sel:[0,1,0] op_sel_hi:[1,1,1]
v_pk_fma_f32 v[242:243], v[212:213], v[194:195], v[216:217] op_sel:[0,1,0] op_sel_hi:[1,1,1]
v_pk_fma_f32 v[160:161], v[160:161], v[192:193], v[236:237] op_sel_hi:[1,0,1]
v_pk_fma_f32 v[162:163], v[162:163], v[192:193], v[238:239] op_sel_hi:[1,0,1]
v_pk_fma_f32 v[164:165], v[164:165], v[194:195], v[240:241] op_sel_hi:[1,0,1]
v_pk_fma_f32 v[166:167], v[166:167], v[194:195], v[242:243] op_sel_hi:[1,0,1]
v_pk_mul_f32 v[236:237], v[160:161], v[160:161]
v_pk_mul_f32 v[238:239], v[162:163], v[162:163]
v_pk_mul_f32 v[240:241], v[164:165], v[164:165]
v_pk_mul_f32 v[242:243], v[166:167], v[166:167]
v_pk_fma_f32 v[236:237], v[236:237], s[60:61], v[208:209] op_sel:[0,0,1] op_sel_hi:[1,1,1]
v_pk_fma_f32 v[238:239], v[238:239], s[60:61], v[208:209] op_sel:[0,0,1] op_sel_hi:[1,1,1]
v_pk_fma_f32 v[240:241], v[240:241], s[60:61], v[208:209] op_sel:[0,0,1] op_sel_hi:[1,1,1]
v_pk_fma_f32 v[242:243], v[242:243], s[60:61], v[208:209] op_sel:[0,0,1] op_sel_hi:[1,1,1]
v_pk_mul_f32 v[236:237], v[236:237], v[160:161]
v_pk_mul_f32 v[238:239], v[238:239], v[162:163]
v_pk_mul_f32 v[240:241], v[240:241], v[164:165]
v_pk_mul_f32 v[242:243], v[242:243], v[166:167]
v_exp_f32 v236, v236
v_exp_f32 v238, v238
v_exp_f32 v240, v240
v_exp_f32 v242, v242
v_exp_f32 v237, v237
v_exp_f32 v239, v239
v_exp_f32 v241, v241
v_exp_f32 v243, v243
v_pk_add_f32 v[236:237], v[236:237], 1.0 op_sel_hi:[1,0]
v_pk_add_f32 v[238:239], v[238:239], 1.0 op_sel_hi:[1,0]
v_pk_add_f32 v[240:241], v[240:241], 1.0 op_sel_hi:[1,0]
v_pk_add_f32 v[242:243], v[242:243], 1.0 op_sel_hi:[1,0]
v_rcp_f32 v236, v236
v_rcp_f32 v238, v238
v_rcp_f32 v240, v240
v_rcp_f32 v242, v242
v_rcp_f32 v237, v237
v_rcp_f32 v239, v239
v_rcp_f32 v241, v241
v_rcp_f32 v243, v243
v_pk_mul_f32 v[160:161], v[160:161], v[236:237]
v_pk_mul_f32 v[162:163], v[162:163], v[238:239]
v_pk_mul_f32 v[164:165], v[164:165], v[240:241]
v_pk_mul_f32 v[166:167], v[166:167], v[242:243]
CP 160,160,161
CP 161,162,163
CP 164,164,165
CP 165,166,167
v_pk_fma_f32 v[236:237], v[210:211], v[196:197], v[214:215] op_sel:[0,1,0] op_sel_hi:[1,1,1]
v_pk_fma_f32 v[238:239], v[212:213], v[196:197], v[216:217] op_sel:[0,1,0] op_sel_hi:[1,1,1]
v_pk_fma_f32 v[240:241], v[210:211], v[198:199], v[214:215] op_sel:[0,1,0] op_sel_hi:[1,1,1]
v_pk_fma_f32 v[242:243], v[212:213], v[198:199], v[216:217] op_sel:[0,1,0] op_sel_hi:[1,1,1]
v_pk_fma_f32 v[168:169], v[168:169], v[196:197], v[236:237] op_sel_hi:[1,0,1]
v_pk_fma_f32 v[170:171], v[170:171], v[196:197], v[238:239] op_sel_hi:[1,0,1]
v_pk_fma_f32 v[172:173], v[172:173], v[198:199], v[240:241] op_sel_hi:[1,0,1]
v_pk_fma_f32 v[174:175], v[174:175], v[198:199], v[242:243] op_sel_hi:[1,0,1]
v_pk_mul_f32 v[236:237], v[168:169], v[168:169]
v_pk_mul_f32 v[238:239], v[170:171], v[170:171]
v_pk_mul_f32 v[240:241], v[172:173], v[172:173]
v_pk_mul_f32 v[242:243], v[174:175], v[174:175]
v_pk_fma_f32 v[236:237], v[236:237], s[60:61], v[208:209] op_sel:[0,0,1] op_sel_hi:[1,1,1]
v_pk_fma_f32 v[238:239], v[238:239], s[60:61], v[208:209] op_sel:[0,0,1] op_sel_hi:[1,1,1]
v_pk_fma_f32 v[240:241], v[240:241], s[60:61], v[208:209] op_sel:[0,0,1] op_sel_hi:[1,1,1]
v_pk_fma_f32 v[242:243], v[242:243], s[60:61], v[208:209] op_sel:[0,0,1] op_sel_hi:[1,1,1]
v_pk_mul_f32 v[236:237], v[236:237], v[168:169]
v_pk_mul_f32 v[238:239], v[238:239], v[170:171]
v_pk_mul_f32 v[240:241], v[240:241], v[172:173]
v_pk_mul_f32 v[242:243], v[242:243], v[174:175]
v_exp_f32 v236, v236
v_exp_f32 v238, v238
v_exp_f32 v240, v240
v_exp_f32 v242, v242
v_exp_f32 v237, v237
v_exp_f32 v239, v239
v_exp_f32 v241, v241
v_exp_f32 v243, v243
v_pk_add_f32 v[236:237], v[236:237], 1.0 op_sel_hi:[1,0]
v_pk_add_f32 v[238:239], v[238:239], 1.0 op_sel_hi:[1,0]
v_pk_add_f32 v[240:241], v[240:241], 1.0 op_sel_hi:[1,0]
v_pk_add_f32 v[242:243], v[242:243], 1.0 op_sel_hi:[1,0]
v_rcp_f32 v236, v236
v_rcp_f32 v238, v238
v_rcp_f32 v240, v240
v_rcp_f32 v242, v242
v_rcp_f32 v237, v237
v_rcp_f32 v239, v239
v_rcp_f32 v241, v241
v_rcp_f32 v243, v243
v_pk_mul_f32 v[168:169], v[168:169], v[236:237]
v_pk_mul_f32 v[170:171], v[170:171], v[238:239]
v_pk_mul_f32 v[172:173], v[172:173], v[240:241]
v_pk_mul_f32 v[174:175], v[174:175], v[242:243]
CP 168,168,169
CP 169,170,171
CP 172,172,173
CP 173,174,175
v_pk_fma_f32 v[236:237], v[210:211], v[200:201], v[214:215] op_sel:[0,1,0] op_sel_hi:[1,1,1]
v_pk_fma_f32 v[238:239], v[212:213], v[200:201], v[216:217] op_sel:[0,1,0] op_sel_hi:[1,1,1]
v_pk_fma_f32 v[240:241], v[210:211], v[202:203], v[214:215] op_sel:[0,1,0] op_sel_hi:[1,1,1]
v_pk_fma_f32 v[242:243], v[212:213], v[202:203], v[216:217] op_sel:[0,1,0] op_sel_hi:[1,1,1]
v_pk_fma_f32 v[176:177], v[176:177], v[200:201], v[236:237] op_sel_hi:[1,0,1]
v_pk_fma_f32 v[178:179], v[178:179], v[200:201], v[238:239] op_sel_hi:[1,0,1]
v_pk_fma_f32 v[180:181], v[180:181], v[202:203], v[240:241] op_sel_hi:[1,0,1]
v_pk_fma_f32 v[182:183], v[182:183], v[202:203], v[242:243] op_sel_hi:[1,0,1]
v_pk_mul_f32 v[236:237], v[176:177], v[176:177]
v_pk_mul_f32 v[238:239], v[178:179], v[178:179]
v_pk_mul_f32 v[240:241], v[180:181], v[180:181]
v_pk_mul_f32 v[242:243], v[182:183], v[182:183]
v_pk_fma_f32 v[236:237], v[236:237], s[60:61], v[208:209] op_sel:[0,0,1] op_sel_hi:[1,1,1]
v_pk_fma_f32 v[238:239], v[238:239], s[60:61], v[208:209] op_sel:[0,0,1] op_sel_hi:[1,1,1]
v_pk_fma_f32 v[240:241], v[240:241], s[60:61], v[208:209] op_sel:[0,0,1] op_sel_hi:[1,1,1]
v_pk_fma_f32 v[242:243], v[242:243], s[60:61], v[208:209] op_sel:[0,0,1] op_sel_hi:[1,1,1]
v_pk_mul_f32 v[236:237], v[236:237], v[176:177]
v_pk_mul_f32 v[238:239], v[238:239], v[178:179]
v_pk_mul_f32 v[240:241], v[240:241], v[180:181]
v_pk_mul_f32 v[242:243], v[242:243], v[182:183]
v_exp_f32 v236, v236
v_exp_f32 v238, v238
v_exp_f32 v240, v240
v_exp_f32 v242, v242
v_exp_f32 v237, v237
v_exp_f32 v239, v239
v_exp_f32 v241, v241
v_exp_f32 v243, v243
v_pk_add_f32 v[236:237], v[236:237], 1.0 op_sel_hi:[1,0]
v_pk_add_f32 v[238:239], v[238:239], 1.0 op_sel_hi:[1,0]
v_pk_add_f32 v[240:241], v[240:241], 1.0 op_sel_hi:[1,0]
v_pk_add_f32 v[242:243], v[242:243], 1.0 op_sel_hi:[1,0]
v_rcp_f32 v236, v236
v_rcp_f32 v238, v238
v_rcp_f32 v240, v240
v_rcp_f32 v242, v242
v_rcp_f32 v237, v237
v_rcp_f32 v239, v239
v_rcp_f32 v241, v241
v_rcp_f32 v243, v243
v_pk_mul_f32 v[176:177], v[176:177], v[236:237]
v_pk_mul_f32 v[178:179], v[178:179], v[238:239]
v_pk_mul_f32 v[180:181], v[180:181], v[240:241]
v_pk_mul_f32 v[182:183], v[182:183], v[242:243]
CP 176,176,177
CP 177,178,179
CP 180,180,181
CP 181,182,183
v_pk_fma_f32 v[236:237], v[210:211], v[204:205], v[214:215] op_sel:[0,1,0] op_sel_hi:[1,1,1]
v_pk_fma_f32 v[238:239], v[212:213], v[204:205], v[216:217] op_sel:[0,1,0] op_sel_hi:[1,1,1]
v_pk_fma_f32 v[240:241], v[210:211], v[206:207], v[214:215] op_sel:[0,1,0] op_sel_hi:[1,1,1]
v_pk_fma_f32 v[242:243], v[212:213], v[206:207], v[216:217] op_sel:[0,1,0] op_sel_hi:[1,1,1]
v_pk_fma_f32 v[184:185], v[184:185], v[204:205], v[236:237] op_sel_hi:[1,0,1]
v_pk_fma_f32 v[186:187], v[186:187], v[204:205], v[238:239] op_sel_hi:[1,0,1]
v_pk_fma_f32 v[188:189], v[188:189], v[206:207], v[240:241] op_sel_hi:[1,0,1]
v_pk_fma_f32 v[190:191], v[190:191], v[206:207], v[242:243] op_sel_hi:[1,0,1]
v_pk_mul_f32 v[236:237], v[184:185], v[184:185]
v_pk_mul_f32 v[238:239], v[186:187], v[186:187]
v_pk_mul_f32 v[240:241], v[188:189], v[188:189]
v_pk_mul_f32 v[242:243], v[190:191], v[190:191]
v_pk_fma_f32 v[236:237], v[236:237], s[60:61], v[208:209] op_sel:[0,0,1] op_sel_hi:[1,1,1]
v_pk_fma_f32 v[238:239], v[238:239], s[60:61], v[208:209] op_sel:[0,0,1] op_sel_hi:[1,1,1]
v_pk_fma_f32 v[240:241], v[240:241], s[60:61], v[208:209] op_sel:[0,0,1] op_sel_hi:[1,1,1]
v_pk_fma_f32 v[242:243], v[242:243], s[60:61], v[208:209] op_sel:[0,0,1] op_sel_hi:[1,1,1]
v_pk_mul_f32 v[236:237], v[236:237], v[184:185]
v_pk_mul_f32 v[238:239], v[238:239], v[186:187]
v_pk_mul_f32 v[240:241], v[240:241], v[188:189]
v_pk_mul_f32 v[242:243], v[242:243], v[190:191]
v_exp_f32 v236, v236
v_exp_f32 v238, v238
v_exp_f32 v240, v240
v_exp_f32 v242, v242
v_exp_f32 v237, v237
v_exp_f32 v239, v239
v_exp_f32 v241, v241
v_exp_f32 v243, v243
v_pk_add_f32 v[236:237], v[236:237], 1.0 op_sel_hi:[1,0]
v_pk_add_f32 v[238:239], v[238:239], 1.0 op_sel_hi:[1,0]
v_pk_add_f32 v[240:241], v[240:241], 1.0 op_sel_hi:[1,0]
v_pk_add_f32 v[242:243], v[242:243], 1.0 op_sel_hi:[1,0]
v_rcp_f32 v236, v236
v_rcp_f32 v238, v238
v_rcp_f32 v240, v240
v_rcp_f32 v242, v242
v_rcp_f32 v237, v237
v_rcp_f32 v239, v239
v_rcp_f32 v241, v241
v_rcp_f32 v243, v243
v_pk_mul_f32 v[184:185], v[184:185], v[236:237]
v_pk_mul_f32 v[186:187], v[186:187], v[238:239]
v_pk_mul_f32 v[188:189], v[188:189], v[240:241]
v_pk_mul_f32 v[190:191], v[190:191], v[242:243]
CP 184,184,185
CP 185,186,187
CP 188,188,189
CP 189,190,191
AR 210,232
AR 211,233
AR 212,234
AR 213,235
AR 215,204
AR 217,205
v_lshlrev_b32 v214, 16, v215
v_and_b32 v215, 0xffff0000, v215
v_lshlrev_b32 v216, 16, v217
v_and_b32 v217, 0xffff0000, v217
AR 244,128
AR 245,129
AR 246,130
AR 247,131
AR 248,132
AR 249,133
AR 250,134
AR 251,135
v_pk_fma_f32 v[236:237], v[210:211], v[192:193], v[214:215] op_sel:[0,1,0] op_sel_hi:[1,1,1]
v_pk_fma_f32 v[238:239], v[212:213], v[192:193], v[216:217] op_sel:[0,1,0] op_sel_hi:[1,1,1]
v_pk_fma_f32 v[240:241], v[210:211], v[194:195], v[214:215] op_sel:[0,1,0] op_sel_hi:[1,1,1]
v_pk_fma_f32 v[242:243], v[212:213], v[194:195], v[216:217] op_sel:[0,1,0] op_sel_hi:[1,1,1]
v_pk_fma_f32 v[244:245], v[244:245], v[192:193], v[236:237] op_sel_hi:[1,0,1]
v_pk_fma_f32 v[246:247], v[246:247], v[192:193], v[238:239] op_sel_hi:[1,0,1]
v_pk_fma_f32 v[248:249], v[248:249], v[194:195], v[240:241] op_sel_hi:[1,0,1]
v_pk_fma_f32 v[250:251], v[250:251], v[194:195], v[242:243] op_sel_hi:[1,0,1]
v_pk_mul_f32 v[236:237], v[244:245], v[244:245]
v_pk_mul_f32 v[238:239], v[246:247], v[246:247]
v_pk_mul_f32 v[240:241], v[248:249], v[248:249]
v_pk_mul_f32 v[242:243], v[250:251], v[250:251]
v_pk_fma_f32 v[236:237], v[236:237], s[60:61], v[208:209] op_sel:[0,0,1] op_sel_hi:[1,1,1]
v_pk_fma_f32 v[238:239], v[238:239], s[60:61], v[208:209] op_sel:[0,0,1] op_sel_hi:[1,1,1]
v_pk_fma_f32 v[240:241], v[240:241], s[60:61], v[208:209] op_sel:[0,0,1] op_sel_hi:[1,1,1]
v_pk_fma_f32 v[242:243], v[242:243], s[60:61], v[208:209] op_sel:[0,0,1] op_sel_hi:[1,1,1]
v_pk_mul_f32 v[236:237], v[236:237], v[244:245]
v_pk_mul_f32 v[238:239], v[238:239], v[246:247]
v_pk_mul_f32 v[240:241], v[240:241], v[248:249]
v_pk_mul_f32 v[242:243], v[242:243], v[250:251]
v_exp_f32 v236, v236
v_exp_f32 v238, v238
v_exp_f32 v240, v240
v_exp_f32 v242, v242
v_exp_f32 v237, v237
v_exp_f32 v239, v239
v_exp_f32 v241, v241
v_exp_f32 v243, v243
v_pk_add_f32 v[236:237], v[236:237], 1.0 op_sel_hi:[1,0]
v_pk_add_f32 v[238:239], v[238:239], 1.0 op_sel_hi:[1,0]
v_pk_add_f32 v[240:241], v[240:241], 1.0 op_sel_hi:[1,0]
v_pk_add_f32 v[242:243], v[242:243], 1.0 op_sel_hi:[1,0]
v_rcp_f32 v236, v236
v_rcp_f32 v238, v238
v_rcp_f32 v240, v240
v_rcp_f32 v242, v242
v_rcp_f32 v237, v237
v_rcp_f32 v239, v239
v_rcp_f32 v241, v241
v_rcp_f32 v243, v243
v_pk_mul_f32 v[244:245], v[244:245], v[236:237]
v_pk_mul_f32 v[246:247], v[246:247], v[238:239]
v_pk_mul_f32 v[248:249], v[248:249], v[240:241]
v_pk_mul_f32 v[250:251], v[250:251], v[242:243]
CP 162,244,245
CP 163,246,247
CP 166,248,249
CP 167,250,251
s_add_u32 s3, s56, 0
buffer_store_dwordx4 v[160:163], v208, s[8:11], s3 offen sc1
s_add_u32 s3, s56, 147456
buffer_store_dwordx4 v[164:167], v208, s[8:11], s3 offen sc1
AR 244,136
AR 245,137
AR 246,138
AR 247,139
AR 248,140
AR 249,141
AR 250,142
AR 251,143
v_pk_fma_f32 v[236:237], v[210:211], v[196:197], v[214:215] op_sel:[0,1,0] op_sel_hi:[1,1,1]
v_pk_fma_f32 v[238:239], v[212:213], v[196:197], v[216:217] op_sel:[0,1,0] op_sel_hi:[1,1,1]
v_pk_fma_f32 v[240:241], v[210:211], v[198:199], v[214:215] op_sel:[0,1,0] op_sel_hi:[1,1,1]
v_pk_fma_f32 v[242:243], v[212:213], v[198:199], v[216:217] op_sel:[0,1,0] op_sel_hi:[1,1,1]
v_pk_fma_f32 v[244:245], v[244:245], v[196:197], v[236:237] op_sel_hi:[1,0,1]
v_pk_fma_f32 v[246:247], v[246:247], v[196:197], v[238:239] op_sel_hi:[1,0,1]
v_pk_fma_f32 v[248:249], v[248:249], v[198:199], v[240:241] op_sel_hi:[1,0,1]
v_pk_fma_f32 v[250:251], v[250:251], v[198:199], v[242:243] op_sel_hi:[1,0,1]
v_pk_mul_f32 v[236:237], v[244:245], v[244:245]
v_pk_mul_f32 v[238:239], v[246:247], v[246:247]
v_pk_mul_f32 v[240:241], v[248:249], v[248:249]
v_pk_mul_f32 v[242:243], v[250:251], v[250:251]
v_pk_fma_f32 v[236:237], v[236:237], s[60:61], v[208:209] op_sel:[0,0,1] op_sel_hi:[1,1,1]
v_pk_fma_f32 v[238:239], v[238:239], s[60:61], v[208:209] op_sel:[0,0,1] op_sel_hi:[1,1,1]
v_pk_fma_f32 v[240:241], v[240:241], s[60:61], v[208:209] op_sel:[0,0,1] op_sel_hi:[1,1,1]
v_pk_fma_f32 v[242:243], v[242:243], s[60:61], v[208:209] op_sel:[0,0,1] op_sel_hi:[1,1,1]
v_pk_mul_f32 v[236:237], v[236:237], v[244:245]
v_pk_mul_f32 v[238:239], v[238:239], v[246:247]
v_pk_mul_f32 v[240:241], v[240:241], v[248:249]
v_pk_mul_f32 v[242:243], v[242:243], v[250:251]
v_exp_f32 v236, v236
v_exp_f32 v238, v238
v_exp_f32 v240, v240
v_exp_f32 v242, v242
v_exp_f32 v237, v237
v_exp_f32 v239, v239
v_exp_f32 v241, v241
v_exp_f32 v243, v243
v_pk_add_f32 v[236:237], v[236:237], 1.0 op_sel_hi:[1,0]
v_pk_add_f32 v[238:239], v[238:239], 1.0 op_sel_hi:[1,0]
v_pk_add_f32 v[240:241], v[240:241], 1.0 op_sel_hi:[1,0]
v_pk_add_f32 v[242:243], v[242:243], 1.0 op_sel_hi:[1,0]
v_rcp_f32 v236, v236
v_rcp_f32 v238, v238
v_rcp_f32 v240, v240
v_rcp_f32 v242, v242
v_rcp_f32 v237, v237
v_rcp_f32 v239, v239
v_rcp_f32 v241, v241
v_rcp_f32 v243, v243
v_pk_mul_f32 v[244:245], v[244:245], v[236:237]
v_pk_mul_f32 v[246:247], v[246:247], v[238:239]
v_pk_mul_f32 v[248:249], v[248:249], v[240:241]
v_pk_mul_f32 v[250:251], v[250:251], v[242:243]
CP 170,244,245
CP 171,246,247
CP 174,248,249
CP 175,250,251
s_add_u32 s3, s56, 294912
buffer_store_dwordx4 v[168:171], v208, s[8:11], s3 offen sc1
s_add_u32 s3, s56, 442368
buffer_store_dwordx4 v[172:175], v208, s[8:11], s3 offen sc1
AR 244,144
AR 245,145
AR 246,146
AR 247,147
AR 248,148
AR 249,149
AR 250,150
AR 251,151
v_pk_fma_f32 v[236:237], v[210:211], v[200:201], v[214:215] op_sel:[0,1,0] op_sel_hi:[1,1,1]
v_pk_fma_f32 v[238:239], v[212:213], v[200:201], v[216:217] op_sel:[0,1,0] op_sel_hi:[1,1,1]
v_pk_fma_f32 v[240:241], v[210:211], v[202:203], v[214:215] op_sel:[0,1,0] op_sel_hi:[1,1,1]
v_pk_fma_f32 v[242:243], v[212:213], v[202:203], v[216:217] op_sel:[0,1,0] op_sel_hi:[1,1,1]
v_pk_fma_f32 v[244:245], v[244:245], v[200:201], v[236:237] op_sel_hi:[1,0,1]
v_pk_fma_f32 v[246:247], v[246:247], v[200:201], v[238:239] op_sel_hi:[1,0,1]
v_pk_fma_f32 v[248:249], v[248:249], v[202:203], v[240:241] op_sel_hi:[1,0,1]
v_pk_fma_f32 v[250:251], v[250:251], v[202:203], v[242:243] op_sel_hi:[1,0,1]
v_pk_mul_f32 v[236:237], v[244:245], v[244:245]
v_pk_mul_f32 v[238:239], v[246:247], v[246:247]
v_pk_mul_f32 v[240:241], v[248:249], v[248:249]
v_pk_mul_f32 v[242:243], v[250:251], v[250:251]
v_pk_fma_f32 v[236:237], v[236:237], s[60:61], v[208:209] op_sel:[0,0,1] op_sel_hi:[1,1,1]
v_pk_fma_f32 v[238:239], v[238:239], s[60:61], v[208:209] op_sel:[0,0,1] op_sel_hi:[1,1,1]
v_pk_fma_f32 v[240:241], v[240:241], s[60:61], v[208:209] op_sel:[0,0,1] op_sel_hi:[1,1,1]
v_pk_fma_f32 v[242:243], v[242:243], s[60:61], v[208:209] op_sel:[0,0,1] op_sel_hi:[1,1,1]
v_pk_mul_f32 v[236:237], v[236:237], v[244:245]
v_pk_mul_f32 v[238:239], v[238:239], v[246:247]
v_pk_mul_f32 v[240:241], v[240:241], v[248:249]
v_pk_mul_f32 v[242:243], v[242:243], v[250:251]
v_exp_f32 v236, v236
v_exp_f32 v238, v238
v_exp_f32 v240, v240
v_exp_f32 v242, v242
v_exp_f32 v237, v237
v_exp_f32 v239, v239
v_exp_f32 v241, v241
v_exp_f32 v243, v243
v_pk_add_f32 v[236:237], v[236:237], 1.0 op_sel_hi:[1,0]
v_pk_add_f32 v[238:239], v[238:239], 1.0 op_sel_hi:[1,0]
v_pk_add_f32 v[240:241], v[240:241], 1.0 op_sel_hi:[1,0]
v_pk_add_f32 v[242:243], v[242:243], 1.0 op_sel_hi:[1,0]
v_rcp_f32 v236, v236
v_rcp_f32 v238, v238
v_rcp_f32 v240, v240
v_rcp_f32 v242, v242
v_rcp_f32 v237, v237
v_rcp_f32 v239, v239
v_rcp_f32 v241, v241
v_rcp_f32 v243, v243
v_pk_mul_f32 v[244:245], v[244:245], v[236:237]
v_pk_mul_f32 v[246:247], v[246:247], v[238:239]
v_pk_mul_f32 v[248:249], v[248:249], v[240:241]
v_pk_mul_f32 v[250:251], v[250:251], v[242:243]
CP 178,244,245
CP 179,246,247
CP 182,248,249
CP 183,250,251
s_add_u32 s3, s56, 589824
buffer_store_dwordx4 v[176:179], v208, s[8:11], s3 offen sc1
s_add_u32 s3, s56, 737280
buffer_store_dwordx4 v[180:183], v208, s[8:11], s3 offen sc1
AR 244,152
AR 245,153
AR 246,154
AR 247,155
AR 248,156
AR 249,157
AR 250,158
AR 251,159
v_pk_fma_f32 v[236:237], v[210:211], v[204:205], v[214:215] op_sel:[0,1,0] op_sel_hi:[1,1,1]
v_pk_fma_f32 v[238:239], v[212:213], v[204:205], v[216:217] op_sel:[0,1,0] op_sel_hi:[1,1,1]
v_pk_fma_f32 v[240:241], v[210:211], v[206:207], v[214:215] op_sel:[0,1,0] op_sel_hi:[1,1,1]
v_pk_fma_f32 v[242:243], v[212:213], v[206:207], v[216:217] op_sel:[0,1,0] op_sel_hi:[1,1,1]
v_pk_fma_f32 v[244:245], v[244:245], v[204:205], v[236:237] op_sel_hi:[1,0,1]
v_pk_fma_f32 v[246:247], v[246:247], v[204:205], v[238:239] op_sel_hi:[1,0,1]
v_pk_fma_f32 v[248:249], v[248:249], v[206:207], v[240:241] op_sel_hi:[1,0,1]
v_pk_fma_f32 v[250:251], v[250:251], v[206:207], v[242:243] op_sel_hi:[1,0,1]
v_pk_mul_f32 v[236:237], v[244:245], v[244:245]
v_pk_mul_f32 v[238:239], v[246:247], v[246:247]
v_pk_mul_f32 v[240:241], v[248:249], v[248:249]
v_pk_mul_f32 v[242:243], v[250:251], v[250:251]
v_pk_fma_f32 v[236:237], v[236:237], s[60:61], v[208:209] op_sel:[0,0,1] op_sel_hi:[1,1,1]
v_pk_fma_f32 v[238:239], v[238:239], s[60:61], v[208:209] op_sel:[0,0,1] op_sel_hi:[1,1,1]
v_pk_fma_f32 v[240:241], v[240:241], s[60:61], v[208:209] op_sel:[0,0,1] op_sel_hi:[1,1,1]
v_pk_fma_f32 v[242:243], v[242:243], s[60:61], v[208:209] op_sel:[0,0,1] op_sel_hi:[1,1,1]
v_pk_mul_f32 v[236:237], v[236:237], v[244:245]
v_pk_mul_f32 v[238:239], v[238:239], v[246:247]
v_pk_mul_f32 v[240:241], v[240:241], v[248:249]
v_pk_mul_f32 v[242:243], v[242:243], v[250:251]
v_exp_f32 v236, v236
v_exp_f32 v238, v238
v_exp_f32 v240, v240
v_exp_f32 v242, v242
v_exp_f32 v237, v237
v_exp_f32 v239, v239
v_exp_f32 v241, v241
v_exp_f32 v243, v243
v_pk_add_f32 v[236:237], v[236:237], 1.0 op_sel_hi:[1,0]
v_pk_add_f32 v[238:239], v[238:239], 1.0 op_sel_hi:[1,0]
v_pk_add_f32 v[240:241], v[240:241], 1.0 op_sel_hi:[1,0]
v_pk_add_f32 v[242:243], v[242:243], 1.0 op_sel_hi:[1,0]
v_rcp_f32 v236, v236
v_rcp_f32 v238, v238
v_rcp_f32 v240, v240
v_rcp_f32 v242, v242
v_rcp_f32 v237, v237
v_rcp_f32 v239, v239
v_rcp_f32 v241, v241
v_rcp_f32 v243, v243
v_pk_mul_f32 v[244:245], v[244:245], v[236:237]
v_pk_mul_f32 v[246:247], v[246:247], v[238:239]
v_pk_mul_f32 v[248:249], v[248:249], v[240:241]
v_pk_mul_f32 v[250:251], v[250:251], v[242:243]
CP 186,244,245
CP 187,246,247
CP 190,248,249
CP 191,250,251
s_add_u32 s3, s56, 884736
buffer_store_dwordx4 v[184:187], v208, s[8:11], s3 offen sc1
s_add_u32 s3, s56, 1032192
buffer_store_dwordx4 v[188:191], v208, s[8:11], s3 offen sc1
s_add_u32 s72, s44, 16
s_lshl_b32 s72, s72, 7
s_branch k1_done
k1_qkv_epi:
v_lshrrev_b32 v210, 4, v206
v_bfe_u32 v211, v206, 2, 2
v_lshl_add_u32 v211, v210, 2, v211
v_and_b32 v212, 3, v206
v_lshlrev_b32 v212, 3, v212
v_lshl_add_u32 v213, v211, 6, v212
s_lshl_b32 s3, s53, 11
s_add_u32 s3, s3, 147456
v_add_u32 v213, s3, v213
TR 0,213,0
TR 2,213,1024
TR 4,213,32
TR 6,213,1056
s_mul_i32 s55, s53, 57344
v_and_b32 v214, 15, v206
s_lshl_b32 s3, s52, 7
v_add_u32 v214, s3, v214
v_mul_u32_u24 v214, 224, v214
v_bfe_u32 v215, v206, 2, 2
v_xor_b32 v215, v215, v210
v_lshl_add_u32 v214, v215, 3, v214
v_add_u32 v192, s55, v214
v_mul_u32_u24 v214, 224, v211
v_and_b32 v215, 3, v206
v_xor_b32 v215, v215, v210
v_lshl_add_u32 v214, v215, 3, v214
v_add_u32 v214, s55, v214
v_add_u32 v194, 128, v214
s_lshl_b32 s3, s52, 6
v_add_u32 v193, s3, v214
s_mov_b32 s60, 0x3fb8aa3b
s_mov_b32 s61, 0xbfb8aa3b
v_mov_b32 v250, 0
global_load_dword v251, v250, s[38:39] sc1
s_waitcnt lgkmcnt(0)
CP 240,64,65
CP 244,68,69
CP 241,66,67
CP 245,70,71
CP 242,96,97
CP 246,100,101
CP 243,98,99
CP 247,102,103
s_nop 0
v_mfma_f32_16x16x32_bf16 v[64:67], a[0:3], v[240:243], 0
v_mfma_f32_16x16x32_bf16 v[68:71], a[0:3], v[244:247], 0
v_mfma_f32_16x16x32_bf16 v[96:99], a[4:7], v[240:243], 0
v_mfma_f32_16x16x32_bf16 v[100:103], a[4:7], v[244:247], 0
CP 240,72,73
CP 244,76,77
CP 241,74,75
CP 245,78,79
CP 242,104,105
CP 246,108,109
CP 243,106,107
CP 247,110,111
s_nop 0
v_mfma_f32_16x16x32_bf16 v[72:75], a[0:3], v[240:243], 0
v_mfma_f32_16x16x32_bf16 v[76:79], a[0:3], v[244:247], 0
v_mfma_f32_16x16x32_bf16 v[104:107], a[4:7], v[240:243], 0
v_mfma_f32_16x16x32_bf16 v[108:111], a[4:7], v[244:247], 0
v_max3_f32 v216, v64, v65, v66
v_max3_f32 v232, v68, v69, v70
v_min3_f32 v217, v64, v65, v66
v_min3_f32 v233, v68, v69, v70
v_max3_f32 v216, v216, v67, v96
v_max3_f32 v232, v232, v71, v100
v_min3_f32 v217, v217, v67, v96
v_min3_f32 v233, v233, v71, v100
v_max3_f32 v216, v216, v97, v98
v_max3_f32 v232, v232, v101, v102
v_min3_f32 v217, v217, v97, v98
v_min3_f32 v233, v233, v101, v102
v_max_f32 v216, v216, v99
v_max_f32 v232, v232, v103
v_min_f32 v217, v217, v99
v_min_f32 v233, v233, v103
v_mov_b64 v[218:219], v[216:217]
v_mov_b64 v[234:235], v[232:233]
s_nop 0
v_permlane16_swap_b32 v218, v216
v_permlane16_swap_b32 v234, v232
v_permlane16_swap_b32 v219, v217
v_permlane16_swap_b32 v235, v233
v_max_f32 v216, v216, v218
v_max_f32 v232, v232, v234
v_min_f32 v217, v217, v219
v_min_f32 v233, v233, v235
v_mov_b64 v[218:219], v[216:217]
v_mov_b64 v[234:235], v[232:233]
s_nop 0
v_permlane32_swap_b32 v218, v216
v_permlane32_swap_b32 v234, v232
v_permlane32_swap_b32 v219, v217
v_permlane32_swap_b32 v235, v233
v_max_f32 v216, v216, v218
v_max_f32 v232, v232, v234
v_min_f32 v217, v217, v219
v_min_f32 v233, v233, v235
v_pk_mul_f32 v[216:217], v[216:217], s[60:61] op_sel:[0,1] op_sel_hi:[1,0]
v_pk_mul_f32 v[232:233], v[232:233], s[60:61] op_sel:[0,1] op_sel_hi:[1,0]
v_pk_fma_f32 v[208:209], v[64:65], s[60:61], v[216:217] op_sel_hi:[1,0,0]
v_pk_fma_f32 v[224:225], v[68:69], s[60:61], v[232:233] op_sel_hi:[1,0,0]
v_pk_fma_f32 v[210:211], v[66:67], s[60:61], v[216:217] op_sel_hi:[1,0,0]
v_pk_fma_f32 v[226:227], v[70:71], s[60:61], v[232:233] op_sel_hi:[1,0,0]
v_pk_fma_f32 v[212:213], v[96:97], s[60:61], v[216:217] op_sel_hi:[1,0,0]
v_pk_fma_f32 v[228:229], v[100:101], s[60:61], v[232:233] op_sel_hi:[1,0,0]
v_pk_fma_f32 v[214:215], v[98:99], s[60:61], v[216:217] op_sel_hi:[1,0,0]
v_pk_fma_f32 v[230:231], v[102:103], s[60:61], v[232:233] op_sel_hi:[1,0,0]
v_pk_fma_f32 v[64:65], v[64:65], s[60:61], v[216:217] op_sel:[0,1,1] op_sel_hi:[1,1,1]
v_pk_fma_f32 v[68:69], v[68:69], s[60:61], v[232:233] op_sel:[0,1,1] op_sel_hi:[1,1,1]
v_pk_fma_f32 v[66:67], v[66:67], s[60:61], v[216:217] op_sel:[0,1,1] op_sel_hi:[1,1,1]
v_pk_fma_f32 v[70:71], v[70:71], s[60:61], v[232:233] op_sel:[0,1,1] op_sel_hi:[1,1,1]
v_pk_fma_f32 v[96:97], v[96:97], s[60:61], v[216:217] op_sel:[0,1,1] op_sel_hi:[1,1,1]
v_pk_fma_f32 v[100:101], v[100:101], s[60:61], v[232:233] op_sel:[0,1,1] op_sel_hi:[1,1,1]
v_pk_fma_f32 v[98:99], v[98:99], s[60:61], v[216:217] op_sel:[0,1,1] op_sel_hi:[1,1,1]
v_pk_fma_f32 v[102:103], v[102:103], s[60:61], v[232:233] op_sel:[0,1,1] op_sel_hi:[1,1,1]
v_exp_f32 v208, v208
v_exp_f32 v224, v224
v_exp_f32 v209, v209
v_exp_f32 v225, v225
v_exp_f32 v210, v210
v_exp_f32 v226, v226
v_exp_f32 v211, v211
v_exp_f32 v227, v227
v_exp_f32 v212, v212
v_exp_f32 v228, v228
v_exp_f32 v213, v213
v_exp_f32 v229, v229
v_exp_f32 v214, v214
v_exp_f32 v230, v230
v_exp_f32 v215, v215
v_exp_f32 v231, v231
v_exp_f32 v64, v64
v_exp_f32 v68, v68
v_exp_f32 v65, v65
v_exp_f32 v69, v69
v_exp_f32 v66, v66
v_exp_f32 v70, v70
v_exp_f32 v67, v67
v_exp_f32 v71, v71
v_exp_f32 v96, v96
v_exp_f32 v100, v100
v_exp_f32 v97, v97
v_exp_f32 v101, v101
v_exp_f32 v98, v98
v_exp_f32 v102, v102
v_exp_f32 v99, v99
v_exp_f32 v103, v103
v_pk_add_f32 v[218:219], v[208:209], v[210:211]
v_pk_add_f32 v[234:235], v[224:225], v[226:227]
v_pk_add_f32 v[216:217], v[212:213], v[214:215]
v_pk_add_f32 v[232:233], v[228:229], v[230:231]
v_pk_add_f32 v[220:221], v[64:65], v[66:67]
v_pk_add_f32 v[236:237], v[68:69], v[70:71]
v_pk_add_f32 v[222:223], v[96:97], v[98:99]
v_pk_add_f32 v[238:239], v[100:101], v[102:103]
v_pk_add_f32 v[218:219], v[218:219], v[216:217]
v_pk_add_f32 v[234:235], v[234:235], v[232:233]
v_pk_add_f32 v[220:221], v[220:221], v[222:223]
v_pk_add_f32 v[236:237], v[236:237], v[238:239]
v_add_f32 v216, v218, v219
v_add_f32 v232, v234, v235
v_add_f32 v217, v220, v221
v_add_f32 v233, v236, v237
v_mov_b64 v[218:219], v[216:217]
v_mov_b64 v[234:235], v[232:233]
s_nop 0
v_permlane16_swap_b32 v218, v216
v_permlane16_swap_b32 v234, v232
v_permlane16_swap_b32 v219, v217
v_permlane16_swap_b32 v235, v233
v_pk_add_f32 v[216:217], v[216:217], v[218:219]
v_pk_add_f32 v[232:233], v[232:233], v[234:235]
v_mov_b64 v[218:219], v[216:217]
v_mov_b64 v[234:235], v[232:233]
s_nop 0
v_permlane32_swap_b32 v218, v216
v_permlane32_swap_b32 v234, v232
v_permlane32_swap_b32 v219, v217
v_permlane32_swap_b32 v235, v233
v_pk_add_f32 v[216:217], v[216:217], v[218:219]
v_pk_add_f32 v[232:233], v[232:233], v[234:235]
v_rcp_f32 v216, v216
v_rcp_f32 v232, v232
v_rcp_f32 v217, v217
v_rcp_f32 v233, v233
v_pk_mul_f32 v[208:209], v[208:209], v[216:217] op_sel_hi:[1,0]
v_pk_mul_f32 v[224:225], v[224:225], v[232:233] op_sel_hi:[1,0]
v_pk_mul_f32 v[210:211], v[210:211], v[216:217] op_sel_hi:[1,0]
v_pk_mul_f32 v[226:227], v[226:227], v[232:233] op_sel_hi:[1,0]
v_pk_mul_f32 v[212:213], v[212:213], v[216:217] op_sel_hi:[1,0]
v_pk_mul_f32 v[228:229], v[228:229], v[232:233] op_sel_hi:[1,0]
v_pk_mul_f32 v[214:215], v[214:215], v[216:217] op_sel_hi:[1,0]
v_pk_mul_f32 v[230:231], v[230:231], v[232:233] op_sel_hi:[1,0]
v_pk_mul_f32 v[64:65], v[64:65], v[216:217] op_sel:[0,1] op_sel_hi:[1,1]
v_pk_mul_f32 v[68:69], v[68:69], v[232:233] op_sel:[0,1] op_sel_hi:[1,1]
v_pk_mul_f32 v[66:67], v[66:67], v[216:217] op_sel:[0,1] op_sel_hi:[1,1]
v_pk_mul_f32 v[70:71], v[70:71], v[232:233] op_sel:[0,1] op_sel_hi:[1,1]
v_pk_mul_f32 v[96:97], v[96:97], v[216:217] op_sel:[0,1] op_sel_hi:[1,1]
v_pk_mul_f32 v[100:101], v[100:101], v[232:233] op_sel:[0,1] op_sel_hi:[1,1]
v_pk_mul_f32 v[98:99], v[98:99], v[216:217] op_sel:[0,1] op_sel_hi:[1,1]
v_pk_mul_f32 v[102:103], v[102:103], v[232:233] op_sel:[0,1] op_sel_hi:[1,1]
CP 220,208,209
CP 236,224,225
CP 221,210,211
CP 237,226,227
CP 222,212,213
CP 238,228,229
CP 223,214,215
CP 239,230,231
CP 208,64,65
CP 224,68,69
CP 209,66,67
CP 225,70,71
CP 210,96,97
CP 226,100,101
CP 211,98,99
CP 227,102,103
ds_write_b64 v192, v[220:221] offset:0
ds_write_b64 v192, v[236:237] offset:3584
ds_write_b64 v192, v[222:223] offset:32
ds_write_b64 v192, v[238:239] offset:3616
ds_write_b64 v192, v[208:209] offset:64
ds_write_b64 v192, v[224:225] offset:3648
ds_write_b64 v192, v[210:211] offset:96
ds_write_b64 v192, v[226:227] offset:3680
CP 212,128,129
CP 228,132,133
CP 213,130,131
CP 229,134,135
CP 214,160,161
CP 230,164,165
CP 215,162,163
CP 231,166,167
ds_write_b64 v192, v[212:213] offset:128
ds_write_b64 v192, v[228:229] offset:3712
ds_write_b64 v192, v[214:215] offset:160
ds_write_b64 v192, v[230:231] offset:3744
CP 240,80,81
CP 244,84,85
CP 241,82,83
CP 245,86,87
CP 242,112,113
CP 246,116,117
CP 243,114,115
CP 247,118,119
s_nop 0
v_mfma_f32_16x16x32_bf16 v[80:83], a[0:3], v[240:243], 0
v_mfma_f32_16x16x32_bf16 v[84:87], a[0:3], v[244:247], 0
v_mfma_f32_16x16x32_bf16 v[112:115], a[4:7], v[240:243], 0
v_mfma_f32_16x16x32_bf16 v[116:119], a[4:7], v[244:247], 0
v_max3_f32 v216, v72, v73, v74
v_max3_f32 v232, v76, v77, v78
v_min3_f32 v217, v72, v73, v74
v_min3_f32 v233, v76, v77, v78
v_max3_f32 v216, v216, v75, v104
v_max3_f32 v232, v232, v79, v108
v_min3_f32 v217, v217, v75, v104
v_min3_f32 v233, v233, v79, v108
v_max3_f32 v216, v216, v105, v106
v_max3_f32 v232, v232, v109, v110
v_min3_f32 v217, v217, v105, v106
v_min3_f32 v233, v233, v109, v110
v_max_f32 v216, v216, v107
v_max_f32 v232, v232, v111
v_min_f32 v217, v217, v107
v_min_f32 v233, v233, v111
v_mov_b64 v[218:219], v[216:217]
v_mov_b64 v[234:235], v[232:233]
s_nop 0
v_permlane16_swap_b32 v218, v216
v_permlane16_swap_b32 v234, v232
v_permlane16_swap_b32 v219, v217
v_permlane16_swap_b32 v235, v233
v_max_f32 v216, v216, v218
v_max_f32 v232, v232, v234
v_min_f32 v217, v217, v219
v_min_f32 v233, v233, v235
v_mov_b64 v[218:219], v[216:217]
v_mov_b64 v[234:235], v[232:233]
s_nop 0
v_permlane32_swap_b32 v218, v216
v_permlane32_swap_b32 v234, v232
v_permlane32_swap_b32 v219, v217
v_permlane32_swap_b32 v235, v233
v_max_f32 v216, v216, v218
v_max_f32 v232, v232, v234
v_min_f32 v217, v217, v219
v_min_f32 v233, v233, v235
v_pk_mul_f32 v[216:217], v[216:217], s[60:61] op_sel:[0,1] op_sel_hi:[1,0]
v_pk_mul_f32 v[232:233], v[232:233], s[60:61] op_sel:[0,1] op_sel_hi:[1,0]
v_pk_fma_f32 v[208:209], v[72:73], s[60:61], v[216:217] op_sel_hi:[1,0,0]
v_pk_fma_f32 v[224:225], v[76:77], s[60:61], v[232:233] op_sel_hi:[1,0,0]
v_pk_fma_f32 v[210:211], v[74:75], s[60:61], v[216:217] op_sel_hi:[1,0,0]
v_pk_fma_f32 v[226:227], v[78:79], s[60:61], v[232:233] op_sel_hi:[1,0,0]
v_pk_fma_f32 v[212:213], v[104:105], s[60:61], v[216:217] op_sel_hi:[1,0,0]
v_pk_fma_f32 v[228:229], v[108:109], s[60:61], v[232:233] op_sel_hi:[1,0,0]
v_pk_fma_f32 v[214:215], v[106:107], s[60:61], v[216:217] op_sel_hi:[1,0,0]
v_pk_fma_f32 v[230:231], v[110:111], s[60:61], v[232:233] op_sel_hi:[1,0,0]
v_pk_fma_f32 v[72:73], v[72:73], s[60:61], v[216:217] op_sel:[0,1,1] op_sel_hi:[1,1,1]
v_pk_fma_f32 v[76:77], v[76:77], s[60:61], v[232:233] op_sel:[0,1,1] op_sel_hi:[1,1,1]
v_pk_fma_f32 v[74:75], v[74:75], s[60:61], v[216:217] op_sel:[0,1,1] op_sel_hi:[1,1,1]
v_pk_fma_f32 v[78:79], v[78:79], s[60:61], v[232:233] op_sel:[0,1,1] op_sel_hi:[1,1,1]
v_pk_fma_f32 v[104:105], v[104:105], s[60:61], v[216:217] op_sel:[0,1,1] op_sel_hi:[1,1,1]
v_pk_fma_f32 v[108:109], v[108:109], s[60:61], v[232:233] op_sel:[0,1,1] op_sel_hi:[1,1,1]
v_pk_fma_f32 v[106:107], v[106:107], s[60:61], v[216:217] op_sel:[0,1,1] op_sel_hi:[1,1,1]
v_pk_fma_f32 v[110:111], v[110:111], s[60:61], v[232:233] op_sel:[0,1,1] op_sel_hi:[1,1,1]
v_exp_f32 v208, v208
v_exp_f32 v224, v224
v_exp_f32 v209, v209
v_exp_f32 v225, v225
v_exp_f32 v210, v210
v_exp_f32 v226, v226
v_exp_f32 v211, v211
v_exp_f32 v227, v227
v_exp_f32 v212, v212
v_exp_f32 v228, v228
v_exp_f32 v213, v213
v_exp_f32 v229, v229
v_exp_f32 v214, v214
v_exp_f32 v230, v230
v_exp_f32 v215, v215
v_exp_f32 v231, v231
v_exp_f32 v72, v72
v_exp_f32 v76, v76
v_exp_f32 v73, v73
v_exp_f32 v77, v77
v_exp_f32 v74, v74
v_exp_f32 v78, v78
v_exp_f32 v75, v75
v_exp_f32 v79, v79
v_exp_f32 v104, v104
v_exp_f32 v108, v108
v_exp_f32 v105, v105
v_exp_f32 v109, v109
v_exp_f32 v106, v106
v_exp_f32 v110, v110
v_exp_f32 v107, v107
v_exp_f32 v111, v111
v_pk_add_f32 v[218:219], v[208:209], v[210:211]
v_pk_add_f32 v[234:235], v[224:225], v[226:227]
v_pk_add_f32 v[216:217], v[212:213], v[214:215]
v_pk_add_f32 v[232:233], v[228:229], v[230:231]
v_pk_add_f32 v[220:221], v[72:73], v[74:75]
v_pk_add_f32 v[236:237], v[76:77], v[78:79]
v_pk_add_f32 v[222:223], v[104:105], v[106:107]
v_pk_add_f32 v[238:239], v[108:109], v[110:111]
v_pk_add_f32 v[218:219], v[218:219], v[216:217]
v_pk_add_f32 v[234:235], v[234:235], v[232:233]
v_pk_add_f32 v[220:221], v[220:221], v[222:223]
v_pk_add_f32 v[236:237], v[236:237], v[238:239]
v_add_f32 v216, v218, v219
v_add_f32 v232, v234, v235
v_add_f32 v217, v220, v221
v_add_f32 v233, v236, v237
v_mov_b64 v[218:219], v[216:217]
v_mov_b64 v[234:235], v[232:233]
s_nop 0
v_permlane16_swap_b32 v218, v216
v_permlane16_swap_b32 v234, v232
v_permlane16_swap_b32 v219, v217
v_permlane16_swap_b32 v235, v233
v_pk_add_f32 v[216:217], v[216:217], v[218:219]
v_pk_add_f32 v[232:233], v[232:233], v[234:235]
v_mov_b64 v[218:219], v[216:217]
v_mov_b64 v[234:235], v[232:233]
s_nop 0
v_permlane32_swap_b32 v218, v216
v_permlane32_swap_b32 v234, v232
v_permlane32_swap_b32 v219, v217
v_permlane32_swap_b32 v235, v233
v_pk_add_f32 v[216:217], v[216:217], v[218:219]
v_pk_add_f32 v[232:233], v[232:233], v[234:235]
v_rcp_f32 v216, v216
v_rcp_f32 v232, v232
v_rcp_f32 v217, v217
v_rcp_f32 v233, v233
v_pk_mul_f32 v[208:209], v[208:209], v[216:217] op_sel_hi:[1,0]
v_pk_mul_f32 v[224:225], v[224:225], v[232:233] op_sel_hi:[1,0]
v_pk_mul_f32 v[210:211], v[210:211], v[216:217] op_sel_hi:[1,0]
v_pk_mul_f32 v[226:227], v[226:227], v[232:233] op_sel_hi:[1,0]
v_pk_mul_f32 v[212:213], v[212:213], v[216:217] op_sel_hi:[1,0]
v_pk_mul_f32 v[228:229], v[228:229], v[232:233] op_sel_hi:[1,0]
v_pk_mul_f32 v[214:215], v[214:215], v[216:217] op_sel_hi:[1,0]
v_pk_mul_f32 v[230:231], v[230:231], v[232:233] op_sel_hi:[1,0]
v_pk_mul_f32 v[72:73], v[72:73], v[216:217] op_sel:[0,1] op_sel_hi:[1,1]
v_pk_mul_f32 v[76:77], v[76:77], v[232:233] op_sel:[0,1] op_sel_hi:[1,1]
v_pk_mul_f32 v[74:75], v[74:75], v[216:217] op_sel:[0,1] op_sel_hi:[1,1]
v_pk_mul_f32 v[78:79], v[78:79], v[232:233] op_sel:[0,1] op_sel_hi:[1,1]
v_pk_mul_f32 v[104:105], v[104:105], v[216:217] op_sel:[0,1] op_sel_hi:[1,1]
v_pk_mul_f32 v[108:109], v[108:109], v[232:233] op_sel:[0,1] op_sel_hi:[1,1]
v_pk_mul_f32 v[106:107], v[106:107], v[216:217] op_sel:[0,1] op_sel_hi:[1,1]
v_pk_mul_f32 v[110:111], v[110:111], v[232:233] op_sel:[0,1] op_sel_hi:[1,1]
CP 220,208,209
CP 236,224,225
CP 221,210,211
CP 237,226,227
CP 222,212,213
CP 238,228,229
CP 223,214,215
CP 239,230,231
CP 208,72,73
CP 224,76,77
CP 209,74,75
CP 225,78,79
CP 210,104,105
CP 226,108,109
CP 211,106,107
CP 227,110,111
ds_write_b64 v192, v[220:221] offset:7168
ds_write_b64 v192, v[236:237] offset:10752
ds_write_b64 v192, v[222:223] offset:7200
ds_write_b64 v192, v[238:239] offset:10784
ds_write_b64 v192, v[208:209] offset:7232
ds_write_b64 v192, v[224:225] offset:10816
ds_write_b64 v192, v[210:211] offset:7264
ds_write_b64 v192, v[226:227] offset:10848
CP 212,136,137
CP 228,140,141
CP 213,138,139
CP 229,142,143
CP 214,168,169
CP 230,172,173
CP 215,170,171
CP 231,174,175
ds_write_b64 v192, v[212:213] offset:7296
ds_write_b64 v192, v[228:229] offset:10880
ds_write_b64 v192, v[214:215] offset:7328
ds_write_b64 v192, v[230:231] offset:10912
CP 240,88,89
CP 244,92,93
CP 241,90,91
CP 245,94,95
CP 242,120,121
CP 246,124,125
CP 243,122,123
CP 247,126,127
s_nop 0
v_mfma_f32_16x16x32_bf16 v[88:91], a[0:3], v[240:243], 0
v_mfma_f32_16x16x32_bf16 v[92:95], a[0:3], v[244:247], 0
v_mfma_f32_16x16x32_bf16 v[120:123], a[4:7], v[240:243], 0
v_mfma_f32_16x16x32_bf16 v[124:127], a[4:7], v[244:247], 0
v_max3_f32 v216, v80, v81, v82
v_max3_f32 v232, v84, v85, v86
v_min3_f32 v217, v80, v81, v82
v_min3_f32 v233, v84, v85, v86
v_max3_f32 v216, v216, v83, v112
v_max3_f32 v232, v232, v87, v116
v_min3_f32 v217, v217, v83, v112
v_min3_f32 v233, v233, v87, v116
v_max3_f32 v216, v216, v113, v114
v_max3_f32 v232, v232, v117, v118
v_min3_f32 v217, v217, v113, v114
v_min3_f32 v233, v233, v117, v118
v_max_f32 v216, v216, v115
v_max_f32 v232, v232, v119
v_min_f32 v217, v217, v115
v_min_f32 v233, v233, v119
v_mov_b64 v[218:219], v[216:217]
v_mov_b64 v[234:235], v[232:233]
s_nop 0
v_permlane16_swap_b32 v218, v216
v_permlane16_swap_b32 v234, v232
v_permlane16_swap_b32 v219, v217
v_permlane16_swap_b32 v235, v233
v_max_f32 v216, v216, v218
v_max_f32 v232, v232, v234
v_min_f32 v217, v217, v219
v_min_f32 v233, v233, v235
v_mov_b64 v[218:219], v[216:217]
v_mov_b64 v[234:235], v[232:233]
s_nop 0
v_permlane32_swap_b32 v218, v216
v_permlane32_swap_b32 v234, v232
v_permlane32_swap_b32 v219, v217
v_permlane32_swap_b32 v235, v233
v_max_f32 v216, v216, v218
v_max_f32 v232, v232, v234
v_min_f32 v217, v217, v219
v_min_f32 v233, v233, v235
v_pk_mul_f32 v[216:217], v[216:217], s[60:61] op_sel:[0,1] op_sel_hi:[1,0]
v_pk_mul_f32 v[232:233], v[232:233], s[60:61] op_sel:[0,1] op_sel_hi:[1,0]
v_pk_fma_f32 v[208:209], v[80:81], s[60:61], v[216:217] op_sel_hi:[1,0,0]
v_pk_fma_f32 v[224:225], v[84:85], s[60:61], v[232:233] op_sel_hi:[1,0,0]
v_pk_fma_f32 v[210:211], v[82:83], s[60:61], v[216:217] op_sel_hi:[1,0,0]
v_pk_fma_f32 v[226:227], v[86:87], s[60:61], v[232:233] op_sel_hi:[1,0,0]
v_pk_fma_f32 v[212:213], v[112:113], s[60:61], v[216:217] op_sel_hi:[1,0,0]
v_pk_fma_f32 v[228:229], v[116:117], s[60:61], v[232:233] op_sel_hi:[1,0,0]
v_pk_fma_f32 v[214:215], v[114:115], s[60:61], v[216:217] op_sel_hi:[1,0,0]
v_pk_fma_f32 v[230:231], v[118:119], s[60:61], v[232:233] op_sel_hi:[1,0,0]
v_pk_fma_f32 v[80:81], v[80:81], s[60:61], v[216:217] op_sel:[0,1,1] op_sel_hi:[1,1,1]
v_pk_fma_f32 v[84:85], v[84:85], s[60:61], v[232:233] op_sel:[0,1,1] op_sel_hi:[1,1,1]
v_pk_fma_f32 v[82:83], v[82:83], s[60:61], v[216:217] op_sel:[0,1,1] op_sel_hi:[1,1,1]
v_pk_fma_f32 v[86:87], v[86:87], s[60:61], v[232:233] op_sel:[0,1,1] op_sel_hi:[1,1,1]
v_pk_fma_f32 v[112:113], v[112:113], s[60:61], v[216:217] op_sel:[0,1,1] op_sel_hi:[1,1,1]
v_pk_fma_f32 v[116:117], v[116:117], s[60:61], v[232:233] op_sel:[0,1,1] op_sel_hi:[1,1,1]
v_pk_fma_f32 v[114:115], v[114:115], s[60:61], v[216:217] op_sel:[0,1,1] op_sel_hi:[1,1,1]
v_pk_fma_f32 v[118:119], v[118:119], s[60:61], v[232:233] op_sel:[0,1,1] op_sel_hi:[1,1,1]
v_exp_f32 v208, v208
v_exp_f32 v224, v224
v_exp_f32 v209, v209
v_exp_f32 v225, v225
v_exp_f32 v210, v210
v_exp_f32 v226, v226
v_exp_f32 v211, v211
v_exp_f32 v227, v227
v_exp_f32 v212, v212
v_exp_f32 v228, v228
v_exp_f32 v213, v213
v_exp_f32 v229, v229
v_exp_f32 v214, v214
v_exp_f32 v230, v230
v_exp_f32 v215, v215
v_exp_f32 v231, v231
v_exp_f32 v80, v80
v_exp_f32 v84, v84
v_exp_f32 v81, v81
v_exp_f32 v85, v85
v_exp_f32 v82, v82
v_exp_f32 v86, v86
v_exp_f32 v83, v83
v_exp_f32 v87, v87
v_exp_f32 v112, v112
v_exp_f32 v116, v116
v_exp_f32 v113, v113
v_exp_f32 v117, v117
v_exp_f32 v114, v114
v_exp_f32 v118, v118
v_exp_f32 v115, v115
v_exp_f32 v119, v119
v_pk_add_f32 v[218:219], v[208:209], v[210:211]
v_pk_add_f32 v[234:235], v[224:225], v[226:227]
v_pk_add_f32 v[216:217], v[212:213], v[214:215]
v_pk_add_f32 v[232:233], v[228:229], v[230:231]
v_pk_add_f32 v[220:221], v[80:81], v[82:83]
v_pk_add_f32 v[236:237], v[84:85], v[86:87]
v_pk_add_f32 v[222:223], v[112:113], v[114:115]
v_pk_add_f32 v[238:239], v[116:117], v[118:119]
v_pk_add_f32 v[218:219], v[218:219], v[216:217]
v_pk_add_f32 v[234:235], v[234:235], v[232:233]
v_pk_add_f32 v[220:221], v[220:221], v[222:223]
v_pk_add_f32 v[236:237], v[236:237], v[238:239]
v_add_f32 v216, v218, v219
v_add_f32 v232, v234, v235
v_add_f32 v217, v220, v221
v_add_f32 v233, v236, v237
v_mov_b64 v[218:219], v[216:217]
v_mov_b64 v[234:235], v[232:233]
s_nop 0
v_permlane16_swap_b32 v218, v216
v_permlane16_swap_b32 v234, v232
v_permlane16_swap_b32 v219, v217
v_permlane16_swap_b32 v235, v233
v_pk_add_f32 v[216:217], v[216:217], v[218:219]
v_pk_add_f32 v[232:233], v[232:233], v[234:235]
v_mov_b64 v[218:219], v[216:217]
v_mov_b64 v[234:235], v[232:233]
s_nop 0
v_permlane32_swap_b32 v218, v216
v_permlane32_swap_b32 v234, v232
v_permlane32_swap_b32 v219, v217
v_permlane32_swap_b32 v235, v233
v_pk_add_f32 v[216:217], v[216:217], v[218:219]
v_pk_add_f32 v[232:233], v[232:233], v[234:235]
v_rcp_f32 v216, v216
v_rcp_f32 v232, v232
v_rcp_f32 v217, v217
v_rcp_f32 v233, v233
v_pk_mul_f32 v[208:209], v[208:209], v[216:217] op_sel_hi:[1,0]
v_pk_mul_f32 v[224:225], v[224:225], v[232:233] op_sel_hi:[1,0]
v_pk_mul_f32 v[210:211], v[210:211], v[216:217] op_sel_hi:[1,0]
v_pk_mul_f32 v[226:227], v[226:227], v[232:233] op_sel_hi:[1,0]
v_pk_mul_f32 v[212:213], v[212:213], v[216:217] op_sel_hi:[1,0]
v_pk_mul_f32 v[228:229], v[228:229], v[232:233] op_sel_hi:[1,0]
v_pk_mul_f32 v[214:215], v[214:215], v[216:217] op_sel_hi:[1,0]
v_pk_mul_f32 v[230:231], v[230:231], v[232:233] op_sel_hi:[1,0]
v_pk_mul_f32 v[80:81], v[80:81], v[216:217] op_sel:[0,1] op_sel_hi:[1,1]
v_pk_mul_f32 v[84:85], v[84:85], v[232:233] op_sel:[0,1] op_sel_hi:[1,1]
v_pk_mul_f32 v[82:83], v[82:83], v[216:217] op_sel:[0,1] op_sel_hi:[1,1]
v_pk_mul_f32 v[86:87], v[86:87], v[232:233] op_sel:[0,1] op_sel_hi:[1,1]
v_pk_mul_f32 v[112:113], v[112:113], v[216:217] op_sel:[0,1] op_sel_hi:[1,1]
v_pk_mul_f32 v[116:117], v[116:117], v[232:233] op_sel:[0,1] op_sel_hi:[1,1]
v_pk_mul_f32 v[114:115], v[114:115], v[216:217] op_sel:[0,1] op_sel_hi:[1,1]
v_pk_mul_f32 v[118:119], v[118:119], v[232:233] op_sel:[0,1] op_sel_hi:[1,1]
CP 220,208,209
CP 236,224,225
CP 221,210,211
CP 237,226,227
CP 222,212,213
CP 238,228,229
CP 223,214,215
CP 239,230,231
CP 208,80,81
CP 224,84,85
CP 209,82,83
CP 225,86,87
CP 210,112,113
CP 226,116,117
CP 211,114,115
CP 227,118,119
ds_write_b64 v192, v[220:221] offset:14336
ds_write_b64 v192, v[236:237] offset:17920
ds_write_b64 v192, v[222:223] offset:14368
ds_write_b64 v192, v[238:239] offset:17952
ds_write_b64 v192, v[208:209] offset:14400
ds_write_b64 v192, v[224:225] offset:17984
ds_write_b64 v192, v[210:211] offset:14432
ds_write_b64 v192, v[226:227] offset:18016
CP 212,144,145
CP 228,148,149
CP 213,146,147
CP 229,150,151
CP 214,176,177
CP 230,180,181
CP 215,178,179
CP 231,182,183
ds_write_b64 v192, v[212:213] offset:14464
ds_write_b64 v192, v[228:229] offset:18048
ds_write_b64 v192, v[214:215] offset:14496
ds_write_b64 v192, v[230:231] offset:18080
CP 240,0,1
CP 244,4,5
CP 241,2,3
CP 245,6,7
CP 242,32,33
CP 246,36,37
CP 243,34,35
CP 247,38,39
s_nop 0
v_mfma_f32_16x16x32_bf16 v[0:3], a[0:3], v[240:243], 0
v_mfma_f32_16x16x32_bf16 v[4:7], a[0:3], v[244:247], 0
v_mfma_f32_16x16x32_bf16 v[32:35], a[4:7], v[240:243], 0
v_mfma_f32_16x16x32_bf16 v[36:39], a[4:7], v[244:247], 0
v_max3_f32 v216, v88, v89, v90
v_max3_f32 v232, v92, v93, v94
v_min3_f32 v217, v88, v89, v90
v_min3_f32 v233, v92, v93, v94
v_max3_f32 v216, v216, v91, v120
v_max3_f32 v232, v232, v95, v124
v_min3_f32 v217, v217, v91, v120
v_min3_f32 v233, v233, v95, v124
v_max3_f32 v216, v216, v121, v122
v_max3_f32 v232, v232, v125, v126
v_min3_f32 v217, v217, v121, v122
v_min3_f32 v233, v233, v125, v126
v_max_f32 v216, v216, v123
v_max_f32 v232, v232, v127
v_min_f32 v217, v217, v123
v_min_f32 v233, v233, v127
v_mov_b64 v[218:219], v[216:217]
v_mov_b64 v[234:235], v[232:233]
s_nop 0
v_permlane16_swap_b32 v218, v216
v_permlane16_swap_b32 v234, v232
v_permlane16_swap_b32 v219, v217
v_permlane16_swap_b32 v235, v233
v_max_f32 v216, v216, v218
v_max_f32 v232, v232, v234
v_min_f32 v217, v217, v219
v_min_f32 v233, v233, v235
v_mov_b64 v[218:219], v[216:217]
v_mov_b64 v[234:235], v[232:233]
s_nop 0
v_permlane32_swap_b32 v218, v216
v_permlane32_swap_b32 v234, v232
v_permlane32_swap_b32 v219, v217
v_permlane32_swap_b32 v235, v233
v_max_f32 v216, v216, v218
v_max_f32 v232, v232, v234
v_min_f32 v217, v217, v219
v_min_f32 v233, v233, v235
v_pk_mul_f32 v[216:217], v[216:217], s[60:61] op_sel:[0,1] op_sel_hi:[1,0]
v_pk_mul_f32 v[232:233], v[232:233], s[60:61] op_sel:[0,1] op_sel_hi:[1,0]
v_pk_fma_f32 v[208:209], v[88:89], s[60:61], v[216:217] op_sel_hi:[1,0,0]
v_pk_fma_f32 v[224:225], v[92:93], s[60:61], v[232:233] op_sel_hi:[1,0,0]
v_pk_fma_f32 v[210:211], v[90:91], s[60:61], v[216:217] op_sel_hi:[1,0,0]
v_pk_fma_f32 v[226:227], v[94:95], s[60:61], v[232:233] op_sel_hi:[1,0,0]
v_pk_fma_f32 v[212:213], v[120:121], s[60:61], v[216:217] op_sel_hi:[1,0,0]
v_pk_fma_f32 v[228:229], v[124:125], s[60:61], v[232:233] op_sel_hi:[1,0,0]
v_pk_fma_f32 v[214:215], v[122:123], s[60:61], v[216:217] op_sel_hi:[1,0,0]
v_pk_fma_f32 v[230:231], v[126:127], s[60:61], v[232:233] op_sel_hi:[1,0,0]
v_pk_fma_f32 v[88:89], v[88:89], s[60:61], v[216:217] op_sel:[0,1,1] op_sel_hi:[1,1,1]
v_pk_fma_f32 v[92:93], v[92:93], s[60:61], v[232:233] op_sel:[0,1,1] op_sel_hi:[1,1,1]
v_pk_fma_f32 v[90:91], v[90:91], s[60:61], v[216:217] op_sel:[0,1,1] op_sel_hi:[1,1,1]
v_pk_fma_f32 v[94:95], v[94:95], s[60:61], v[232:233] op_sel:[0,1,1] op_sel_hi:[1,1,1]
v_pk_fma_f32 v[120:121], v[120:121], s[60:61], v[216:217] op_sel:[0,1,1] op_sel_hi:[1,1,1]
v_pk_fma_f32 v[124:125], v[124:125], s[60:61], v[232:233] op_sel:[0,1,1] op_sel_hi:[1,1,1]
v_pk_fma_f32 v[122:123], v[122:123], s[60:61], v[216:217] op_sel:[0,1,1] op_sel_hi:[1,1,1]
v_pk_fma_f32 v[126:127], v[126:127], s[60:61], v[232:233] op_sel:[0,1,1] op_sel_hi:[1,1,1]
v_exp_f32 v208, v208
v_exp_f32 v224, v224
v_exp_f32 v209, v209
v_exp_f32 v225, v225
v_exp_f32 v210, v210
v_exp_f32 v226, v226
v_exp_f32 v211, v211
v_exp_f32 v227, v227
v_exp_f32 v212, v212
v_exp_f32 v228, v228
v_exp_f32 v213, v213
v_exp_f32 v229, v229
v_exp_f32 v214, v214
v_exp_f32 v230, v230
v_exp_f32 v215, v215
v_exp_f32 v231, v231
v_exp_f32 v88, v88
v_exp_f32 v92, v92
v_exp_f32 v89, v89
v_exp_f32 v93, v93
v_exp_f32 v90, v90
v_exp_f32 v94, v94
v_exp_f32 v91, v91
v_exp_f32 v95, v95
v_exp_f32 v120, v120
v_exp_f32 v124, v124
v_exp_f32 v121, v121
v_exp_f32 v125, v125
v_exp_f32 v122, v122
v_exp_f32 v126, v126
v_exp_f32 v123, v123
v_exp_f32 v127, v127
v_pk_add_f32 v[218:219], v[208:209], v[210:211]
v_pk_add_f32 v[234:235], v[224:225], v[226:227]
v_pk_add_f32 v[216:217], v[212:213], v[214:215]
v_pk_add_f32 v[232:233], v[228:229], v[230:231]
v_pk_add_f32 v[220:221], v[88:89], v[90:91]
v_pk_add_f32 v[236:237], v[92:93], v[94:95]
v_pk_add_f32 v[222:223], v[120:121], v[122:123]
v_pk_add_f32 v[238:239], v[124:125], v[126:127]
v_pk_add_f32 v[218:219], v[218:219], v[216:217]
v_pk_add_f32 v[234:235], v[234:235], v[232:233]
v_pk_add_f32 v[220:221], v[220:221], v[222:223]
v_pk_add_f32 v[236:237], v[236:237], v[238:239]
v_add_f32 v216, v218, v219
v_add_f32 v232, v234, v235
v_add_f32 v217, v220, v221
v_add_f32 v233, v236, v237
v_mov_b64 v[218:219], v[216:217]
v_mov_b64 v[234:235], v[232:233]
s_nop 0
v_permlane16_swap_b32 v218, v216
v_permlane16_swap_b32 v234, v232
v_permlane16_swap_b32 v219, v217
v_permlane16_swap_b32 v235, v233
v_pk_add_f32 v[216:217], v[216:217], v[218:219]
v_pk_add_f32 v[232:233], v[232:233], v[234:235]
v_mov_b64 v[218:219], v[216:217]
v_mov_b64 v[234:235], v[232:233]
s_nop 0
v_permlane32_swap_b32 v218, v216
v_permlane32_swap_b32 v234, v232
v_permlane32_swap_b32 v219, v217
v_permlane32_swap_b32 v235, v233
v_pk_add_f32 v[216:217], v[216:217], v[218:219]
v_pk_add_f32 v[232:233], v[232:233], v[234:235]
v_rcp_f32 v216, v216
v_rcp_f32 v232, v232
v_rcp_f32 v217, v217
v_rcp_f32 v233, v233
v_pk_mul_f32 v[208:209], v[208:209], v[216:217] op_sel_hi:[1,0]
v_pk_mul_f32 v[224:225], v[224:225], v[232:233] op_sel_hi:[1,0]
v_pk_mul_f32 v[210:211], v[210:211], v[216:217] op_sel_hi:[1,0]
v_pk_mul_f32 v[226:227], v[226:227], v[232:233] op_sel_hi:[1,0]
v_pk_mul_f32 v[212:213], v[212:213], v[216:217] op_sel_hi:[1,0]
v_pk_mul_f32 v[228:229], v[228:229], v[232:233] op_sel_hi:[1,0]
v_pk_mul_f32 v[214:215], v[214:215], v[216:217] op_sel_hi:[1,0]
v_pk_mul_f32 v[230:231], v[230:231], v[232:233] op_sel_hi:[1,0]
v_pk_mul_f32 v[88:89], v[88:89], v[216:217] op_sel:[0,1] op_sel_hi:[1,1]
v_pk_mul_f32 v[92:93], v[92:93], v[232:233] op_sel:[0,1] op_sel_hi:[1,1]
v_pk_mul_f32 v[90:91], v[90:91], v[216:217] op_sel:[0,1] op_sel_hi:[1,1]
v_pk_mul_f32 v[94:95], v[94:95], v[232:233] op_sel:[0,1] op_sel_hi:[1,1]
v_pk_mul_f32 v[120:121], v[120:121], v[216:217] op_sel:[0,1] op_sel_hi:[1,1]
v_pk_mul_f32 v[124:125], v[124:125], v[232:233] op_sel:[0,1] op_sel_hi:[1,1]
v_pk_mul_f32 v[122:123], v[122:123], v[216:217] op_sel:[0,1] op_sel_hi:[1,1]
v_pk_mul_f32 v[126:127], v[126:127], v[232:233] op_sel:[0,1] op_sel_hi:[1,1]
CP 220,208,209
CP 236,224,225
CP 221,210,211
CP 237,226,227
CP 222,212,213
CP 238,228,229
CP 223,214,215
CP 239,230,231
CP 208,88,89
CP 224,92,93
CP 209,90,91
CP 225,94,95
CP 210,120,121
CP 226,124,125
CP 211,122,123
CP 227,126,127
ds_write_b64 v192, v[220:221] offset:21504
ds_write_b64 v192, v[236:237] offset:25088
ds_write_b64 v192, v[222:223] offset:21536
ds_write_b64 v192, v[238:239] offset:25120
ds_write_b64 v192, v[208:209] offset:21568
ds_write_b64 v192, v[224:225] offset:25152
ds_write_b64 v192, v[210:211] offset:21600
ds_write_b64 v192, v[226:227] offset:25184
CP 212,152,153
CP 228,156,157
CP 213,154,155
CP 229,158,159
CP 214,184,185
CP 230,188,189
CP 215,186,187
CP 231,190,191
ds_write_b64 v192, v[212:213] offset:21632
ds_write_b64 v192, v[228:229] offset:25216
ds_write_b64 v192, v[214:215] offset:21664
ds_write_b64 v192, v[230:231] offset:25248
s_cmp_eq_u32 s42, 0
s_cbranch_scc0 k1_clear_checked
s_waitcnt vmcnt(0)
v_readfirstlane_b32 s55, v251
s_nop 3
s_cmp_ge_u32 s55, 128
s_cbranch_scc1 k1_clear_checked
s_mov_b64 exec, 1
k1_kvside_spin:
global_load_dword v251, v250, s[38:39] sc1
s_waitcnt vmcnt(0)
v_readfirstlane_b32 s55, v251
s_nop 3
s_cmp_ge_u32 s55, 128
s_cbranch_scc1 k1_kvside_ok
s_sleep 2
s_branch k1_kvside_spin
k1_kvside_ok:
s_mov_b64 exec, -1
k1_clear_checked:
s_waitcnt lgkmcnt(0)
s_barrier
v_mov_b32 v88, 0x3f803f80
v_mov_b32 v89, 0x3f803f80
v_mov_b32 v90, 0x3f803f80
v_mov_b32 v91, 0x3f803f80
TR 16,193,0
TR 18,193,3584
TR 20,193,32
TR 22,193,3616
TR 24,194,0
TR 26,194,3584
TR 28,194,32
TR 30,194,3616
TR 32,193,7168
TR 34,193,10752
TR 36,193,7200
TR 38,193,10784
TR 40,194,7168
TR 42,194,10752
TR 44,194,7200
TR 46,194,10784
s_waitcnt lgkmcnt(8)
MVZ 64,16,24
MVZ 68,16,28
v_mfma_f32_16x16x32_bf16 v[72:75], a[16:19], v[88:91], 0
MVZ 76,20,24
MVZ 80,20,28
v_mfma_f32_16x16x32_bf16 v[84:87], a[20:23], v[88:91], 0
TR 16,193,14336
TR 18,193,17920
TR 20,193,14368
TR 22,193,17952
TR 24,194,14336
TR 26,194,17920
TR 28,194,14368
TR 30,194,17952
s_waitcnt lgkmcnt(8)
MV 64,32,40
MV 68,32,44
v_mfma_f32_16x16x32_bf16 v[72:75], a[32:35], v[88:91], v[72:75]
MV 76,36,40
MV 80,36,44
v_mfma_f32_16x16x32_bf16 v[84:87], a[36:39], v[88:91], v[84:87]
TR 32,193,21504
TR 34,193,25088
TR 36,193,21536
TR 38,193,25120
TR 40,194,21504
TR 42,194,25088
TR 44,194,21536
TR 46,194,25120
s_waitcnt lgkmcnt(8)
MV 64,16,24
MV 68,16,28
v_mfma_f32_16x16x32_bf16 v[72:75], a[16:19], v[88:91], v[72:75]
MV 76,20,24
MV 80,20,28
v_mfma_f32_16x16x32_bf16 v[84:87], a[20:23], v[88:91], v[84:87]
TR 16,193,28672
TR 18,193,32256
TR 20,193,28704
TR 22,193,32288
TR 24,194,28672
TR 26,194,32256
TR 28,194,28704
TR 30,194,32288
s_waitcnt lgkmcnt(8)
MV 64,32,40
MV 68,32,44
v_mfma_f32_16x16x32_bf16 v[72:75], a[32:35], v[88:91], v[72:75]
MV 76,36,40
MV 80,36,44
v_mfma_f32_16x16x32_bf16 v[84:87], a[36:39], v[88:91], v[84:87]
TR 32,193,35840
TR 34,193,39424
TR 36,193,35872
TR 38,193,39456
TR 40,194,35840
TR 42,194,39424
TR 44,194,35872
TR 46,194,39456
s_waitcnt lgkmcnt(8)
MV 64,16,24
MV 68,16,28
v_mfma_f32_16x16x32_bf16 v[72:75], a[16:19], v[88:91], v[72:75]
MV 76,20,24
MV 80,20,28
v_mfma_f32_16x16x32_bf16 v[84:87], a[20:23], v[88:91], v[84:87]
TR 16,193,43008
TR 18,193,46592
TR 20,193,43040
TR 22,193,46624
TR 24,194,43008
TR 26,194,46592
TR 28,194,43040
TR 30,194,46624
s_waitcnt lgkmcnt(8)
MV 64,32,40
MV 68,32,44
v_mfma_f32_16x16x32_bf16 v[72:75], a[32:35], v[88:91], v[72:75]
MV 76,36,40
MV 80,36,44
v_mfma_f32_16x16x32_bf16 v[84:87], a[36:39], v[88:91], v[84:87]
TR 32,193,50176
TR 34,193,53760
TR 36,193,50208
TR 38,193,53792
TR 40,194,50176
TR 42,194,53760
TR 44,194,50208
TR 46,194,53792
s_waitcnt lgkmcnt(8)
MV 64,16,24
MV 68,16,28
v_mfma_f32_16x16x32_bf16 v[72:75], a[16:19], v[88:91], v[72:75]
MV 76,20,24
MV 80,20,28
v_mfma_f32_16x16x32_bf16 v[84:87], a[20:23], v[88:91], v[84:87]
s_waitcnt lgkmcnt(0)
MV 64,32,40
MV 68,32,44
v_mfma_f32_16x16x32_bf16 v[72:75], a[32:35], v[88:91], v[72:75]
MV 76,36,40
MV 80,36,44
v_mfma_f32_16x16x32_bf16 v[84:87], a[36:39], v[88:91], v[84:87]
s_add_u32 s8, s40, 24117248
s_addc_u32 s9, s41, 0
s_and_b32 s9, s9, 0xffff
s_mov_b32 s10, 262144
s_mov_b32 s11, 0x20000
s_add_u32 s12, s40, 27262976
s_addc_u32 s13, s41, 0
s_and_b32 s13, s13, 0xffff
s_mov_b32 s14, 8192
s_mov_b32 s15, 0x20000
s_lshl_b32 s55, s45, 1
s_add_u32 s55, s55, s53
s_lshl_b32 s55, s55, 1
s_add_u32 s68, s55, s52
s_lshl_b32 s57, s68, 12
v_lshlrev_b32 v195, 4, v206
v_lshlrev_b32 v197, 2, v206
v_lshrrev_b32 v196, 4, v206
v_lshlrev_b32 v196, 4, v196
s_lshl_b32 s69, s68, 12
s_lshl_b32 s57, s68, 7
s_mov_b64 s[58:59], exec
s_mov_b32 exec_lo, 0x00010001
s_mov_b32 exec_hi, 0x00010001
buffer_atomic_add_f32 v72, v196, s[12:15], s57 offen offset:0
buffer_atomic_add_f32 v73, v196, s[12:15], s57 offen offset:4
buffer_atomic_add_f32 v74, v196, s[12:15], s57 offen offset:8
buffer_atomic_add_f32 v75, v196, s[12:15], s57 offen offset:12
buffer_atomic_add_f32 v84, v196, s[12:15], s57 offen offset:64
buffer_atomic_add_f32 v85, v196, s[12:15], s57 offen offset:68
buffer_atomic_add_f32 v86, v196, s[12:15], s57 offen offset:72
buffer_atomic_add_f32 v87, v196, s[12:15], s57 offen offset:76
s_mov_b64 exec, s[58:59]
CP 240,8,9
CP 244,12,13
CP 241,10,11
CP 245,14,15
CP 242,40,41
CP 246,44,45
CP 243,42,43
CP 247,46,47
s_nop 0
v_mfma_f32_16x16x32_bf16 v[8:11], a[0:3], v[240:243], 0
v_mfma_f32_16x16x32_bf16 v[12:15], a[0:3], v[244:247], 0
v_mfma_f32_16x16x32_bf16 v[40:43], a[4:7], v[240:243], 0
v_mfma_f32_16x16x32_bf16 v[44:47], a[4:7], v[244:247], 0
v_max3_f32 v216, v0, v1, v2
v_max3_f32 v232, v4, v5, v6
v_min3_f32 v217, v0, v1, v2
v_min3_f32 v233, v4, v5, v6
v_max3_f32 v216, v216, v3, v32
v_max3_f32 v232, v232, v7, v36
v_min3_f32 v217, v217, v3, v32
v_min3_f32 v233, v233, v7, v36
v_max3_f32 v216, v216, v33, v34
buffer_atomic_add_f32 v64, v197, s[8:11], s69 offen offset:0
v_max3_f32 v232, v232, v37, v38
v_min3_f32 v217, v217, v33, v34
v_min3_f32 v233, v233, v37, v38
v_max_f32 v216, v216, v35
v_max_f32 v232, v232, v39
v_min_f32 v217, v217, v35
v_min_f32 v233, v233, v39
v_mov_b64 v[218:219], v[216:217]
v_mov_b64 v[234:235], v[232:233]
buffer_atomic_add_f32 v65, v197, s[8:11], s69 offen offset:256
v_permlane16_swap_b32 v218, v216
v_permlane16_swap_b32 v234, v232
v_permlane16_swap_b32 v219, v217
v_permlane16_swap_b32 v235, v233
v_max_f32 v216, v216, v218
v_max_f32 v232, v232, v234
v_min_f32 v217, v217, v219
v_min_f32 v233, v233, v235
v_mov_b64 v[218:219], v[216:217]
buffer_atomic_add_f32 v66, v197, s[8:11], s69 offen offset:512
v_mov_b64 v[234:235], v[232:233]
v_permlane32_swap_b32 v218, v216
s_nop 0
v_permlane32_swap_b32 v234, v232
v_permlane32_swap_b32 v219, v217
v_permlane32_swap_b32 v235, v233
v_max_f32 v216, v216, v218
v_max_f32 v232, v232, v234
v_min_f32 v217, v217, v219
v_min_f32 v233, v233, v235
buffer_atomic_add_f32 v67, v197, s[8:11], s69 offen offset:768
v_pk_mul_f32 v[216:217], v[216:217], s[60:61] op_sel:[0,1] op_sel_hi:[1,0]
v_pk_mul_f32 v[232:233], v[232:233], s[60:61] op_sel:[0,1] op_sel_hi:[1,0]
v_pk_fma_f32 v[208:209], v[0:1], s[60:61], v[216:217] op_sel_hi:[1,0,0]
v_pk_fma_f32 v[224:225], v[4:5], s[60:61], v[232:233] op_sel_hi:[1,0,0]
v_pk_fma_f32 v[210:211], v[2:3], s[60:61], v[216:217] op_sel_hi:[1,0,0]
v_pk_fma_f32 v[226:227], v[6:7], s[60:61], v[232:233] op_sel_hi:[1,0,0]
v_pk_fma_f32 v[212:213], v[32:33], s[60:61], v[216:217] op_sel_hi:[1,0,0]
v_pk_fma_f32 v[228:229], v[36:37], s[60:61], v[232:233] op_sel_hi:[1,0,0]
v_pk_fma_f32 v[214:215], v[34:35], s[60:61], v[216:217] op_sel_hi:[1,0,0]
buffer_atomic_add_f32 v68, v197, s[8:11], s69 offen offset:1024
v_pk_fma_f32 v[230:231], v[38:39], s[60:61], v[232:233] op_sel_hi:[1,0,0]
v_pk_fma_f32 v[0:1], v[0:1], s[60:61], v[216:217] op_sel:[0,1,1] op_sel_hi:[1,1,1]
v_pk_fma_f32 v[4:5], v[4:5], s[60:61], v[232:233] op_sel:[0,1,1] op_sel_hi:[1,1,1]
v_pk_fma_f32 v[2:3], v[2:3], s[60:61], v[216:217] op_sel:[0,1,1] op_sel_hi:[1,1,1]
v_pk_fma_f32 v[6:7], v[6:7], s[60:61], v[232:233] op_sel:[0,1,1] op_sel_hi:[1,1,1]
v_pk_fma_f32 v[32:33], v[32:33], s[60:61], v[216:217] op_sel:[0,1,1] op_sel_hi:[1,1,1]
v_pk_fma_f32 v[36:37], v[36:37], s[60:61], v[232:233] op_sel:[0,1,1] op_sel_hi:[1,1,1]
v_pk_fma_f32 v[34:35], v[34:35], s[60:61], v[216:217] op_sel:[0,1,1] op_sel_hi:[1,1,1]
v_pk_fma_f32 v[38:39], v[38:39], s[60:61], v[232:233] op_sel:[0,1,1] op_sel_hi:[1,1,1]
buffer_atomic_add_f32 v69, v197, s[8:11], s69 offen offset:1280
v_exp_f32 v208, v208
v_exp_f32 v224, v224
v_exp_f32 v209, v209
v_exp_f32 v225, v225
v_exp_f32 v210, v210
v_exp_f32 v226, v226
v_exp_f32 v211, v211
v_exp_f32 v227, v227
v_exp_f32 v212, v212
buffer_atomic_add_f32 v70, v197, s[8:11], s69 offen offset:1536
v_exp_f32 v228, v228
v_exp_f32 v213, v213
v_exp_f32 v229, v229
v_exp_f32 v214, v214
v_exp_f32 v230, v230
v_exp_f32 v215, v215
v_exp_f32 v231, v231
v_exp_f32 v0, v0
v_exp_f32 v4, v4
buffer_atomic_add_f32 v71, v197, s[8:11], s69 offen offset:1792
v_exp_f32 v1, v1
v_exp_f32 v5, v5
v_exp_f32 v2, v2
v_exp_f32 v6, v6
v_exp_f32 v3, v3
v_exp_f32 v7, v7
v_exp_f32 v32, v32
v_exp_f32 v36, v36
v_exp_f32 v33, v33
buffer_atomic_add_f32 v76, v197, s[8:11], s69 offen offset:2048
v_exp_f32 v37, v37
v_exp_f32 v34, v34
v_exp_f32 v38, v38
v_exp_f32 v35, v35
v_exp_f32 v39, v39
v_pk_add_f32 v[218:219], v[208:209], v[210:211]
v_pk_add_f32 v[234:235], v[224:225], v[226:227]
v_pk_add_f32 v[216:217], v[212:213], v[214:215]
v_pk_add_f32 v[232:233], v[228:229], v[230:231]
buffer_atomic_add_f32 v77, v197, s[8:11], s69 offen offset:2304
v_pk_add_f32 v[128:129], v[0:1], v[2:3]
v_pk_add_f32 v[136:137], v[4:5], v[6:7]
v_pk_add_f32 v[130:131], v[32:33], v[34:35]
v_pk_add_f32 v[138:139], v[36:37], v[38:39]
v_pk_add_f32 v[218:219], v[218:219], v[216:217]
v_pk_add_f32 v[234:235], v[234:235], v[232:233]
v_pk_add_f32 v[128:129], v[128:129], v[130:131]
v_pk_add_f32 v[136:137], v[136:137], v[138:139]
v_add_f32 v216, v218, v219
buffer_atomic_add_f32 v78, v197, s[8:11], s69 offen offset:2560
v_add_f32 v232, v234, v235
v_add_f32 v217, v128, v129
v_add_f32 v233, v136, v137
v_mov_b64 v[218:219], v[216:217]
v_mov_b64 v[234:235], v[232:233]
s_nop 0
v_permlane16_swap_b32 v218, v216
v_permlane16_swap_b32 v234, v232
v_permlane16_swap_b32 v219, v217
v_permlane16_swap_b32 v235, v233
buffer_atomic_add_f32 v79, v197, s[8:11], s69 offen offset:2816
v_pk_add_f32 v[216:217], v[216:217], v[218:219]
v_pk_add_f32 v[232:233], v[232:233], v[234:235]
v_mov_b64 v[218:219], v[216:217]
v_mov_b64 v[234:235], v[232:233]
s_nop 0
v_permlane32_swap_b32 v218, v216
v_permlane32_swap_b32 v234, v232
v_permlane32_swap_b32 v219, v217
v_permlane32_swap_b32 v235, v233
v_pk_add_f32 v[216:217], v[216:217], v[218:219]
buffer_atomic_add_f32 v80, v197, s[8:11], s69 offen offset:3072
v_pk_add_f32 v[232:233], v[232:233], v[234:235]
v_rcp_f32 v216, v216
v_rcp_f32 v232, v232
v_rcp_f32 v217, v217
v_rcp_f32 v233, v233
v_pk_mul_f32 v[208:209], v[208:209], v[216:217] op_sel_hi:[1,0]
v_pk_mul_f32 v[224:225], v[224:225], v[232:233] op_sel_hi:[1,0]
v_pk_mul_f32 v[210:211], v[210:211], v[216:217] op_sel_hi:[1,0]
v_pk_mul_f32 v[226:227], v[226:227], v[232:233] op_sel_hi:[1,0]
buffer_atomic_add_f32 v81, v197, s[8:11], s69 offen offset:3328
v_pk_mul_f32 v[212:213], v[212:213], v[216:217] op_sel_hi:[1,0]
v_pk_mul_f32 v[228:229], v[228:229], v[232:233] op_sel_hi:[1,0]
v_pk_mul_f32 v[214:215], v[214:215], v[216:217] op_sel_hi:[1,0]
v_pk_mul_f32 v[230:231], v[230:231], v[232:233] op_sel_hi:[1,0]
v_pk_mul_f32 v[0:1], v[0:1], v[216:217] op_sel:[0,1] op_sel_hi:[1,1]
v_pk_mul_f32 v[4:5], v[4:5], v[232:233] op_sel:[0,1] op_sel_hi:[1,1]
v_pk_mul_f32 v[2:3], v[2:3], v[216:217] op_sel:[0,1] op_sel_hi:[1,1]
v_pk_mul_f32 v[6:7], v[6:7], v[232:233] op_sel:[0,1] op_sel_hi:[1,1]
v_pk_mul_f32 v[32:33], v[32:33], v[216:217] op_sel:[0,1] op_sel_hi:[1,1]
buffer_atomic_add_f32 v82, v197, s[8:11], s69 offen offset:3584
v_pk_mul_f32 v[36:37], v[36:37], v[232:233] op_sel:[0,1] op_sel_hi:[1,1]
v_pk_mul_f32 v[34:35], v[34:35], v[216:217] op_sel:[0,1] op_sel_hi:[1,1]
v_pk_mul_f32 v[38:39], v[38:39], v[232:233] op_sel:[0,1] op_sel_hi:[1,1]
CP 128,208,209
CP 136,224,225
CP 129,210,211
CP 137,226,227
CP 130,212,213
CP 138,228,229
buffer_atomic_add_f32 v83, v197, s[8:11], s69 offen offset:3840
CP 131,214,215
CP 139,230,231
CP 132,0,1
CP 140,4,5
CP 133,2,3
CP 141,6,7
CP 134,32,33
CP 142,36,37
CP 135,34,35
CP 143,38,39
CP 240,16,17
CP 244,20,21
CP 241,18,19
CP 245,22,23
CP 242,48,49
CP 246,52,53
CP 243,50,51
CP 247,54,55
s_nop 0
v_mfma_f32_16x16x32_bf16 v[16:19], a[0:3], v[240:243], 0
v_mfma_f32_16x16x32_bf16 v[20:23], a[0:3], v[244:247], 0
v_mfma_f32_16x16x32_bf16 v[48:51], a[4:7], v[240:243], 0
v_mfma_f32_16x16x32_bf16 v[52:55], a[4:7], v[244:247], 0
v_max3_f32 v216, v8, v9, v10
v_max3_f32 v232, v12, v13, v14
v_min3_f32 v217, v8, v9, v10
v_min3_f32 v233, v12, v13, v14
v_max3_f32 v216, v216, v11, v40
v_max3_f32 v232, v232, v15, v44
v_min3_f32 v217, v217, v11, v40
v_min3_f32 v233, v233, v15, v44
v_max3_f32 v216, v216, v41, v42
v_max3_f32 v232, v232, v45, v46
v_min3_f32 v217, v217, v41, v42
v_min3_f32 v233, v233, v45, v46
v_max_f32 v216, v216, v43
v_max_f32 v232, v232, v47
v_min_f32 v217, v217, v43
v_min_f32 v233, v233, v47
v_mov_b64 v[218:219], v[216:217]
v_mov_b64 v[234:235], v[232:233]
s_nop 0
v_permlane16_swap_b32 v218, v216
v_permlane16_swap_b32 v234, v232
v_permlane16_swap_b32 v219, v217
v_permlane16_swap_b32 v235, v233
v_max_f32 v216, v216, v218
v_max_f32 v232, v232, v234
v_min_f32 v217, v217, v219
v_min_f32 v233, v233, v235
v_mov_b64 v[218:219], v[216:217]
v_mov_b64 v[234:235], v[232:233]
s_nop 0
v_permlane32_swap_b32 v218, v216
v_permlane32_swap_b32 v234, v232
v_permlane32_swap_b32 v219, v217
v_permlane32_swap_b32 v235, v233
v_max_f32 v216, v216, v218
v_max_f32 v232, v232, v234
v_min_f32 v217, v217, v219
v_min_f32 v233, v233, v235
v_pk_mul_f32 v[216:217], v[216:217], s[60:61] op_sel:[0,1] op_sel_hi:[1,0]
v_pk_mul_f32 v[232:233], v[232:233], s[60:61] op_sel:[0,1] op_sel_hi:[1,0]
v_pk_fma_f32 v[208:209], v[8:9], s[60:61], v[216:217] op_sel_hi:[1,0,0]
v_pk_fma_f32 v[224:225], v[12:13], s[60:61], v[232:233] op_sel_hi:[1,0,0]
v_pk_fma_f32 v[210:211], v[10:11], s[60:61], v[216:217] op_sel_hi:[1,0,0]
v_pk_fma_f32 v[226:227], v[14:15], s[60:61], v[232:233] op_sel_hi:[1,0,0]
v_pk_fma_f32 v[212:213], v[40:41], s[60:61], v[216:217] op_sel_hi:[1,0,0]
v_pk_fma_f32 v[228:229], v[44:45], s[60:61], v[232:233] op_sel_hi:[1,0,0]
v_pk_fma_f32 v[214:215], v[42:43], s[60:61], v[216:217] op_sel_hi:[1,0,0]
v_pk_fma_f32 v[230:231], v[46:47], s[60:61], v[232:233] op_sel_hi:[1,0,0]
v_pk_fma_f32 v[8:9], v[8:9], s[60:61], v[216:217] op_sel:[0,1,1] op_sel_hi:[1,1,1]
v_pk_fma_f32 v[12:13], v[12:13], s[60:61], v[232:233] op_sel:[0,1,1] op_sel_hi:[1,1,1]
v_pk_fma_f32 v[10:11], v[10:11], s[60:61], v[216:217] op_sel:[0,1,1] op_sel_hi:[1,1,1]
v_pk_fma_f32 v[14:15], v[14:15], s[60:61], v[232:233] op_sel:[0,1,1] op_sel_hi:[1,1,1]
v_pk_fma_f32 v[40:41], v[40:41], s[60:61], v[216:217] op_sel:[0,1,1] op_sel_hi:[1,1,1]
v_pk_fma_f32 v[44:45], v[44:45], s[60:61], v[232:233] op_sel:[0,1,1] op_sel_hi:[1,1,1]
v_pk_fma_f32 v[42:43], v[42:43], s[60:61], v[216:217] op_sel:[0,1,1] op_sel_hi:[1,1,1]
v_pk_fma_f32 v[46:47], v[46:47], s[60:61], v[232:233] op_sel:[0,1,1] op_sel_hi:[1,1,1]
v_exp_f32 v208, v208
v_exp_f32 v224, v224
v_exp_f32 v209, v209
v_exp_f32 v225, v225
v_exp_f32 v210, v210
v_exp_f32 v226, v226
v_exp_f32 v211, v211
v_exp_f32 v227, v227
v_exp_f32 v212, v212
v_exp_f32 v228, v228
v_exp_f32 v213, v213
v_exp_f32 v229, v229
v_exp_f32 v214, v214
v_exp_f32 v230, v230
v_exp_f32 v215, v215
v_exp_f32 v231, v231
v_exp_f32 v8, v8
v_exp_f32 v12, v12
v_exp_f32 v9, v9
v_exp_f32 v13, v13
v_exp_f32 v10, v10
v_exp_f32 v14, v14
v_exp_f32 v11, v11
v_exp_f32 v15, v15
v_exp_f32 v40, v40
v_exp_f32 v44, v44
v_exp_f32 v41, v41
v_exp_f32 v45, v45
v_exp_f32 v42, v42
v_exp_f32 v46, v46
v_exp_f32 v43, v43
v_exp_f32 v47, v47
v_pk_add_f32 v[218:219], v[208:209], v[210:211]
v_pk_add_f32 v[234:235], v[224:225], v[226:227]
v_pk_add_f32 v[216:217], v[212:213], v[214:215]
v_pk_add_f32 v[232:233], v[228:229], v[230:231]
v_pk_add_f32 v[144:145], v[8:9], v[10:11]
v_pk_add_f32 v[152:153], v[12:13], v[14:15]
v_pk_add_f32 v[146:147], v[40:41], v[42:43]
v_pk_add_f32 v[154:155], v[44:45], v[46:47]
v_pk_add_f32 v[218:219], v[218:219], v[216:217]
v_pk_add_f32 v[234:235], v[234:235], v[232:233]
v_pk_add_f32 v[144:145], v[144:145], v[146:147]
v_pk_add_f32 v[152:153], v[152:153], v[154:155]
v_add_f32 v216, v218, v219
v_add_f32 v232, v234, v235
v_add_f32 v217, v144, v145
v_add_f32 v233, v152, v153
v_mov_b64 v[218:219], v[216:217]
v_mov_b64 v[234:235], v[232:233]
s_nop 0
v_permlane16_swap_b32 v218, v216
v_permlane16_swap_b32 v234, v232
v_permlane16_swap_b32 v219, v217
v_permlane16_swap_b32 v235, v233
v_pk_add_f32 v[216:217], v[216:217], v[218:219]
v_pk_add_f32 v[232:233], v[232:233], v[234:235]
v_mov_b64 v[218:219], v[216:217]
v_mov_b64 v[234:235], v[232:233]
s_nop 0
v_permlane32_swap_b32 v218, v216
v_permlane32_swap_b32 v234, v232
v_permlane32_swap_b32 v219, v217
v_permlane32_swap_b32 v235, v233
v_pk_add_f32 v[216:217], v[216:217], v[218:219]
v_pk_add_f32 v[232:233], v[232:233], v[234:235]
v_rcp_f32 v216, v216
v_rcp_f32 v232, v232
v_rcp_f32 v217, v217
v_rcp_f32 v233, v233
v_pk_mul_f32 v[208:209], v[208:209], v[216:217] op_sel_hi:[1,0]
v_pk_mul_f32 v[224:225], v[224:225], v[232:233] op_sel_hi:[1,0]
v_pk_mul_f32 v[210:211], v[210:211], v[216:217] op_sel_hi:[1,0]
v_pk_mul_f32 v[226:227], v[226:227], v[232:233] op_sel_hi:[1,0]
v_pk_mul_f32 v[212:213], v[212:213], v[216:217] op_sel_hi:[1,0]
v_pk_mul_f32 v[228:229], v[228:229], v[232:233] op_sel_hi:[1,0]
v_pk_mul_f32 v[214:215], v[214:215], v[216:217] op_sel_hi:[1,0]
v_pk_mul_f32 v[230:231], v[230:231], v[232:233] op_sel_hi:[1,0]
v_pk_mul_f32 v[8:9], v[8:9], v[216:217] op_sel:[0,1] op_sel_hi:[1,1]
v_pk_mul_f32 v[12:13], v[12:13], v[232:233] op_sel:[0,1] op_sel_hi:[1,1]
v_pk_mul_f32 v[10:11], v[10:11], v[216:217] op_sel:[0,1] op_sel_hi:[1,1]
v_pk_mul_f32 v[14:15], v[14:15], v[232:233] op_sel:[0,1] op_sel_hi:[1,1]
v_pk_mul_f32 v[40:41], v[40:41], v[216:217] op_sel:[0,1] op_sel_hi:[1,1]
v_pk_mul_f32 v[44:45], v[44:45], v[232:233] op_sel:[0,1] op_sel_hi:[1,1]
v_pk_mul_f32 v[42:43], v[42:43], v[216:217] op_sel:[0,1] op_sel_hi:[1,1]
v_pk_mul_f32 v[46:47], v[46:47], v[232:233] op_sel:[0,1] op_sel_hi:[1,1]
CP 144,208,209
CP 152,224,225
CP 145,210,211
CP 153,226,227
CP 146,212,213
CP 154,228,229
CP 147,214,215
CP 155,230,231
CP 148,8,9
CP 156,12,13
CP 149,10,11
CP 157,14,15
CP 150,40,41
CP 158,44,45
CP 151,42,43
CP 159,46,47
s_waitcnt vmcnt(0)
s_barrier
s_cmp_eq_u32 s42, 0
s_cbranch_scc0 k1_kv_signalled
s_mov_b64 exec, 1
s_add_u32 s62, s40, 28311552
s_addc_u32 s63, s41, 0
s_lshl_b32 s3, s45, 7
v_mov_b32 v250, s3
v_mov_b32 v251, 1
global_atomic_add v250, v251, s[62:63] sc1
s_mov_b64 exec, -1
k1_kv_signalled:
CP 240,24,25
CP 244,28,29
CP 241,26,27
CP 245,30,31
CP 242,56,57
CP 246,60,61
CP 243,58,59
CP 247,62,63
s_nop 0
v_mfma_f32_16x16x32_bf16 v[24:27], a[0:3], v[240:243], 0
v_mfma_f32_16x16x32_bf16 v[28:31], a[0:3], v[244:247], 0
v_mfma_f32_16x16x32_bf16 v[56:59], a[4:7], v[240:243], 0
v_mfma_f32_16x16x32_bf16 v[60:63], a[4:7], v[244:247], 0
v_max3_f32 v216, v16, v17, v18
v_max3_f32 v232, v20, v21, v22
v_min3_f32 v217, v16, v17, v18
v_min3_f32 v233, v20, v21, v22
v_max3_f32 v216, v216, v19, v48
v_max3_f32 v232, v232, v23, v52
v_min3_f32 v217, v217, v19, v48
v_min3_f32 v233, v233, v23, v52
v_max3_f32 v216, v216, v49, v50
v_max3_f32 v232, v232, v53, v54
v_min3_f32 v217, v217, v49, v50
v_min3_f32 v233, v233, v53, v54
v_max_f32 v216, v216, v51
v_max_f32 v232, v232, v55
v_min_f32 v217, v217, v51
v_min_f32 v233, v233, v55
v_mov_b64 v[218:219], v[216:217]
v_mov_b64 v[234:235], v[232:233]
s_nop 0
v_permlane16_swap_b32 v218, v216
v_permlane16_swap_b32 v234, v232
v_permlane16_swap_b32 v219, v217
v_permlane16_swap_b32 v235, v233
v_max_f32 v216, v216, v218
v_max_f32 v232, v232, v234
v_min_f32 v217, v217, v219
v_min_f32 v233, v233, v235
v_mov_b64 v[218:219], v[216:217]
v_mov_b64 v[234:235], v[232:233]
s_nop 0
v_permlane32_swap_b32 v218, v216
v_permlane32_swap_b32 v234, v232
v_permlane32_swap_b32 v219, v217
v_permlane32_swap_b32 v235, v233
v_max_f32 v216, v216, v218
v_max_f32 v232, v232, v234
v_min_f32 v217, v217, v219
v_min_f32 v233, v233, v235
v_pk_mul_f32 v[216:217], v[216:217], s[60:61] op_sel:[0,1] op_sel_hi:[1,0]
v_pk_mul_f32 v[232:233], v[232:233], s[60:61] op_sel:[0,1] op_sel_hi:[1,0]
v_pk_fma_f32 v[208:209], v[16:17], s[60:61], v[216:217] op_sel_hi:[1,0,0]
v_pk_fma_f32 v[224:225], v[20:21], s[60:61], v[232:233] op_sel_hi:[1,0,0]
v_pk_fma_f32 v[210:211], v[18:19], s[60:61], v[216:217] op_sel_hi:[1,0,0]
v_pk_fma_f32 v[226:227], v[22:23], s[60:61], v[232:233] op_sel_hi:[1,0,0]
v_pk_fma_f32 v[212:213], v[48:49], s[60:61], v[216:217] op_sel_hi:[1,0,0]
v_pk_fma_f32 v[228:229], v[52:53], s[60:61], v[232:233] op_sel_hi:[1,0,0]
v_pk_fma_f32 v[214:215], v[50:51], s[60:61], v[216:217] op_sel_hi:[1,0,0]
v_pk_fma_f32 v[230:231], v[54:55], s[60:61], v[232:233] op_sel_hi:[1,0,0]
v_pk_fma_f32 v[16:17], v[16:17], s[60:61], v[216:217] op_sel:[0,1,1] op_sel_hi:[1,1,1]
v_pk_fma_f32 v[20:21], v[20:21], s[60:61], v[232:233] op_sel:[0,1,1] op_sel_hi:[1,1,1]
v_pk_fma_f32 v[18:19], v[18:19], s[60:61], v[216:217] op_sel:[0,1,1] op_sel_hi:[1,1,1]
v_pk_fma_f32 v[22:23], v[22:23], s[60:61], v[232:233] op_sel:[0,1,1] op_sel_hi:[1,1,1]
v_pk_fma_f32 v[48:49], v[48:49], s[60:61], v[216:217] op_sel:[0,1,1] op_sel_hi:[1,1,1]
v_pk_fma_f32 v[52:53], v[52:53], s[60:61], v[232:233] op_sel:[0,1,1] op_sel_hi:[1,1,1]
v_pk_fma_f32 v[50:51], v[50:51], s[60:61], v[216:217] op_sel:[0,1,1] op_sel_hi:[1,1,1]
v_pk_fma_f32 v[54:55], v[54:55], s[60:61], v[232:233] op_sel:[0,1,1] op_sel_hi:[1,1,1]
v_exp_f32 v208, v208
v_exp_f32 v224, v224
v_exp_f32 v209, v209
v_exp_f32 v225, v225
v_exp_f32 v210, v210
v_exp_f32 v226, v226
v_exp_f32 v211, v211
v_exp_f32 v227, v227
v_exp_f32 v212, v212
v_exp_f32 v228, v228
v_exp_f32 v213, v213
v_exp_f32 v229, v229
v_exp_f32 v214, v214
v_exp_f32 v230, v230
v_exp_f32 v215, v215
v_exp_f32 v231, v231
v_exp_f32 v16, v16
v_exp_f32 v20, v20
v_exp_f32 v17, v17
v_exp_f32 v21, v21
v_exp_f32 v18, v18
v_exp_f32 v22, v22
v_exp_f32 v19, v19
v_exp_f32 v23, v23
v_exp_f32 v48, v48
v_exp_f32 v52, v52
v_exp_f32 v49, v49
v_exp_f32 v53, v53
v_exp_f32 v50, v50
v_exp_f32 v54, v54
v_exp_f32 v51, v51
v_exp_f32 v55, v55
v_pk_add_f32 v[218:219], v[208:209], v[210:211]
v_pk_add_f32 v[234:235], v[224:225], v[226:227]
v_pk_add_f32 v[216:217], v[212:213], v[214:215]
v_pk_add_f32 v[232:233], v[228:229], v[230:231]
v_pk_add_f32 v[160:161], v[16:17], v[18:19]
v_pk_add_f32 v[168:169], v[20:21], v[22:23]
v_pk_add_f32 v[162:163], v[48:49], v[50:51]
v_pk_add_f32 v[170:171], v[52:53], v[54:55]
v_pk_add_f32 v[218:219], v[218:219], v[216:217]
v_pk_add_f32 v[234:235], v[234:235], v[232:233]
v_pk_add_f32 v[160:161], v[160:161], v[162:163]
v_pk_add_f32 v[168:169], v[168:169], v[170:171]
v_add_f32 v216, v218, v219
v_add_f32 v232, v234, v235
v_add_f32 v217, v160, v161
v_add_f32 v233, v168, v169
v_mov_b64 v[218:219], v[216:217]
v_mov_b64 v[234:235], v[232:233]
s_nop 0
v_permlane16_swap_b32 v218, v216
v_permlane16_swap_b32 v234, v232
v_permlane16_swap_b32 v219, v217
v_permlane16_swap_b32 v235, v233
v_pk_add_f32 v[216:217], v[216:217], v[218:219]
v_pk_add_f32 v[232:233], v[232:233], v[234:235]
v_mov_b64 v[218:219], v[216:217]
v_mov_b64 v[234:235], v[232:233]
s_nop 0
v_permlane32_swap_b32 v218, v216
v_permlane32_swap_b32 v234, v232
v_permlane32_swap_b32 v219, v217
v_permlane32_swap_b32 v235, v233
v_pk_add_f32 v[216:217], v[216:217], v[218:219]
v_pk_add_f32 v[232:233], v[232:233], v[234:235]
v_rcp_f32 v216, v216
v_rcp_f32 v232, v232
v_rcp_f32 v217, v217
v_rcp_f32 v233, v233
v_pk_mul_f32 v[208:209], v[208:209], v[216:217] op_sel_hi:[1,0]
v_pk_mul_f32 v[224:225], v[224:225], v[232:233] op_sel_hi:[1,0]
v_pk_mul_f32 v[210:211], v[210:211], v[216:217] op_sel_hi:[1,0]
v_pk_mul_f32 v[226:227], v[226:227], v[232:233] op_sel_hi:[1,0]
v_pk_mul_f32 v[212:213], v[212:213], v[216:217] op_sel_hi:[1,0]
v_pk_mul_f32 v[228:229], v[228:229], v[232:233] op_sel_hi:[1,0]
v_pk_mul_f32 v[214:215], v[214:215], v[216:217] op_sel_hi:[1,0]
v_pk_mul_f32 v[230:231], v[230:231], v[232:233] op_sel_hi:[1,0]
v_pk_mul_f32 v[16:17], v[16:17], v[216:217] op_sel:[0,1] op_sel_hi:[1,1]
v_pk_mul_f32 v[20:21], v[20:21], v[232:233] op_sel:[0,1] op_sel_hi:[1,1]
v_pk_mul_f32 v[18:19], v[18:19], v[216:217] op_sel:[0,1] op_sel_hi:[1,1]
v_pk_mul_f32 v[22:23], v[22:23], v[232:233] op_sel:[0,1] op_sel_hi:[1,1]
v_pk_mul_f32 v[48:49], v[48:49], v[216:217] op_sel:[0,1] op_sel_hi:[1,1]
v_pk_mul_f32 v[52:53], v[52:53], v[232:233] op_sel:[0,1] op_sel_hi:[1,1]
v_pk_mul_f32 v[50:51], v[50:51], v[216:217] op_sel:[0,1] op_sel_hi:[1,1]
v_pk_mul_f32 v[54:55], v[54:55], v[232:233] op_sel:[0,1] op_sel_hi:[1,1]
CP 160,208,209
CP 168,224,225
CP 161,210,211
CP 169,226,227
CP 162,212,213
CP 170,228,229
CP 163,214,215
CP 171,230,231
CP 164,16,17
CP 172,20,21
CP 165,18,19
CP 173,22,23
CP 166,48,49
CP 174,52,53
CP 167,50,51
CP 175,54,55
v_max3_f32 v216, v24, v25, v26
v_max3_f32 v232, v28, v29, v30
v_min3_f32 v217, v24, v25, v26
v_min3_f32 v233, v28, v29, v30
v_max3_f32 v216, v216, v27, v56
v_max3_f32 v232, v232, v31, v60
v_min3_f32 v217, v217, v27, v56
v_min3_f32 v233, v233, v31, v60
v_max3_f32 v216, v216, v57, v58
v_max3_f32 v232, v232, v61, v62
v_min3_f32 v217, v217, v57, v58
v_min3_f32 v233, v233, v61, v62
v_max_f32 v216, v216, v59
v_max_f32 v232, v232, v63
v_min_f32 v217, v217, v59
v_min_f32 v233, v233, v63
v_mov_b64 v[218:219], v[216:217]
v_mov_b64 v[234:235], v[232:233]
s_nop 0
v_permlane16_swap_b32 v218, v216
v_permlane16_swap_b32 v234, v232
v_permlane16_swap_b32 v219, v217
v_permlane16_swap_b32 v235, v233
v_max_f32 v216, v216, v218
v_max_f32 v232, v232, v234
v_min_f32 v217, v217, v219
v_min_f32 v233, v233, v235
v_mov_b64 v[218:219], v[216:217]
v_mov_b64 v[234:235], v[232:233]
s_nop 0
v_permlane32_swap_b32 v218, v216
v_permlane32_swap_b32 v234, v232
v_permlane32_swap_b32 v219, v217
v_permlane32_swap_b32 v235, v233
v_max_f32 v216, v216, v218
v_max_f32 v232, v232, v234
v_min_f32 v217, v217, v219
v_min_f32 v233, v233, v235
v_pk_mul_f32 v[216:217], v[216:217], s[60:61] op_sel:[0,1] op_sel_hi:[1,0]
v_pk_mul_f32 v[232:233], v[232:233], s[60:61] op_sel:[0,1] op_sel_hi:[1,0]
v_pk_fma_f32 v[208:209], v[24:25], s[60:61], v[216:217] op_sel_hi:[1,0,0]
v_pk_fma_f32 v[224:225], v[28:29], s[60:61], v[232:233] op_sel_hi:[1,0,0]
v_pk_fma_f32 v[210:211], v[26:27], s[60:61], v[216:217] op_sel_hi:[1,0,0]
v_pk_fma_f32 v[226:227], v[30:31], s[60:61], v[232:233] op_sel_hi:[1,0,0]
v_pk_fma_f32 v[212:213], v[56:57], s[60:61], v[216:217] op_sel_hi:[1,0,0]
v_pk_fma_f32 v[228:229], v[60:61], s[60:61], v[232:233] op_sel_hi:[1,0,0]
v_pk_fma_f32 v[214:215], v[58:59], s[60:61], v[216:217] op_sel_hi:[1,0,0]
v_pk_fma_f32 v[230:231], v[62:63], s[60:61], v[232:233] op_sel_hi:[1,0,0]
v_pk_fma_f32 v[24:25], v[24:25], s[60:61], v[216:217] op_sel:[0,1,1] op_sel_hi:[1,1,1]
v_pk_fma_f32 v[28:29], v[28:29], s[60:61], v[232:233] op_sel:[0,1,1] op_sel_hi:[1,1,1]
v_pk_fma_f32 v[26:27], v[26:27], s[60:61], v[216:217] op_sel:[0,1,1] op_sel_hi:[1,1,1]
v_pk_fma_f32 v[30:31], v[30:31], s[60:61], v[232:233] op_sel:[0,1,1] op_sel_hi:[1,1,1]
v_pk_fma_f32 v[56:57], v[56:57], s[60:61], v[216:217] op_sel:[0,1,1] op_sel_hi:[1,1,1]
v_pk_fma_f32 v[60:61], v[60:61], s[60:61], v[232:233] op_sel:[0,1,1] op_sel_hi:[1,1,1]
v_pk_fma_f32 v[58:59], v[58:59], s[60:61], v[216:217] op_sel:[0,1,1] op_sel_hi:[1,1,1]
v_pk_fma_f32 v[62:63], v[62:63], s[60:61], v[232:233] op_sel:[0,1,1] op_sel_hi:[1,1,1]
v_exp_f32 v208, v208
v_exp_f32 v224, v224
v_exp_f32 v209, v209
v_exp_f32 v225, v225
v_exp_f32 v210, v210
v_exp_f32 v226, v226
v_exp_f32 v211, v211
v_exp_f32 v227, v227
v_exp_f32 v212, v212
v_exp_f32 v228, v228
v_exp_f32 v213, v213
v_exp_f32 v229, v229
v_exp_f32 v214, v214
v_exp_f32 v230, v230
v_exp_f32 v215, v215
v_exp_f32 v231, v231
v_exp_f32 v24, v24
v_exp_f32 v28, v28
v_exp_f32 v25, v25
v_exp_f32 v29, v29
v_exp_f32 v26, v26
v_exp_f32 v30, v30
v_exp_f32 v27, v27
v_exp_f32 v31, v31
v_exp_f32 v56, v56
v_exp_f32 v60, v60
v_exp_f32 v57, v57
v_exp_f32 v61, v61
v_exp_f32 v58, v58
v_exp_f32 v62, v62
v_exp_f32 v59, v59
v_exp_f32 v63, v63
v_pk_add_f32 v[218:219], v[208:209], v[210:211]
v_pk_add_f32 v[234:235], v[224:225], v[226:227]
v_pk_add_f32 v[216:217], v[212:213], v[214:215]
v_pk_add_f32 v[232:233], v[228:229], v[230:231]
v_pk_add_f32 v[176:177], v[24:25], v[26:27]
v_pk_add_f32 v[184:185], v[28:29], v[30:31]
v_pk_add_f32 v[178:179], v[56:57], v[58:59]
v_pk_add_f32 v[186:187], v[60:61], v[62:63]
v_pk_add_f32 v[218:219], v[218:219], v[216:217]
v_pk_add_f32 v[234:235], v[234:235], v[232:233]
v_pk_add_f32 v[176:177], v[176:177], v[178:179]
v_pk_add_f32 v[184:185], v[184:185], v[186:187]
v_add_f32 v216, v218, v219
v_add_f32 v232, v234, v235
v_add_f32 v217, v176, v177
v_add_f32 v233, v184, v185
v_mov_b64 v[218:219], v[216:217]
v_mov_b64 v[234:235], v[232:233]
s_nop 0
v_permlane16_swap_b32 v218, v216
v_permlane16_swap_b32 v234, v232
v_permlane16_swap_b32 v219, v217
v_permlane16_swap_b32 v235, v233
v_pk_add_f32 v[216:217], v[216:217], v[218:219]
v_pk_add_f32 v[232:233], v[232:233], v[234:235]
v_mov_b64 v[218:219], v[216:217]
v_mov_b64 v[234:235], v[232:233]
s_nop 0
v_permlane32_swap_b32 v218, v216
v_permlane32_swap_b32 v234, v232
v_permlane32_swap_b32 v219, v217
v_permlane32_swap_b32 v235, v233
v_pk_add_f32 v[216:217], v[216:217], v[218:219]
v_pk_add_f32 v[232:233], v[232:233], v[234:235]
v_rcp_f32 v216, v216
v_rcp_f32 v232, v232
v_rcp_f32 v217, v217
v_rcp_f32 v233, v233
v_pk_mul_f32 v[208:209], v[208:209], v[216:217] op_sel_hi:[1,0]
v_pk_mul_f32 v[224:225], v[224:225], v[232:233] op_sel_hi:[1,0]
v_pk_mul_f32 v[210:211], v[210:211], v[216:217] op_sel_hi:[1,0]
v_pk_mul_f32 v[226:227], v[226:227], v[232:233] op_sel_hi:[1,0]
v_pk_mul_f32 v[212:213], v[212:213], v[216:217] op_sel_hi:[1,0]
v_pk_mul_f32 v[228:229], v[228:229], v[232:233] op_sel_hi:[1,0]
v_pk_mul_f32 v[214:215], v[214:215], v[216:217] op_sel_hi:[1,0]
v_pk_mul_f32 v[230:231], v[230:231], v[232:233] op_sel_hi:[1,0]
v_pk_mul_f32 v[24:25], v[24:25], v[216:217] op_sel:[0,1] op_sel_hi:[1,1]
v_pk_mul_f32 v[28:29], v[28:29], v[232:233] op_sel:[0,1] op_sel_hi:[1,1]
v_pk_mul_f32 v[26:27], v[26:27], v[216:217] op_sel:[0,1] op_sel_hi:[1,1]
v_pk_mul_f32 v[30:31], v[30:31], v[232:233] op_sel:[0,1] op_sel_hi:[1,1]
v_pk_mul_f32 v[56:57], v[56:57], v[216:217] op_sel:[0,1] op_sel_hi:[1,1]
v_pk_mul_f32 v[60:61], v[60:61], v[232:233] op_sel:[0,1] op_sel_hi:[1,1]
v_pk_mul_f32 v[58:59], v[58:59], v[216:217] op_sel:[0,1] op_sel_hi:[1,1]
v_pk_mul_f32 v[62:63], v[62:63], v[232:233] op_sel:[0,1] op_sel_hi:[1,1]
CP 176,208,209
CP 184,224,225
CP 177,210,211
CP 185,226,227
CP 178,212,213
CP 186,228,229
CP 179,214,215
CP 187,230,231
CP 180,24,25
CP 188,28,29
CP 181,26,27
CP 189,30,31
CP 182,56,57
CP 190,60,61
CP 183,58,59
CP 191,62,63
s_cmp_eq_u32 s42, 0
s_cbranch_scc0 k1_kv_polled
s_mov_b64 exec, 1
s_add_u32 s60, s40, 28311552
s_addc_u32 s61, s41, 0
s_lshl_b32 s3, s45, 7
v_mov_b32 v210, s3
k1_kv_spin:
global_load_dword v211, v210, s[60:61] sc1
s_waitcnt vmcnt(0)
v_readfirstlane_b32 s55, v211
s_nop 3
s_cmp_ge_u32 s55, 8
s_cbranch_scc1 k1_kv_ok
s_sleep 2
s_branch k1_kv_spin
k1_kv_ok:
s_mov_b64 exec, -1
k1_kv_polled:
s_barrier
s_lshl_b32 s57, s68, 7
buffer_load_dwordx4 v[220:223], v196, s[12:15], s57 offen offset:0 sc1
buffer_load_dwordx4 v[224:227], v196, s[12:15], s57 offen offset:64 sc1
s_lshl_b32 s57, s68, 12
buffer_load_dword v0, v197, s[8:11], s57 offen offset:0 sc1
buffer_load_dword v1, v197, s[8:11], s57 offen offset:256 sc1
buffer_load_dword v2, v197, s[8:11], s57 offen offset:512 sc1
buffer_load_dword v3, v197, s[8:11], s57 offen offset:768 sc1
buffer_load_dword v4, v197, s[8:11], s57 offen offset:1024 sc1
buffer_load_dword v5, v197, s[8:11], s57 offen offset:1280 sc1
buffer_load_dword v6, v197, s[8:11], s57 offen offset:1536 sc1
buffer_load_dword v7, v197, s[8:11], s57 offen offset:1792 sc1
buffer_load_dword v8, v197, s[8:11], s57 offen offset:2048 sc1
buffer_load_dword v9, v197, s[8:11], s57 offen offset:2304 sc1
buffer_load_dword v10, v197, s[8:11], s57 offen offset:2560 sc1
buffer_load_dword v11, v197, s[8:11], s57 offen offset:2816 sc1
buffer_load_dword v12, v197, s[8:11], s57 offen offset:3072 sc1
buffer_load_dword v13, v197, s[8:11], s57 offen offset:3328 sc1
buffer_load_dword v14, v197, s[8:11], s57 offen offset:3584 sc1
buffer_load_dword v15, v197, s[8:11], s57 offen offset:3840 sc1
s_waitcnt vmcnt(0)
CP 16,0,1
CP 17,2,3
CP 18,8,9
CP 19,10,11
CP 20,4,5
CP 21,6,7
CP 22,12,13
CP 23,14,15
CP 24,220,221
CP 25,222,223
CP 26,224,225
CP 27,226,227
s_lshl_b32 s3, s53, 1
s_add_u32 s56, s3, s52
s_mul_i32 s56, s56, 3072
s_add_u32 s56, s56, 114688
v_add_u32 v240, s56, v195
ds_write_b128 v240, v[16:19] offset:0
ds_write_b128 v240, v[20:23] offset:1024
ds_write_b128 v240, v[24:27] offset:2048
s_mul_i32 s56, s3, 3072
s_add_u32 s56, s56, 114688
v_add_u32 v210, s56, v195
s_waitcnt lgkmcnt(0)
s_barrier
RB 16,210,0
RB 20,210,1024
RB 24,210,2048
RB 28,210,3072
RB 32,210,4096
RB 36,210,5120
s_add_u32 s8, s40, 0
s_addc_u32 s9, s41, 0
s_and_b32 s9, s9, 0xffff
s_mov_b32 s10, 18874368
s_mov_b32 s11, 0x20000
s_lshl_b32 s56, s44, 4
s_lshl_b32 s3, s52, 3
s_add_u32 s56, s56, s3
s_mul_i32 s56, s56, 147456
s_lshl_b32 s3, s45, 1
s_add_u32 s3, s3, s53
s_add_u32 s3, s3, 112
s_lshl_b32 s3, s3, 10
s_add_u32 s56, s56, s3
s_waitcnt lgkmcnt(0)
v_mfma_f32_16x16x32_bf16 v[32:35], a[16:19], v[128:131], 0
v_mfma_f32_16x16x32_bf16 v[36:39], a[20:23], v[128:131], 0
v_mfma_f32_16x16x32_bf16 v[40:43], a[24:27], v[128:131], 0
v_mfma_f32_16x16x32_bf16 v[32:35], a[28:31], v[132:135], v[32:35]
v_mfma_f32_16x16x32_bf16 v[36:39], a[32:35], v[132:135], v[36:39]
v_mfma_f32_16x16x32_bf16 v[40:43], a[36:39], v[132:135], v[40:43]
v_mfma_f32_16x16x32_bf16 v[48:51], a[16:19], v[136:139], 0
v_mfma_f32_16x16x32_bf16 v[52:55], a[20:23], v[136:139], 0
v_mfma_f32_16x16x32_bf16 v[56:59], a[24:27], v[136:139], 0
v_mfma_f32_16x16x32_bf16 v[48:51], a[28:31], v[140:143], v[48:51]
v_mfma_f32_16x16x32_bf16 v[52:55], a[32:35], v[140:143], v[52:55]
v_mfma_f32_16x16x32_bf16 v[56:59], a[36:39], v[140:143], v[56:59]
s_nop 1
v_add_f32 v40, 0x358637bd, v40
v_rcp_f32 v40, v40
s_add_u32 s3, s56, 0
v_pk_mul_f32 v[32:33], v[32:33], v[40:41] op_sel_hi:[1,0]
v_pk_mul_f32 v[34:35], v[34:35], v[40:41] op_sel_hi:[1,0]
v_pk_mul_f32 v[36:37], v[36:37], v[40:41] op_sel_hi:[1,0]
v_pk_mul_f32 v[38:39], v[38:39], v[40:41] op_sel_hi:[1,0]
CP 64,32,33
CP 65,34,35
CP 66,36,37
CP 67,38,39
buffer_store_dwordx4 v[64:67], v195, s[8:11], s3 offen sc1
v_mfma_f32_16x16x32_bf16 v[32:35], a[16:19], v[144:147], 0
v_mfma_f32_16x16x32_bf16 v[36:39], a[20:23], v[144:147], 0
v_mfma_f32_16x16x32_bf16 v[40:43], a[24:27], v[144:147], 0
v_mfma_f32_16x16x32_bf16 v[32:35], a[28:31], v[148:151], v[32:35]
v_mfma_f32_16x16x32_bf16 v[36:39], a[32:35], v[148:151], v[36:39]
v_mfma_f32_16x16x32_bf16 v[40:43], a[36:39], v[148:151], v[40:43]
v_add_f32 v56, 0x358637bd, v56
v_rcp_f32 v56, v56
s_add_u32 s3, s56, 147456
v_pk_mul_f32 v[48:49], v[48:49], v[56:57] op_sel_hi:[1,0]
v_pk_mul_f32 v[50:51], v[50:51], v[56:57] op_sel_hi:[1,0]
v_pk_mul_f32 v[52:53], v[52:53], v[56:57] op_sel_hi:[1,0]
v_pk_mul_f32 v[54:55], v[54:55], v[56:57] op_sel_hi:[1,0]
CP 68,48,49
CP 69,50,51
CP 70,52,53
CP 71,54,55
buffer_store_dwordx4 v[68:71], v195, s[8:11], s3 offen sc1
v_mfma_f32_16x16x32_bf16 v[48:51], a[16:19], v[152:155], 0
v_mfma_f32_16x16x32_bf16 v[52:55], a[20:23], v[152:155], 0
v_mfma_f32_16x16x32_bf16 v[56:59], a[24:27], v[152:155], 0
v_mfma_f32_16x16x32_bf16 v[48:51], a[28:31], v[156:159], v[48:51]
v_mfma_f32_16x16x32_bf16 v[52:55], a[32:35], v[156:159], v[52:55]
v_mfma_f32_16x16x32_bf16 v[56:59], a[36:39], v[156:159], v[56:59]
v_add_f32 v40, 0x358637bd, v40
v_rcp_f32 v40, v40
s_add_u32 s3, s56, 294912
v_pk_mul_f32 v[32:33], v[32:33], v[40:41] op_sel_hi:[1,0]
v_pk_mul_f32 v[34:35], v[34:35], v[40:41] op_sel_hi:[1,0]
v_pk_mul_f32 v[36:37], v[36:37], v[40:41] op_sel_hi:[1,0]
v_pk_mul_f32 v[38:39], v[38:39], v[40:41] op_sel_hi:[1,0]
CP 64,32,33
CP 65,34,35
CP 66,36,37
CP 67,38,39
buffer_store_dwordx4 v[64:67], v195, s[8:11], s3 offen sc1
v_mfma_f32_16x16x32_bf16 v[32:35], a[16:19], v[160:163], 0
v_mfma_f32_16x16x32_bf16 v[36:39], a[20:23], v[160:163], 0
v_mfma_f32_16x16x32_bf16 v[40:43], a[24:27], v[160:163], 0
v_mfma_f32_16x16x32_bf16 v[32:35], a[28:31], v[164:167], v[32:35]
v_mfma_f32_16x16x32_bf16 v[36:39], a[32:35], v[164:167], v[36:39]
v_mfma_f32_16x16x32_bf16 v[40:43], a[36:39], v[164:167], v[40:43]
v_add_f32 v56, 0x358637bd, v56
v_rcp_f32 v56, v56
s_add_u32 s3, s56, 442368
v_pk_mul_f32 v[48:49], v[48:49], v[56:57] op_sel_hi:[1,0]
v_pk_mul_f32 v[50:51], v[50:51], v[56:57] op_sel_hi:[1,0]
v_pk_mul_f32 v[52:53], v[52:53], v[56:57] op_sel_hi:[1,0]
v_pk_mul_f32 v[54:55], v[54:55], v[56:57] op_sel_hi:[1,0]
CP 68,48,49
CP 69,50,51
CP 70,52,53
CP 71,54,55
buffer_store_dwordx4 v[68:71], v195, s[8:11], s3 offen sc1
v_mfma_f32_16x16x32_bf16 v[48:51], a[16:19], v[168:171], 0
v_mfma_f32_16x16x32_bf16 v[52:55], a[20:23], v[168:171], 0
v_mfma_f32_16x16x32_bf16 v[56:59], a[24:27], v[168:171], 0
v_mfma_f32_16x16x32_bf16 v[48:51], a[28:31], v[172:175], v[48:51]
v_mfma_f32_16x16x32_bf16 v[52:55], a[32:35], v[172:175], v[52:55]
v_mfma_f32_16x16x32_bf16 v[56:59], a[36:39], v[172:175], v[56:59]
v_add_f32 v40, 0x358637bd, v40
v_rcp_f32 v40, v40
s_add_u32 s3, s56, 589824
v_pk_mul_f32 v[32:33], v[32:33], v[40:41] op_sel_hi:[1,0]
v_pk_mul_f32 v[34:35], v[34:35], v[40:41] op_sel_hi:[1,0]
v_pk_mul_f32 v[36:37], v[36:37], v[40:41] op_sel_hi:[1,0]
v_pk_mul_f32 v[38:39], v[38:39], v[40:41] op_sel_hi:[1,0]
CP 64,32,33
CP 65,34,35
CP 66,36,37
CP 67,38,39
buffer_store_dwordx4 v[64:67], v195, s[8:11], s3 offen sc1
v_mfma_f32_16x16x32_bf16 v[32:35], a[16:19], v[176:179], 0
v_mfma_f32_16x16x32_bf16 v[36:39], a[20:23], v[176:179], 0
v_mfma_f32_16x16x32_bf16 v[40:43], a[24:27], v[176:179], 0
v_mfma_f32_16x16x32_bf16 v[32:35], a[28:31], v[180:183], v[32:35]
v_mfma_f32_16x16x32_bf16 v[36:39], a[32:35], v[180:183], v[36:39]
v_mfma_f32_16x16x32_bf16 v[40:43], a[36:39], v[180:183], v[40:43]
v_add_f32 v56, 0x358637bd, v56
v_rcp_f32 v56, v56
s_add_u32 s3, s56, 737280
v_pk_mul_f32 v[48:49], v[48:49], v[56:57] op_sel_hi:[1,0]
v_pk_mul_f32 v[50:51], v[50:51], v[56:57] op_sel_hi:[1,0]
v_pk_mul_f32 v[52:53], v[52:53], v[56:57] op_sel_hi:[1,0]
v_pk_mul_f32 v[54:55], v[54:55], v[56:57] op_sel_hi:[1,0]
CP 68,48,49
CP 69,50,51
CP 70,52,53
CP 71,54,55
buffer_store_dwordx4 v[68:71], v195, s[8:11], s3 offen sc1
v_mfma_f32_16x16x32_bf16 v[48:51], a[16:19], v[184:187], 0
v_mfma_f32_16x16x32_bf16 v[52:55], a[20:23], v[184:187], 0
v_mfma_f32_16x16x32_bf16 v[56:59], a[24:27], v[184:187], 0
v_mfma_f32_16x16x32_bf16 v[48:51], a[28:31], v[188:191], v[48:51]
v_mfma_f32_16x16x32_bf16 v[52:55], a[32:35], v[188:191], v[52:55]
v_mfma_f32_16x16x32_bf16 v[56:59], a[36:39], v[188:191], v[56:59]
v_add_f32 v40, 0x358637bd, v40
v_rcp_f32 v40, v40
s_add_u32 s3, s56, 884736
v_pk_mul_f32 v[32:33], v[32:33], v[40:41] op_sel_hi:[1,0]
v_pk_mul_f32 v[34:35], v[34:35], v[40:41] op_sel_hi:[1,0]
v_pk_mul_f32 v[36:37], v[36:37], v[40:41] op_sel_hi:[1,0]
v_pk_mul_f32 v[38:39], v[38:39], v[40:41] op_sel_hi:[1,0]
CP 64,32,33
CP 65,34,35
CP 66,36,37
CP 67,38,39
buffer_store_dwordx4 v[64:67], v195, s[8:11], s3 offen sc1
v_add_f32 v56, 0x358637bd, v56
v_rcp_f32 v56, v56
s_add_u32 s3, s56, 1032192
v_pk_mul_f32 v[48:49], v[48:49], v[56:57] op_sel_hi:[1,0]
v_pk_mul_f32 v[50:51], v[50:51], v[56:57] op_sel_hi:[1,0]
v_pk_mul_f32 v[52:53], v[52:53], v[56:57] op_sel_hi:[1,0]
v_pk_mul_f32 v[54:55], v[54:55], v[56:57] op_sel_hi:[1,0]
CP 68,48,49
CP 69,50,51
CP 70,52,53
CP 71,54,55
buffer_store_dwordx4 v[68:71], v195, s[8:11], s3 offen sc1
s_add_u32 s72, s44, 24
s_lshl_b32 s72, s72, 7
s_branch k1_done
k1_done:
p3_start:
v_mbcnt_lo_u32_b32 v146, -1, 0
v_mbcnt_hi_u32_b32 v146, -1, v146
s_and_b32 s45, s2, 1
s_bfe_u32 s43, s2, 0x10001
s_lshl_b32 s43, s43, 3
s_bfe_u32 s3, s2, 0x30003
s_add_u32 s43, s43, s3
s_bfe_u32 s44, s2, 0x10002
s_lshl_b32 s44, s44, 2
s_lshr_b32 s3, s2, 6
s_add_u32 s44, s44, s3
s_lshl_b32 s50, s42, 13
s_lshr_b32 s52, s42, 1
s_and_b32 s53, s42, 1
v_lshlrev_b32 v197, 4, v146
s_lshl_b32 s3, s52, 13
v_add_u32 v136, s3, v197
v_add_u32 v137, 0x10000, v136
v_lshrrev_b32 v148, 4, v146
v_bfe_u32 v149, v146, 2, 2
v_lshl_add_u32 v149, v148, 2, v149
v_and_b32 v150, 7, v149
v_and_b32 v151, 3, v146
v_lshlrev_b32 v151, 3, v151
v_lshl_add_u32 v151, v149, 8, v151
v_add_u32 v151, 16384, v151
s_lshl_b32 s3, s53, 2
s_add_u32 s62, s3, 0
v_xor_b32 v152, s62, v150
v_lshl_add_u32 v138, v152, 5, v151
v_add_u32 v142, 0x10000, v138
s_add_u32 s62, s3, 1
v_xor_b32 v152, s62, v150
v_lshl_add_u32 v139, v152, 5, v151
v_add_u32 v143, 0x10000, v139
s_add_u32 s62, s3, 2
v_xor_b32 v152, s62, v150
v_lshl_add_u32 v140, v152, 5, v151
v_add_u32 v144, 0x10000, v140
s_add_u32 s62, s3, 3
v_xor_b32 v152, s62, v150
v_lshl_add_u32 v141, v152, 5, v151
v_add_u32 v145, 0x10000, v141
s_cmp_ge_u32 s42, 2
s_cbranch_scc1 p3_wsetup
s_mul_i32 s3, s42, 589824
v_add_u32 v148, s3, v197
v_add_u32 v128, 0, v148
v_add_u32 v129, 1024, v148
v_add_u32 v130, 147456, v148
v_add_u32 v131, 148480, v148
v_add_u32 v132, 294912, v148
v_add_u32 v133, 295936, v148
v_add_u32 v134, 442368, v148
v_add_u32 v135, 443392, v148
s_mul_i32 s3, s43, 1179648
s_mul_i32 s62, s45, 73728
s_add_u32 s3, s3, s62
s_add_u32 s4, s40, s3
s_addc_u32 s5, s41, 0
s_sub_u32 s51, 18874368, s3
s_mov_b32 s47, 2048
s_branch p3_setup_done
p3_wsetup:
v_lshrrev_b32 v148, 4, v146
v_and_b32 v149, 15, v146
s_sub_u32 s3, s42, 2
s_lshl_b32 s3, s3, 16
v_add_u32 v150, 0, v148
v_lshlrev_b32 v151, 1, v150
v_xor_b32 v151, v151, v149
v_lshlrev_b32 v151, 4, v151
v_lshl_add_u32 v151, v148, 11, v151
v_add_u32 v151, s3, v151
v_add_u32 v128, 0, v151
v_add_u32 v130, 16384, v151
v_add_u32 v132, 32768, v151
v_add_u32 v134, 49152, v151
v_add_u32 v150, 4, v148
v_lshlrev_b32 v151, 1, v150
v_xor_b32 v151, v151, v149
v_lshlrev_b32 v151, 4, v151
v_lshl_add_u32 v151, v148, 11, v151
v_add_u32 v151, s3, v151
v_add_u32 v129, 8192, v151
v_add_u32 v131, 24576, v151
v_add_u32 v133, 40960, v151
v_add_u32 v135, 57344, v151
s_mul_i32 s3, s45, 4718592
s_lshl_b32 s62, s44, 8
s_add_u32 s3, s3, s62
s_add_u32 s4, s30, s3
s_addc_u32 s5, s31, 0
s_sub_u32 s51, 7340032, s3
s_mov_b32 s47, 131072
p3_setup_done:
s_and_b32 s5, s5, 0xffff
s_mov_b32 s6, s51
s_mov_b32 s7, 0x20000
s_mov_b32 s46, 0
s_add_u32 s70, s40, 28311552
s_addc_u32 s71, s41, 0
v_mov_b32 v64, 0
v_mov_b32 v65, 0
v_mov_b32 v66, 0
v_mov_b32 v67, 0
v_mov_b32 v68, 0
v_mov_b32 v69, 0
v_mov_b32 v70, 0
v_mov_b32 v71, 0
v_mov_b32 v72, 0
v_mov_b32 v73, 0
v_mov_b32 v74, 0
v_mov_b32 v75, 0
v_mov_b32 v76, 0
v_mov_b32 v77, 0
v_mov_b32 v78, 0
v_mov_b32 v79, 0
v_mov_b32 v80, 0
v_mov_b32 v81, 0
v_mov_b32 v82, 0
v_mov_b32 v83, 0
v_mov_b32 v84, 0
v_mov_b32 v85, 0
v_mov_b32 v86, 0
v_mov_b32 v87, 0
v_mov_b32 v88, 0
v_mov_b32 v89, 0
v_mov_b32 v90, 0
v_mov_b32 v91, 0
v_mov_b32 v92, 0
v_mov_b32 v93, 0
v_mov_b32 v94, 0
v_mov_b32 v95, 0
v_mov_b32 v96, 0
v_mov_b32 v97, 0
v_mov_b32 v98, 0
v_mov_b32 v99, 0
v_mov_b32 v100, 0
v_mov_b32 v101, 0
v_mov_b32 v102, 0
v_mov_b32 v103, 0
v_mov_b32 v104, 0
v_mov_b32 v105, 0
v_mov_b32 v106, 0
v_mov_b32 v107, 0
v_mov_b32 v108, 0
v_mov_b32 v109, 0
v_mov_b32 v110, 0
v_mov_b32 v111, 0
v_mov_b32 v112, 0
v_mov_b32 v113, 0
v_mov_b32 v114, 0
v_mov_b32 v115, 0
v_mov_b32 v116, 0
v_mov_b32 v117, 0
v_mov_b32 v118, 0
v_mov_b32 v119, 0
v_mov_b32 v120, 0
v_mov_b32 v121, 0
v_mov_b32 v122, 0
v_mov_b32 v123, 0
v_mov_b32 v124, 0
v_mov_b32 v125, 0
v_mov_b32 v126, 0
v_mov_b32 v127, 0
s_waitcnt vmcnt(0)
s_barrier
s_cmp_ge_u32 s42, 2
s_cbranch_scc1 p3_go
s_mov_b64 exec, 1
s_cmp_eq_u32 s42, 0
s_cbranch_scc0 p3_noreport
v_mov_b32 v148, s72
v_mov_b32 v149, 1
global_atomic_add v148, v149, s[70:71] sc1
p3_noreport:
s_lshr_b32 s3, s43, 1
s_add_u32 s3, s3, 16
s_lshl_b32 s3, s3, 7
v_mov_b32 v148, s3
p3_hready_spin:
global_load_dword v149, v148, s[70:71] sc1
s_waitcnt vmcnt(0)
v_readfirstlane_b32 s3, v149
s_nop 3
s_cmp_ge_u32 s3, 16
s_cbranch_scc1 p3_hready_ok
s_sleep 1
s_branch p3_hready_spin
p3_hready_ok:
s_mov_b64 exec, -1
p3_go:
s_add_u32 m0, s50, 0
s_nop 0
buffer_load_dwordx4 v128, s[4:7], s46 offen sc1 lds
s_add_u32 m0, s50, 1024
s_nop 0
buffer_load_dwordx4 v129, s[4:7], s46 offen sc1 lds
s_add_u32 m0, s50, 2048
s_nop 0
buffer_load_dwordx4 v130, s[4:7], s46 offen sc1 lds
s_add_u32 m0, s50, 3072
s_nop 0
buffer_load_dwordx4 v131, s[4:7], s46 offen sc1 lds
s_add_u32 m0, s50, 4096
s_nop 0
buffer_load_dwordx4 v132, s[4:7], s46 offen sc1 lds
s_add_u32 m0, s50, 5120
s_nop 0
buffer_load_dwordx4 v133, s[4:7], s46 offen sc1 lds
s_add_u32 m0, s50, 6144
s_nop 0
buffer_load_dwordx4 v134, s[4:7], s46 offen sc1 lds
s_add_u32 m0, s50, 7168
s_nop 0
buffer_load_dwordx4 v135, s[4:7], s46 offen sc1 lds
s_add_u32 s46, s46, s47
s_add_u32 m0, s50, 32768
s_nop 0
buffer_load_dwordx4 v128, s[4:7], s46 offen sc1 lds
s_add_u32 m0, s50, 33792
s_nop 0
buffer_load_dwordx4 v129, s[4:7], s46 offen sc1 lds
s_add_u32 m0, s50, 34816
s_nop 0
buffer_load_dwordx4 v130, s[4:7], s46 offen sc1 lds
s_add_u32 m0, s50, 35840
s_nop 0
buffer_load_dwordx4 v131, s[4:7], s46 offen sc1 lds
s_add_u32 m0, s50, 36864
s_nop 0
buffer_load_dwordx4 v132, s[4:7], s46 offen sc1 lds
s_add_u32 m0, s50, 37888
s_nop 0
buffer_load_dwordx4 v133, s[4:7], s46 offen sc1 lds
s_add_u32 m0, s50, 38912
s_nop 0
buffer_load_dwordx4 v134, s[4:7], s46 offen sc1 lds
s_add_u32 m0, s50, 39936
s_nop 0
buffer_load_dwordx4 v135, s[4:7], s46 offen sc1 lds
s_add_u32 s46, s46, s47
s_add_u32 m0, s50, 65536
s_nop 0
buffer_load_dwordx4 v128, s[4:7], s46 offen sc1 lds
s_add_u32 m0, s50, 66560
s_nop 0
buffer_load_dwordx4 v129, s[4:7], s46 offen sc1 lds
s_add_u32 m0, s50, 67584
s_nop 0
buffer_load_dwordx4 v130, s[4:7], s46 offen sc1 lds
s_add_u32 m0, s50, 68608
s_nop 0
buffer_load_dwordx4 v131, s[4:7], s46 offen sc1 lds
s_add_u32 m0, s50, 69632
s_nop 0
buffer_load_dwordx4 v132, s[4:7], s46 offen sc1 lds
s_add_u32 m0, s50, 70656
s_nop 0
buffer_load_dwordx4 v133, s[4:7], s46 offen sc1 lds
s_add_u32 m0, s50, 71680
s_nop 0
buffer_load_dwordx4 v134, s[4:7], s46 offen sc1 lds
s_add_u32 m0, s50, 72704
s_nop 0
buffer_load_dwordx4 v135, s[4:7], s46 offen sc1 lds
s_add_u32 s46, s46, s47
s_add_u32 s8, s40, 22020096
s_addc_u32 s9, s41, 0
s_and_b32 s9, s9, 0xffff
s_mov_b32 s10, 8192
s_mov_b32 s11, 0x20000
v_and_b32 v148, 15, v146
s_lshl_b32 s3, s43, 7
s_lshl_b32 s62, s52, 6
s_add_u32 s3, s3, s62
v_add_u32 v196, s3, v148
v_lshlrev_b32 v150, 2, v196
buffer_load_dword v164, v150, s[8:11], 0 offen offset:0 sc1
buffer_load_dword v166, v150, s[8:11], 0 offen offset:64 sc1
buffer_load_dword v168, v150, s[8:11], 0 offen offset:128 sc1
buffer_load_dword v170, v150, s[8:11], 0 offen offset:192 sc1
s_mov_b32 s12, s32
s_and_b32 s13, s33, 0xffff
s_mov_b32 s14, 2048
s_mov_b32 s15, 0x20000
v_lshrrev_b32 v151, 4, v146
v_lshlrev_b32 v151, 3, v151
s_lshl_b32 s3, s44, 8
s_lshl_b32 s62, s53, 7
s_add_u32 s73, s3, s62
buffer_load_dwordx2 v[172:173], v151, s[12:15], s73 offen offset:0
buffer_load_dwordx2 v[174:175], v151, s[12:15], s73 offen offset:32
buffer_load_dwordx2 v[176:177], v151, s[12:15], s73 offen offset:64
buffer_load_dwordx2 v[178:179], v151, s[12:15], s73 offen offset:96
s_mul_i32 s3, s45, 4
s_sub_u32 s49, 9, s3
s_waitcnt vmcnt(16)
s_barrier
TR 32,138,0
TR 34,138,4096
RB 0,136,0
RB 4,136,2048
RB 8,136,4096
RB 12,136,6144
TR 36,139,0
TR 38,139,4096
TR 40,140,0
TR 42,140,4096
TR 44,141,0
TR 46,141,4096
TR 48,138,8192
TR 50,138,12288
RB 16,136,1024
RB 20,136,3072
RB 24,136,5120
RB 28,136,7168
TR 52,139,8192
TR 54,139,12288
TR 56,140,8192
TR 58,140,12288
TR 60,141,8192
TR 62,141,12288
s_waitcnt lgkmcnt(0)
s_barrier
MVZ 0,32,0
TR 96,138,32768
s_add_u32 m0, s50, 98304
MVZ 4,32,4
TR 98,138,36864
buffer_load_dwordx4 v128, s[4:7], s46 offen sc1 lds
s_add_u32 m0, s50, 99328
MVZ 8,32,8
RB 64,136,32768
buffer_load_dwordx4 v129, s[4:7], s46 offen sc1 lds
MVZ 12,32,12
RB 68,136,34816
s_add_u32 m0, s50, 100352
MVZ 16,36,0
RB 72,136,36864
buffer_load_dwordx4 v130, s[4:7], s46 offen sc1 lds
s_add_u32 m0, s50, 101376
MVZ 20,36,4
RB 76,136,38912
buffer_load_dwordx4 v131, s[4:7], s46 offen sc1 lds
MVZ 24,36,8
TR 100,139,32768
s_add_u32 m0, s50, 102400
MVZ 28,36,12
TR 102,139,36864
buffer_load_dwordx4 v132, s[4:7], s46 offen sc1 lds
s_add_u32 m0, s50, 103424
MVZ 32,40,0
buffer_load_dwordx4 v133, s[4:7], s46 offen sc1 lds
MVZ 36,40,4
TR 104,140,32768
s_add_u32 m0, s50, 104448
MVZ 40,40,8
TR 106,140,36864
buffer_load_dwordx4 v134, s[4:7], s46 offen sc1 lds
s_add_u32 m0, s50, 105472
MVZ 44,40,12
TR 108,141,32768
buffer_load_dwordx4 v135, s[4:7], s46 offen sc1 lds
s_add_u32 s46, s46, s47
MVZ 48,44,0
TR 110,141,36864
s_add_u32 m0, s50, 0
MVZ 52,44,4
TR 112,138,40960
buffer_load_dwordx4 v128, s[4:7], s46 offen sc1 lds
s_add_u32 m0, s50, 1024
MVZ 56,44,8
TR 114,138,45056
buffer_load_dwordx4 v129, s[4:7], s46 offen sc1 lds
MVZ 60,44,12
RB 80,136,33792
s_add_u32 m0, s50, 2048
MV 0,48,16
RB 84,136,35840
buffer_load_dwordx4 v130, s[4:7], s46 offen sc1 lds
s_add_u32 m0, s50, 3072
MV 4,48,20
buffer_load_dwordx4 v131, s[4:7], s46 offen sc1 lds
MV 8,48,24
RB 88,136,37888
s_add_u32 m0, s50, 4096
MV 12,48,28
RB 92,136,39936
buffer_load_dwordx4 v132, s[4:7], s46 offen sc1 lds
s_add_u32 m0, s50, 5120
MV 16,52,16
TR 116,139,40960
buffer_load_dwordx4 v133, s[4:7], s46 offen sc1 lds
MV 20,52,20
TR 118,139,45056
s_add_u32 m0, s50, 6144
MV 24,52,24
TR 120,140,40960
buffer_load_dwordx4 v134, s[4:7], s46 offen sc1 lds
s_add_u32 m0, s50, 7168
MV 28,52,28
TR 122,140,45056
buffer_load_dwordx4 v135, s[4:7], s46 offen sc1 lds
MV 32,56,16
TR 124,141,40960
MV 36,56,20
TR 126,141,45056
MV 40,56,24
MV 44,56,28
MV 48,60,16
MV 52,60,20
MV 56,60,24
MV 60,60,28
s_add_u32 s46, s46, s47
s_waitcnt vmcnt(24) lgkmcnt(0)
s_barrier
MV 0,96,64
TR 32,142,0
s_add_u32 m0, s50, 32768
MV 4,96,68
TR 34,142,4096
buffer_load_dwordx4 v128, s[4:7], s46 offen sc1 lds
MV 8,96,72
RB 0,137,0
MV 12,96,76
RB 4,137,2048
s_add_u32 m0, s50, 33792
MV 16,100,64
RB 8,137,4096
buffer_load_dwordx4 v129, s[4:7], s46 offen sc1 lds
MV 20,100,68
RB 12,137,6144
MV 24,100,72
TR 36,143,0
s_add_u32 m0, s50, 34816
MV 28,100,76
TR 38,143,4096
buffer_load_dwordx4 v130, s[4:7], s46 offen sc1 lds
MV 32,104,64
MV 36,104,68
TR 40,144,0
s_add_u32 m0, s50, 35840
MV 40,104,72
TR 42,144,4096
buffer_load_dwordx4 v131, s[4:7], s46 offen sc1 lds
MV 44,104,76
TR 44,145,0
MV 48,108,64
TR 46,145,4096
s_add_u32 m0, s50, 36864
MV 52,108,68
TR 48,142,8192
buffer_load_dwordx4 v132, s[4:7], s46 offen sc1 lds
MV 56,108,72
TR 50,142,12288
MV 60,108,76
RB 16,137,1024
s_add_u32 m0, s50, 37888
MV 0,112,80
RB 20,137,3072
buffer_load_dwordx4 v133, s[4:7], s46 offen sc1 lds
MV 4,112,84
MV 8,112,88
RB 24,137,5120
s_add_u32 m0, s50, 38912
MV 12,112,92
RB 28,137,7168
buffer_load_dwordx4 v134, s[4:7], s46 offen sc1 lds
MV 16,116,80
TR 52,143,8192
MV 20,116,84
TR 54,143,12288
s_add_u32 m0, s50, 39936
MV 24,116,88
TR 56,144,8192
buffer_load_dwordx4 v135, s[4:7], s46 offen sc1 lds
MV 28,116,92
TR 58,144,12288
MV 32,120,80
TR 60,145,8192
MV 36,120,84
TR 62,145,12288
MV 40,120,88
MV 44,120,92
MV 48,124,80
MV 52,124,84
MV 56,124,88
MV 60,124,92
s_add_u32 s46, s46, s47
s_waitcnt vmcnt(16) lgkmcnt(0)
s_barrier
MV 0,32,0
TR 96,142,32768
s_add_u32 m0, s50, 65536
MV 4,32,4
TR 98,142,36864
buffer_load_dwordx4 v128, s[4:7], s46 offen sc1 lds
MV 8,32,8
RB 64,137,32768
MV 12,32,12
RB 68,137,34816
s_add_u32 m0, s50, 66560
MV 16,36,0
RB 72,137,36864
buffer_load_dwordx4 v129, s[4:7], s46 offen sc1 lds
MV 20,36,4
RB 76,137,38912
MV 24,36,8
TR 100,143,32768
s_add_u32 m0, s50, 67584
MV 28,36,12
TR 102,143,36864
buffer_load_dwordx4 v130, s[4:7], s46 offen sc1 lds
MV 32,40,0
MV 36,40,4
TR 104,144,32768
s_add_u32 m0, s50, 68608
MV 40,40,8
TR 106,144,36864
buffer_load_dwordx4 v131, s[4:7], s46 offen sc1 lds
MV 44,40,12
TR 108,145,32768
MV 48,44,0
TR 110,145,36864
s_add_u32 m0, s50, 69632
MV 52,44,4
TR 112,142,40960
buffer_load_dwordx4 v132, s[4:7], s46 offen sc1 lds
MV 56,44,8
TR 114,142,45056
MV 60,44,12
RB 80,137,33792
s_add_u32 m0, s50, 70656
MV 0,48,16
RB 84,137,35840
buffer_load_dwordx4 v133, s[4:7], s46 offen sc1 lds
MV 4,48,20
MV 8,48,24
RB 88,137,37888
s_add_u32 m0, s50, 71680
MV 12,48,28
RB 92,137,39936
buffer_load_dwordx4 v134, s[4:7], s46 offen sc1 lds
MV 16,52,16
TR 116,143,40960
MV 20,52,20
TR 118,143,45056
s_add_u32 m0, s50, 72704
MV 24,52,24
TR 120,144,40960
buffer_load_dwordx4 v135, s[4:7], s46 offen sc1 lds
MV 28,52,28
TR 122,144,45056
MV 32,56,16
TR 124,145,40960
MV 36,56,20
TR 126,145,45056
MV 40,56,24
MV 44,56,28
MV 48,60,16
MV 52,60,20
MV 56,60,24
MV 60,60,28
s_add_u32 s46, s46, s47
s_waitcnt vmcnt(16) lgkmcnt(0)
s_barrier
MV 0,96,64
TR 32,138,0
s_add_u32 m0, s50, 98304
MV 4,96,68
TR 34,138,4096
buffer_load_dwordx4 v128, s[4:7], s46 offen sc1 lds
MV 8,96,72
RB 0,136,0
MV 12,96,76
RB 4,136,2048
s_add_u32 m0, s50, 99328
MV 16,100,64
RB 8,136,4096
buffer_load_dwordx4 v129, s[4:7], s46 offen sc1 lds
MV 20,100,68
RB 12,136,6144
MV 24,100,72
TR 36,139,0
s_add_u32 m0, s50, 100352
MV 28,100,76
TR 38,139,4096
buffer_load_dwordx4 v130, s[4:7], s46 offen sc1 lds
MV 32,104,64
MV 36,104,68
TR 40,140,0
s_add_u32 m0, s50, 101376
MV 40,104,72
TR 42,140,4096
buffer_load_dwordx4 v131, s[4:7], s46 offen sc1 lds
MV 44,104,76
TR 44,141,0
MV 48,108,64
TR 46,141,4096
s_add_u32 m0, s50, 102400
MV 52,108,68
TR 48,138,8192
buffer_load_dwordx4 v132, s[4:7], s46 offen sc1 lds
MV 56,108,72
TR 50,138,12288
MV 60,108,76
RB 16,136,1024
s_add_u32 m0, s50, 103424
MV 0,112,80
RB 20,136,3072
buffer_load_dwordx4 v133, s[4:7], s46 offen sc1 lds
MV 4,112,84
MV 8,112,88
RB 24,136,5120
s_add_u32 m0, s50, 104448
MV 12,112,92
RB 28,136,7168
buffer_load_dwordx4 v134, s[4:7], s46 offen sc1 lds
MV 16,116,80
TR 52,139,8192
MV 20,116,84
TR 54,139,12288
s_add_u32 m0, s50, 105472
MV 24,116,88
TR 56,140,8192
buffer_load_dwordx4 v135, s[4:7], s46 offen sc1 lds
MV 28,116,92
TR 58,140,12288
MV 32,120,80
TR 60,141,8192
MV 36,120,84
TR 62,141,12288
MV 40,120,88
MV 44,120,92
MV 48,124,80
MV 52,124,84
MV 56,124,88
MV 60,124,92
s_add_u32 s46, s46, s47
s_waitcnt vmcnt(16) lgkmcnt(0)
s_barrier
s_mov_b32 s48, 1
p3_loopB:
s_cmp_eq_u32 s48, 8
s_cselect_b32 s6, 0, s6
s_cmp_eq_u32 s45, 1
s_cbranch_scc0 p3_head_done
s_cmp_eq_u32 s48, 3
s_cbranch_scc0 p3_head_4
s_cmp_lt_u32 s42, 2
s_cbranch_scc0 p3_head_done
s_lshr_b32 s3, s43, 1
s_add_u32 s3, s3, 24
s_lshl_b32 s3, s3, 7
v_mov_b32 v148, s3
global_load_dword v147, v148, s[70:71] sc1
s_branch p3_head_done
p3_head_4:
s_cmp_eq_u32 s48, 4
s_cbranch_scc0 p3_head_done
s_cmp_ge_u32 s42, 2
s_cbranch_scc1 p3_head_w
v_readfirstlane_b32 s3, v147
s_nop 3
s_cmp_ge_u32 s3, 16
s_cbranch_scc1 p3_head_done
p3_oready_spin:
global_load_dword v147, v148, s[70:71] sc1
s_waitcnt vmcnt(0)
v_readfirstlane_b32 s3, v147
s_nop 3
s_cmp_ge_u32 s3, 16
s_cbranch_scc1 p3_oready_ok
s_sleep 1
s_branch p3_oready_spin
p3_oready_ok:
s_branch p3_head_done
p3_head_w:
s_lshl_b32 s3, s44, 8
s_add_u32 s4, s22, s3
s_addc_u32 s5, s23, 0
s_and_b32 s5, s5, 0xffff
s_sub_u32 s6, 2097152, s3
s_mov_b32 s46, 0
p3_head_done:
MV 0,32,0
TR 96,138,32768
s_add_u32 m0, s50, 0
MV 4,32,4
TR 98,138,36864
buffer_load_dwordx4 v128, s[4:7], s46 offen sc1 lds
MV 8,32,8
RB 64,136,32768
MV 12,32,12
RB 68,136,34816
s_add_u32 m0, s50, 1024
MV 16,36,0
RB 72,136,36864
buffer_load_dwordx4 v129, s[4:7], s46 offen sc1 lds
MV 20,36,4
RB 76,136,38912
MV 24,36,8
TR 100,139,32768
s_add_u32 m0, s50, 2048
MV 28,36,12
TR 102,139,36864
buffer_load_dwordx4 v130, s[4:7], s46 offen sc1 lds
MV 32,40,0
MV 36,40,4
TR 104,140,32768
s_add_u32 m0, s50, 3072
MV 40,40,8
TR 106,140,36864
buffer_load_dwordx4 v131, s[4:7], s46 offen sc1 lds
MV 44,40,12
TR 108,141,32768
MV 48,44,0
TR 110,141,36864
s_add_u32 m0, s50, 4096
MV 52,44,4
TR 112,138,40960
buffer_load_dwordx4 v132, s[4:7], s46 offen sc1 lds
MV 56,44,8
TR 114,138,45056
MV 60,44,12
RB 80,136,33792
s_add_u32 m0, s50, 5120
MV 0,48,16
RB 84,136,35840
buffer_load_dwordx4 v133, s[4:7], s46 offen sc1 lds
MV 4,48,20
MV 8,48,24
RB 88,136,37888
s_add_u32 m0, s50, 6144
MV 12,48,28
RB 92,136,39936
buffer_load_dwordx4 v134, s[4:7], s46 offen sc1 lds
MV 16,52,16
TR 116,139,40960
MV 20,52,20
TR 118,139,45056
s_add_u32 m0, s50, 7168
MV 24,52,24
TR 120,140,40960
buffer_load_dwordx4 v135, s[4:7], s46 offen sc1 lds
MV 28,52,28
TR 122,140,45056
MV 32,56,16
TR 124,141,40960
MV 36,56,20
TR 126,141,45056
MV 40,56,24
MV 44,56,28
MV 48,60,16
MV 52,60,20
MV 56,60,24
MV 60,60,28
s_add_u32 s46, s46, s47
s_waitcnt vmcnt(16) lgkmcnt(0)
s_barrier
MV 0,96,64
TR 32,142,0
s_add_u32 m0, s50, 32768
MV 4,96,68
TR 34,142,4096
buffer_load_dwordx4 v128, s[4:7], s46 offen sc1 lds
MV 8,96,72
RB 0,137,0
MV 12,96,76
RB 4,137,2048
s_add_u32 m0, s50, 33792
MV 16,100,64
RB 8,137,4096
buffer_load_dwordx4 v129, s[4:7], s46 offen sc1 lds
MV 20,100,68
RB 12,137,6144
MV 24,100,72
TR 36,143,0
s_add_u32 m0, s50, 34816
MV 28,100,76
TR 38,143,4096
buffer_load_dwordx4 v130, s[4:7], s46 offen sc1 lds
MV 32,104,64
MV 36,104,68
TR 40,144,0
s_add_u32 m0, s50, 35840
MV 40,104,72
TR 42,144,4096
buffer_load_dwordx4 v131, s[4:7], s46 offen sc1 lds
MV 44,104,76
TR 44,145,0
MV 48,108,64
TR 46,145,4096
s_add_u32 m0, s50, 36864
MV 52,108,68
TR 48,142,8192
buffer_load_dwordx4 v132, s[4:7], s46 offen sc1 lds
MV 56,108,72
TR 50,142,12288
MV 60,108,76
RB 16,137,1024
s_add_u32 m0, s50, 37888
MV 0,112,80
RB 20,137,3072
buffer_load_dwordx4 v133, s[4:7], s46 offen sc1 lds
MV 4,112,84
MV 8,112,88
RB 24,137,5120
s_add_u32 m0, s50, 38912
MV 12,112,92
RB 28,137,7168
buffer_load_dwordx4 v134, s[4:7], s46 offen sc1 lds
MV 16,116,80
TR 52,143,8192
MV 20,116,84
TR 54,143,12288
s_add_u32 m0, s50, 39936
MV 24,116,88
TR 56,144,8192
buffer_load_dwordx4 v135, s[4:7], s46 offen sc1 lds
MV 28,116,92
TR 58,144,12288
MV 32,120,80
TR 60,145,8192
MV 36,120,84
TR 62,145,12288
MV 40,120,88
MV 44,120,92
MV 48,124,80
MV 52,124,84
MV 56,124,88
MV 60,124,92
s_add_u32 s46, s46, s47
s_waitcnt vmcnt(16) lgkmcnt(0)
s_barrier
MV 0,32,0
TR 96,142,32768
s_add_u32 m0, s50, 65536
MV 4,32,4
TR 98,142,36864
buffer_load_dwordx4 v128, s[4:7], s46 offen sc1 lds
MV 8,32,8
RB 64,137,32768
MV 12,32,12
RB 68,137,34816
s_add_u32 m0, s50, 66560
MV 16,36,0
RB 72,137,36864
buffer_load_dwordx4 v129, s[4:7], s46 offen sc1 lds
MV 20,36,4
RB 76,137,38912
MV 24,36,8
TR 100,143,32768
s_add_u32 m0, s50, 67584
MV 28,36,12
TR 102,143,36864
buffer_load_dwordx4 v130, s[4:7], s46 offen sc1 lds
MV 32,40,0
MV 36,40,4
TR 104,144,32768
s_add_u32 m0, s50, 68608
MV 40,40,8
TR 106,144,36864
buffer_load_dwordx4 v131, s[4:7], s46 offen sc1 lds
MV 44,40,12
TR 108,145,32768
MV 48,44,0
TR 110,145,36864
s_add_u32 m0, s50, 69632
MV 52,44,4
TR 112,142,40960
buffer_load_dwordx4 v132, s[4:7], s46 offen sc1 lds
MV 56,44,8
TR 114,142,45056
MV 60,44,12
RB 80,137,33792
s_add_u32 m0, s50, 70656
MV 0,48,16
RB 84,137,35840
buffer_load_dwordx4 v133, s[4:7], s46 offen sc1 lds
MV 4,48,20
MV 8,48,24
RB 88,137,37888
s_add_u32 m0, s50, 71680
MV 12,48,28
RB 92,137,39936
buffer_load_dwordx4 v134, s[4:7], s46 offen sc1 lds
MV 16,52,16
TR 116,143,40960
MV 20,52,20
TR 118,143,45056
s_add_u32 m0, s50, 72704
MV 24,52,24
TR 120,144,40960
buffer_load_dwordx4 v135, s[4:7], s46 offen sc1 lds
MV 28,52,28
TR 122,144,45056
MV 32,56,16
TR 124,145,40960
MV 36,56,20
TR 126,145,45056
MV 40,56,24
MV 44,56,28
MV 48,60,16
MV 52,60,20
MV 56,60,24
MV 60,60,28
s_add_u32 s46, s46, s47
s_waitcnt vmcnt(16) lgkmcnt(0)
s_barrier
MV 0,96,64
TR 32,138,0
s_add_u32 m0, s50, 98304
MV 4,96,68
TR 34,138,4096
buffer_load_dwordx4 v128, s[4:7], s46 offen sc1 lds
MV 8,96,72
RB 0,136,0
MV 12,96,76
RB 4,136,2048
s_add_u32 m0, s50, 99328
MV 16,100,64
RB 8,136,4096
buffer_load_dwordx4 v129, s[4:7], s46 offen sc1 lds
MV 20,100,68
RB 12,136,6144
MV 24,100,72
TR 36,139,0
s_add_u32 m0, s50, 100352
MV 28,100,76
TR 38,139,4096
buffer_load_dwordx4 v130, s[4:7], s46 offen sc1 lds
MV 32,104,64
MV 36,104,68
TR 40,140,0
s_add_u32 m0, s50, 101376
MV 40,104,72
TR 42,140,4096
buffer_load_dwordx4 v131, s[4:7], s46 offen sc1 lds
MV 44,104,76
TR 44,141,0
MV 48,108,64
TR 46,141,4096
s_add_u32 m0, s50, 102400
MV 52,108,68
TR 48,138,8192
buffer_load_dwordx4 v132, s[4:7], s46 offen sc1 lds
MV 56,108,72
TR 50,138,12288
MV 60,108,76
RB 16,136,1024
s_add_u32 m0, s50, 103424
MV 0,112,80
RB 20,136,3072
buffer_load_dwordx4 v133, s[4:7], s46 offen sc1 lds
MV 4,112,84
MV 8,112,88
RB 24,136,5120
s_add_u32 m0, s50, 104448
MV 12,112,92
RB 28,136,7168
buffer_load_dwordx4 v134, s[4:7], s46 offen sc1 lds
MV 16,116,80
TR 52,139,8192
MV 20,116,84
TR 54,139,12288
s_add_u32 m0, s50, 105472
MV 24,116,88
TR 56,140,8192
buffer_load_dwordx4 v135, s[4:7], s46 offen sc1 lds
MV 28,116,92
TR 58,140,12288
MV 32,120,80
TR 60,141,8192
MV 36,120,84
TR 62,141,12288
MV 40,120,88
MV 44,120,92
MV 48,124,80
MV 52,124,84
MV 56,124,88
MV 60,124,92
s_add_u32 s46, s46, s47
s_waitcnt vmcnt(16) lgkmcnt(0)
s_barrier
s_add_u32 s48, s48, 1
s_cmp_lt_u32 s48, s49
s_cbranch_scc1 p3_loopB
s_cmp_eq_u32 s45, 0
s_cbranch_scc1 p3_loops_done
p3_loopA:
s_cmp_eq_u32 s48, 8
s_cselect_b32 s6, 0, s6
MV 64,32,0
TR 96,138,32768
s_add_u32 m0, s50, 0
MV 68,32,4
TR 98,138,36864
buffer_load_dwordx4 v128, s[4:7], s46 offen sc1 lds
MV 72,32,8
RB 64,136,32768
MV 76,32,12
RB 68,136,34816
s_add_u32 m0, s50, 1024
MV 80,36,0
RB 72,136,36864
buffer_load_dwordx4 v129, s[4:7], s46 offen sc1 lds
MV 84,36,4
RB 76,136,38912
MV 88,36,8
TR 100,139,32768
s_add_u32 m0, s50, 2048
MV 92,36,12
TR 102,139,36864
buffer_load_dwordx4 v130, s[4:7], s46 offen sc1 lds
MV 96,40,0
MV 100,40,4
TR 104,140,32768
s_add_u32 m0, s50, 3072
MV 104,40,8
TR 106,140,36864
buffer_load_dwordx4 v131, s[4:7], s46 offen sc1 lds
MV 108,40,12
TR 108,141,32768
MV 112,44,0
TR 110,141,36864
s_add_u32 m0, s50, 4096
MV 116,44,4
TR 112,138,40960
buffer_load_dwordx4 v132, s[4:7], s46 offen sc1 lds
MV 120,44,8
TR 114,138,45056
MV 124,44,12
RB 80,136,33792
s_add_u32 m0, s50, 5120
MV 64,48,16
RB 84,136,35840
buffer_load_dwordx4 v133, s[4:7], s46 offen sc1 lds
MV 68,48,20
MV 72,48,24
RB 88,136,37888
s_add_u32 m0, s50, 6144
MV 76,48,28
RB 92,136,39936
buffer_load_dwordx4 v134, s[4:7], s46 offen sc1 lds
MV 80,52,16
TR 116,139,40960
MV 84,52,20
TR 118,139,45056
s_add_u32 m0, s50, 7168
MV 88,52,24
TR 120,140,40960
buffer_load_dwordx4 v135, s[4:7], s46 offen sc1 lds
MV 92,52,28
TR 122,140,45056
MV 96,56,16
TR 124,141,40960
MV 100,56,20
TR 126,141,45056
MV 104,56,24
MV 108,56,28
MV 112,60,16
MV 116,60,20
MV 120,60,24
MV 124,60,28
s_add_u32 s46, s46, s47
s_waitcnt vmcnt(16) lgkmcnt(0)
s_barrier
MV 64,96,64
TR 32,142,0
s_add_u32 m0, s50, 32768
MV 68,96,68
TR 34,142,4096
buffer_load_dwordx4 v128, s[4:7], s46 offen sc1 lds
MV 72,96,72
RB 0,137,0
MV 76,96,76
RB 4,137,2048
s_add_u32 m0, s50, 33792
MV 80,100,64
RB 8,137,4096
buffer_load_dwordx4 v129, s[4:7], s46 offen sc1 lds
MV 84,100,68
RB 12,137,6144
MV 88,100,72
TR 36,143,0
s_add_u32 m0, s50, 34816
MV 92,100,76
TR 38,143,4096
buffer_load_dwordx4 v130, s[4:7], s46 offen sc1 lds
MV 96,104,64
MV 100,104,68
TR 40,144,0
s_add_u32 m0, s50, 35840
MV 104,104,72
TR 42,144,4096
buffer_load_dwordx4 v131, s[4:7], s46 offen sc1 lds
MV 108,104,76
TR 44,145,0
MV 112,108,64
TR 46,145,4096
s_add_u32 m0, s50, 36864
MV 116,108,68
TR 48,142,8192
buffer_load_dwordx4 v132, s[4:7], s46 offen sc1 lds
MV 120,108,72
TR 50,142,12288
MV 124,108,76
RB 16,137,1024
s_add_u32 m0, s50, 37888
MV 64,112,80
RB 20,137,3072
buffer_load_dwordx4 v133, s[4:7], s46 offen sc1 lds
MV 68,112,84
MV 72,112,88
RB 24,137,5120
s_add_u32 m0, s50, 38912
MV 76,112,92
RB 28,137,7168
buffer_load_dwordx4 v134, s[4:7], s46 offen sc1 lds
MV 80,116,80
TR 52,143,8192
MV 84,116,84
TR 54,143,12288
s_add_u32 m0, s50, 39936
MV 88,116,88
TR 56,144,8192
buffer_load_dwordx4 v135, s[4:7], s46 offen sc1 lds
MV 92,116,92
TR 58,144,12288
MV 96,120,80
TR 60,145,8192
MV 100,120,84
TR 62,145,12288
MV 104,120,88
MV 108,120,92
MV 112,124,80
MV 116,124,84
MV 120,124,88
MV 124,124,92
s_add_u32 s46, s46, s47
s_waitcnt vmcnt(16) lgkmcnt(0)
s_barrier
MV 64,32,0
TR 96,142,32768
s_add_u32 m0, s50, 65536
MV 68,32,4
TR 98,142,36864
buffer_load_dwordx4 v128, s[4:7], s46 offen sc1 lds
MV 72,32,8
RB 64,137,32768
MV 76,32,12
RB 68,137,34816
s_add_u32 m0, s50, 66560
MV 80,36,0
RB 72,137,36864
buffer_load_dwordx4 v129, s[4:7], s46 offen sc1 lds
MV 84,36,4
RB 76,137,38912
MV 88,36,8
TR 100,143,32768
s_add_u32 m0, s50, 67584
MV 92,36,12
TR 102,143,36864
buffer_load_dwordx4 v130, s[4:7], s46 offen sc1 lds
MV 96,40,0
MV 100,40,4
TR 104,144,32768
s_add_u32 m0, s50, 68608
MV 104,40,8
TR 106,144,36864
buffer_load_dwordx4 v131, s[4:7], s46 offen sc1 lds
MV 108,40,12
TR 108,145,32768
MV 112,44,0
TR 110,145,36864
s_add_u32 m0, s50, 69632
MV 116,44,4
TR 112,142,40960
buffer_load_dwordx4 v132, s[4:7], s46 offen sc1 lds
MV 120,44,8
TR 114,142,45056
MV 124,44,12
RB 80,137,33792
s_add_u32 m0, s50, 70656
MV 64,48,16
RB 84,137,35840
buffer_load_dwordx4 v133, s[4:7], s46 offen sc1 lds
MV 68,48,20
MV 72,48,24
RB 88,137,37888
s_add_u32 m0, s50, 71680
MV 76,48,28
RB 92,137,39936
buffer_load_dwordx4 v134, s[4:7], s46 offen sc1 lds
MV 80,52,16
TR 116,143,40960
MV 84,52,20
TR 118,143,45056
s_add_u32 m0, s50, 72704
MV 88,52,24
TR 120,144,40960
buffer_load_dwordx4 v135, s[4:7], s46 offen sc1 lds
MV 92,52,28
TR 122,144,45056
MV 96,56,16
TR 124,145,40960
MV 100,56,20
TR 126,145,45056
MV 104,56,24
MV 108,56,28
MV 112,60,16
MV 116,60,20
MV 120,60,24
MV 124,60,28
s_add_u32 s46, s46, s47
s_waitcnt vmcnt(16) lgkmcnt(0)
s_barrier
MV 64,96,64
TR 32,138,0
s_add_u32 m0, s50, 98304
MV 68,96,68
TR 34,138,4096
buffer_load_dwordx4 v128, s[4:7], s46 offen sc1 lds
MV 72,96,72
RB 0,136,0
MV 76,96,76
RB 4,136,2048
s_add_u32 m0, s50, 99328
MV 80,100,64
RB 8,136,4096
buffer_load_dwordx4 v129, s[4:7], s46 offen sc1 lds
MV 84,100,68
RB 12,136,6144
MV 88,100,72
TR 36,139,0
s_add_u32 m0, s50, 100352
MV 92,100,76
TR 38,139,4096
buffer_load_dwordx4 v130, s[4:7], s46 offen sc1 lds
MV 96,104,64
MV 100,104,68
TR 40,140,0
s_add_u32 m0, s50, 101376
MV 104,104,72
TR 42,140,4096
buffer_load_dwordx4 v131, s[4:7], s46 offen sc1 lds
MV 108,104,76
TR 44,141,0
MV 112,108,64
TR 46,141,4096
s_add_u32 m0, s50, 102400
MV 116,108,68
TR 48,138,8192
buffer_load_dwordx4 v132, s[4:7], s46 offen sc1 lds
MV 120,108,72
TR 50,138,12288
MV 124,108,76
RB 16,136,1024
s_add_u32 m0, s50, 103424
MV 64,112,80
RB 20,136,3072
buffer_load_dwordx4 v133, s[4:7], s46 offen sc1 lds
MV 68,112,84
MV 72,112,88
RB 24,136,5120
s_add_u32 m0, s50, 104448
MV 76,112,92
RB 28,136,7168
buffer_load_dwordx4 v134, s[4:7], s46 offen sc1 lds
MV 80,116,80
TR 52,139,8192
MV 84,116,84
TR 54,139,12288
s_add_u32 m0, s50, 105472
MV 88,116,88
TR 56,140,8192
buffer_load_dwordx4 v135, s[4:7], s46 offen sc1 lds
MV 92,116,92
TR 58,140,12288
MV 96,120,80
TR 60,141,8192
MV 100,120,84
TR 62,141,12288
MV 104,120,88
MV 108,120,92
MV 112,124,80
MV 116,124,84
MV 120,124,88
MV 124,124,92
s_add_u32 s46, s46, s47
s_waitcnt vmcnt(16) lgkmcnt(0)
s_barrier
s_add_u32 s48, s48, 1
s_cmp_lt_u32 s48, 9
s_cbranch_scc1 p3_loopA
p3_loops_done:
s_add_u32 s8, s40, 33554432
s_addc_u32 s9, s41, 0
s_and_b32 s9, s9, 0xffff
s_mov_b32 s10, 8388608
s_mov_b32 s11, 0x20000
s_lshl_b32 s3, s2, 15
s_lshl_b32 s62, s42, 13
s_add_u32 s66, s3, s62
s_xor_b32 s3, s2, 1
s_lshl_b32 s3, s3, 15
s_add_u32 s67, s3, s62
s_waitcnt vmcnt(0)
v_sub_f32 v165, 1.0, v164
v_sub_f32 v167, 1.0, v166
v_sub_f32 v169, 1.0, v168
v_sub_f32 v171, 1.0, v170
s_cmp_eq_u32 s45, 0
s_cbranch_scc0 p3_epi1
v_pk_mul_f32 v[8:9], v[8:9], v[168:169] op_sel:[0,1] op_sel_hi:[1,1]
v_pk_mul_f32 v[10:11], v[10:11], v[168:169] op_sel:[0,1] op_sel_hi:[1,1]
buffer_store_dwordx4 v[8:11], v197, s[8:11], s66 offen offset:0 sc1
v_pk_mul_f32 v[12:13], v[12:13], v[170:171] op_sel:[0,1] op_sel_hi:[1,1]
v_pk_mul_f32 v[14:15], v[14:15], v[170:171] op_sel:[0,1] op_sel_hi:[1,1]
buffer_store_dwordx4 v[12:15], v197, s[8:11], s66 offen offset:1024 sc1
v_pk_mul_f32 v[24:25], v[24:25], v[168:169] op_sel:[0,1] op_sel_hi:[1,1]
v_pk_mul_f32 v[26:27], v[26:27], v[168:169] op_sel:[0,1] op_sel_hi:[1,1]
buffer_store_dwordx4 v[24:27], v197, s[8:11], s66 offen offset:2048 sc1
v_pk_mul_f32 v[28:29], v[28:29], v[170:171] op_sel:[0,1] op_sel_hi:[1,1]
v_pk_mul_f32 v[30:31], v[30:31], v[170:171] op_sel:[0,1] op_sel_hi:[1,1]
buffer_store_dwordx4 v[28:31], v197, s[8:11], s66 offen offset:3072 sc1
v_pk_mul_f32 v[40:41], v[40:41], v[168:169] op_sel:[0,1] op_sel_hi:[1,1]
v_pk_mul_f32 v[42:43], v[42:43], v[168:169] op_sel:[0,1] op_sel_hi:[1,1]
s_add_u32 s66, s66, 4096
buffer_store_dwordx4 v[40:43], v197, s[8:11], s66 offen offset:0 sc1
v_pk_mul_f32 v[44:45], v[44:45], v[170:171] op_sel:[0,1] op_sel_hi:[1,1]
v_pk_mul_f32 v[46:47], v[46:47], v[170:171] op_sel:[0,1] op_sel_hi:[1,1]
buffer_store_dwordx4 v[44:47], v197, s[8:11], s66 offen offset:1024 sc1
v_pk_mul_f32 v[56:57], v[56:57], v[168:169] op_sel:[0,1] op_sel_hi:[1,1]
v_pk_mul_f32 v[58:59], v[58:59], v[168:169] op_sel:[0,1] op_sel_hi:[1,1]
buffer_store_dwordx4 v[56:59], v197, s[8:11], s66 offen offset:2048 sc1
v_pk_mul_f32 v[60:61], v[60:61], v[170:171] op_sel:[0,1] op_sel_hi:[1,1]
v_pk_mul_f32 v[62:63], v[62:63], v[170:171] op_sel:[0,1] op_sel_hi:[1,1]
buffer_store_dwordx4 v[60:63], v197, s[8:11], s66 offen offset:3072 sc1
v_lshlrev_b32 v180, 16, v172
v_and_b32 v181, 0xffff0000, v172
v_lshlrev_b32 v182, 16, v173
v_and_b32 v183, 0xffff0000, v173
v_lshlrev_b32 v184, 16, v174
v_and_b32 v185, 0xffff0000, v174
v_lshlrev_b32 v186, 16, v175
v_and_b32 v187, 0xffff0000, v175
v_lshlrev_b32 v188, 16, v176
v_and_b32 v189, 0xffff0000, v176
v_lshlrev_b32 v190, 16, v177
v_and_b32 v191, 0xffff0000, v177
v_lshlrev_b32 v192, 16, v178
v_and_b32 v193, 0xffff0000, v178
v_lshlrev_b32 v194, 16, v179
v_and_b32 v195, 0xffff0000, v179
v_pk_add_f32 v[0:1], v[0:1], v[180:181]
v_pk_add_f32 v[2:3], v[2:3], v[182:183]
v_pk_mul_f32 v[0:1], v[0:1], v[164:165] op_sel:[0,1] op_sel_hi:[1,1]
v_pk_mul_f32 v[2:3], v[2:3], v[164:165] op_sel:[0,1] op_sel_hi:[1,1]
v_pk_add_f32 v[4:5], v[4:5], v[180:181]
v_pk_add_f32 v[6:7], v[6:7], v[182:183]
v_pk_mul_f32 v[4:5], v[4:5], v[166:167] op_sel:[0,1] op_sel_hi:[1,1]
v_pk_mul_f32 v[6:7], v[6:7], v[166:167] op_sel:[0,1] op_sel_hi:[1,1]
v_pk_add_f32 v[16:17], v[16:17], v[184:185]
v_pk_add_f32 v[18:19], v[18:19], v[186:187]
v_pk_mul_f32 v[16:17], v[16:17], v[164:165] op_sel:[0,1] op_sel_hi:[1,1]
v_pk_mul_f32 v[18:19], v[18:19], v[164:165] op_sel:[0,1] op_sel_hi:[1,1]
v_pk_add_f32 v[20:21], v[20:21], v[184:185]
v_pk_add_f32 v[22:23], v[22:23], v[186:187]
v_pk_mul_f32 v[20:21], v[20:21], v[166:167] op_sel:[0,1] op_sel_hi:[1,1]
v_pk_mul_f32 v[22:23], v[22:23], v[166:167] op_sel:[0,1] op_sel_hi:[1,1]
v_pk_add_f32 v[32:33], v[32:33], v[188:189]
v_pk_add_f32 v[34:35], v[34:35], v[190:191]
v_pk_mul_f32 v[32:33], v[32:33], v[164:165] op_sel:[0,1] op_sel_hi:[1,1]
v_pk_mul_f32 v[34:35], v[34:35], v[164:165] op_sel:[0,1] op_sel_hi:[1,1]
v_pk_add_f32 v[36:37], v[36:37], v[188:189]
v_pk_add_f32 v[38:39], v[38:39], v[190:191]
v_pk_mul_f32 v[36:37], v[36:37], v[166:167] op_sel:[0,1] op_sel_hi:[1,1]
v_pk_mul_f32 v[38:39], v[38:39], v[166:167] op_sel:[0,1] op_sel_hi:[1,1]
v_pk_add_f32 v[48:49], v[48:49], v[192:193]
v_pk_add_f32 v[50:51], v[50:51], v[194:195]
v_pk_mul_f32 v[48:49], v[48:49], v[164:165] op_sel:[0,1] op_sel_hi:[1,1]
v_pk_mul_f32 v[50:51], v[50:51], v[164:165] op_sel:[0,1] op_sel_hi:[1,1]
v_pk_add_f32 v[52:53], v[52:53], v[192:193]
v_pk_add_f32 v[54:55], v[54:55], v[194:195]
v_pk_mul_f32 v[52:53], v[52:53], v[166:167] op_sel:[0,1] op_sel_hi:[1,1]
v_pk_mul_f32 v[54:55], v[54:55], v[166:167] op_sel:[0,1] op_sel_hi:[1,1]
v_add_u32 v196, 0, v196
v_lshlrev_b32 v196, 11, v196
v_lshrrev_b32 v150, 4, v146
v_and_b32 v148, 1, v150
v_lshlrev_b32 v148, 5, v148
v_lshrrev_b32 v150, 1, v150
v_lshl_add_u32 v148, v150, 4, v148
v_add_u32 v196, v148, v196
s_mov_b32 s12, s36
s_and_b32 s13, s37, 0xffff
s_mov_b32 s14, 4194304
s_mov_b32 s15, 0x20000
s_add_u32 s70, s40, 29360128
s_addc_u32 s71, s41, 0
s_lshl_b32 s3, s2, 2
s_add_u32 s3, s3, s42
s_lshl_b32 s62, s3, 6
s_xor_b32 s3, s3, 4
s_lshl_b32 s63, s3, 6
s_waitcnt vmcnt(0)
s_mov_b64 exec, 1
v_mov_b32 v152, s62
v_mov_b32 v153, 1
global_store_dword v152, v153, s[70:71] sc1
v_mov_b32 v152, s63
p3_x0_spin:
global_load_dword v154, v152, s[70:71] sc1
s_waitcnt vmcnt(0)
v_readfirstlane_b32 s3, v154
s_nop 3
s_cmp_ge_u32 s3, 1
s_cbranch_scc1 p3_x0_ok
s_sleep 1
s_branch p3_x0_spin
p3_x0_ok:
s_mov_b64 exec, -1
buffer_load_dwordx4 v[8:11], v197, s[8:11], s67 offen offset:0 sc1
buffer_load_dwordx4 v[12:15], v197, s[8:11], s67 offen offset:1024 sc1
buffer_load_dwordx4 v[24:27], v197, s[8:11], s67 offen offset:2048 sc1
buffer_load_dwordx4 v[28:31], v197, s[8:11], s67 offen offset:3072 sc1
s_add_u32 s67, s67, 4096
buffer_load_dwordx4 v[40:43], v197, s[8:11], s67 offen offset:0 sc1
buffer_load_dwordx4 v[44:47], v197, s[8:11], s67 offen offset:1024 sc1
buffer_load_dwordx4 v[56:59], v197, s[8:11], s67 offen offset:2048 sc1
buffer_load_dwordx4 v[60:63], v197, s[8:11], s67 offen offset:3072 sc1
s_waitcnt vmcnt(6)
v_pk_add_f32 v[0:1], v[0:1], v[8:9]
v_pk_add_f32 v[2:3], v[2:3], v[10:11]
v_pk_add_f32 v[4:5], v[4:5], v[12:13]
v_pk_add_f32 v[6:7], v[6:7], v[14:15]
s_waitcnt vmcnt(4)
v_pk_add_f32 v[16:17], v[16:17], v[24:25]
v_pk_add_f32 v[18:19], v[18:19], v[26:27]
v_pk_add_f32 v[20:21], v[20:21], v[28:29]
v_pk_add_f32 v[22:23], v[22:23], v[30:31]
s_waitcnt vmcnt(2)
v_pk_add_f32 v[32:33], v[32:33], v[40:41]
v_pk_add_f32 v[34:35], v[34:35], v[42:43]
v_pk_add_f32 v[36:37], v[36:37], v[44:45]
v_pk_add_f32 v[38:39], v[38:39], v[46:47]
s_waitcnt vmcnt(0)
v_pk_add_f32 v[48:49], v[48:49], v[56:57]
v_pk_add_f32 v[50:51], v[50:51], v[58:59]
v_pk_add_f32 v[52:53], v[52:53], v[60:61]
v_pk_add_f32 v[54:55], v[54:55], v[62:63]
CP 148,0,1
CP 149,2,3
CP 150,16,17
CP 151,18,19
s_nop 0
v_permlane16_swap_b32 v148, v150
v_permlane16_swap_b32 v149, v151
buffer_store_dwordx4 v[148:151], v196, s[12:15], s73 offen offset:0 nt
CP 152,32,33
CP 153,34,35
CP 154,48,49
CP 155,50,51
s_nop 0
v_permlane16_swap_b32 v152, v154
v_permlane16_swap_b32 v153, v155
buffer_store_dwordx4 v[152:155], v196, s[12:15], s73 offen offset:64 nt
v_add_u32 v196, 32768, v196
CP 148,4,5
CP 149,6,7
CP 150,20,21
CP 151,22,23
s_nop 0
v_permlane16_swap_b32 v148, v150
v_permlane16_swap_b32 v149, v151
buffer_store_dwordx4 v[148:151], v196, s[12:15], s73 offen offset:0 nt
CP 152,36,37
CP 153,38,39
CP 154,52,53
CP 155,54,55
s_nop 0
v_permlane16_swap_b32 v152, v154
v_permlane16_swap_b32 v153, v155
buffer_store_dwordx4 v[152:155], v196, s[12:15], s73 offen offset:64 nt
s_branch p3_end
p3_epi1:
v_pk_mul_f32 v[0:1], v[0:1], v[164:165] op_sel:[0,1] op_sel_hi:[1,1]
v_pk_mul_f32 v[2:3], v[2:3], v[164:165] op_sel:[0,1] op_sel_hi:[1,1]
v_pk_fma_f32 v[0:1], v[64:65], v[164:165], v[0:1] op_sel_hi:[1,0,1]
v_pk_fma_f32 v[2:3], v[66:67], v[164:165], v[2:3] op_sel_hi:[1,0,1]
buffer_store_dwordx4 v[0:3], v197, s[8:11], s66 offen offset:0 sc1
v_pk_mul_f32 v[4:5], v[4:5], v[166:167] op_sel:[0,1] op_sel_hi:[1,1]
v_pk_mul_f32 v[6:7], v[6:7], v[166:167] op_sel:[0,1] op_sel_hi:[1,1]
v_pk_fma_f32 v[4:5], v[68:69], v[166:167], v[4:5] op_sel_hi:[1,0,1]
v_pk_fma_f32 v[6:7], v[70:71], v[166:167], v[6:7] op_sel_hi:[1,0,1]
buffer_store_dwordx4 v[4:7], v197, s[8:11], s66 offen offset:1024 sc1
v_pk_mul_f32 v[16:17], v[16:17], v[164:165] op_sel:[0,1] op_sel_hi:[1,1]
v_pk_mul_f32 v[18:19], v[18:19], v[164:165] op_sel:[0,1] op_sel_hi:[1,1]
v_pk_fma_f32 v[16:17], v[80:81], v[164:165], v[16:17] op_sel_hi:[1,0,1]
v_pk_fma_f32 v[18:19], v[82:83], v[164:165], v[18:19] op_sel_hi:[1,0,1]
buffer_store_dwordx4 v[16:19], v197, s[8:11], s66 offen offset:2048 sc1
v_pk_mul_f32 v[20:21], v[20:21], v[166:167] op_sel:[0,1] op_sel_hi:[1,1]
v_pk_mul_f32 v[22:23], v[22:23], v[166:167] op_sel:[0,1] op_sel_hi:[1,1]
v_pk_fma_f32 v[20:21], v[84:85], v[166:167], v[20:21] op_sel_hi:[1,0,1]
v_pk_fma_f32 v[22:23], v[86:87], v[166:167], v[22:23] op_sel_hi:[1,0,1]
buffer_store_dwordx4 v[20:23], v197, s[8:11], s66 offen offset:3072 sc1
v_pk_mul_f32 v[32:33], v[32:33], v[164:165] op_sel:[0,1] op_sel_hi:[1,1]
v_pk_mul_f32 v[34:35], v[34:35], v[164:165] op_sel:[0,1] op_sel_hi:[1,1]
v_pk_fma_f32 v[32:33], v[96:97], v[164:165], v[32:33] op_sel_hi:[1,0,1]
v_pk_fma_f32 v[34:35], v[98:99], v[164:165], v[34:35] op_sel_hi:[1,0,1]
s_add_u32 s66, s66, 4096
buffer_store_dwordx4 v[32:35], v197, s[8:11], s66 offen offset:0 sc1
v_pk_mul_f32 v[36:37], v[36:37], v[166:167] op_sel:[0,1] op_sel_hi:[1,1]
v_pk_mul_f32 v[38:39], v[38:39], v[166:167] op_sel:[0,1] op_sel_hi:[1,1]
v_pk_fma_f32 v[36:37], v[100:101], v[166:167], v[36:37] op_sel_hi:[1,0,1]
v_pk_fma_f32 v[38:39], v[102:103], v[166:167], v[38:39] op_sel_hi:[1,0,1]
buffer_store_dwordx4 v[36:39], v197, s[8:11], s66 offen offset:1024 sc1
v_pk_mul_f32 v[48:49], v[48:49], v[164:165] op_sel:[0,1] op_sel_hi:[1,1]
v_pk_mul_f32 v[50:51], v[50:51], v[164:165] op_sel:[0,1] op_sel_hi:[1,1]
v_pk_fma_f32 v[48:49], v[112:113], v[164:165], v[48:49] op_sel_hi:[1,0,1]
v_pk_fma_f32 v[50:51], v[114:115], v[164:165], v[50:51] op_sel_hi:[1,0,1]
buffer_store_dwordx4 v[48:51], v197, s[8:11], s66 offen offset:2048 sc1
v_pk_mul_f32 v[52:53], v[52:53], v[166:167] op_sel:[0,1] op_sel_hi:[1,1]
v_pk_mul_f32 v[54:55], v[54:55], v[166:167] op_sel:[0,1] op_sel_hi:[1,1]
v_pk_fma_f32 v[52:53], v[116:117], v[166:167], v[52:53] op_sel_hi:[1,0,1]
v_pk_fma_f32 v[54:55], v[118:119], v[166:167], v[54:55] op_sel_hi:[1,0,1]
buffer_store_dwordx4 v[52:55], v197, s[8:11], s66 offen offset:3072 sc1
v_lshlrev_b32 v180, 16, v172
v_and_b32 v181, 0xffff0000, v172
v_lshlrev_b32 v182, 16, v173
v_and_b32 v183, 0xffff0000, v173
v_lshlrev_b32 v184, 16, v174
v_and_b32 v185, 0xffff0000, v174
v_lshlrev_b32 v186, 16, v175
v_and_b32 v187, 0xffff0000, v175
v_lshlrev_b32 v188, 16, v176
v_and_b32 v189, 0xffff0000, v176
v_lshlrev_b32 v190, 16, v177
v_and_b32 v191, 0xffff0000, v177
v_lshlrev_b32 v192, 16, v178
v_and_b32 v193, 0xffff0000, v178
v_lshlrev_b32 v194, 16, v179
v_and_b32 v195, 0xffff0000, v179
v_pk_add_f32 v[8:9], v[8:9], v[180:181]
v_pk_add_f32 v[10:11], v[10:11], v[182:183]
v_pk_mul_f32 v[8:9], v[8:9], v[168:169] op_sel:[0,1] op_sel_hi:[1,1]
v_pk_mul_f32 v[10:11], v[10:11], v[168:169] op_sel:[0,1] op_sel_hi:[1,1]
v_pk_fma_f32 v[8:9], v[72:73], v[168:169], v[8:9] op_sel_hi:[1,0,1]
v_pk_fma_f32 v[10:11], v[74:75], v[168:169], v[10:11] op_sel_hi:[1,0,1]
v_pk_add_f32 v[12:13], v[12:13], v[180:181]
v_pk_add_f32 v[14:15], v[14:15], v[182:183]
v_pk_mul_f32 v[12:13], v[12:13], v[170:171] op_sel:[0,1] op_sel_hi:[1,1]
v_pk_mul_f32 v[14:15], v[14:15], v[170:171] op_sel:[0,1] op_sel_hi:[1,1]
v_pk_fma_f32 v[12:13], v[76:77], v[170:171], v[12:13] op_sel_hi:[1,0,1]
v_pk_fma_f32 v[14:15], v[78:79], v[170:171], v[14:15] op_sel_hi:[1,0,1]
v_pk_add_f32 v[24:25], v[24:25], v[184:185]
v_pk_add_f32 v[26:27], v[26:27], v[186:187]
v_pk_mul_f32 v[24:25], v[24:25], v[168:169] op_sel:[0,1] op_sel_hi:[1,1]
v_pk_mul_f32 v[26:27], v[26:27], v[168:169] op_sel:[0,1] op_sel_hi:[1,1]
v_pk_fma_f32 v[24:25], v[88:89], v[168:169], v[24:25] op_sel_hi:[1,0,1]
v_pk_fma_f32 v[26:27], v[90:91], v[168:169], v[26:27] op_sel_hi:[1,0,1]
v_pk_add_f32 v[28:29], v[28:29], v[184:185]
v_pk_add_f32 v[30:31], v[30:31], v[186:187]
v_pk_mul_f32 v[28:29], v[28:29], v[170:171] op_sel:[0,1] op_sel_hi:[1,1]
v_pk_mul_f32 v[30:31], v[30:31], v[170:171] op_sel:[0,1] op_sel_hi:[1,1]
v_pk_fma_f32 v[28:29], v[92:93], v[170:171], v[28:29] op_sel_hi:[1,0,1]
v_pk_fma_f32 v[30:31], v[94:95], v[170:171], v[30:31] op_sel_hi:[1,0,1]
v_pk_add_f32 v[40:41], v[40:41], v[188:189]
v_pk_add_f32 v[42:43], v[42:43], v[190:191]
v_pk_mul_f32 v[40:41], v[40:41], v[168:169] op_sel:[0,1] op_sel_hi:[1,1]
v_pk_mul_f32 v[42:43], v[42:43], v[168:169] op_sel:[0,1] op_sel_hi:[1,1]
v_pk_fma_f32 v[40:41], v[104:105], v[168:169], v[40:41] op_sel_hi:[1,0,1]
v_pk_fma_f32 v[42:43], v[106:107], v[168:169], v[42:43] op_sel_hi:[1,0,1]
v_pk_add_f32 v[44:45], v[44:45], v[188:189]
v_pk_add_f32 v[46:47], v[46:47], v[190:191]
v_pk_mul_f32 v[44:45], v[44:45], v[170:171] op_sel:[0,1] op_sel_hi:[1,1]
v_pk_mul_f32 v[46:47], v[46:47], v[170:171] op_sel:[0,1] op_sel_hi:[1,1]
v_pk_fma_f32 v[44:45], v[108:109], v[170:171], v[44:45] op_sel_hi:[1,0,1]
v_pk_fma_f32 v[46:47], v[110:111], v[170:171], v[46:47] op_sel_hi:[1,0,1]
v_pk_add_f32 v[56:57], v[56:57], v[192:193]
v_pk_add_f32 v[58:59], v[58:59], v[194:195]
v_pk_mul_f32 v[56:57], v[56:57], v[168:169] op_sel:[0,1] op_sel_hi:[1,1]
v_pk_mul_f32 v[58:59], v[58:59], v[168:169] op_sel:[0,1] op_sel_hi:[1,1]
v_pk_fma_f32 v[56:57], v[120:121], v[168:169], v[56:57] op_sel_hi:[1,0,1]
v_pk_fma_f32 v[58:59], v[122:123], v[168:169], v[58:59] op_sel_hi:[1,0,1]
v_pk_add_f32 v[60:61], v[60:61], v[192:193]
v_pk_add_f32 v[62:63], v[62:63], v[194:195]
v_pk_mul_f32 v[60:61], v[60:61], v[170:171] op_sel:[0,1] op_sel_hi:[1,1]
v_pk_mul_f32 v[62:63], v[62:63], v[170:171] op_sel:[0,1] op_sel_hi:[1,1]
v_pk_fma_f32 v[60:61], v[124:125], v[170:171], v[60:61] op_sel_hi:[1,0,1]
v_pk_fma_f32 v[62:63], v[126:127], v[170:171], v[62:63] op_sel_hi:[1,0,1]
v_add_u32 v196, 32, v196
v_lshlrev_b32 v196, 11, v196
v_lshrrev_b32 v150, 4, v146
v_and_b32 v148, 1, v150
v_lshlrev_b32 v148, 5, v148
v_lshrrev_b32 v150, 1, v150
v_lshl_add_u32 v148, v150, 4, v148
v_add_u32 v196, v148, v196
s_mov_b32 s12, s36
s_and_b32 s13, s37, 0xffff
s_mov_b32 s14, 4194304
s_mov_b32 s15, 0x20000
s_add_u32 s70, s40, 29360128
s_addc_u32 s71, s41, 0
s_lshl_b32 s3, s2, 2
s_add_u32 s3, s3, s42
s_lshl_b32 s62, s3, 6
s_xor_b32 s3, s3, 4
s_lshl_b32 s63, s3, 6
s_waitcnt vmcnt(0)
s_mov_b64 exec, 1
v_mov_b32 v152, s62
v_mov_b32 v153, 1
global_store_dword v152, v153, s[70:71] sc1
v_mov_b32 v152, s63
p3_x1_spin:
global_load_dword v154, v152, s[70:71] sc1
s_waitcnt vmcnt(0)
v_readfirstlane_b32 s3, v154
s_nop 3
s_cmp_ge_u32 s3, 1
s_cbranch_scc1 p3_x1_ok
s_sleep 1
s_branch p3_x1_spin
p3_x1_ok:
s_mov_b64 exec, -1
buffer_load_dwordx4 v[0:3], v197, s[8:11], s67 offen offset:0 sc1
buffer_load_dwordx4 v[4:7], v197, s[8:11], s67 offen offset:1024 sc1
buffer_load_dwordx4 v[16:19], v197, s[8:11], s67 offen offset:2048 sc1
buffer_load_dwordx4 v[20:23], v197, s[8:11], s67 offen offset:3072 sc1
s_add_u32 s67, s67, 4096
buffer_load_dwordx4 v[32:35], v197, s[8:11], s67 offen offset:0 sc1
buffer_load_dwordx4 v[36:39], v197, s[8:11], s67 offen offset:1024 sc1
buffer_load_dwordx4 v[48:51], v197, s[8:11], s67 offen offset:2048 sc1
buffer_load_dwordx4 v[52:55], v197, s[8:11], s67 offen offset:3072 sc1
s_waitcnt vmcnt(6)
v_pk_add_f32 v[8:9], v[8:9], v[0:1]
v_pk_add_f32 v[10:11], v[10:11], v[2:3]
v_pk_add_f32 v[12:13], v[12:13], v[4:5]
v_pk_add_f32 v[14:15], v[14:15], v[6:7]
s_waitcnt vmcnt(4)
v_pk_add_f32 v[24:25], v[24:25], v[16:17]
v_pk_add_f32 v[26:27], v[26:27], v[18:19]
v_pk_add_f32 v[28:29], v[28:29], v[20:21]
v_pk_add_f32 v[30:31], v[30:31], v[22:23]
s_waitcnt vmcnt(2)
v_pk_add_f32 v[40:41], v[40:41], v[32:33]
v_pk_add_f32 v[42:43], v[42:43], v[34:35]
v_pk_add_f32 v[44:45], v[44:45], v[36:37]
v_pk_add_f32 v[46:47], v[46:47], v[38:39]
s_waitcnt vmcnt(0)
v_pk_add_f32 v[56:57], v[56:57], v[48:49]
v_pk_add_f32 v[58:59], v[58:59], v[50:51]
v_pk_add_f32 v[60:61], v[60:61], v[52:53]
v_pk_add_f32 v[62:63], v[62:63], v[54:55]
CP 148,8,9
CP 149,10,11
CP 150,24,25
CP 151,26,27
s_nop 0
v_permlane16_swap_b32 v148, v150
v_permlane16_swap_b32 v149, v151
buffer_store_dwordx4 v[148:151], v196, s[12:15], s73 offen offset:0 nt
CP 152,40,41
CP 153,42,43
CP 154,56,57
CP 155,58,59
s_nop 0
v_permlane16_swap_b32 v152, v154
v_permlane16_swap_b32 v153, v155
buffer_store_dwordx4 v[152:155], v196, s[12:15], s73 offen offset:64 nt
v_add_u32 v196, 32768, v196
CP 148,12,13
CP 149,14,15
CP 150,28,29
CP 151,30,31
s_nop 0
v_permlane16_swap_b32 v148, v150
v_permlane16_swap_b32 v149, v151
buffer_store_dwordx4 v[148:151], v196, s[12:15], s73 offen offset:0 nt
CP 152,44,45
CP 153,46,47
CP 154,60,61
CP 155,62,63
s_nop 0
v_permlane16_swap_b32 v152, v154
v_permlane16_swap_b32 v153, v155
buffer_store_dwordx4 v[152:155], v196, s[12:15], s73 offen offset:64 nt
p3_end:
k1_exit:
s_endpgm
k1_code_end:
.section .rodata,"a"
.p2align 6
.amdhsa_kernel gated_mix__linear_kernel_hedgehog__mixer_channel_mlp__prompt_kernel
  .amdhsa_next_free_vgpr 512
  .amdhsa_next_free_sgpr 102
  .amdhsa_accum_offset 256
  .amdhsa_group_segment_fixed_size 0
  .amdhsa_kernarg_size 104
  .amdhsa_user_sgpr_count 2
  .amdhsa_user_sgpr_kernarg_segment_ptr 1
  .amdhsa_system_sgpr_workgroup_id_x 1
  .amdhsa_float_denorm_mode_32 3
.end_amdhsa_kernel
```
